```python
import torch

def _softmax(x, axis=-1):
    return torch.softmax(x, dim=axis)
def _gelu(x):
    return torch.nn.functional.gelu(x, approximate="tanh")
def _silu(x):
    return torch.nn.functional.silu(x)
def _sigmoid(x):
    return torch.sigmoid(x)
def _layernorm(x, axis=-1, eps=1e-5):
    m = x.mean(dim=axis, keepdim=True)
    v = x.var(dim=axis, keepdim=True, unbiased=False)
    return (x - m) / torch.sqrt(v + eps)
def _scatter_add(tgt, idx, src, axis=0):
    return tgt.clone().index_add_(axis, idx, src)
def _segment_sum(src, seg, n):
    out = torch.zeros((n,) + src.shape[1:], dtype=src.dtype)
    return out.index_add_(0, seg, src)
def _pad(x, pw):
    flat = tuple(v for pair in reversed(pw) for v in pair)
    return torch.nn.functional.pad(x, flat)

kernel_name = 'recurrent_scan__gqa_block_cached__dense_activation_relu__prompt'

def setup_inputs():

    _w = (lambda a: (lambda t: t.to(torch.bfloat16) if t.is_floating_point() else t)(torch.as_tensor(a)))
    def _A_setup():
        B, Sq, D = 1, 2048, 640
        Hq, Hkv, Sk, Dh = 32, 32, 2048, 192
        assert Hq % Hkv == 0, (Hq, Hkv)
        return {
            "x": _w((lambda *s: torch.randn(*s, dtype=torch.bfloat16) * 0.05)(B, Sq, D)),
            "k_cache": _w((lambda *s: torch.randn(*s, dtype=torch.bfloat16) * 1.6)(B, Hkv, Sk, Dh)),
            "v_cache": _w((lambda *s: torch.randn(*s, dtype=torch.bfloat16) * 0.2)(B, Hkv, Sk, Dh)),
            "wq": _w((lambda *s: torch.randn(*s, dtype=torch.bfloat16) * 1.6)(D, Hq * Dh) * (D ** -0.5)),
            "wo": _w((lambda *s: torch.randn(*s, dtype=torch.bfloat16) * 0.2)(Hq * Dh, D) * ((Hq * Dh) ** -0.5)),
        }
    _A_in = _A_setup()

    def _B_setup():
        B, S, D, Dff = 1, 2048, 640, 1536
        return {
            "x": _w((lambda *s: torch.randn(*s, dtype=torch.bfloat16) * 0.05)(B, S, D)),
            "w1": _w((lambda *s: torch.randn(*s, dtype=torch.bfloat16) * 0.1)(D, Dff)),
            "w2": _w((lambda *s: torch.randn(*s, dtype=torch.bfloat16) * 0.1)(Dff, D)),
        }
    _B_in = _B_setup()

    return {
        "A_x": _A_in["x"],
        "A_k_cache": _A_in["k_cache"],
        "A_v_cache": _A_in["v_cache"],
        "A_wq": _A_in["wq"],
        "A_wo": _A_in["wo"],
        "B_x": _B_in["x"],
        "B_w1": _B_in["w1"],
        "B_w2": _B_in["w2"],
    }

def reference(A_x, A_k_cache, A_v_cache, A_wq, A_wo, B_x, B_w1, B_w2):
    def _A_ref(x, k_cache, v_cache, wq, wo):
        B, Sq, D = x.shape
        Hq, Dh = 32, 192
        Hkv = k_cache.shape[1]
        rep = Hq // Hkv
        q = (lambda x, *d: x.permute(*d))((x @ wq).reshape(B, Sq, Hq, Dh), 0, 2, 1, 3)
        k = (lambda x, n, axis: torch.repeat_interleave(x, n, dim=axis))(k_cache, rep, axis=1)
        v = (lambda x, n, axis: torch.repeat_interleave(x, n, dim=axis))(v_cache, rep, axis=1)
        scores = torch.einsum("bhqd,bhkd->bhqk", q, k) * (Dh ** -0.5)
        p = _softmax(scores, axis=-1)
        o = torch.einsum("bhqk,bhkd->bhqd", p, v)
        return (lambda x, *d: x.permute(*d))(o, 0, 2, 1, 3).reshape(B, Sq, Hq * Dh) @ wo

    def _B_ref(x, w1, w2):
        h = torch.einsum("bsd,df->bsf", x, w1)
        zero = torch.zeros_like(h)
        h = torch.maximum(h, zero)
        return torch.einsum("bsf,fd->bsd", h, w2)

    x = A_x
    xn = _layernorm(x, axis=-1)
    s = _A_ref(xn, A_k_cache, A_v_cache, A_wq, A_wo)
    g = _silu(_B_ref(xn, B_w1, B_w2))
    return x + s * g
```

```asm
; @launch grid=(256,1,1) block=(256,1,1) lds=163840
.amdgcn_target "amdgcn-amd-amdhsa--gfx950"
.text
.globl recurrent_scan__gqa_block_cached__dense_activation_relu__prompt_kernel
.p2align 8
.type recurrent_scan__gqa_block_cached__dense_activation_relu__prompt_kernel,@function
recurrent_scan__gqa_block_cached__dense_activation_relu__prompt_kernel:
s_cmp_ge_u32 s2, 256
s_cbranch_scc1 L_k2_end
.p2align 3
s_load_dwordx2 s[48:49], s[0:1], 0
s_load_dwordx4 s[4:7], s[0:1], 8
s_load_dwordx2 s[26:27], s[0:1], 24
s_load_dwordx2 s[38:39], s[0:1], 48
s_load_dwordx2 s[56:57], s[0:1], 80
s_load_dwordx2 s[78:79], s[0:1], 32
s_load_dwordx2 s[80:81], s[0:1], 56
s_load_dwordx2 s[90:91], s[0:1], 72
s_and_b32 s60, s2, 7
s_lshr_b32 s61, s2, 6
s_lshr_b32 s3, s2, 3
s_and_b32 s3, s3, 7
s_lshl_b32 s92, s3, 4
s_lshl_b32 s3, s60, 1
s_add_u32 s92, s92, s3
s_and_b32 s3, s61, 1
s_add_u32 s92, s92, s3
v_and_b32 v64, 15, v0
s_lshl_b32 s3, s92, 4
v_add_u32 v64, s3, v64
v_mul_u32_u24 v64, 1280, v64
v_lshrrev_b32 v65, 6, v0
v_mul_u32_u24 v65, 320, v65
v_add_u32 v64, v64, v65
v_bfe_u32 v65, v0, 4, 2
v_lshl_add_u32 v65, v65, 4, v64
s_cmp_lt_u32 s61, 2
s_cselect_b32 s50, 2621440, 0
s_mov_b32 s51, 0x00020000
s_waitcnt lgkmcnt(0)
buffer_load_dwordx4 v[68:71], v65, s[48:51], 0 offen offset:0
buffer_load_dwordx4 v[72:75], v65, s[48:51], 0 offen offset:64
buffer_load_dwordx4 v[76:79], v65, s[48:51], 0 offen offset:128
buffer_load_dwordx4 v[80:83], v65, s[48:51], 0 offen offset:192
buffer_load_dwordx4 v[84:87], v65, s[48:51], 0 offen offset:256
s_mov_b32 s40, s56
s_mov_b32 s41, s57
s_mov_b32 s42, 92405760
s_mov_b32 s43, 0x00020000
s_lshl_b32 s3, s2, 9
s_add_u32 s3, s3, 92274944
v_and_b32 v18, 15, v0
v_lshlrev_b32 v18, 2, v18
v_mov_b32 v19, 0
buffer_store_dword v19, v18, s[40:43], s3 offen sc0 sc1
s_and_b32 s36, s2, 7
s_lshr_b32 s37, s2, 3
s_lshl_b32 s36, s36, 2
s_lshr_b32 s3, s37, 3
s_add_u32 s36, s36, s3
s_and_b32 s37, s37, 7
s_mul_i32 s3, s36, 786432
s_mul_i32 s58, s36, 384
s_mul_i32 s59, s36, 96
s_and_b32 s54, s36, 1
s_lshl_b32 s55, s54, 5
s_sub_u32 s59, s59, s55
s_lshl_b32 s54, s54, 1
s_waitcnt lgkmcnt(0)
s_add_u32 s8, s4, s3
s_addc_u32 s9, s5, 0
s_mov_b32 s10, 786432
s_mov_b32 s11, 0x00020000
s_add_u32 s12, s6, s3
s_addc_u32 s13, s7, 0
s_mov_b32 s14, 786432
s_mov_b32 s15, 0x00020000
s_add_u32 s28, s26, s58
s_addc_u32 s29, s27, 0
s_sub_u32 s30, 7864320, s58
s_mov_b32 s31, 0x00020000
s_add_u32 s32, s38, s59
s_addc_u32 s33, s39, 0
s_sub_u32 s34, 1966080, s59
s_mov_b32 s35, 0x00020000
s_mov_b32 s40, s56
s_mov_b32 s41, s57
s_mov_b32 s42, 92405760
s_mov_b32 s43, 0x00020000
s_mov_b32 s20, 0
s_mov_b32 s21, 0
s_mov_b32 s52, 0
v_and_b32 v1, 63, v0
v_lshrrev_b32 v2, 6, v0
s_nop 0
v_readfirstlane_b32 s25, v2
s_nop 0
s_mul_i32 s26, s25, 3072
s_lshl_b32 s27, s25, 3
s_lshl_b32 s53, s37, 4
s_lshl_b32 s3, s25, 2
s_add_u32 s53, s53, s3
s_mul_i32 s3, s53, 20480
s_add_u32 s16, s56, s3
s_addc_u32 s17, s57, 0
s_mov_b32 s18, 81920
s_mov_b32 s19, 0x00020000
v_lshrrev_b32 v18, 3, v1
v_add_u32 v18, 0, v18
v_mul_u32_u24 v19, 43, v18
v_lshrrev_b32 v19, 7, v19
v_mul_u32_u24 v20, 3, v19
v_sub_u32 v20, v18, v20
v_add_u32 v19, s27, v19
v_bfe_u32 v21, v19, 1, 1
v_lshlrev_b32 v21, 2, v21
v_and_b32 v22, 7, v1
v_xor_b32 v21, v21, v22
v_lshlrev_b32 v21, 4, v21
v_lshl_add_u32 v21, v20, 7, v21
v_mul_u32_u24 v19, 0x3000, v19
v_add_u32 v21, v21, v19
v_subrev_u32 v32, 0, v21
v_lshrrev_b32 v18, 3, v1
v_add_u32 v18, 8, v18
v_mul_u32_u24 v19, 43, v18
v_lshrrev_b32 v19, 7, v19
v_mul_u32_u24 v20, 3, v19
v_sub_u32 v20, v18, v20
v_add_u32 v19, s27, v19
v_bfe_u32 v21, v19, 1, 1
v_lshlrev_b32 v21, 2, v21
v_and_b32 v22, 7, v1
v_xor_b32 v21, v21, v22
v_lshlrev_b32 v21, 4, v21
v_lshl_add_u32 v21, v20, 7, v21
v_mul_u32_u24 v19, 0x3000, v19
v_add_u32 v21, v21, v19
v_subrev_u32 v33, 1024, v21
v_lshrrev_b32 v18, 3, v1
v_add_u32 v18, 16, v18
v_mul_u32_u24 v19, 43, v18
v_lshrrev_b32 v19, 7, v19
v_mul_u32_u24 v20, 3, v19
v_sub_u32 v20, v18, v20
v_add_u32 v19, s27, v19
v_bfe_u32 v21, v19, 1, 1
v_lshlrev_b32 v21, 2, v21
v_and_b32 v22, 7, v1
v_xor_b32 v21, v21, v22
v_lshlrev_b32 v21, 4, v21
v_lshl_add_u32 v21, v20, 7, v21
v_mul_u32_u24 v19, 0x3000, v19
v_add_u32 v21, v21, v19
v_subrev_u32 v34, 2048, v21
v_lshrrev_b32 v18, 3, v1
v_add_u32 v18, s27, v18
v_bfe_u32 v19, v18, 1, 1
v_bfe_u32 v20, v18, 3, 1
v_lshl_or_b32 v19, v20, 1, v19
v_lshlrev_b32 v19, 1, v19
v_and_b32 v20, 7, v1
v_xor_b32 v19, v19, v20
v_mul_u32_u24 v18, 0xc00, v18
v_lshl_add_u32 v35, v19, 4, v18
s_mov_b32 s44, 0
s_mov_b32 s45, 0
s_mov_b32 s46, 0
s_lshl_b32 s50, s25, 10
s_add_u32 s50, s50, 57344
s_add_u32 s26, s26, 32768
s_add_u32 m0, s26, 0
s_nop 0
buffer_load_dwordx4 v32, s[28:31], s44 offen offset:0 lds
buffer_load_dwordx4 v33, s[28:31], s44 offen offset:1024 lds
buffer_load_dwordx4 v34, s[28:31], s44 offen offset:2048 lds
s_add_u32 s44, s44, 393216
s_add_u32 m0, s26, 12288
s_nop 0
buffer_load_dwordx4 v32, s[28:31], s44 offen offset:0 lds
buffer_load_dwordx4 v33, s[28:31], s44 offen offset:1024 lds
buffer_load_dwordx4 v34, s[28:31], s44 offen offset:2048 lds
s_add_u32 s44, s44, 393216
s_add_u32 m0, s50, 0
s_nop 0
buffer_load_dwordx4 v35, s[32:35], s45 offen lds
s_add_u32 s45, s45, 98304
s_add_u32 m0, s50, 4096
s_nop 0
buffer_load_dwordx4 v35, s[32:35], s45 offen lds
s_add_u32 s45, s45, 98304
s_getpc_b64 s[88:89]
L_pc_k2:
s_add_u32 s88, s88, L_pc_k2-L_pc_k2
s_addc_u32 s89, s89, 0
v_lshlrev_b32 v40, 7, v0
.p2align 3
v_min_u32 v41, L_k2_slow-L_pc_k2-4, v40
global_load_dword v41, v41, s[88:89]
v_add_u32 v40, 32768, v40
v_min_u32 v42, L_k2_slow-L_pc_k2-4, v40
global_load_dword v42, v42, s[88:89]
v_add_u32 v40, 32768, v40
v_min_u32 v43, L_k2_slow-L_pc_k2-4, v40
global_load_dword v43, v43, s[88:89]
s_mul_i32 s93, s92, 20480
s_add_u32 s93, s93, 0
s_cmp_lt_u32 s61, 2
s_cselect_b32 s93, s93, 0x7f000000
v_and_b32 v64, 15, v1
v_lshlrev_b32 v64, 4, v64
v_add_u32 v64, 162816, v64
s_lshl_b32 s3, s25, 2
v_add_u32 v66, s3, v64
s_mul_i32 s3, s25, 5120
v_lshlrev_b32 v67, 4, v1
v_add_u32 v67, s3, v67
s_waitcnt vmcnt(12)
v_lshlrev_b32 v88, 16, v68
v_and_b32 v89, 0xffff0000, v68
v_lshlrev_b32 v90, 16, v69
v_and_b32 v91, 0xffff0000, v69
v_lshlrev_b32 v92, 16, v70
v_and_b32 v93, 0xffff0000, v70
v_lshlrev_b32 v94, 16, v71
v_and_b32 v95, 0xffff0000, v71
v_lshlrev_b32 v96, 16, v72
v_and_b32 v97, 0xffff0000, v72
v_lshlrev_b32 v98, 16, v73
v_and_b32 v99, 0xffff0000, v73
v_lshlrev_b32 v100, 16, v74
v_and_b32 v101, 0xffff0000, v74
v_lshlrev_b32 v102, 16, v75
v_and_b32 v103, 0xffff0000, v75
v_lshlrev_b32 v104, 16, v76
v_and_b32 v105, 0xffff0000, v76
v_lshlrev_b32 v106, 16, v77
v_and_b32 v107, 0xffff0000, v77
v_lshlrev_b32 v108, 16, v78
v_and_b32 v109, 0xffff0000, v78
v_lshlrev_b32 v110, 16, v79
v_and_b32 v111, 0xffff0000, v79
v_lshlrev_b32 v112, 16, v80
v_and_b32 v113, 0xffff0000, v80
v_lshlrev_b32 v114, 16, v81
v_and_b32 v115, 0xffff0000, v81
v_lshlrev_b32 v116, 16, v82
v_and_b32 v117, 0xffff0000, v82
v_lshlrev_b32 v118, 16, v83
v_and_b32 v119, 0xffff0000, v83
v_lshlrev_b32 v120, 16, v84
v_and_b32 v121, 0xffff0000, v84
v_lshlrev_b32 v122, 16, v85
v_and_b32 v123, 0xffff0000, v85
v_lshlrev_b32 v124, 16, v86
v_and_b32 v125, 0xffff0000, v86
v_lshlrev_b32 v126, 16, v87
.p2align 3
v_and_b32 v127, 0xffff0000, v87
v_pk_add_f32 v[128:129], v[88:89], v[92:93]
v_pk_add_f32 v[130:131], v[90:91], v[94:95]
v_pk_add_f32 v[128:129], v[128:129], v[96:97]
v_pk_add_f32 v[130:131], v[130:131], v[98:99]
v_pk_add_f32 v[128:129], v[128:129], v[100:101]
v_pk_add_f32 v[130:131], v[130:131], v[102:103]
v_pk_add_f32 v[128:129], v[128:129], v[104:105]
v_pk_add_f32 v[130:131], v[130:131], v[106:107]
v_pk_add_f32 v[128:129], v[128:129], v[108:109]
v_pk_add_f32 v[130:131], v[130:131], v[110:111]
v_pk_add_f32 v[128:129], v[128:129], v[112:113]
v_pk_add_f32 v[130:131], v[130:131], v[114:115]
v_pk_add_f32 v[128:129], v[128:129], v[116:117]
v_pk_add_f32 v[130:131], v[130:131], v[118:119]
v_pk_add_f32 v[128:129], v[128:129], v[120:121]
v_pk_add_f32 v[130:131], v[130:131], v[122:123]
v_pk_add_f32 v[128:129], v[128:129], v[124:125]
v_pk_add_f32 v[130:131], v[130:131], v[126:127]
v_add_f32 v128, v128, v129
v_add_f32 v130, v130, v131
v_add_f32 v128, v128, v130
v_mov_b32 v129, v128
s_nop 1
v_permlane16_swap_b32 v128, v129
v_add_f32 v128, v128, v129
v_mov_b32 v129, v128
s_nop 1
v_permlane32_swap_b32 v128, v129
v_add_f32 v128, v128, v129
ds_write_b32 v66, v128 offset:0
s_waitcnt lgkmcnt(0)
s_barrier
ds_read_b128 v[132:135], v64 offset:0
s_waitcnt lgkmcnt(0)
v_add_f32 v132, v132, v133
v_add_f32 v134, v134, v135
v_add_f32 v132, v132, v134
v_mul_f32 v136, 0xbacccccd, v132
v_mul_f32 v137, 0xbacccccd, v132
v_mov_b32 v128, 0
v_mov_b32 v129, 0
v_mov_b32 v130, 0
v_mov_b32 v131, 0
.p2align 3
v_pk_add_f32 v[140:141], v[88:89], v[136:137]
v_pk_fma_f32 v[128:129], v[140:141], v[140:141], v[128:129]
v_pk_add_f32 v[142:143], v[90:91], v[136:137]
v_pk_fma_f32 v[130:131], v[142:143], v[142:143], v[130:131]
v_pk_add_f32 v[140:141], v[92:93], v[136:137]
v_pk_fma_f32 v[128:129], v[140:141], v[140:141], v[128:129]
v_pk_add_f32 v[142:143], v[94:95], v[136:137]
v_pk_fma_f32 v[130:131], v[142:143], v[142:143], v[130:131]
v_pk_add_f32 v[140:141], v[96:97], v[136:137]
v_pk_fma_f32 v[128:129], v[140:141], v[140:141], v[128:129]
v_pk_add_f32 v[142:143], v[98:99], v[136:137]
v_pk_fma_f32 v[130:131], v[142:143], v[142:143], v[130:131]
v_pk_add_f32 v[140:141], v[100:101], v[136:137]
v_pk_fma_f32 v[128:129], v[140:141], v[140:141], v[128:129]
v_pk_add_f32 v[142:143], v[102:103], v[136:137]
v_pk_fma_f32 v[130:131], v[142:143], v[142:143], v[130:131]
v_pk_add_f32 v[140:141], v[104:105], v[136:137]
v_pk_fma_f32 v[128:129], v[140:141], v[140:141], v[128:129]
v_pk_add_f32 v[142:143], v[106:107], v[136:137]
v_pk_fma_f32 v[130:131], v[142:143], v[142:143], v[130:131]
v_pk_add_f32 v[140:141], v[108:109], v[136:137]
v_pk_fma_f32 v[128:129], v[140:141], v[140:141], v[128:129]
v_pk_add_f32 v[142:143], v[110:111], v[136:137]
v_pk_fma_f32 v[130:131], v[142:143], v[142:143], v[130:131]
v_pk_add_f32 v[140:141], v[112:113], v[136:137]
v_pk_fma_f32 v[128:129], v[140:141], v[140:141], v[128:129]
v_pk_add_f32 v[142:143], v[114:115], v[136:137]
v_pk_fma_f32 v[130:131], v[142:143], v[142:143], v[130:131]
v_pk_add_f32 v[140:141], v[116:117], v[136:137]
v_pk_fma_f32 v[128:129], v[140:141], v[140:141], v[128:129]
v_pk_add_f32 v[142:143], v[118:119], v[136:137]
v_pk_fma_f32 v[130:131], v[142:143], v[142:143], v[130:131]
v_pk_add_f32 v[140:141], v[120:121], v[136:137]
v_pk_fma_f32 v[128:129], v[140:141], v[140:141], v[128:129]
v_pk_add_f32 v[142:143], v[122:123], v[136:137]
v_pk_fma_f32 v[130:131], v[142:143], v[142:143], v[130:131]
v_pk_add_f32 v[140:141], v[124:125], v[136:137]
v_pk_fma_f32 v[128:129], v[140:141], v[140:141], v[128:129]
v_pk_add_f32 v[142:143], v[126:127], v[136:137]
v_pk_fma_f32 v[130:131], v[142:143], v[142:143], v[130:131]
v_add_f32 v128, v128, v129
v_add_f32 v130, v130, v131
v_add_f32 v128, v128, v130
v_mov_b32 v129, v128
s_nop 1
v_permlane16_swap_b32 v128, v129
v_add_f32 v128, v128, v129
v_mov_b32 v129, v128
s_nop 1
v_permlane32_swap_b32 v128, v129
v_add_f32 v128, v128, v129
ds_write_b32 v66, v128 offset:256
s_waitcnt lgkmcnt(0)
s_barrier
ds_read_b128 v[132:135], v64 offset:256
s_waitcnt lgkmcnt(0)
v_add_f32 v132, v132, v133
v_add_f32 v134, v134, v135
v_add_f32 v132, v132, v134
v_mul_f32 v132, 0x3acccccd, v132
v_cvt_pk_bf16_f32 v132, v132, v136
v_and_b32 v136, 0xffff0000, v132
v_mov_b32 v137, v136
v_lshlrev_b32 v132, 16, v132
v_add_f32 v132, 0x3727c5ac, v132
v_cvt_pk_bf16_f32 v132, v132, v132
v_lshlrev_b32 v132, 16, v132
v_sqrt_f32 v132, v132
s_nop 0
v_cvt_pk_bf16_f32 v132, v132, v132
v_lshlrev_b32 v132, 16, v132
v_rcp_f32 v132, v132
s_nop 0
v_mul_f32 v138, 0x3dd53b95, v132
v_mul_f32 v139, 0x3dd53b95, v132
v_pk_add_f32 v[88:89], v[88:89], v[136:137]
v_cvt_pk_bf16_f32 v68, v88, v89
v_lshlrev_b32 v88, 16, v68
v_and_b32 v89, 0xffff0000, v68
v_pk_mul_f32 v[88:89], v[88:89], v[138:139]
v_cvt_pk_bf16_f32 v68, v88, v89
v_pk_add_f32 v[90:91], v[90:91], v[136:137]
v_cvt_pk_bf16_f32 v69, v90, v91
v_lshlrev_b32 v90, 16, v69
v_and_b32 v91, 0xffff0000, v69
v_pk_mul_f32 v[90:91], v[90:91], v[138:139]
v_cvt_pk_bf16_f32 v69, v90, v91
v_pk_add_f32 v[92:93], v[92:93], v[136:137]
v_cvt_pk_bf16_f32 v70, v92, v93
v_lshlrev_b32 v92, 16, v70
v_and_b32 v93, 0xffff0000, v70
v_pk_mul_f32 v[92:93], v[92:93], v[138:139]
v_cvt_pk_bf16_f32 v70, v92, v93
v_pk_add_f32 v[94:95], v[94:95], v[136:137]
v_cvt_pk_bf16_f32 v71, v94, v95
v_lshlrev_b32 v94, 16, v71
.p2align 3
v_and_b32 v95, 0xffff0000, v71
v_pk_mul_f32 v[94:95], v[94:95], v[138:139]
v_cvt_pk_bf16_f32 v71, v94, v95
buffer_store_dwordx4 v[68:71], v67, s[40:43], s93 offen offset:0 sc0 sc1
v_pk_add_f32 v[96:97], v[96:97], v[136:137]
v_cvt_pk_bf16_f32 v72, v96, v97
v_lshlrev_b32 v96, 16, v72
v_and_b32 v97, 0xffff0000, v72
v_pk_mul_f32 v[96:97], v[96:97], v[138:139]
v_cvt_pk_bf16_f32 v72, v96, v97
v_pk_add_f32 v[98:99], v[98:99], v[136:137]
v_cvt_pk_bf16_f32 v73, v98, v99
v_lshlrev_b32 v98, 16, v73
v_and_b32 v99, 0xffff0000, v73
v_pk_mul_f32 v[98:99], v[98:99], v[138:139]
v_cvt_pk_bf16_f32 v73, v98, v99
v_pk_add_f32 v[100:101], v[100:101], v[136:137]
v_cvt_pk_bf16_f32 v74, v100, v101
v_lshlrev_b32 v100, 16, v74
v_and_b32 v101, 0xffff0000, v74
v_pk_mul_f32 v[100:101], v[100:101], v[138:139]
v_cvt_pk_bf16_f32 v74, v100, v101
v_pk_add_f32 v[102:103], v[102:103], v[136:137]
v_cvt_pk_bf16_f32 v75, v102, v103
v_lshlrev_b32 v102, 16, v75
.p2align 3
v_and_b32 v103, 0xffff0000, v75
v_pk_mul_f32 v[102:103], v[102:103], v[138:139]
v_cvt_pk_bf16_f32 v75, v102, v103
buffer_store_dwordx4 v[72:75], v67, s[40:43], s93 offen offset:1024 sc0 sc1
v_pk_add_f32 v[104:105], v[104:105], v[136:137]
v_cvt_pk_bf16_f32 v76, v104, v105
v_lshlrev_b32 v104, 16, v76
v_and_b32 v105, 0xffff0000, v76
v_pk_mul_f32 v[104:105], v[104:105], v[138:139]
v_cvt_pk_bf16_f32 v76, v104, v105
v_pk_add_f32 v[106:107], v[106:107], v[136:137]
v_cvt_pk_bf16_f32 v77, v106, v107
v_lshlrev_b32 v106, 16, v77
v_and_b32 v107, 0xffff0000, v77
v_pk_mul_f32 v[106:107], v[106:107], v[138:139]
v_cvt_pk_bf16_f32 v77, v106, v107
v_pk_add_f32 v[108:109], v[108:109], v[136:137]
v_cvt_pk_bf16_f32 v78, v108, v109
v_lshlrev_b32 v108, 16, v78
v_and_b32 v109, 0xffff0000, v78
v_pk_mul_f32 v[108:109], v[108:109], v[138:139]
v_cvt_pk_bf16_f32 v78, v108, v109
v_pk_add_f32 v[110:111], v[110:111], v[136:137]
v_cvt_pk_bf16_f32 v79, v110, v111
v_lshlrev_b32 v110, 16, v79
.p2align 3
v_and_b32 v111, 0xffff0000, v79
v_pk_mul_f32 v[110:111], v[110:111], v[138:139]
v_cvt_pk_bf16_f32 v79, v110, v111
buffer_store_dwordx4 v[76:79], v67, s[40:43], s93 offen offset:2048 sc0 sc1
v_pk_add_f32 v[112:113], v[112:113], v[136:137]
v_cvt_pk_bf16_f32 v80, v112, v113
v_lshlrev_b32 v112, 16, v80
v_and_b32 v113, 0xffff0000, v80
v_pk_mul_f32 v[112:113], v[112:113], v[138:139]
v_cvt_pk_bf16_f32 v80, v112, v113
v_pk_add_f32 v[114:115], v[114:115], v[136:137]
v_cvt_pk_bf16_f32 v81, v114, v115
v_lshlrev_b32 v114, 16, v81
v_and_b32 v115, 0xffff0000, v81
v_pk_mul_f32 v[114:115], v[114:115], v[138:139]
v_cvt_pk_bf16_f32 v81, v114, v115
v_pk_add_f32 v[116:117], v[116:117], v[136:137]
v_cvt_pk_bf16_f32 v82, v116, v117
v_lshlrev_b32 v116, 16, v82
v_and_b32 v117, 0xffff0000, v82
v_pk_mul_f32 v[116:117], v[116:117], v[138:139]
v_cvt_pk_bf16_f32 v82, v116, v117
v_pk_add_f32 v[118:119], v[118:119], v[136:137]
v_cvt_pk_bf16_f32 v83, v118, v119
v_lshlrev_b32 v118, 16, v83
.p2align 3
v_and_b32 v119, 0xffff0000, v83
v_pk_mul_f32 v[118:119], v[118:119], v[138:139]
v_cvt_pk_bf16_f32 v83, v118, v119
buffer_store_dwordx4 v[80:83], v67, s[40:43], s93 offen offset:3072 sc0 sc1
v_pk_add_f32 v[120:121], v[120:121], v[136:137]
v_cvt_pk_bf16_f32 v84, v120, v121
v_lshlrev_b32 v120, 16, v84
v_and_b32 v121, 0xffff0000, v84
v_pk_mul_f32 v[120:121], v[120:121], v[138:139]
v_cvt_pk_bf16_f32 v84, v120, v121
v_pk_add_f32 v[122:123], v[122:123], v[136:137]
v_cvt_pk_bf16_f32 v85, v122, v123
v_lshlrev_b32 v122, 16, v85
v_and_b32 v123, 0xffff0000, v85
v_pk_mul_f32 v[122:123], v[122:123], v[138:139]
v_cvt_pk_bf16_f32 v85, v122, v123
v_pk_add_f32 v[124:125], v[124:125], v[136:137]
v_cvt_pk_bf16_f32 v86, v124, v125
v_lshlrev_b32 v124, 16, v86
v_and_b32 v125, 0xffff0000, v86
v_pk_mul_f32 v[124:125], v[124:125], v[138:139]
v_cvt_pk_bf16_f32 v86, v124, v125
v_pk_add_f32 v[126:127], v[126:127], v[136:137]
v_cvt_pk_bf16_f32 v87, v126, v127
v_lshlrev_b32 v126, 16, v87
.p2align 3
v_and_b32 v127, 0xffff0000, v87
v_pk_mul_f32 v[126:127], v[126:127], v[138:139]
v_cvt_pk_bf16_f32 v87, v126, v127
s_add_u32 s93, s93, 4096
buffer_store_dwordx4 v[84:87], v67, s[40:43], s93 offen offset:0 sc0 sc1
s_add_u32 m0, s26, 32768
s_nop 0
buffer_load_dwordx4 v32, s[28:31], s44 offen offset:0 lds
buffer_load_dwordx4 v33, s[28:31], s44 offen offset:1024 lds
buffer_load_dwordx4 v34, s[28:31], s44 offen offset:2048 lds
s_add_u32 s44, s44, 393216
s_add_u32 m0, s26, 45056
s_nop 0
buffer_load_dwordx4 v32, s[28:31], s44 offen offset:0 lds
buffer_load_dwordx4 v33, s[28:31], s44 offen offset:1024 lds
buffer_load_dwordx4 v34, s[28:31], s44 offen offset:2048 lds
s_add_u32 s44, s44, 393216
s_add_u32 m0, s50, 32768
s_nop 0
buffer_load_dwordx4 v35, s[32:35], s45 offen lds
s_add_u32 s45, s45, 98304
s_add_u32 m0, s50, 36864
s_nop 0
buffer_load_dwordx4 v35, s[32:35], s45 offen lds
s_add_u32 s45, s45, 98304
s_mul_i32 s55, s25, 3072
v_lshrrev_b32 v18, 3, v1
v_add_u32 v18, 0, v18
v_mul_u32_u24 v19, 43, v18
v_lshrrev_b32 v19, 7, v19
v_add_u32 v19, s27, v19
v_and_b32 v20, 7, v1
v_lshrrev_b32 v21, 3, v1
v_lshlrev_b32 v21, 7, v21
v_add_u32 v21, s55, v21
v_bfe_u32 v22, v19, 1, 3
v_xor_b32 v22, v22, v20
v_lshl_add_u32 v8, v22, 4, v21
v_bfe_u32 v22, v19, 1, 2
v_lshlrev_b32 v22, 1, v22
v_xor_b32 v22, v22, v20
v_lshl_add_u32 v11, v22, 4, v21
v_lshrrev_b32 v18, 3, v1
v_add_u32 v18, 8, v18
v_mul_u32_u24 v19, 43, v18
v_lshrrev_b32 v19, 7, v19
v_add_u32 v19, s27, v19
v_and_b32 v20, 7, v1
v_lshrrev_b32 v21, 3, v1
v_lshlrev_b32 v21, 7, v21
v_add_u32 v21, s55, v21
v_bfe_u32 v22, v19, 1, 3
v_xor_b32 v22, v22, v20
v_lshl_add_u32 v9, v22, 4, v21
v_bfe_u32 v22, v19, 1, 2
v_lshlrev_b32 v22, 1, v22
v_xor_b32 v22, v22, v20
v_lshl_add_u32 v12, v22, 4, v21
v_lshrrev_b32 v18, 3, v1
v_add_u32 v18, 16, v18
v_mul_u32_u24 v19, 43, v18
v_lshrrev_b32 v19, 7, v19
v_add_u32 v19, s27, v19
v_and_b32 v20, 7, v1
v_lshrrev_b32 v21, 3, v1
v_lshlrev_b32 v21, 7, v21
v_add_u32 v21, s55, v21
v_bfe_u32 v22, v19, 1, 3
v_xor_b32 v22, v22, v20
v_lshl_add_u32 v10, v22, 4, v21
v_bfe_u32 v22, v19, 1, 2
v_lshlrev_b32 v22, 1, v22
v_xor_b32 v22, v22, v20
v_lshl_add_u32 v13, v22, 4, v21
s_add_u32 s22, s55, 0
s_add_u32 s23, s55, 49152
v_and_b32 v18, 15, v1
v_lshrrev_b32 v19, 4, v1
v_bfe_u32 v20, v18, 1, 3
v_mul_u32_u24 v21, 384, v18
v_or_b32 v22, 0, v19
v_xor_b32 v22, v22, v20
v_lshl_add_u32 v2, v22, 4, v21
v_or_b32 v22, 4, v19
v_xor_b32 v22, v22, v20
v_lshl_add_u32 v3, v22, 4, v21
v_lshrrev_b32 v18, 2, v1
v_bfe_u32 v20, v18, 1, 2
v_lshlrev_b32 v20, 1, v20
v_mul_u32_u24 v18, 384, v18
v_and_b32 v19, 1, v1
v_lshl_add_u32 v18, v19, 3, v18
v_add_u32 v18, 49152, v18
v_bfe_u32 v19, v1, 1, 1
v_or_b32 v22, 0, v19
v_xor_b32 v22, v22, v20
v_lshl_add_u32 v4, v22, 4, v18
v_or_b32 v22, 2, v19
v_xor_b32 v22, v22, v20
v_lshl_add_u32 v5, v22, 4, v18
v_or_b32 v22, 4, v19
v_xor_b32 v22, v22, v20
v_lshl_add_u32 v6, v22, 4, v18
v_or_b32 v22, 6, v19
v_xor_b32 v22, v22, v20
v_lshl_add_u32 v7, v22, 4, v18
s_xor_b32 s3, s54, 0
s_mul_i32 s3, s3, 20480
v_lshlrev_b32 v18, 4, v1
v_add_u32 v36, s3, v18
s_xor_b32 s3, s54, 1
s_mul_i32 s3, s3, 20480
v_lshlrev_b32 v18, 4, v1
v_add_u32 v37, s3, v18
s_xor_b32 s3, s54, 2
s_mul_i32 s3, s3, 20480
v_lshlrev_b32 v18, 4, v1
v_add_u32 v38, s3, v18
s_xor_b32 s3, s54, 3
s_mul_i32 s3, s3, 20480
v_lshlrev_b32 v18, 4, v1
v_add_u32 v39, s3, v18
v_lshrrev_b32 v18, 4, v1
v_lshlrev_b32 v18, 3, v18
v_bfe_u32 v19, v1, 2, 2
v_add_u32 v18, v18, v19
v_mul_u32_u24 v21, 384, v18
v_add_u32 v21, 32768, v21
v_bfe_u32 v19, v1, 3, 1
v_lshlrev_b32 v19, 2, v19
v_and_b32 v20, 3, v1
v_xor_b32 v19, v19, v20
v_lshl_add_u32 v26, v19, 4, v21
v_xor_b32 v19, 4, v19
v_lshl_add_u32 v27, v19, 4, v21
v_lshlrev_b32 v21, 7, v18
v_add_u32 v21, 57344, v21
v_and_b32 v19, 1, v1
.p2align 3
v_lshl_add_u32 v21, v19, 3, v21
v_bfe_u32 v19, v1, 1, 1
v_lshl_add_u32 v21, v19, 4, v21
v_bfe_u32 v19, v1, 3, 1
v_bfe_u32 v20, v1, 4, 1
v_lshl_or_b32 v19, v20, 1, v19
s_xor_b32 s3, s54, 0
v_xor_b32 v20, s3, v19
v_lshl_add_u32 v28, v20, 5, v21
s_xor_b32 s3, s54, 1
v_xor_b32 v20, s3, v19
v_lshl_add_u32 v29, v20, 5, v21
s_xor_b32 s3, s54, 2
v_xor_b32 v20, s3, v19
v_lshl_add_u32 v30, v20, 5, v21
s_xor_b32 s3, s54, 3
v_xor_b32 v20, s3, v19
v_lshl_add_u32 v31, v20, 5, v21
s_and_b32 s60, s2, 7
s_lshr_b32 s61, s2, 6
s_lshl_b32 s3, s2, 9
s_add_u32 s3, s3, 92274688
v_lshlrev_b32 v18, 2, v1
s_add_u32 s39, s60, 48
v_cmp_eq_u32 vcc, s39, v1
s_nop 1
v_cndmask_b32 v19, 0, 1, vcc
s_nop 0
buffer_store_dword v19, v18, s[40:43], s3 offen sc0 sc1
s_mov_b32 s86, 1966080
s_mov_b32 s83, 192
s_cmp_lt_u32 s2, 192
s_cselect_b32 s84, s78, s80
s_cselect_b32 s85, s79, s81
s_cselect_b32 s86, 7864320, s86
s_cselect_b32 s3, 0, s83
s_mov_b32 s87, 0x00020000
s_sub_u32 s3, s2, s3
s_mul_i32 s82, s3, 40960
s_mul_i32 s3, s25, 320
s_add_u32 s82, s82, s3
v_mov_b32 v14, 0
v_mov_b32 v15, 0
v_mov_b32 v16, 0
v_mov_b32 v17, 0
s_waitcnt vmcnt(9)
s_barrier
s_cmp_lg_u32 s25, 0
s_cbranch_scc1 L_ln_done
s_cmp_ge_u32 s61, 2
s_cbranch_scc1 L_li_nosend
v_and_b32 v18, 7, v1
v_lshrrev_b32 v19, 3, v1
v_lshl_add_u32 v18, v19, 6, v18
s_lshl_b32 s3, s37, 3
v_add_u32 v18, s3, v18
v_lshlrev_b32 v18, 9, v18
v_mov_b32 v19, 1
s_lshl_b32 s3, s60, 1
s_and_b32 s92, s61, 1
s_add_u32 s3, s3, s92
s_lshl_b32 s3, s3, 2
s_add_u32 s3, s3, 92274944
s_mov_b32 exec_hi, 0
buffer_store_dword v19, v18, s[40:43], s3 offen sc0 sc1
s_mov_b64 exec, -1
L_li_nosend:
s_and_b32 s3, s37, 3
s_lshl_b32 s3, s3, 6
s_lshr_b32 s92, s37, 2
s_lshl_b32 s92, s92, 4
s_add_u32 s3, s3, s92
s_add_u32 s3, s3, 16
v_mov_b32 v20, s3
v_mov_b32 v19, 1
s_cmp_ge_u32 s61, 2
s_cbranch_scc1 L_li_noadd
s_mov_b64 exec, 1
global_atomic_add v20, v19, s[90:91] sc1
s_mov_b64 exec, -1
L_li_noadd:
v_and_b32 v18, 15, v1
v_lshlrev_b32 v18, 2, v18
s_lshl_b32 s3, s2, 9
s_add_u32 s93, s3, 92274944
s_mov_b32 s92, 48
L_li_spin:
buffer_load_dword v19, v18, s[40:43], s93 offen sc0 sc1
s_waitcnt vmcnt(0)
v_cmp_ne_u32 vcc, 1, v19
s_nop 0
s_cmp_eq_u64 vcc, 0
s_cbranch_scc1 L_ln_done
s_sleep 2
s_sub_u32 s92, s92, 1
s_cmp_lg_u32 s92, 0
s_cbranch_scc1 L_li_spin
v_mov_b32 v18, v20
s_branch L_ln_noadd
L_ln_noadd:
s_mov_b32 s92, 262144
s_sleep 40
L_ln_spin:
global_load_dword v19, v18, s[90:91] sc0 sc1
s_waitcnt vmcnt(0)
v_readfirstlane_b32 s3, v19
s_nop 0
s_cmp_ge_u32 s3, 16
s_cbranch_scc1 L_ln_done
s_sub_u32 s92, s92, 1
s_cmp_eq_u32 s92, 0
s_cbranch_scc1 L_ln_done
s_sleep 16
s_branch L_ln_spin
L_ln_done:
s_barrier
.p2align 3
buffer_load_dwordx4 a[40:43], v36, s[16:19], s46 offen offset:0 sc0 sc1
buffer_load_dwordx4 a[44:47], v36, s[16:19], s46 offen offset:1024 sc0 sc1
buffer_load_dwordx4 a[48:51], v37, s[16:19], s46 offen offset:0 sc0 sc1
buffer_load_dwordx4 a[52:55], v37, s[16:19], s46 offen offset:1024 sc0 sc1
buffer_load_dwordx4 a[56:59], v38, s[16:19], s46 offen offset:0 sc0 sc1
buffer_load_dwordx4 a[60:63], v38, s[16:19], s46 offen offset:1024 sc0 sc1
buffer_load_dwordx4 a[64:67], v39, s[16:19], s46 offen offset:0 sc0 sc1
buffer_load_dwordx4 a[68:71], v39, s[16:19], s46 offen offset:1024 sc0 sc1
s_barrier
.p2align 3
ds_read_b64_tr_b16 a[192:193], v26 offset:0
ds_read_b64_tr_b16 a[194:195], v26 offset:1536
ds_read_b64_tr_b16 a[196:197], v26 offset:12288
ds_read_b64_tr_b16 a[198:199], v26 offset:13824
ds_read_b64_tr_b16 a[200:201], v26 offset:8
ds_read_b64_tr_b16 a[202:203], v26 offset:1544
ds_read_b64_tr_b16 a[204:205], v26 offset:12296
ds_read_b64_tr_b16 a[206:207], v26 offset:13832
ds_read_b64_tr_b16 a[208:209], v27 offset:0
ds_read_b64_tr_b16 a[210:211], v27 offset:1536
ds_read_b64_tr_b16 a[212:213], v27 offset:12288
ds_read_b64_tr_b16 a[214:215], v27 offset:13824
L_k2_gemm:
s_waitcnt vmcnt(0) lgkmcnt(8)
v_mfma_f32_16x16x32_bf16 v[64:67], a[192:195], a[40:43], 0
ds_read_b64_tr_b16 a[216:217], v27 offset:8
ds_read_b64_tr_b16 a[218:219], v27 offset:1544
v_mfma_f32_16x16x32_bf16 v[64:67], a[196:199], a[44:47], v[64:67]
s_add_u32 s46, s46, 2048
v_mfma_f32_16x16x32_bf16 v[112:115], a[192:195], a[48:51], 0
ds_read_b64_tr_b16 a[220:221], v27 offset:12296
ds_read_b64_tr_b16 a[222:223], v27 offset:13832
v_mfma_f32_16x16x32_bf16 v[112:115], a[196:199], a[52:55], v[112:115]
buffer_load_dwordx4 a[72:75], v36, s[16:19], s46 offen offset:0 sc0 sc1
v_mfma_f32_16x16x32_bf16 v[160:163], a[192:195], a[56:59], 0
buffer_load_dwordx4 a[76:79], v36, s[16:19], s46 offen offset:1024 sc0 sc1
v_mfma_f32_16x16x32_bf16 v[160:163], a[196:199], a[60:63], v[160:163]
v_mfma_f32_16x16x32_bf16 v[208:211], a[192:195], a[64:67], 0
v_mfma_f32_16x16x32_bf16 v[208:211], a[196:199], a[68:71], v[208:211]
s_waitcnt lgkmcnt(8)
v_mfma_f32_16x16x32_bf16 v[68:71], a[200:203], a[40:43], 0
ds_read_b64_tr_b16 a[192:193], v30 offset:0
ds_read_b64_tr_b16 a[194:195], v30 offset:512
v_mfma_f32_16x16x32_bf16 v[68:71], a[204:207], a[44:47], v[68:71]
buffer_load_dwordx4 a[80:83], v37, s[16:19], s46 offen offset:0 sc0 sc1
v_mfma_f32_16x16x32_bf16 v[116:119], a[200:203], a[48:51], 0
ds_read_b64_tr_b16 a[196:197], v30 offset:4096
ds_read_b64_tr_b16 a[198:199], v30 offset:4608
v_mfma_f32_16x16x32_bf16 v[116:119], a[204:207], a[52:55], v[116:119]
buffer_load_dwordx4 a[84:87], v37, s[16:19], s46 offen offset:1024 sc0 sc1
v_mfma_f32_16x16x32_bf16 v[164:167], a[200:203], a[56:59], 0
v_mfma_f32_16x16x32_bf16 v[164:167], a[204:207], a[60:63], v[164:167]
buffer_load_dwordx4 a[88:91], v38, s[16:19], s46 offen offset:0 sc0 sc1
v_mfma_f32_16x16x32_bf16 v[212:215], a[200:203], a[64:67], 0
v_mfma_f32_16x16x32_bf16 v[212:215], a[204:207], a[68:71], v[212:215]
s_waitcnt lgkmcnt(8)
v_mfma_f32_16x16x32_bf16 v[72:75], a[208:211], a[40:43], 0
ds_read_b64_tr_b16 a[200:201], v26 offset:128
ds_read_b64_tr_b16 a[202:203], v26 offset:1664
v_mfma_f32_16x16x32_bf16 v[72:75], a[212:215], a[44:47], v[72:75]
buffer_load_dwordx4 a[92:95], v38, s[16:19], s46 offen offset:1024 sc0 sc1
v_mfma_f32_16x16x32_bf16 v[120:123], a[208:211], a[48:51], 0
ds_read_b64_tr_b16 a[204:205], v26 offset:12416
ds_read_b64_tr_b16 a[206:207], v26 offset:13952
v_mfma_f32_16x16x32_bf16 v[120:123], a[212:215], a[52:55], v[120:123]
v_mfma_f32_16x16x32_bf16 v[168:171], a[208:211], a[56:59], 0
buffer_load_dwordx4 a[96:99], v39, s[16:19], s46 offen offset:0 sc0 sc1
v_mfma_f32_16x16x32_bf16 v[168:171], a[212:215], a[60:63], v[168:171]
v_mfma_f32_16x16x32_bf16 v[216:219], a[208:211], a[64:67], 0
v_mfma_f32_16x16x32_bf16 v[216:219], a[212:215], a[68:71], v[216:219]
s_waitcnt lgkmcnt(8)
v_mfma_f32_16x16x32_bf16 v[76:79], a[216:219], a[40:43], 0
ds_read_b64_tr_b16 a[208:209], v26 offset:136
ds_read_b64_tr_b16 a[210:211], v26 offset:1672
v_mfma_f32_16x16x32_bf16 v[76:79], a[220:223], a[44:47], v[76:79]
buffer_load_dwordx4 a[100:103], v39, s[16:19], s46 offen offset:1024 sc0 sc1
v_mfma_f32_16x16x32_bf16 v[124:127], a[216:219], a[48:51], 0
ds_read_b64_tr_b16 a[212:213], v26 offset:12424
ds_read_b64_tr_b16 a[214:215], v26 offset:13960
v_mfma_f32_16x16x32_bf16 v[124:127], a[220:223], a[52:55], v[124:127]
s_add_u32 m0, s26, 65536
v_mfma_f32_16x16x32_bf16 v[172:175], a[216:219], a[56:59], 0
buffer_load_dwordx4 v32, s[28:31], s44 offen offset:0 lds
v_mfma_f32_16x16x32_bf16 v[172:175], a[220:223], a[60:63], v[172:175]
buffer_load_dwordx4 v33, s[28:31], s44 offen offset:1024 lds
v_mfma_f32_16x16x32_bf16 v[220:223], a[216:219], a[64:67], 0
v_mfma_f32_16x16x32_bf16 v[220:223], a[220:223], a[68:71], v[220:223]
s_waitcnt lgkmcnt(8)
v_mfma_f32_16x16x32_bf16 a[176:179], a[192:195], a[40:43], 0
ds_read_b64_tr_b16 a[216:217], v27 offset:128
ds_read_b64_tr_b16 a[218:219], v27 offset:1664
v_mfma_f32_16x16x32_bf16 a[176:179], a[196:199], a[44:47], a[176:179]
buffer_load_dwordx4 v34, s[28:31], s44 offen offset:2048 lds
v_mfma_f32_16x16x32_bf16 a[184:187], a[192:195], a[48:51], 0
ds_read_b64_tr_b16 a[220:221], v27 offset:12416
ds_read_b64_tr_b16 a[222:223], v27 offset:13952
v_mfma_f32_16x16x32_bf16 a[184:187], a[196:199], a[52:55], a[184:187]
s_waitcnt lgkmcnt(8)
v_mfma_f32_16x16x32_bf16 v[80:83], a[200:203], a[40:43], 0
ds_read_b64_tr_b16 a[192:193], v27 offset:136
ds_read_b64_tr_b16 a[194:195], v27 offset:1672
v_mfma_f32_16x16x32_bf16 v[80:83], a[204:207], a[44:47], v[80:83]
s_add_u32 s44, s44, 393216
s_add_u32 m0, s26, 77824
v_mfma_f32_16x16x32_bf16 v[128:131], a[200:203], a[48:51], 0
ds_read_b64_tr_b16 a[196:197], v27 offset:12424
ds_read_b64_tr_b16 a[198:199], v27 offset:13960
v_mfma_f32_16x16x32_bf16 v[128:131], a[204:207], a[52:55], v[128:131]
buffer_load_dwordx4 v32, s[28:31], s44 offen offset:0 lds
v_mfma_f32_16x16x32_bf16 v[176:179], a[200:203], a[56:59], 0
buffer_load_dwordx4 v33, s[28:31], s44 offen offset:1024 lds
v_mfma_f32_16x16x32_bf16 v[176:179], a[204:207], a[60:63], v[176:179]
v_mfma_f32_16x16x32_bf16 v[224:227], a[200:203], a[64:67], 0
buffer_load_dwordx4 v34, s[28:31], s44 offen offset:2048 lds
v_mfma_f32_16x16x32_bf16 v[224:227], a[204:207], a[68:71], v[224:227]
s_waitcnt lgkmcnt(8)
v_mfma_f32_16x16x32_bf16 v[84:87], a[208:211], a[40:43], 0
ds_read_b64_tr_b16 a[200:201], v26 offset:256
ds_read_b64_tr_b16 a[202:203], v26 offset:1792
v_mfma_f32_16x16x32_bf16 v[84:87], a[212:215], a[44:47], v[84:87]
s_add_u32 s44, s44, 393216
s_add_u32 m0, s50, 65536
v_mfma_f32_16x16x32_bf16 v[132:135], a[208:211], a[48:51], 0
ds_read_b64_tr_b16 a[204:205], v26 offset:12544
ds_read_b64_tr_b16 a[206:207], v26 offset:14080
v_mfma_f32_16x16x32_bf16 v[132:135], a[212:215], a[52:55], v[132:135]
buffer_load_dwordx4 v35, s[32:35], s45 offen lds
v_mfma_f32_16x16x32_bf16 v[180:183], a[208:211], a[56:59], 0
s_add_u32 s45, s45, 98304
s_add_u32 m0, s50, 69632
v_mfma_f32_16x16x32_bf16 v[180:183], a[212:215], a[60:63], v[180:183]
buffer_load_dwordx4 v35, s[32:35], s45 offen lds
v_mfma_f32_16x16x32_bf16 v[228:231], a[208:211], a[64:67], 0
s_add_u32 s45, s45, 98304
s_add_u32 s46, s46, 2048
v_mfma_f32_16x16x32_bf16 v[228:231], a[212:215], a[68:71], v[228:231]
s_waitcnt lgkmcnt(8)
v_mfma_f32_16x16x32_bf16 v[88:91], a[216:219], a[40:43], 0
ds_read_b64_tr_b16 a[208:209], v31 offset:0
ds_read_b64_tr_b16 a[210:211], v31 offset:512
v_mfma_f32_16x16x32_bf16 v[88:91], a[220:223], a[44:47], v[88:91]
buffer_load_dwordx4 a[104:107], v36, s[16:19], s46 offen offset:0 sc0 sc1
v_mfma_f32_16x16x32_bf16 v[136:139], a[216:219], a[48:51], 0
ds_read_b64_tr_b16 a[212:213], v31 offset:4096
ds_read_b64_tr_b16 a[214:215], v31 offset:4608
v_mfma_f32_16x16x32_bf16 v[136:139], a[220:223], a[52:55], v[136:139]
buffer_load_dwordx4 a[108:111], v36, s[16:19], s46 offen offset:1024 sc0 sc1
v_mfma_f32_16x16x32_bf16 v[184:187], a[216:219], a[56:59], 0
v_mfma_f32_16x16x32_bf16 v[184:187], a[220:223], a[60:63], v[184:187]
v_mfma_f32_16x16x32_bf16 v[232:235], a[216:219], a[64:67], 0
buffer_load_dwordx4 a[112:115], v37, s[16:19], s46 offen offset:0 sc0 sc1
v_mfma_f32_16x16x32_bf16 v[232:235], a[220:223], a[68:71], v[232:235]
s_waitcnt lgkmcnt(8)
v_mfma_f32_16x16x32_bf16 v[92:95], a[192:195], a[40:43], 0
ds_read_b64_tr_b16 a[216:217], v26 offset:264
ds_read_b64_tr_b16 a[218:219], v26 offset:1800
v_mfma_f32_16x16x32_bf16 v[92:95], a[196:199], a[44:47], v[92:95]
buffer_load_dwordx4 a[116:119], v37, s[16:19], s46 offen offset:1024 sc0 sc1
v_mfma_f32_16x16x32_bf16 v[140:143], a[192:195], a[48:51], 0
ds_read_b64_tr_b16 a[220:221], v26 offset:12552
ds_read_b64_tr_b16 a[222:223], v26 offset:14088
v_mfma_f32_16x16x32_bf16 v[140:143], a[196:199], a[52:55], v[140:143]
v_mfma_f32_16x16x32_bf16 v[188:191], a[192:195], a[56:59], 0
v_mfma_f32_16x16x32_bf16 v[188:191], a[196:199], a[60:63], v[188:191]
buffer_load_dwordx4 a[120:123], v38, s[16:19], s46 offen offset:0 sc0 sc1
v_mfma_f32_16x16x32_bf16 v[236:239], a[192:195], a[64:67], 0
v_mfma_f32_16x16x32_bf16 v[236:239], a[196:199], a[68:71], v[236:239]
s_waitcnt lgkmcnt(8)
v_mfma_f32_16x16x32_bf16 v[96:99], a[200:203], a[40:43], 0
ds_read_b64_tr_b16 a[192:193], v27 offset:256
ds_read_b64_tr_b16 a[194:195], v27 offset:1792
v_mfma_f32_16x16x32_bf16 v[96:99], a[204:207], a[44:47], v[96:99]
buffer_load_dwordx4 a[124:127], v38, s[16:19], s46 offen offset:1024 sc0 sc1
v_mfma_f32_16x16x32_bf16 v[144:147], a[200:203], a[48:51], 0
ds_read_b64_tr_b16 a[196:197], v27 offset:12544
ds_read_b64_tr_b16 a[198:199], v27 offset:14080
v_mfma_f32_16x16x32_bf16 v[144:147], a[204:207], a[52:55], v[144:147]
buffer_load_dwordx4 a[128:131], v39, s[16:19], s46 offen offset:0 sc0 sc1
v_mfma_f32_16x16x32_bf16 v[192:195], a[200:203], a[56:59], 0
v_mfma_f32_16x16x32_bf16 v[192:195], a[204:207], a[60:63], v[192:195]
v_mfma_f32_16x16x32_bf16 v[240:243], a[200:203], a[64:67], 0
buffer_load_dwordx4 a[132:135], v39, s[16:19], s46 offen offset:1024 sc0 sc1
v_mfma_f32_16x16x32_bf16 v[240:243], a[204:207], a[68:71], v[240:243]
s_waitcnt lgkmcnt(8)
v_mfma_f32_16x16x32_bf16 a[180:183], a[208:211], a[40:43], 0
ds_read_b64_tr_b16 a[200:201], v27 offset:264
ds_read_b64_tr_b16 a[202:203], v27 offset:1800
v_mfma_f32_16x16x32_bf16 a[180:183], a[212:215], a[44:47], a[180:183]
s_add_u32 m0, s26, 98304
v_mfma_f32_16x16x32_bf16 a[188:191], a[208:211], a[48:51], 0
ds_read_b64_tr_b16 a[204:205], v27 offset:12552
ds_read_b64_tr_b16 a[206:207], v27 offset:14088
v_mfma_f32_16x16x32_bf16 a[188:191], a[212:215], a[52:55], a[188:191]
s_waitcnt lgkmcnt(8)
v_mfma_f32_16x16x32_bf16 v[100:103], a[216:219], a[40:43], 0
ds_read_b64_tr_b16 a[208:209], v28 offset:0
ds_read_b64_tr_b16 a[210:211], v28 offset:512
v_mfma_f32_16x16x32_bf16 v[100:103], a[220:223], a[44:47], v[100:103]
buffer_load_dwordx4 v32, s[28:31], s44 offen offset:0 lds
v_mfma_f32_16x16x32_bf16 v[148:151], a[216:219], a[48:51], 0
ds_read_b64_tr_b16 a[212:213], v28 offset:4096
ds_read_b64_tr_b16 a[214:215], v28 offset:4608
v_mfma_f32_16x16x32_bf16 v[148:151], a[220:223], a[52:55], v[148:151]
buffer_load_dwordx4 v33, s[28:31], s44 offen offset:1024 lds
v_mfma_f32_16x16x32_bf16 v[196:199], a[216:219], a[56:59], 0
buffer_load_dwordx4 v34, s[28:31], s44 offen offset:2048 lds
v_mfma_f32_16x16x32_bf16 v[196:199], a[220:223], a[60:63], v[196:199]
s_add_u32 s44, s44, 393216
s_add_u32 m0, s26, 110592
v_mfma_f32_16x16x32_bf16 v[244:247], a[216:219], a[64:67], 0
v_mfma_f32_16x16x32_bf16 v[244:247], a[220:223], a[68:71], v[244:247]
s_waitcnt lgkmcnt(8)
v_mfma_f32_16x16x32_bf16 v[104:107], a[192:195], a[40:43], 0
ds_read_b64_tr_b16 a[216:217], v29 offset:0
ds_read_b64_tr_b16 a[218:219], v29 offset:512
v_mfma_f32_16x16x32_bf16 v[104:107], a[196:199], a[44:47], v[104:107]
buffer_load_dwordx4 v32, s[28:31], s44 offen offset:0 lds
v_mfma_f32_16x16x32_bf16 v[152:155], a[192:195], a[48:51], 0
ds_read_b64_tr_b16 a[220:221], v29 offset:4096
ds_read_b64_tr_b16 a[222:223], v29 offset:4608
v_mfma_f32_16x16x32_bf16 v[152:155], a[196:199], a[52:55], v[152:155]
buffer_load_dwordx4 v33, s[28:31], s44 offen offset:1024 lds
v_mfma_f32_16x16x32_bf16 v[200:203], a[192:195], a[56:59], 0
v_mfma_f32_16x16x32_bf16 v[200:203], a[196:199], a[60:63], v[200:203]
buffer_load_dwordx4 v34, s[28:31], s44 offen offset:2048 lds
v_mfma_f32_16x16x32_bf16 v[248:251], a[192:195], a[64:67], 0
v_mfma_f32_16x16x32_bf16 v[248:251], a[196:199], a[68:71], v[248:251]
s_waitcnt lgkmcnt(8)
v_mfma_f32_16x16x32_bf16 v[108:111], a[200:203], a[40:43], 0
s_waitcnt lgkmcnt(0)
s_barrier
v_mfma_f32_16x16x32_bf16 v[108:111], a[204:207], a[44:47], v[108:111]
ds_read_b64_tr_b16 a[192:193], v26 offset:32768
ds_read_b64_tr_b16 a[194:195], v26 offset:34304
v_mfma_f32_16x16x32_bf16 v[156:159], a[200:203], a[48:51], 0
s_add_u32 s44, s44, 393216
s_add_u32 m0, s50, 98304
v_mfma_f32_16x16x32_bf16 v[156:159], a[204:207], a[52:55], v[156:159]
ds_read_b64_tr_b16 a[196:197], v26 offset:45056
ds_read_b64_tr_b16 a[198:199], v26 offset:46592
v_mfma_f32_16x16x32_bf16 v[204:207], a[200:203], a[56:59], 0
buffer_load_dwordx4 v35, s[32:35], s45 offen lds
v_mfma_f32_16x16x32_bf16 v[204:207], a[204:207], a[60:63], v[204:207]
s_add_u32 s45, s45, 98304
s_add_u32 m0, s50, 102400
v_mfma_f32_16x16x32_bf16 v[252:255], a[200:203], a[64:67], 0
buffer_load_dwordx4 v35, s[32:35], s45 offen lds
v_mfma_f32_16x16x32_bf16 v[252:255], a[204:207], a[68:71], v[252:255]
v_mfma_f32_16x16x32_bf16 a[144:147], a[208:211], a[40:43], 0
ds_read_b64_tr_b16 a[200:201], v26 offset:32776
ds_read_b64_tr_b16 a[202:203], v26 offset:34312
v_mfma_f32_16x16x32_bf16 a[144:147], a[212:215], a[44:47], a[144:147]
s_add_u32 s45, s45, 98304
v_add_u32 v18, 0, v1
v_mfma_f32_16x16x32_bf16 a[152:155], a[208:211], a[48:51], 0
ds_read_b64_tr_b16 a[204:205], v26 offset:45064
ds_read_b64_tr_b16 a[206:207], v26 offset:46600
v_mfma_f32_16x16x32_bf16 a[152:155], a[212:215], a[52:55], a[152:155]
v_mul_u32_u24 v19, 0x199a, v18
v_lshrrev_b32 v19, 16, v19
v_mfma_f32_16x16x32_bf16 a[160:163], a[208:211], a[56:59], 0
v_mul_u32_u24 v20, 10, v19
v_sub_u32 v20, v18, v20
v_mfma_f32_16x16x32_bf16 a[160:163], a[212:215], a[60:63], a[160:163]
v_mul_u32_u24 v19, 1280, v19
v_lshl_add_u32 v21, v20, 4, v19
v_mfma_f32_16x16x32_bf16 a[168:171], a[208:211], a[64:67], 0
buffer_load_dwordx4 a[0:3], v21, s[84:87], s82 offen offset:0
v_mfma_f32_16x16x32_bf16 a[168:171], a[212:215], a[68:71], a[168:171]
v_mfma_f32_16x16x32_bf16 a[148:151], a[216:219], a[40:43], 0
ds_read_b64_tr_b16 a[208:209], v27 offset:32768
ds_read_b64_tr_b16 a[210:211], v27 offset:34304
v_mfma_f32_16x16x32_bf16 a[148:151], a[220:223], a[44:47], a[148:151]
buffer_load_dwordx4 a[20:23], v21, s[84:87], s82 offen offset:160
v_mfma_f32_16x16x32_bf16 a[156:159], a[216:219], a[48:51], 0
ds_read_b64_tr_b16 a[212:213], v27 offset:45056
ds_read_b64_tr_b16 a[214:215], v27 offset:46592
v_mfma_f32_16x16x32_bf16 a[156:159], a[220:223], a[52:55], a[156:159]
v_mfma_f32_16x16x32_bf16 a[164:167], a[216:219], a[56:59], 0
v_mfma_f32_16x16x32_bf16 a[164:167], a[220:223], a[60:63], a[164:167]
v_mfma_f32_16x16x32_bf16 a[172:175], a[216:219], a[64:67], 0
v_mfma_f32_16x16x32_bf16 a[172:175], a[220:223], a[68:71], a[172:175]
s_waitcnt vmcnt(26) lgkmcnt(8)
v_mfma_f32_16x16x32_bf16 v[64:67], a[192:195], a[72:75], v[64:67]
ds_read_b64_tr_b16 a[216:217], v27 offset:32776
ds_read_b64_tr_b16 a[218:219], v27 offset:34312
v_mfma_f32_16x16x32_bf16 v[64:67], a[196:199], a[76:79], v[64:67]
s_add_u32 s46, s46, 2048
v_mfma_f32_16x16x32_bf16 v[112:115], a[192:195], a[80:83], v[112:115]
ds_read_b64_tr_b16 a[220:221], v27 offset:45064
ds_read_b64_tr_b16 a[222:223], v27 offset:46600
v_mfma_f32_16x16x32_bf16 v[112:115], a[196:199], a[84:87], v[112:115]
buffer_load_dwordx4 a[40:43], v36, s[16:19], s46 offen offset:0 sc0 sc1
v_mfma_f32_16x16x32_bf16 v[160:163], a[192:195], a[88:91], v[160:163]
v_mfma_f32_16x16x32_bf16 v[160:163], a[196:199], a[92:95], v[160:163]
v_mfma_f32_16x16x32_bf16 v[208:211], a[192:195], a[96:99], v[208:211]
v_mfma_f32_16x16x32_bf16 v[208:211], a[196:199], a[100:103], v[208:211]
s_waitcnt lgkmcnt(8)
v_mfma_f32_16x16x32_bf16 v[68:71], a[200:203], a[72:75], v[68:71]
ds_read_b64_tr_b16 a[192:193], v30 offset:32768
ds_read_b64_tr_b16 a[194:195], v30 offset:33280
v_mfma_f32_16x16x32_bf16 v[68:71], a[204:207], a[76:79], v[68:71]
buffer_load_dwordx4 a[44:47], v36, s[16:19], s46 offen offset:1024 sc0 sc1
v_mfma_f32_16x16x32_bf16 v[116:119], a[200:203], a[80:83], v[116:119]
ds_read_b64_tr_b16 a[196:197], v30 offset:36864
ds_read_b64_tr_b16 a[198:199], v30 offset:37376
v_mfma_f32_16x16x32_bf16 v[116:119], a[204:207], a[84:87], v[116:119]
v_mfma_f32_16x16x32_bf16 v[164:167], a[200:203], a[88:91], v[164:167]
v_mfma_f32_16x16x32_bf16 v[164:167], a[204:207], a[92:95], v[164:167]
buffer_load_dwordx4 a[48:51], v37, s[16:19], s46 offen offset:0 sc0 sc1
v_mfma_f32_16x16x32_bf16 v[212:215], a[200:203], a[96:99], v[212:215]
v_mfma_f32_16x16x32_bf16 v[212:215], a[204:207], a[100:103], v[212:215]
s_waitcnt lgkmcnt(8)
v_mfma_f32_16x16x32_bf16 v[72:75], a[208:211], a[72:75], v[72:75]
ds_read_b64_tr_b16 a[200:201], v26 offset:32896
ds_read_b64_tr_b16 a[202:203], v26 offset:34432
v_mfma_f32_16x16x32_bf16 v[72:75], a[212:215], a[76:79], v[72:75]
v_mfma_f32_16x16x32_bf16 v[120:123], a[208:211], a[80:83], v[120:123]
ds_read_b64_tr_b16 a[204:205], v26 offset:45184
ds_read_b64_tr_b16 a[206:207], v26 offset:46720
v_mfma_f32_16x16x32_bf16 v[120:123], a[212:215], a[84:87], v[120:123]
buffer_load_dwordx4 a[52:55], v37, s[16:19], s46 offen offset:1024 sc0 sc1
v_mfma_f32_16x16x32_bf16 v[168:171], a[208:211], a[88:91], v[168:171]
v_mfma_f32_16x16x32_bf16 v[168:171], a[212:215], a[92:95], v[168:171]
v_mfma_f32_16x16x32_bf16 v[216:219], a[208:211], a[96:99], v[216:219]
v_mfma_f32_16x16x32_bf16 v[216:219], a[212:215], a[100:103], v[216:219]
s_waitcnt lgkmcnt(8)
v_mfma_f32_16x16x32_bf16 v[76:79], a[216:219], a[72:75], v[76:79]
ds_read_b64_tr_b16 a[208:209], v26 offset:32904
ds_read_b64_tr_b16 a[210:211], v26 offset:34440
v_mfma_f32_16x16x32_bf16 v[76:79], a[220:223], a[76:79], v[76:79]
buffer_load_dwordx4 a[56:59], v38, s[16:19], s46 offen offset:0 sc0 sc1
v_mfma_f32_16x16x32_bf16 v[124:127], a[216:219], a[80:83], v[124:127]
ds_read_b64_tr_b16 a[212:213], v26 offset:45192
ds_read_b64_tr_b16 a[214:215], v26 offset:46728
v_mfma_f32_16x16x32_bf16 v[124:127], a[220:223], a[84:87], v[124:127]
v_mfma_f32_16x16x32_bf16 v[172:175], a[216:219], a[88:91], v[172:175]
v_mfma_f32_16x16x32_bf16 v[172:175], a[220:223], a[92:95], v[172:175]
v_mfma_f32_16x16x32_bf16 v[220:223], a[216:219], a[96:99], v[220:223]
v_mfma_f32_16x16x32_bf16 v[220:223], a[220:223], a[100:103], v[220:223]
s_waitcnt lgkmcnt(8)
v_mfma_f32_16x16x32_bf16 a[176:179], a[192:195], a[72:75], a[176:179]
ds_read_b64_tr_b16 a[216:217], v27 offset:32896
ds_read_b64_tr_b16 a[218:219], v27 offset:34432
v_mfma_f32_16x16x32_bf16 a[176:179], a[196:199], a[76:79], a[176:179]
buffer_load_dwordx4 a[60:63], v38, s[16:19], s46 offen offset:1024 sc0 sc1
v_mfma_f32_16x16x32_bf16 a[184:187], a[192:195], a[80:83], a[184:187]
ds_read_b64_tr_b16 a[220:221], v27 offset:45184
ds_read_b64_tr_b16 a[222:223], v27 offset:46720
v_mfma_f32_16x16x32_bf16 a[184:187], a[196:199], a[84:87], a[184:187]
s_waitcnt lgkmcnt(8)
v_mfma_f32_16x16x32_bf16 v[80:83], a[200:203], a[72:75], v[80:83]
ds_read_b64_tr_b16 a[192:193], v27 offset:32904
ds_read_b64_tr_b16 a[194:195], v27 offset:34440
v_mfma_f32_16x16x32_bf16 v[80:83], a[204:207], a[76:79], v[80:83]
buffer_load_dwordx4 a[64:67], v39, s[16:19], s46 offen offset:0 sc0 sc1
v_mfma_f32_16x16x32_bf16 v[128:131], a[200:203], a[80:83], v[128:131]
ds_read_b64_tr_b16 a[196:197], v27 offset:45192
ds_read_b64_tr_b16 a[198:199], v27 offset:46728
v_mfma_f32_16x16x32_bf16 v[128:131], a[204:207], a[84:87], v[128:131]
v_mfma_f32_16x16x32_bf16 v[176:179], a[200:203], a[88:91], v[176:179]
v_mfma_f32_16x16x32_bf16 v[176:179], a[204:207], a[92:95], v[176:179]
v_mfma_f32_16x16x32_bf16 v[224:227], a[200:203], a[96:99], v[224:227]
v_mfma_f32_16x16x32_bf16 v[224:227], a[204:207], a[100:103], v[224:227]
s_waitcnt lgkmcnt(8)
v_mfma_f32_16x16x32_bf16 v[84:87], a[208:211], a[72:75], v[84:87]
ds_read_b64_tr_b16 a[200:201], v26 offset:33024
ds_read_b64_tr_b16 a[202:203], v26 offset:34560
v_mfma_f32_16x16x32_bf16 v[84:87], a[212:215], a[76:79], v[84:87]
buffer_load_dwordx4 a[68:71], v39, s[16:19], s46 offen offset:1024 sc0 sc1
v_mfma_f32_16x16x32_bf16 v[132:135], a[208:211], a[80:83], v[132:135]
ds_read_b64_tr_b16 a[204:205], v26 offset:45312
ds_read_b64_tr_b16 a[206:207], v26 offset:46848
v_mfma_f32_16x16x32_bf16 v[132:135], a[212:215], a[84:87], v[132:135]
s_add_u32 m0, s26, 0
v_mfma_f32_16x16x32_bf16 v[180:183], a[208:211], a[88:91], v[180:183]
v_mfma_f32_16x16x32_bf16 v[180:183], a[212:215], a[92:95], v[180:183]
buffer_load_dwordx4 v32, s[28:31], s44 offen offset:0 lds
v_mfma_f32_16x16x32_bf16 v[228:231], a[208:211], a[96:99], v[228:231]
v_mfma_f32_16x16x32_bf16 v[228:231], a[212:215], a[100:103], v[228:231]
s_waitcnt lgkmcnt(8)
v_mfma_f32_16x16x32_bf16 v[88:91], a[216:219], a[72:75], v[88:91]
ds_read_b64_tr_b16 a[208:209], v31 offset:32768
ds_read_b64_tr_b16 a[210:211], v31 offset:33280
v_mfma_f32_16x16x32_bf16 v[88:91], a[220:223], a[76:79], v[88:91]
v_mfma_f32_16x16x32_bf16 v[136:139], a[216:219], a[80:83], v[136:139]
ds_read_b64_tr_b16 a[212:213], v31 offset:36864
ds_read_b64_tr_b16 a[214:215], v31 offset:37376
v_mfma_f32_16x16x32_bf16 v[136:139], a[220:223], a[84:87], v[136:139]
buffer_load_dwordx4 v33, s[28:31], s44 offen offset:1024 lds
v_mfma_f32_16x16x32_bf16 v[184:187], a[216:219], a[88:91], v[184:187]
v_mfma_f32_16x16x32_bf16 v[184:187], a[220:223], a[92:95], v[184:187]
v_mfma_f32_16x16x32_bf16 v[232:235], a[216:219], a[96:99], v[232:235]
v_mfma_f32_16x16x32_bf16 v[232:235], a[220:223], a[100:103], v[232:235]
s_waitcnt lgkmcnt(8)
v_mfma_f32_16x16x32_bf16 v[92:95], a[192:195], a[72:75], v[92:95]
ds_read_b64_tr_b16 a[216:217], v26 offset:33032
ds_read_b64_tr_b16 a[218:219], v26 offset:34568
v_mfma_f32_16x16x32_bf16 v[92:95], a[196:199], a[76:79], v[92:95]
buffer_load_dwordx4 v34, s[28:31], s44 offen offset:2048 lds
v_mfma_f32_16x16x32_bf16 v[140:143], a[192:195], a[80:83], v[140:143]
ds_read_b64_tr_b16 a[220:221], v26 offset:45320
ds_read_b64_tr_b16 a[222:223], v26 offset:46856
v_mfma_f32_16x16x32_bf16 v[140:143], a[196:199], a[84:87], v[140:143]
v_mfma_f32_16x16x32_bf16 v[188:191], a[192:195], a[88:91], v[188:191]
v_mfma_f32_16x16x32_bf16 v[188:191], a[196:199], a[92:95], v[188:191]
s_add_u32 s44, s44, 393216
s_add_u32 m0, s26, 12288
v_mfma_f32_16x16x32_bf16 v[236:239], a[192:195], a[96:99], v[236:239]
v_mfma_f32_16x16x32_bf16 v[236:239], a[196:199], a[100:103], v[236:239]
s_waitcnt lgkmcnt(8)
v_mfma_f32_16x16x32_bf16 v[96:99], a[200:203], a[72:75], v[96:99]
ds_read_b64_tr_b16 a[192:193], v27 offset:33024
ds_read_b64_tr_b16 a[194:195], v27 offset:34560
v_mfma_f32_16x16x32_bf16 v[96:99], a[204:207], a[76:79], v[96:99]
buffer_load_dwordx4 v32, s[28:31], s44 offen offset:0 lds
v_mfma_f32_16x16x32_bf16 v[144:147], a[200:203], a[80:83], v[144:147]
ds_read_b64_tr_b16 a[196:197], v27 offset:45312
ds_read_b64_tr_b16 a[198:199], v27 offset:46848
v_mfma_f32_16x16x32_bf16 v[144:147], a[204:207], a[84:87], v[144:147]
v_mfma_f32_16x16x32_bf16 v[192:195], a[200:203], a[88:91], v[192:195]
v_mfma_f32_16x16x32_bf16 v[192:195], a[204:207], a[92:95], v[192:195]
buffer_load_dwordx4 v33, s[28:31], s44 offen offset:1024 lds
v_mfma_f32_16x16x32_bf16 v[240:243], a[200:203], a[96:99], v[240:243]
v_mfma_f32_16x16x32_bf16 v[240:243], a[204:207], a[100:103], v[240:243]
s_waitcnt lgkmcnt(8)
v_mfma_f32_16x16x32_bf16 a[180:183], a[208:211], a[72:75], a[180:183]
ds_read_b64_tr_b16 a[200:201], v27 offset:33032
ds_read_b64_tr_b16 a[202:203], v27 offset:34568
v_mfma_f32_16x16x32_bf16 a[180:183], a[212:215], a[76:79], a[180:183]
v_mfma_f32_16x16x32_bf16 a[188:191], a[208:211], a[80:83], a[188:191]
ds_read_b64_tr_b16 a[204:205], v27 offset:45320
ds_read_b64_tr_b16 a[206:207], v27 offset:46856
v_mfma_f32_16x16x32_bf16 a[188:191], a[212:215], a[84:87], a[188:191]
s_waitcnt lgkmcnt(8)
v_mfma_f32_16x16x32_bf16 v[100:103], a[216:219], a[72:75], v[100:103]
ds_read_b64_tr_b16 a[208:209], v28 offset:32768
ds_read_b64_tr_b16 a[210:211], v28 offset:33280
v_mfma_f32_16x16x32_bf16 v[100:103], a[220:223], a[76:79], v[100:103]
buffer_load_dwordx4 v34, s[28:31], s44 offen offset:2048 lds
v_mfma_f32_16x16x32_bf16 v[148:151], a[216:219], a[80:83], v[148:151]
ds_read_b64_tr_b16 a[212:213], v28 offset:36864
ds_read_b64_tr_b16 a[214:215], v28 offset:37376
v_mfma_f32_16x16x32_bf16 v[148:151], a[220:223], a[84:87], v[148:151]
s_add_u32 s44, s44, 393216
s_add_u32 m0, s50, 0
v_mfma_f32_16x16x32_bf16 v[196:199], a[216:219], a[88:91], v[196:199]
v_mfma_f32_16x16x32_bf16 v[196:199], a[220:223], a[92:95], v[196:199]
buffer_load_dwordx4 v35, s[32:35], s45 offen lds
v_mfma_f32_16x16x32_bf16 v[244:247], a[216:219], a[96:99], v[244:247]
v_mfma_f32_16x16x32_bf16 v[244:247], a[220:223], a[100:103], v[244:247]
s_waitcnt lgkmcnt(8)
v_mfma_f32_16x16x32_bf16 v[104:107], a[192:195], a[72:75], v[104:107]
ds_read_b64_tr_b16 a[216:217], v29 offset:32768
ds_read_b64_tr_b16 a[218:219], v29 offset:33280
v_mfma_f32_16x16x32_bf16 v[104:107], a[196:199], a[76:79], v[104:107]
s_add_u32 s45, s45, 98304
s_add_u32 m0, s50, 4096
v_mfma_f32_16x16x32_bf16 v[152:155], a[192:195], a[80:83], v[152:155]
ds_read_b64_tr_b16 a[220:221], v29 offset:36864
ds_read_b64_tr_b16 a[222:223], v29 offset:37376
v_mfma_f32_16x16x32_bf16 v[152:155], a[196:199], a[84:87], v[152:155]
v_add_u32 v26, 65536, v26
v_add_u32 v27, 65536, v27
v_mfma_f32_16x16x32_bf16 v[200:203], a[192:195], a[88:91], v[200:203]
v_add_u32 v28, 65536, v28
v_add_u32 v29, 65536, v29
v_mfma_f32_16x16x32_bf16 v[200:203], a[196:199], a[92:95], v[200:203]
v_add_u32 v30, 65536, v30
v_add_u32 v31, 65536, v31
v_mfma_f32_16x16x32_bf16 v[248:251], a[192:195], a[96:99], v[248:251]
buffer_load_dwordx4 v35, s[32:35], s45 offen lds
v_mfma_f32_16x16x32_bf16 v[248:251], a[196:199], a[100:103], v[248:251]
s_waitcnt lgkmcnt(8)
v_mfma_f32_16x16x32_bf16 v[108:111], a[200:203], a[72:75], v[108:111]
s_waitcnt vmcnt(34) lgkmcnt(0)
s_barrier
v_mfma_f32_16x16x32_bf16 v[108:111], a[204:207], a[76:79], v[108:111]
ds_read_b64_tr_b16 a[192:193], v26 offset:0
ds_read_b64_tr_b16 a[194:195], v26 offset:1536
v_mfma_f32_16x16x32_bf16 v[156:159], a[200:203], a[80:83], v[156:159]
s_add_u32 s45, s45, 98304
v_add_u32 v18, 64, v1
v_mfma_f32_16x16x32_bf16 v[156:159], a[204:207], a[84:87], v[156:159]
ds_read_b64_tr_b16 a[196:197], v26 offset:12288
ds_read_b64_tr_b16 a[198:199], v26 offset:13824
v_mfma_f32_16x16x32_bf16 v[204:207], a[200:203], a[88:91], v[204:207]
v_mul_u32_u24 v19, 0x199a, v18
v_lshrrev_b32 v19, 16, v19
v_mfma_f32_16x16x32_bf16 v[204:207], a[204:207], a[92:95], v[204:207]
v_mul_u32_u24 v20, 10, v19
v_sub_u32 v20, v18, v20
v_mfma_f32_16x16x32_bf16 v[252:255], a[200:203], a[96:99], v[252:255]
v_mul_u32_u24 v19, 1280, v19
v_lshl_add_u32 v21, v20, 4, v19
v_mfma_f32_16x16x32_bf16 v[252:255], a[204:207], a[100:103], v[252:255]
v_mfma_f32_16x16x32_bf16 a[144:147], a[208:211], a[72:75], a[144:147]
ds_read_b64_tr_b16 a[200:201], v26 offset:8
ds_read_b64_tr_b16 a[202:203], v26 offset:1544
v_mfma_f32_16x16x32_bf16 a[144:147], a[212:215], a[76:79], a[144:147]
buffer_load_dwordx4 a[4:7], v21, s[84:87], s82 offen offset:0
v_mfma_f32_16x16x32_bf16 a[152:155], a[208:211], a[80:83], a[152:155]
ds_read_b64_tr_b16 a[204:205], v26 offset:12296
ds_read_b64_tr_b16 a[206:207], v26 offset:13832
v_mfma_f32_16x16x32_bf16 a[152:155], a[212:215], a[84:87], a[152:155]
buffer_load_dwordx4 a[24:27], v21, s[84:87], s82 offen offset:160
v_mfma_f32_16x16x32_bf16 a[160:163], a[208:211], a[88:91], a[160:163]
v_mfma_f32_16x16x32_bf16 a[160:163], a[212:215], a[92:95], a[160:163]
v_mfma_f32_16x16x32_bf16 a[168:171], a[208:211], a[96:99], a[168:171]
v_mfma_f32_16x16x32_bf16 a[168:171], a[212:215], a[100:103], a[168:171]
v_mfma_f32_16x16x32_bf16 a[148:151], a[216:219], a[72:75], a[148:151]
ds_read_b64_tr_b16 a[208:209], v27 offset:0
ds_read_b64_tr_b16 a[210:211], v27 offset:1536
v_mfma_f32_16x16x32_bf16 a[148:151], a[220:223], a[76:79], a[148:151]
v_mfma_f32_16x16x32_bf16 a[156:159], a[216:219], a[80:83], a[156:159]
ds_read_b64_tr_b16 a[212:213], v27 offset:12288
ds_read_b64_tr_b16 a[214:215], v27 offset:13824
v_mfma_f32_16x16x32_bf16 a[156:159], a[220:223], a[84:87], a[156:159]
v_mfma_f32_16x16x32_bf16 a[164:167], a[216:219], a[88:91], a[164:167]
v_mfma_f32_16x16x32_bf16 a[164:167], a[220:223], a[92:95], a[164:167]
v_mfma_f32_16x16x32_bf16 a[172:175], a[216:219], a[96:99], a[172:175]
v_mfma_f32_16x16x32_bf16 a[172:175], a[220:223], a[100:103], a[172:175]
s_waitcnt vmcnt(28) lgkmcnt(8)
v_mfma_f32_16x16x32_bf16 v[64:67], a[192:195], a[104:107], v[64:67]
ds_read_b64_tr_b16 a[216:217], v27 offset:8
ds_read_b64_tr_b16 a[218:219], v27 offset:1544
v_mfma_f32_16x16x32_bf16 v[64:67], a[196:199], a[108:111], v[64:67]
s_add_u32 s46, s46, 2048
v_mfma_f32_16x16x32_bf16 v[112:115], a[192:195], a[112:115], v[112:115]
ds_read_b64_tr_b16 a[220:221], v27 offset:12296
ds_read_b64_tr_b16 a[222:223], v27 offset:13832
v_mfma_f32_16x16x32_bf16 v[112:115], a[196:199], a[116:119], v[112:115]
buffer_load_dwordx4 a[72:75], v36, s[16:19], s46 offen offset:0 sc0 sc1
v_mfma_f32_16x16x32_bf16 v[160:163], a[192:195], a[120:123], v[160:163]
v_mfma_f32_16x16x32_bf16 v[160:163], a[196:199], a[124:127], v[160:163]
v_mfma_f32_16x16x32_bf16 v[208:211], a[192:195], a[128:131], v[208:211]
v_mfma_f32_16x16x32_bf16 v[208:211], a[196:199], a[132:135], v[208:211]
s_waitcnt lgkmcnt(8)
v_mfma_f32_16x16x32_bf16 v[68:71], a[200:203], a[104:107], v[68:71]
ds_read_b64_tr_b16 a[192:193], v30 offset:0
ds_read_b64_tr_b16 a[194:195], v30 offset:512
v_mfma_f32_16x16x32_bf16 v[68:71], a[204:207], a[108:111], v[68:71]
buffer_load_dwordx4 a[76:79], v36, s[16:19], s46 offen offset:1024 sc0 sc1
v_mfma_f32_16x16x32_bf16 v[116:119], a[200:203], a[112:115], v[116:119]
ds_read_b64_tr_b16 a[196:197], v30 offset:4096
ds_read_b64_tr_b16 a[198:199], v30 offset:4608
v_mfma_f32_16x16x32_bf16 v[116:119], a[204:207], a[116:119], v[116:119]
v_mfma_f32_16x16x32_bf16 v[164:167], a[200:203], a[120:123], v[164:167]
v_mfma_f32_16x16x32_bf16 v[164:167], a[204:207], a[124:127], v[164:167]
buffer_load_dwordx4 a[80:83], v37, s[16:19], s46 offen offset:0 sc0 sc1
v_mfma_f32_16x16x32_bf16 v[212:215], a[200:203], a[128:131], v[212:215]
v_mfma_f32_16x16x32_bf16 v[212:215], a[204:207], a[132:135], v[212:215]
s_waitcnt lgkmcnt(8)
v_mfma_f32_16x16x32_bf16 v[72:75], a[208:211], a[104:107], v[72:75]
ds_read_b64_tr_b16 a[200:201], v26 offset:128
ds_read_b64_tr_b16 a[202:203], v26 offset:1664
v_mfma_f32_16x16x32_bf16 v[72:75], a[212:215], a[108:111], v[72:75]
v_mfma_f32_16x16x32_bf16 v[120:123], a[208:211], a[112:115], v[120:123]
ds_read_b64_tr_b16 a[204:205], v26 offset:12416
ds_read_b64_tr_b16 a[206:207], v26 offset:13952
v_mfma_f32_16x16x32_bf16 v[120:123], a[212:215], a[116:119], v[120:123]
buffer_load_dwordx4 a[84:87], v37, s[16:19], s46 offen offset:1024 sc0 sc1
v_mfma_f32_16x16x32_bf16 v[168:171], a[208:211], a[120:123], v[168:171]
v_mfma_f32_16x16x32_bf16 v[168:171], a[212:215], a[124:127], v[168:171]
v_mfma_f32_16x16x32_bf16 v[216:219], a[208:211], a[128:131], v[216:219]
v_mfma_f32_16x16x32_bf16 v[216:219], a[212:215], a[132:135], v[216:219]
s_waitcnt lgkmcnt(8)
v_mfma_f32_16x16x32_bf16 v[76:79], a[216:219], a[104:107], v[76:79]
ds_read_b64_tr_b16 a[208:209], v26 offset:136
ds_read_b64_tr_b16 a[210:211], v26 offset:1672
v_mfma_f32_16x16x32_bf16 v[76:79], a[220:223], a[108:111], v[76:79]
buffer_load_dwordx4 a[88:91], v38, s[16:19], s46 offen offset:0 sc0 sc1
v_mfma_f32_16x16x32_bf16 v[124:127], a[216:219], a[112:115], v[124:127]
ds_read_b64_tr_b16 a[212:213], v26 offset:12424
ds_read_b64_tr_b16 a[214:215], v26 offset:13960
v_mfma_f32_16x16x32_bf16 v[124:127], a[220:223], a[116:119], v[124:127]
v_mfma_f32_16x16x32_bf16 v[172:175], a[216:219], a[120:123], v[172:175]
v_mfma_f32_16x16x32_bf16 v[172:175], a[220:223], a[124:127], v[172:175]
v_mfma_f32_16x16x32_bf16 v[220:223], a[216:219], a[128:131], v[220:223]
v_mfma_f32_16x16x32_bf16 v[220:223], a[220:223], a[132:135], v[220:223]
s_waitcnt lgkmcnt(8)
v_mfma_f32_16x16x32_bf16 a[176:179], a[192:195], a[104:107], a[176:179]
ds_read_b64_tr_b16 a[216:217], v27 offset:128
ds_read_b64_tr_b16 a[218:219], v27 offset:1664
v_mfma_f32_16x16x32_bf16 a[176:179], a[196:199], a[108:111], a[176:179]
buffer_load_dwordx4 a[92:95], v38, s[16:19], s46 offen offset:1024 sc0 sc1
v_mfma_f32_16x16x32_bf16 a[184:187], a[192:195], a[112:115], a[184:187]
ds_read_b64_tr_b16 a[220:221], v27 offset:12416
ds_read_b64_tr_b16 a[222:223], v27 offset:13952
v_mfma_f32_16x16x32_bf16 a[184:187], a[196:199], a[116:119], a[184:187]
s_waitcnt lgkmcnt(8)
v_mfma_f32_16x16x32_bf16 v[80:83], a[200:203], a[104:107], v[80:83]
ds_read_b64_tr_b16 a[192:193], v27 offset:136
ds_read_b64_tr_b16 a[194:195], v27 offset:1672
v_mfma_f32_16x16x32_bf16 v[80:83], a[204:207], a[108:111], v[80:83]
buffer_load_dwordx4 a[96:99], v39, s[16:19], s46 offen offset:0 sc0 sc1
v_mfma_f32_16x16x32_bf16 v[128:131], a[200:203], a[112:115], v[128:131]
ds_read_b64_tr_b16 a[196:197], v27 offset:12424
ds_read_b64_tr_b16 a[198:199], v27 offset:13960
v_mfma_f32_16x16x32_bf16 v[128:131], a[204:207], a[116:119], v[128:131]
v_mfma_f32_16x16x32_bf16 v[176:179], a[200:203], a[120:123], v[176:179]
v_mfma_f32_16x16x32_bf16 v[176:179], a[204:207], a[124:127], v[176:179]
v_mfma_f32_16x16x32_bf16 v[224:227], a[200:203], a[128:131], v[224:227]
v_mfma_f32_16x16x32_bf16 v[224:227], a[204:207], a[132:135], v[224:227]
s_waitcnt lgkmcnt(8)
v_mfma_f32_16x16x32_bf16 v[84:87], a[208:211], a[104:107], v[84:87]
ds_read_b64_tr_b16 a[200:201], v26 offset:256
ds_read_b64_tr_b16 a[202:203], v26 offset:1792
v_mfma_f32_16x16x32_bf16 v[84:87], a[212:215], a[108:111], v[84:87]
buffer_load_dwordx4 a[100:103], v39, s[16:19], s46 offen offset:1024 sc0 sc1
v_mfma_f32_16x16x32_bf16 v[132:135], a[208:211], a[112:115], v[132:135]
ds_read_b64_tr_b16 a[204:205], v26 offset:12544
ds_read_b64_tr_b16 a[206:207], v26 offset:14080
v_mfma_f32_16x16x32_bf16 v[132:135], a[212:215], a[116:119], v[132:135]
s_add_u32 m0, s26, 32768
v_mfma_f32_16x16x32_bf16 v[180:183], a[208:211], a[120:123], v[180:183]
v_mfma_f32_16x16x32_bf16 v[180:183], a[212:215], a[124:127], v[180:183]
buffer_load_dwordx4 v32, s[28:31], s44 offen offset:0 lds
v_mfma_f32_16x16x32_bf16 v[228:231], a[208:211], a[128:131], v[228:231]
v_mfma_f32_16x16x32_bf16 v[228:231], a[212:215], a[132:135], v[228:231]
s_waitcnt lgkmcnt(8)
v_mfma_f32_16x16x32_bf16 v[88:91], a[216:219], a[104:107], v[88:91]
ds_read_b64_tr_b16 a[208:209], v31 offset:0
ds_read_b64_tr_b16 a[210:211], v31 offset:512
v_mfma_f32_16x16x32_bf16 v[88:91], a[220:223], a[108:111], v[88:91]
v_mfma_f32_16x16x32_bf16 v[136:139], a[216:219], a[112:115], v[136:139]
ds_read_b64_tr_b16 a[212:213], v31 offset:4096
ds_read_b64_tr_b16 a[214:215], v31 offset:4608
v_mfma_f32_16x16x32_bf16 v[136:139], a[220:223], a[116:119], v[136:139]
buffer_load_dwordx4 v33, s[28:31], s44 offen offset:1024 lds
v_mfma_f32_16x16x32_bf16 v[184:187], a[216:219], a[120:123], v[184:187]
v_mfma_f32_16x16x32_bf16 v[184:187], a[220:223], a[124:127], v[184:187]
v_mfma_f32_16x16x32_bf16 v[232:235], a[216:219], a[128:131], v[232:235]
v_mfma_f32_16x16x32_bf16 v[232:235], a[220:223], a[132:135], v[232:235]
s_waitcnt lgkmcnt(8)
v_mfma_f32_16x16x32_bf16 v[92:95], a[192:195], a[104:107], v[92:95]
ds_read_b64_tr_b16 a[216:217], v26 offset:264
ds_read_b64_tr_b16 a[218:219], v26 offset:1800
v_mfma_f32_16x16x32_bf16 v[92:95], a[196:199], a[108:111], v[92:95]
buffer_load_dwordx4 v34, s[28:31], s44 offen offset:2048 lds
v_mfma_f32_16x16x32_bf16 v[140:143], a[192:195], a[112:115], v[140:143]
ds_read_b64_tr_b16 a[220:221], v26 offset:12552
ds_read_b64_tr_b16 a[222:223], v26 offset:14088
v_mfma_f32_16x16x32_bf16 v[140:143], a[196:199], a[116:119], v[140:143]
v_mfma_f32_16x16x32_bf16 v[188:191], a[192:195], a[120:123], v[188:191]
v_mfma_f32_16x16x32_bf16 v[188:191], a[196:199], a[124:127], v[188:191]
s_add_u32 s44, s44, 393216
s_add_u32 m0, s26, 45056
v_mfma_f32_16x16x32_bf16 v[236:239], a[192:195], a[128:131], v[236:239]
v_mfma_f32_16x16x32_bf16 v[236:239], a[196:199], a[132:135], v[236:239]
s_waitcnt lgkmcnt(8)
v_mfma_f32_16x16x32_bf16 v[96:99], a[200:203], a[104:107], v[96:99]
ds_read_b64_tr_b16 a[192:193], v27 offset:256
ds_read_b64_tr_b16 a[194:195], v27 offset:1792
v_mfma_f32_16x16x32_bf16 v[96:99], a[204:207], a[108:111], v[96:99]
buffer_load_dwordx4 v32, s[28:31], s44 offen offset:0 lds
v_mfma_f32_16x16x32_bf16 v[144:147], a[200:203], a[112:115], v[144:147]
ds_read_b64_tr_b16 a[196:197], v27 offset:12544
ds_read_b64_tr_b16 a[198:199], v27 offset:14080
v_mfma_f32_16x16x32_bf16 v[144:147], a[204:207], a[116:119], v[144:147]
v_mfma_f32_16x16x32_bf16 v[192:195], a[200:203], a[120:123], v[192:195]
v_mfma_f32_16x16x32_bf16 v[192:195], a[204:207], a[124:127], v[192:195]
buffer_load_dwordx4 v33, s[28:31], s44 offen offset:1024 lds
v_mfma_f32_16x16x32_bf16 v[240:243], a[200:203], a[128:131], v[240:243]
v_mfma_f32_16x16x32_bf16 v[240:243], a[204:207], a[132:135], v[240:243]
s_waitcnt lgkmcnt(8)
v_mfma_f32_16x16x32_bf16 a[180:183], a[208:211], a[104:107], a[180:183]
ds_read_b64_tr_b16 a[200:201], v27 offset:264
ds_read_b64_tr_b16 a[202:203], v27 offset:1800
v_mfma_f32_16x16x32_bf16 a[180:183], a[212:215], a[108:111], a[180:183]
v_mfma_f32_16x16x32_bf16 a[188:191], a[208:211], a[112:115], a[188:191]
ds_read_b64_tr_b16 a[204:205], v27 offset:12552
ds_read_b64_tr_b16 a[206:207], v27 offset:14088
v_mfma_f32_16x16x32_bf16 a[188:191], a[212:215], a[116:119], a[188:191]
s_waitcnt lgkmcnt(8)
v_mfma_f32_16x16x32_bf16 v[100:103], a[216:219], a[104:107], v[100:103]
ds_read_b64_tr_b16 a[208:209], v28 offset:0
ds_read_b64_tr_b16 a[210:211], v28 offset:512
v_mfma_f32_16x16x32_bf16 v[100:103], a[220:223], a[108:111], v[100:103]
buffer_load_dwordx4 v34, s[28:31], s44 offen offset:2048 lds
v_mfma_f32_16x16x32_bf16 v[148:151], a[216:219], a[112:115], v[148:151]
ds_read_b64_tr_b16 a[212:213], v28 offset:4096
ds_read_b64_tr_b16 a[214:215], v28 offset:4608
v_mfma_f32_16x16x32_bf16 v[148:151], a[220:223], a[116:119], v[148:151]
s_add_u32 s44, s44, 393216
s_add_u32 m0, s50, 32768
v_mfma_f32_16x16x32_bf16 v[196:199], a[216:219], a[120:123], v[196:199]
v_mfma_f32_16x16x32_bf16 v[196:199], a[220:223], a[124:127], v[196:199]
buffer_load_dwordx4 v35, s[32:35], s45 offen lds
v_mfma_f32_16x16x32_bf16 v[244:247], a[216:219], a[128:131], v[244:247]
v_mfma_f32_16x16x32_bf16 v[244:247], a[220:223], a[132:135], v[244:247]
s_waitcnt lgkmcnt(8)
v_mfma_f32_16x16x32_bf16 v[104:107], a[192:195], a[104:107], v[104:107]
ds_read_b64_tr_b16 a[216:217], v29 offset:0
ds_read_b64_tr_b16 a[218:219], v29 offset:512
v_mfma_f32_16x16x32_bf16 v[104:107], a[196:199], a[108:111], v[104:107]
s_add_u32 s45, s45, 98304
s_add_u32 m0, s50, 36864
v_mfma_f32_16x16x32_bf16 v[152:155], a[192:195], a[112:115], v[152:155]
ds_read_b64_tr_b16 a[220:221], v29 offset:4096
ds_read_b64_tr_b16 a[222:223], v29 offset:4608
v_mfma_f32_16x16x32_bf16 v[152:155], a[196:199], a[116:119], v[152:155]
buffer_load_dwordx4 v35, s[32:35], s45 offen lds
v_mfma_f32_16x16x32_bf16 v[200:203], a[192:195], a[120:123], v[200:203]
s_add_u32 s45, s45, 98304
v_add_u32 v18, 128, v1
v_mfma_f32_16x16x32_bf16 v[200:203], a[196:199], a[124:127], v[200:203]
v_mul_u32_u24 v19, 0x199a, v18
v_lshrrev_b32 v19, 16, v19
v_mfma_f32_16x16x32_bf16 v[248:251], a[192:195], a[128:131], v[248:251]
v_mul_u32_u24 v20, 10, v19
v_sub_u32 v20, v18, v20
v_mfma_f32_16x16x32_bf16 v[248:251], a[196:199], a[132:135], v[248:251]
s_waitcnt lgkmcnt(8)
v_mfma_f32_16x16x32_bf16 v[108:111], a[200:203], a[104:107], v[108:111]
s_waitcnt vmcnt(36) lgkmcnt(0)
s_barrier
v_mfma_f32_16x16x32_bf16 v[108:111], a[204:207], a[108:111], v[108:111]
ds_read_b64_tr_b16 a[192:193], v26 offset:32768
ds_read_b64_tr_b16 a[194:195], v26 offset:34304
v_mfma_f32_16x16x32_bf16 v[156:159], a[200:203], a[112:115], v[156:159]
v_mul_u32_u24 v19, 1280, v19
v_lshl_add_u32 v21, v20, 4, v19
v_mfma_f32_16x16x32_bf16 v[156:159], a[204:207], a[116:119], v[156:159]
ds_read_b64_tr_b16 a[196:197], v26 offset:45056
ds_read_b64_tr_b16 a[198:199], v26 offset:46592
v_mfma_f32_16x16x32_bf16 v[204:207], a[200:203], a[120:123], v[204:207]
buffer_load_dwordx4 a[8:11], v21, s[84:87], s82 offen offset:0
v_mfma_f32_16x16x32_bf16 v[204:207], a[204:207], a[124:127], v[204:207]
v_mfma_f32_16x16x32_bf16 v[252:255], a[200:203], a[128:131], v[252:255]
v_mfma_f32_16x16x32_bf16 v[252:255], a[204:207], a[132:135], v[252:255]
v_mfma_f32_16x16x32_bf16 a[144:147], a[208:211], a[104:107], a[144:147]
ds_read_b64_tr_b16 a[200:201], v26 offset:32776
ds_read_b64_tr_b16 a[202:203], v26 offset:34312
v_mfma_f32_16x16x32_bf16 a[144:147], a[212:215], a[108:111], a[144:147]
buffer_load_dwordx4 a[28:31], v21, s[84:87], s82 offen offset:160
v_mfma_f32_16x16x32_bf16 a[152:155], a[208:211], a[112:115], a[152:155]
ds_read_b64_tr_b16 a[204:205], v26 offset:45064
ds_read_b64_tr_b16 a[206:207], v26 offset:46600
v_mfma_f32_16x16x32_bf16 a[152:155], a[212:215], a[116:119], a[152:155]
v_mfma_f32_16x16x32_bf16 a[160:163], a[208:211], a[120:123], a[160:163]
v_mfma_f32_16x16x32_bf16 a[160:163], a[212:215], a[124:127], a[160:163]
v_mfma_f32_16x16x32_bf16 a[168:171], a[208:211], a[128:131], a[168:171]
v_mfma_f32_16x16x32_bf16 a[168:171], a[212:215], a[132:135], a[168:171]
v_mfma_f32_16x16x32_bf16 a[148:151], a[216:219], a[104:107], a[148:151]
ds_read_b64_tr_b16 a[208:209], v27 offset:32768
ds_read_b64_tr_b16 a[210:211], v27 offset:34304
v_mfma_f32_16x16x32_bf16 a[148:151], a[220:223], a[108:111], a[148:151]
v_mfma_f32_16x16x32_bf16 a[156:159], a[216:219], a[112:115], a[156:159]
ds_read_b64_tr_b16 a[212:213], v27 offset:45056
ds_read_b64_tr_b16 a[214:215], v27 offset:46592
v_mfma_f32_16x16x32_bf16 a[156:159], a[220:223], a[116:119], a[156:159]
v_mfma_f32_16x16x32_bf16 a[164:167], a[216:219], a[120:123], a[164:167]
v_mfma_f32_16x16x32_bf16 a[164:167], a[220:223], a[124:127], a[164:167]
v_mfma_f32_16x16x32_bf16 a[172:175], a[216:219], a[128:131], a[172:175]
v_mfma_f32_16x16x32_bf16 a[172:175], a[220:223], a[132:135], a[172:175]
s_waitcnt vmcnt(28) lgkmcnt(8)
v_mfma_f32_16x16x32_bf16 v[64:67], a[192:195], a[40:43], v[64:67]
ds_read_b64_tr_b16 a[216:217], v27 offset:32776
ds_read_b64_tr_b16 a[218:219], v27 offset:34312
v_mfma_f32_16x16x32_bf16 v[64:67], a[196:199], a[44:47], v[64:67]
s_add_u32 s46, s46, 2048
v_mfma_f32_16x16x32_bf16 v[112:115], a[192:195], a[48:51], v[112:115]
ds_read_b64_tr_b16 a[220:221], v27 offset:45064
ds_read_b64_tr_b16 a[222:223], v27 offset:46600
v_mfma_f32_16x16x32_bf16 v[112:115], a[196:199], a[52:55], v[112:115]
buffer_load_dwordx4 a[104:107], v36, s[16:19], s46 offen offset:0 sc0 sc1
v_mfma_f32_16x16x32_bf16 v[160:163], a[192:195], a[56:59], v[160:163]
v_mfma_f32_16x16x32_bf16 v[160:163], a[196:199], a[60:63], v[160:163]
v_mfma_f32_16x16x32_bf16 v[208:211], a[192:195], a[64:67], v[208:211]
v_mfma_f32_16x16x32_bf16 v[208:211], a[196:199], a[68:71], v[208:211]
s_waitcnt lgkmcnt(8)
v_mfma_f32_16x16x32_bf16 v[68:71], a[200:203], a[40:43], v[68:71]
ds_read_b64_tr_b16 a[192:193], v30 offset:32768
ds_read_b64_tr_b16 a[194:195], v30 offset:33280
v_mfma_f32_16x16x32_bf16 v[68:71], a[204:207], a[44:47], v[68:71]
buffer_load_dwordx4 a[108:111], v36, s[16:19], s46 offen offset:1024 sc0 sc1
v_mfma_f32_16x16x32_bf16 v[116:119], a[200:203], a[48:51], v[116:119]
ds_read_b64_tr_b16 a[196:197], v30 offset:36864
ds_read_b64_tr_b16 a[198:199], v30 offset:37376
v_mfma_f32_16x16x32_bf16 v[116:119], a[204:207], a[52:55], v[116:119]
v_mfma_f32_16x16x32_bf16 v[164:167], a[200:203], a[56:59], v[164:167]
v_mfma_f32_16x16x32_bf16 v[164:167], a[204:207], a[60:63], v[164:167]
buffer_load_dwordx4 a[112:115], v37, s[16:19], s46 offen offset:0 sc0 sc1
v_mfma_f32_16x16x32_bf16 v[212:215], a[200:203], a[64:67], v[212:215]
v_mfma_f32_16x16x32_bf16 v[212:215], a[204:207], a[68:71], v[212:215]
s_waitcnt lgkmcnt(8)
v_mfma_f32_16x16x32_bf16 v[72:75], a[208:211], a[40:43], v[72:75]
ds_read_b64_tr_b16 a[200:201], v26 offset:32896
ds_read_b64_tr_b16 a[202:203], v26 offset:34432
v_mfma_f32_16x16x32_bf16 v[72:75], a[212:215], a[44:47], v[72:75]
v_mfma_f32_16x16x32_bf16 v[120:123], a[208:211], a[48:51], v[120:123]
ds_read_b64_tr_b16 a[204:205], v26 offset:45184
ds_read_b64_tr_b16 a[206:207], v26 offset:46720
v_mfma_f32_16x16x32_bf16 v[120:123], a[212:215], a[52:55], v[120:123]
buffer_load_dwordx4 a[116:119], v37, s[16:19], s46 offen offset:1024 sc0 sc1
v_mfma_f32_16x16x32_bf16 v[168:171], a[208:211], a[56:59], v[168:171]
v_mfma_f32_16x16x32_bf16 v[168:171], a[212:215], a[60:63], v[168:171]
v_mfma_f32_16x16x32_bf16 v[216:219], a[208:211], a[64:67], v[216:219]
v_mfma_f32_16x16x32_bf16 v[216:219], a[212:215], a[68:71], v[216:219]
s_waitcnt lgkmcnt(8)
v_mfma_f32_16x16x32_bf16 v[76:79], a[216:219], a[40:43], v[76:79]
ds_read_b64_tr_b16 a[208:209], v26 offset:32904
ds_read_b64_tr_b16 a[210:211], v26 offset:34440
v_mfma_f32_16x16x32_bf16 v[76:79], a[220:223], a[44:47], v[76:79]
buffer_load_dwordx4 a[120:123], v38, s[16:19], s46 offen offset:0 sc0 sc1
v_mfma_f32_16x16x32_bf16 v[124:127], a[216:219], a[48:51], v[124:127]
ds_read_b64_tr_b16 a[212:213], v26 offset:45192
ds_read_b64_tr_b16 a[214:215], v26 offset:46728
v_mfma_f32_16x16x32_bf16 v[124:127], a[220:223], a[52:55], v[124:127]
v_mfma_f32_16x16x32_bf16 v[172:175], a[216:219], a[56:59], v[172:175]
v_mfma_f32_16x16x32_bf16 v[172:175], a[220:223], a[60:63], v[172:175]
v_mfma_f32_16x16x32_bf16 v[220:223], a[216:219], a[64:67], v[220:223]
v_mfma_f32_16x16x32_bf16 v[220:223], a[220:223], a[68:71], v[220:223]
s_waitcnt lgkmcnt(8)
v_mfma_f32_16x16x32_bf16 a[176:179], a[192:195], a[40:43], a[176:179]
ds_read_b64_tr_b16 a[216:217], v27 offset:32896
ds_read_b64_tr_b16 a[218:219], v27 offset:34432
v_mfma_f32_16x16x32_bf16 a[176:179], a[196:199], a[44:47], a[176:179]
buffer_load_dwordx4 a[124:127], v38, s[16:19], s46 offen offset:1024 sc0 sc1
v_mfma_f32_16x16x32_bf16 a[184:187], a[192:195], a[48:51], a[184:187]
ds_read_b64_tr_b16 a[220:221], v27 offset:45184
ds_read_b64_tr_b16 a[222:223], v27 offset:46720
v_mfma_f32_16x16x32_bf16 a[184:187], a[196:199], a[52:55], a[184:187]
s_waitcnt lgkmcnt(8)
v_mfma_f32_16x16x32_bf16 v[80:83], a[200:203], a[40:43], v[80:83]
ds_read_b64_tr_b16 a[192:193], v27 offset:32904
ds_read_b64_tr_b16 a[194:195], v27 offset:34440
v_mfma_f32_16x16x32_bf16 v[80:83], a[204:207], a[44:47], v[80:83]
buffer_load_dwordx4 a[128:131], v39, s[16:19], s46 offen offset:0 sc0 sc1
v_mfma_f32_16x16x32_bf16 v[128:131], a[200:203], a[48:51], v[128:131]
ds_read_b64_tr_b16 a[196:197], v27 offset:45192
ds_read_b64_tr_b16 a[198:199], v27 offset:46728
v_mfma_f32_16x16x32_bf16 v[128:131], a[204:207], a[52:55], v[128:131]
v_mfma_f32_16x16x32_bf16 v[176:179], a[200:203], a[56:59], v[176:179]
v_mfma_f32_16x16x32_bf16 v[176:179], a[204:207], a[60:63], v[176:179]
v_mfma_f32_16x16x32_bf16 v[224:227], a[200:203], a[64:67], v[224:227]
v_mfma_f32_16x16x32_bf16 v[224:227], a[204:207], a[68:71], v[224:227]
s_waitcnt lgkmcnt(8)
v_mfma_f32_16x16x32_bf16 v[84:87], a[208:211], a[40:43], v[84:87]
ds_read_b64_tr_b16 a[200:201], v26 offset:33024
ds_read_b64_tr_b16 a[202:203], v26 offset:34560
v_mfma_f32_16x16x32_bf16 v[84:87], a[212:215], a[44:47], v[84:87]
buffer_load_dwordx4 a[132:135], v39, s[16:19], s46 offen offset:1024 sc0 sc1
v_mfma_f32_16x16x32_bf16 v[132:135], a[208:211], a[48:51], v[132:135]
ds_read_b64_tr_b16 a[204:205], v26 offset:45312
ds_read_b64_tr_b16 a[206:207], v26 offset:46848
v_mfma_f32_16x16x32_bf16 v[132:135], a[212:215], a[52:55], v[132:135]
s_add_u32 m0, s26, 65536
v_mfma_f32_16x16x32_bf16 v[180:183], a[208:211], a[56:59], v[180:183]
v_mfma_f32_16x16x32_bf16 v[180:183], a[212:215], a[60:63], v[180:183]
buffer_load_dwordx4 v32, s[28:31], s44 offen offset:0 lds
v_mfma_f32_16x16x32_bf16 v[228:231], a[208:211], a[64:67], v[228:231]
v_mfma_f32_16x16x32_bf16 v[228:231], a[212:215], a[68:71], v[228:231]
s_waitcnt lgkmcnt(8)
v_mfma_f32_16x16x32_bf16 v[88:91], a[216:219], a[40:43], v[88:91]
ds_read_b64_tr_b16 a[208:209], v31 offset:32768
ds_read_b64_tr_b16 a[210:211], v31 offset:33280
v_mfma_f32_16x16x32_bf16 v[88:91], a[220:223], a[44:47], v[88:91]
v_mfma_f32_16x16x32_bf16 v[136:139], a[216:219], a[48:51], v[136:139]
ds_read_b64_tr_b16 a[212:213], v31 offset:36864
ds_read_b64_tr_b16 a[214:215], v31 offset:37376
v_mfma_f32_16x16x32_bf16 v[136:139], a[220:223], a[52:55], v[136:139]
buffer_load_dwordx4 v33, s[28:31], s44 offen offset:1024 lds
v_mfma_f32_16x16x32_bf16 v[184:187], a[216:219], a[56:59], v[184:187]
v_mfma_f32_16x16x32_bf16 v[184:187], a[220:223], a[60:63], v[184:187]
v_mfma_f32_16x16x32_bf16 v[232:235], a[216:219], a[64:67], v[232:235]
v_mfma_f32_16x16x32_bf16 v[232:235], a[220:223], a[68:71], v[232:235]
s_waitcnt lgkmcnt(8)
v_mfma_f32_16x16x32_bf16 v[92:95], a[192:195], a[40:43], v[92:95]
ds_read_b64_tr_b16 a[216:217], v26 offset:33032
ds_read_b64_tr_b16 a[218:219], v26 offset:34568
v_mfma_f32_16x16x32_bf16 v[92:95], a[196:199], a[44:47], v[92:95]
buffer_load_dwordx4 v34, s[28:31], s44 offen offset:2048 lds
v_mfma_f32_16x16x32_bf16 v[140:143], a[192:195], a[48:51], v[140:143]
ds_read_b64_tr_b16 a[220:221], v26 offset:45320
ds_read_b64_tr_b16 a[222:223], v26 offset:46856
v_mfma_f32_16x16x32_bf16 v[140:143], a[196:199], a[52:55], v[140:143]
v_mfma_f32_16x16x32_bf16 v[188:191], a[192:195], a[56:59], v[188:191]
v_mfma_f32_16x16x32_bf16 v[188:191], a[196:199], a[60:63], v[188:191]
s_add_u32 s44, s44, 393216
s_add_u32 m0, s26, 77824
v_mfma_f32_16x16x32_bf16 v[236:239], a[192:195], a[64:67], v[236:239]
v_mfma_f32_16x16x32_bf16 v[236:239], a[196:199], a[68:71], v[236:239]
s_waitcnt lgkmcnt(8)
v_mfma_f32_16x16x32_bf16 v[96:99], a[200:203], a[40:43], v[96:99]
ds_read_b64_tr_b16 a[192:193], v27 offset:33024
ds_read_b64_tr_b16 a[194:195], v27 offset:34560
v_mfma_f32_16x16x32_bf16 v[96:99], a[204:207], a[44:47], v[96:99]
buffer_load_dwordx4 v32, s[28:31], s44 offen offset:0 lds
v_mfma_f32_16x16x32_bf16 v[144:147], a[200:203], a[48:51], v[144:147]
ds_read_b64_tr_b16 a[196:197], v27 offset:45312
ds_read_b64_tr_b16 a[198:199], v27 offset:46848
v_mfma_f32_16x16x32_bf16 v[144:147], a[204:207], a[52:55], v[144:147]
v_mfma_f32_16x16x32_bf16 v[192:195], a[200:203], a[56:59], v[192:195]
v_mfma_f32_16x16x32_bf16 v[192:195], a[204:207], a[60:63], v[192:195]
buffer_load_dwordx4 v33, s[28:31], s44 offen offset:1024 lds
v_mfma_f32_16x16x32_bf16 v[240:243], a[200:203], a[64:67], v[240:243]
v_mfma_f32_16x16x32_bf16 v[240:243], a[204:207], a[68:71], v[240:243]
s_waitcnt lgkmcnt(8)
v_mfma_f32_16x16x32_bf16 a[180:183], a[208:211], a[40:43], a[180:183]
ds_read_b64_tr_b16 a[200:201], v27 offset:33032
ds_read_b64_tr_b16 a[202:203], v27 offset:34568
v_mfma_f32_16x16x32_bf16 a[180:183], a[212:215], a[44:47], a[180:183]
v_mfma_f32_16x16x32_bf16 a[188:191], a[208:211], a[48:51], a[188:191]
ds_read_b64_tr_b16 a[204:205], v27 offset:45320
ds_read_b64_tr_b16 a[206:207], v27 offset:46856
v_mfma_f32_16x16x32_bf16 a[188:191], a[212:215], a[52:55], a[188:191]
s_waitcnt lgkmcnt(8)
v_mfma_f32_16x16x32_bf16 v[100:103], a[216:219], a[40:43], v[100:103]
ds_read_b64_tr_b16 a[208:209], v28 offset:32768
ds_read_b64_tr_b16 a[210:211], v28 offset:33280
v_mfma_f32_16x16x32_bf16 v[100:103], a[220:223], a[44:47], v[100:103]
buffer_load_dwordx4 v34, s[28:31], s44 offen offset:2048 lds
v_mfma_f32_16x16x32_bf16 v[148:151], a[216:219], a[48:51], v[148:151]
ds_read_b64_tr_b16 a[212:213], v28 offset:36864
ds_read_b64_tr_b16 a[214:215], v28 offset:37376
v_mfma_f32_16x16x32_bf16 v[148:151], a[220:223], a[52:55], v[148:151]
s_add_u32 s44, s44, 393216
s_add_u32 m0, s50, 65536
v_mfma_f32_16x16x32_bf16 v[196:199], a[216:219], a[56:59], v[196:199]
v_mfma_f32_16x16x32_bf16 v[196:199], a[220:223], a[60:63], v[196:199]
buffer_load_dwordx4 v35, s[32:35], s45 offen lds
v_mfma_f32_16x16x32_bf16 v[244:247], a[216:219], a[64:67], v[244:247]
v_mfma_f32_16x16x32_bf16 v[244:247], a[220:223], a[68:71], v[244:247]
s_waitcnt lgkmcnt(8)
v_mfma_f32_16x16x32_bf16 v[104:107], a[192:195], a[40:43], v[104:107]
ds_read_b64_tr_b16 a[216:217], v29 offset:32768
ds_read_b64_tr_b16 a[218:219], v29 offset:33280
v_mfma_f32_16x16x32_bf16 v[104:107], a[196:199], a[44:47], v[104:107]
s_add_u32 s45, s45, 98304
s_add_u32 m0, s50, 69632
v_mfma_f32_16x16x32_bf16 v[152:155], a[192:195], a[48:51], v[152:155]
ds_read_b64_tr_b16 a[220:221], v29 offset:36864
ds_read_b64_tr_b16 a[222:223], v29 offset:37376
v_mfma_f32_16x16x32_bf16 v[152:155], a[196:199], a[52:55], v[152:155]
v_add_u32 v26, 4294901760, v26
v_add_u32 v27, 4294901760, v27
v_mfma_f32_16x16x32_bf16 v[200:203], a[192:195], a[56:59], v[200:203]
v_add_u32 v28, 4294901760, v28
v_add_u32 v29, 4294901760, v29
v_mfma_f32_16x16x32_bf16 v[200:203], a[196:199], a[60:63], v[200:203]
v_add_u32 v30, 4294901760, v30
v_add_u32 v31, 4294901760, v31
v_mfma_f32_16x16x32_bf16 v[248:251], a[192:195], a[64:67], v[248:251]
buffer_load_dwordx4 v35, s[32:35], s45 offen lds
v_mfma_f32_16x16x32_bf16 v[248:251], a[196:199], a[68:71], v[248:251]
s_waitcnt lgkmcnt(8)
v_mfma_f32_16x16x32_bf16 v[108:111], a[200:203], a[40:43], v[108:111]
s_waitcnt vmcnt(36) lgkmcnt(0)
s_barrier
v_mfma_f32_16x16x32_bf16 v[108:111], a[204:207], a[44:47], v[108:111]
ds_read_b64_tr_b16 a[192:193], v26 offset:0
ds_read_b64_tr_b16 a[194:195], v26 offset:1536
v_mfma_f32_16x16x32_bf16 v[156:159], a[200:203], a[48:51], v[156:159]
s_add_u32 s45, s45, 98304
v_add_u32 v18, 192, v1
v_mfma_f32_16x16x32_bf16 v[156:159], a[204:207], a[52:55], v[156:159]
ds_read_b64_tr_b16 a[196:197], v26 offset:12288
ds_read_b64_tr_b16 a[198:199], v26 offset:13824
v_mfma_f32_16x16x32_bf16 v[204:207], a[200:203], a[56:59], v[204:207]
v_mul_u32_u24 v19, 0x199a, v18
v_lshrrev_b32 v19, 16, v19
v_mfma_f32_16x16x32_bf16 v[204:207], a[204:207], a[60:63], v[204:207]
v_mul_u32_u24 v20, 10, v19
v_sub_u32 v20, v18, v20
v_mfma_f32_16x16x32_bf16 v[252:255], a[200:203], a[64:67], v[252:255]
v_mul_u32_u24 v19, 1280, v19
v_lshl_add_u32 v21, v20, 4, v19
v_mfma_f32_16x16x32_bf16 v[252:255], a[204:207], a[68:71], v[252:255]
v_mfma_f32_16x16x32_bf16 a[144:147], a[208:211], a[40:43], a[144:147]
ds_read_b64_tr_b16 a[200:201], v26 offset:8
ds_read_b64_tr_b16 a[202:203], v26 offset:1544
v_mfma_f32_16x16x32_bf16 a[144:147], a[212:215], a[44:47], a[144:147]
buffer_load_dwordx4 a[12:15], v21, s[84:87], s82 offen offset:0
v_mfma_f32_16x16x32_bf16 a[152:155], a[208:211], a[48:51], a[152:155]
ds_read_b64_tr_b16 a[204:205], v26 offset:12296
ds_read_b64_tr_b16 a[206:207], v26 offset:13832
v_mfma_f32_16x16x32_bf16 a[152:155], a[212:215], a[52:55], a[152:155]
buffer_load_dwordx4 a[32:35], v21, s[84:87], s82 offen offset:160
v_mfma_f32_16x16x32_bf16 a[160:163], a[208:211], a[56:59], a[160:163]
v_mfma_f32_16x16x32_bf16 a[160:163], a[212:215], a[60:63], a[160:163]
v_mfma_f32_16x16x32_bf16 a[168:171], a[208:211], a[64:67], a[168:171]
v_mfma_f32_16x16x32_bf16 a[168:171], a[212:215], a[68:71], a[168:171]
v_mfma_f32_16x16x32_bf16 a[148:151], a[216:219], a[40:43], a[148:151]
ds_read_b64_tr_b16 a[208:209], v27 offset:0
ds_read_b64_tr_b16 a[210:211], v27 offset:1536
v_mfma_f32_16x16x32_bf16 a[148:151], a[220:223], a[44:47], a[148:151]
v_mfma_f32_16x16x32_bf16 a[156:159], a[216:219], a[48:51], a[156:159]
ds_read_b64_tr_b16 a[212:213], v27 offset:12288
ds_read_b64_tr_b16 a[214:215], v27 offset:13824
v_mfma_f32_16x16x32_bf16 a[156:159], a[220:223], a[52:55], a[156:159]
v_mfma_f32_16x16x32_bf16 a[164:167], a[216:219], a[56:59], a[164:167]
v_mfma_f32_16x16x32_bf16 a[164:167], a[220:223], a[60:63], a[164:167]
v_mfma_f32_16x16x32_bf16 a[172:175], a[216:219], a[64:67], a[172:175]
v_mfma_f32_16x16x32_bf16 a[172:175], a[220:223], a[68:71], a[172:175]
s_waitcnt vmcnt(28) lgkmcnt(8)
v_mfma_f32_16x16x32_bf16 v[64:67], a[192:195], a[72:75], v[64:67]
ds_read_b64_tr_b16 a[216:217], v27 offset:8
ds_read_b64_tr_b16 a[218:219], v27 offset:1544
v_mfma_f32_16x16x32_bf16 v[64:67], a[196:199], a[76:79], v[64:67]
s_add_u32 s46, s46, 2048
v_mfma_f32_16x16x32_bf16 v[112:115], a[192:195], a[80:83], v[112:115]
ds_read_b64_tr_b16 a[220:221], v27 offset:12296
ds_read_b64_tr_b16 a[222:223], v27 offset:13832
v_mfma_f32_16x16x32_bf16 v[112:115], a[196:199], a[84:87], v[112:115]
buffer_load_dwordx4 a[40:43], v36, s[16:19], s46 offen offset:0 sc0 sc1
v_mfma_f32_16x16x32_bf16 v[160:163], a[192:195], a[88:91], v[160:163]
v_mfma_f32_16x16x32_bf16 v[160:163], a[196:199], a[92:95], v[160:163]
v_mfma_f32_16x16x32_bf16 v[208:211], a[192:195], a[96:99], v[208:211]
buffer_load_dwordx4 a[44:47], v36, s[16:19], s46 offen offset:1024 sc0 sc1
v_mfma_f32_16x16x32_bf16 v[208:211], a[196:199], a[100:103], v[208:211]
s_waitcnt lgkmcnt(8)
v_mfma_f32_16x16x32_bf16 v[68:71], a[200:203], a[72:75], v[68:71]
ds_read_b64_tr_b16 a[192:193], v30 offset:0
ds_read_b64_tr_b16 a[194:195], v30 offset:512
v_mfma_f32_16x16x32_bf16 v[68:71], a[204:207], a[76:79], v[68:71]
v_mfma_f32_16x16x32_bf16 v[116:119], a[200:203], a[80:83], v[116:119]
ds_read_b64_tr_b16 a[196:197], v30 offset:4096
ds_read_b64_tr_b16 a[198:199], v30 offset:4608
v_mfma_f32_16x16x32_bf16 v[116:119], a[204:207], a[84:87], v[116:119]
v_mfma_f32_16x16x32_bf16 v[164:167], a[200:203], a[88:91], v[164:167]
buffer_load_dwordx4 a[48:51], v37, s[16:19], s46 offen offset:0 sc0 sc1
v_mfma_f32_16x16x32_bf16 v[164:167], a[204:207], a[92:95], v[164:167]
v_mfma_f32_16x16x32_bf16 v[212:215], a[200:203], a[96:99], v[212:215]
v_mfma_f32_16x16x32_bf16 v[212:215], a[204:207], a[100:103], v[212:215]
s_waitcnt lgkmcnt(8)
v_mfma_f32_16x16x32_bf16 v[72:75], a[208:211], a[72:75], v[72:75]
ds_read_b64_tr_b16 a[200:201], v26 offset:128
ds_read_b64_tr_b16 a[202:203], v26 offset:1664
v_mfma_f32_16x16x32_bf16 v[72:75], a[212:215], a[76:79], v[72:75]
v_mfma_f32_16x16x32_bf16 v[120:123], a[208:211], a[80:83], v[120:123]
ds_read_b64_tr_b16 a[204:205], v26 offset:12416
ds_read_b64_tr_b16 a[206:207], v26 offset:13952
v_mfma_f32_16x16x32_bf16 v[120:123], a[212:215], a[84:87], v[120:123]
buffer_load_dwordx4 a[52:55], v37, s[16:19], s46 offen offset:1024 sc0 sc1
v_mfma_f32_16x16x32_bf16 v[168:171], a[208:211], a[88:91], v[168:171]
v_mfma_f32_16x16x32_bf16 v[168:171], a[212:215], a[92:95], v[168:171]
v_mfma_f32_16x16x32_bf16 v[216:219], a[208:211], a[96:99], v[216:219]
v_mfma_f32_16x16x32_bf16 v[216:219], a[212:215], a[100:103], v[216:219]
s_waitcnt lgkmcnt(8)
v_mfma_f32_16x16x32_bf16 v[76:79], a[216:219], a[72:75], v[76:79]
ds_read_b64_tr_b16 a[208:209], v26 offset:136
ds_read_b64_tr_b16 a[210:211], v26 offset:1672
v_mfma_f32_16x16x32_bf16 v[76:79], a[220:223], a[76:79], v[76:79]
buffer_load_dwordx4 a[56:59], v38, s[16:19], s46 offen offset:0 sc0 sc1
v_mfma_f32_16x16x32_bf16 v[124:127], a[216:219], a[80:83], v[124:127]
ds_read_b64_tr_b16 a[212:213], v26 offset:12424
ds_read_b64_tr_b16 a[214:215], v26 offset:13960
v_mfma_f32_16x16x32_bf16 v[124:127], a[220:223], a[84:87], v[124:127]
v_mfma_f32_16x16x32_bf16 v[172:175], a[216:219], a[88:91], v[172:175]
v_mfma_f32_16x16x32_bf16 v[172:175], a[220:223], a[92:95], v[172:175]
buffer_load_dwordx4 a[60:63], v38, s[16:19], s46 offen offset:1024 sc0 sc1
v_mfma_f32_16x16x32_bf16 v[220:223], a[216:219], a[96:99], v[220:223]
v_mfma_f32_16x16x32_bf16 v[220:223], a[220:223], a[100:103], v[220:223]
s_waitcnt lgkmcnt(8)
v_mfma_f32_16x16x32_bf16 a[176:179], a[192:195], a[72:75], a[176:179]
ds_read_b64_tr_b16 a[216:217], v27 offset:128
ds_read_b64_tr_b16 a[218:219], v27 offset:1664
v_mfma_f32_16x16x32_bf16 a[176:179], a[196:199], a[76:79], a[176:179]
v_mfma_f32_16x16x32_bf16 a[184:187], a[192:195], a[80:83], a[184:187]
ds_read_b64_tr_b16 a[220:221], v27 offset:12416
ds_read_b64_tr_b16 a[222:223], v27 offset:13952
v_mfma_f32_16x16x32_bf16 a[184:187], a[196:199], a[84:87], a[184:187]
s_waitcnt lgkmcnt(8)
v_mfma_f32_16x16x32_bf16 v[80:83], a[200:203], a[72:75], v[80:83]
ds_read_b64_tr_b16 a[192:193], v27 offset:136
ds_read_b64_tr_b16 a[194:195], v27 offset:1672
v_mfma_f32_16x16x32_bf16 v[80:83], a[204:207], a[76:79], v[80:83]
buffer_load_dwordx4 a[64:67], v39, s[16:19], s46 offen offset:0 sc0 sc1
v_mfma_f32_16x16x32_bf16 v[128:131], a[200:203], a[80:83], v[128:131]
ds_read_b64_tr_b16 a[196:197], v27 offset:12424
ds_read_b64_tr_b16 a[198:199], v27 offset:13960
v_mfma_f32_16x16x32_bf16 v[128:131], a[204:207], a[84:87], v[128:131]
v_mfma_f32_16x16x32_bf16 v[176:179], a[200:203], a[88:91], v[176:179]
v_mfma_f32_16x16x32_bf16 v[176:179], a[204:207], a[92:95], v[176:179]
buffer_load_dwordx4 a[68:71], v39, s[16:19], s46 offen offset:1024 sc0 sc1
v_mfma_f32_16x16x32_bf16 v[224:227], a[200:203], a[96:99], v[224:227]
v_mfma_f32_16x16x32_bf16 v[224:227], a[204:207], a[100:103], v[224:227]
s_waitcnt lgkmcnt(8)
v_mfma_f32_16x16x32_bf16 v[84:87], a[208:211], a[72:75], v[84:87]
ds_read_b64_tr_b16 a[200:201], v26 offset:256
ds_read_b64_tr_b16 a[202:203], v26 offset:1792
v_mfma_f32_16x16x32_bf16 v[84:87], a[212:215], a[76:79], v[84:87]
s_add_u32 m0, s26, 98304
v_mfma_f32_16x16x32_bf16 v[132:135], a[208:211], a[80:83], v[132:135]
ds_read_b64_tr_b16 a[204:205], v26 offset:12544
ds_read_b64_tr_b16 a[206:207], v26 offset:14080
v_mfma_f32_16x16x32_bf16 v[132:135], a[212:215], a[84:87], v[132:135]
buffer_load_dwordx4 v32, s[28:31], s44 offen offset:0 lds
v_mfma_f32_16x16x32_bf16 v[180:183], a[208:211], a[88:91], v[180:183]
v_mfma_f32_16x16x32_bf16 v[180:183], a[212:215], a[92:95], v[180:183]
v_mfma_f32_16x16x32_bf16 v[228:231], a[208:211], a[96:99], v[228:231]
v_mfma_f32_16x16x32_bf16 v[228:231], a[212:215], a[100:103], v[228:231]
s_waitcnt lgkmcnt(8)
v_mfma_f32_16x16x32_bf16 v[88:91], a[216:219], a[72:75], v[88:91]
ds_read_b64_tr_b16 a[208:209], v31 offset:0
ds_read_b64_tr_b16 a[210:211], v31 offset:512
v_mfma_f32_16x16x32_bf16 v[88:91], a[220:223], a[76:79], v[88:91]
buffer_load_dwordx4 v33, s[28:31], s44 offen offset:1024 lds
v_mfma_f32_16x16x32_bf16 v[136:139], a[216:219], a[80:83], v[136:139]
ds_read_b64_tr_b16 a[212:213], v31 offset:4096
ds_read_b64_tr_b16 a[214:215], v31 offset:4608
v_mfma_f32_16x16x32_bf16 v[136:139], a[220:223], a[84:87], v[136:139]
v_mfma_f32_16x16x32_bf16 v[184:187], a[216:219], a[88:91], v[184:187]
v_mfma_f32_16x16x32_bf16 v[184:187], a[220:223], a[92:95], v[184:187]
v_mfma_f32_16x16x32_bf16 v[232:235], a[216:219], a[96:99], v[232:235]
buffer_load_dwordx4 v34, s[28:31], s44 offen offset:2048 lds
v_mfma_f32_16x16x32_bf16 v[232:235], a[220:223], a[100:103], v[232:235]
s_waitcnt lgkmcnt(8)
v_mfma_f32_16x16x32_bf16 v[92:95], a[192:195], a[72:75], v[92:95]
ds_read_b64_tr_b16 a[216:217], v26 offset:264
ds_read_b64_tr_b16 a[218:219], v26 offset:1800
v_mfma_f32_16x16x32_bf16 v[92:95], a[196:199], a[76:79], v[92:95]
v_mfma_f32_16x16x32_bf16 v[140:143], a[192:195], a[80:83], v[140:143]
ds_read_b64_tr_b16 a[220:221], v26 offset:12552
ds_read_b64_tr_b16 a[222:223], v26 offset:14088
v_mfma_f32_16x16x32_bf16 v[140:143], a[196:199], a[84:87], v[140:143]
s_add_u32 s44, s44, 393216
s_add_u32 m0, s26, 110592
v_mfma_f32_16x16x32_bf16 v[188:191], a[192:195], a[88:91], v[188:191]
buffer_load_dwordx4 v32, s[28:31], s44 offen offset:0 lds
v_mfma_f32_16x16x32_bf16 v[188:191], a[196:199], a[92:95], v[188:191]
v_mfma_f32_16x16x32_bf16 v[236:239], a[192:195], a[96:99], v[236:239]
v_mfma_f32_16x16x32_bf16 v[236:239], a[196:199], a[100:103], v[236:239]
s_waitcnt lgkmcnt(8)
v_mfma_f32_16x16x32_bf16 v[96:99], a[200:203], a[72:75], v[96:99]
ds_read_b64_tr_b16 a[192:193], v27 offset:256
ds_read_b64_tr_b16 a[194:195], v27 offset:1792
v_mfma_f32_16x16x32_bf16 v[96:99], a[204:207], a[76:79], v[96:99]
buffer_load_dwordx4 v33, s[28:31], s44 offen offset:1024 lds
v_mfma_f32_16x16x32_bf16 v[144:147], a[200:203], a[80:83], v[144:147]
ds_read_b64_tr_b16 a[196:197], v27 offset:12544
ds_read_b64_tr_b16 a[198:199], v27 offset:14080
v_mfma_f32_16x16x32_bf16 v[144:147], a[204:207], a[84:87], v[144:147]
v_mfma_f32_16x16x32_bf16 v[192:195], a[200:203], a[88:91], v[192:195]
v_mfma_f32_16x16x32_bf16 v[192:195], a[204:207], a[92:95], v[192:195]
v_mfma_f32_16x16x32_bf16 v[240:243], a[200:203], a[96:99], v[240:243]
v_mfma_f32_16x16x32_bf16 v[240:243], a[204:207], a[100:103], v[240:243]
s_waitcnt lgkmcnt(8)
v_mfma_f32_16x16x32_bf16 a[180:183], a[208:211], a[72:75], a[180:183]
ds_read_b64_tr_b16 a[200:201], v27 offset:264
ds_read_b64_tr_b16 a[202:203], v27 offset:1800
v_mfma_f32_16x16x32_bf16 a[180:183], a[212:215], a[76:79], a[180:183]
buffer_load_dwordx4 v34, s[28:31], s44 offen offset:2048 lds
v_mfma_f32_16x16x32_bf16 a[188:191], a[208:211], a[80:83], a[188:191]
ds_read_b64_tr_b16 a[204:205], v27 offset:12552
ds_read_b64_tr_b16 a[206:207], v27 offset:14088
v_mfma_f32_16x16x32_bf16 a[188:191], a[212:215], a[84:87], a[188:191]
s_waitcnt lgkmcnt(8)
v_mfma_f32_16x16x32_bf16 v[100:103], a[216:219], a[72:75], v[100:103]
ds_read_b64_tr_b16 a[208:209], v28 offset:0
ds_read_b64_tr_b16 a[210:211], v28 offset:512
v_mfma_f32_16x16x32_bf16 v[100:103], a[220:223], a[76:79], v[100:103]
s_add_u32 s44, s44, 393216
s_add_u32 m0, s50, 98304
v_mfma_f32_16x16x32_bf16 v[148:151], a[216:219], a[80:83], v[148:151]
ds_read_b64_tr_b16 a[212:213], v28 offset:4096
ds_read_b64_tr_b16 a[214:215], v28 offset:4608
v_mfma_f32_16x16x32_bf16 v[148:151], a[220:223], a[84:87], v[148:151]
buffer_load_dwordx4 v35, s[32:35], s45 offen lds
v_mfma_f32_16x16x32_bf16 v[196:199], a[216:219], a[88:91], v[196:199]
v_mfma_f32_16x16x32_bf16 v[196:199], a[220:223], a[92:95], v[196:199]
s_add_u32 s45, s45, 98304
s_add_u32 m0, s50, 102400
v_mfma_f32_16x16x32_bf16 v[244:247], a[216:219], a[96:99], v[244:247]
v_mfma_f32_16x16x32_bf16 v[244:247], a[220:223], a[100:103], v[244:247]
s_waitcnt lgkmcnt(8)
v_mfma_f32_16x16x32_bf16 v[104:107], a[192:195], a[72:75], v[104:107]
ds_read_b64_tr_b16 a[216:217], v29 offset:0
ds_read_b64_tr_b16 a[218:219], v29 offset:512
v_mfma_f32_16x16x32_bf16 v[104:107], a[196:199], a[76:79], v[104:107]
buffer_load_dwordx4 v35, s[32:35], s45 offen lds
v_mfma_f32_16x16x32_bf16 v[152:155], a[192:195], a[80:83], v[152:155]
ds_read_b64_tr_b16 a[220:221], v29 offset:4096
ds_read_b64_tr_b16 a[222:223], v29 offset:4608
v_mfma_f32_16x16x32_bf16 v[152:155], a[196:199], a[84:87], v[152:155]
s_add_u32 s45, s45, 98304
v_add_u32 v18, 256, v1
v_mfma_f32_16x16x32_bf16 v[200:203], a[192:195], a[88:91], v[200:203]
v_mul_u32_u24 v19, 0x199a, v18
v_lshrrev_b32 v19, 16, v19
v_mfma_f32_16x16x32_bf16 v[200:203], a[196:199], a[92:95], v[200:203]
v_mul_u32_u24 v20, 10, v19
v_sub_u32 v20, v18, v20
v_mfma_f32_16x16x32_bf16 v[248:251], a[192:195], a[96:99], v[248:251]
v_mul_u32_u24 v19, 1280, v19
v_lshl_add_u32 v21, v20, 4, v19
v_mfma_f32_16x16x32_bf16 v[248:251], a[196:199], a[100:103], v[248:251]
s_waitcnt lgkmcnt(8)
v_mfma_f32_16x16x32_bf16 v[108:111], a[200:203], a[72:75], v[108:111]
s_waitcnt vmcnt(36) lgkmcnt(0)
s_barrier
v_mfma_f32_16x16x32_bf16 v[108:111], a[204:207], a[76:79], v[108:111]
ds_read_b64_tr_b16 a[192:193], v26 offset:32768
ds_read_b64_tr_b16 a[194:195], v26 offset:34304
v_mfma_f32_16x16x32_bf16 v[156:159], a[200:203], a[80:83], v[156:159]
buffer_load_dwordx4 a[16:19], v21, s[84:87], s82 offen offset:0
v_mfma_f32_16x16x32_bf16 v[156:159], a[204:207], a[84:87], v[156:159]
ds_read_b64_tr_b16 a[196:197], v26 offset:45056
ds_read_b64_tr_b16 a[198:199], v26 offset:46592
v_mfma_f32_16x16x32_bf16 v[204:207], a[200:203], a[88:91], v[204:207]
buffer_load_dwordx4 a[36:39], v21, s[84:87], s82 offen offset:160
v_mfma_f32_16x16x32_bf16 v[204:207], a[204:207], a[92:95], v[204:207]
s_mul_i32 s38, s25, 2457600
s_mul_i32 s39, s2, 5120
v_mfma_f32_16x16x32_bf16 v[252:255], a[200:203], a[96:99], v[252:255]
s_add_u32 s38, s38, s39
s_add_u32 s38, s38, 41943040
v_mfma_f32_16x16x32_bf16 v[252:255], a[204:207], a[100:103], v[252:255]
v_mfma_f32_16x16x32_bf16 a[144:147], a[208:211], a[72:75], a[144:147]
ds_read_b64_tr_b16 a[200:201], v26 offset:32776
ds_read_b64_tr_b16 a[202:203], v26 offset:34312
v_mfma_f32_16x16x32_bf16 a[144:147], a[212:215], a[76:79], a[144:147]
s_cmp_lt_u32 s2, 240
s_cselect_b32 s38, s38, 0x7f000000
v_mfma_f32_16x16x32_bf16 a[152:155], a[208:211], a[80:83], a[152:155]
ds_read_b64_tr_b16 a[204:205], v26 offset:45064
ds_read_b64_tr_b16 a[206:207], v26 offset:46600
v_mfma_f32_16x16x32_bf16 a[152:155], a[212:215], a[84:87], a[152:155]
s_add_u32 s39, s38, 1228800
v_lshlrev_b32 v24, 4, v1
v_mfma_f32_16x16x32_bf16 a[160:163], a[208:211], a[88:91], a[160:163]
v_add_u32 v23, 4096, v24
v_mfma_f32_16x16x32_bf16 a[160:163], a[212:215], a[92:95], a[160:163]
v_mfma_f32_16x16x32_bf16 a[168:171], a[208:211], a[96:99], a[168:171]
v_mfma_f32_16x16x32_bf16 a[168:171], a[212:215], a[100:103], a[168:171]
v_mfma_f32_16x16x32_bf16 a[148:151], a[216:219], a[72:75], a[148:151]
ds_read_b64_tr_b16 a[208:209], v27 offset:32768
ds_read_b64_tr_b16 a[210:211], v27 offset:34304
v_mfma_f32_16x16x32_bf16 a[148:151], a[220:223], a[76:79], a[148:151]
v_mfma_f32_16x16x32_bf16 a[156:159], a[216:219], a[80:83], a[156:159]
ds_read_b64_tr_b16 a[212:213], v27 offset:45056
ds_read_b64_tr_b16 a[214:215], v27 offset:46592
v_mfma_f32_16x16x32_bf16 a[156:159], a[220:223], a[84:87], a[156:159]
v_mfma_f32_16x16x32_bf16 a[164:167], a[216:219], a[88:91], a[164:167]
v_mfma_f32_16x16x32_bf16 a[164:167], a[220:223], a[92:95], a[164:167]
v_mfma_f32_16x16x32_bf16 a[172:175], a[216:219], a[96:99], a[172:175]
v_mfma_f32_16x16x32_bf16 a[172:175], a[220:223], a[100:103], a[172:175]
s_waitcnt vmcnt(28) lgkmcnt(8)
v_mfma_f32_16x16x32_bf16 v[64:67], a[192:195], a[104:107], v[64:67]
ds_read_b64_tr_b16 a[216:217], v27 offset:32776
ds_read_b64_tr_b16 a[218:219], v27 offset:34312
v_mfma_f32_16x16x32_bf16 v[64:67], a[196:199], a[108:111], v[64:67]
s_add_u32 s46, s46, 2048
v_mfma_f32_16x16x32_bf16 v[112:115], a[192:195], a[112:115], v[112:115]
ds_read_b64_tr_b16 a[220:221], v27 offset:45064
ds_read_b64_tr_b16 a[222:223], v27 offset:46600
v_mfma_f32_16x16x32_bf16 v[112:115], a[196:199], a[116:119], v[112:115]
buffer_load_dwordx4 a[72:75], v36, s[16:19], s46 offen offset:0 sc0 sc1
v_mfma_f32_16x16x32_bf16 v[160:163], a[192:195], a[120:123], v[160:163]
v_mfma_f32_16x16x32_bf16 v[160:163], a[196:199], a[124:127], v[160:163]
v_mfma_f32_16x16x32_bf16 v[208:211], a[192:195], a[128:131], v[208:211]
buffer_load_dwordx4 a[76:79], v36, s[16:19], s46 offen offset:1024 sc0 sc1
v_mfma_f32_16x16x32_bf16 v[208:211], a[196:199], a[132:135], v[208:211]
s_waitcnt lgkmcnt(8)
v_mfma_f32_16x16x32_bf16 v[68:71], a[200:203], a[104:107], v[68:71]
ds_read_b64_tr_b16 a[192:193], v30 offset:32768
ds_read_b64_tr_b16 a[194:195], v30 offset:33280
v_mfma_f32_16x16x32_bf16 v[68:71], a[204:207], a[108:111], v[68:71]
v_mfma_f32_16x16x32_bf16 v[116:119], a[200:203], a[112:115], v[116:119]
ds_read_b64_tr_b16 a[196:197], v30 offset:36864
ds_read_b64_tr_b16 a[198:199], v30 offset:37376
v_mfma_f32_16x16x32_bf16 v[116:119], a[204:207], a[116:119], v[116:119]
v_mfma_f32_16x16x32_bf16 v[164:167], a[200:203], a[120:123], v[164:167]
buffer_load_dwordx4 a[80:83], v37, s[16:19], s46 offen offset:0 sc0 sc1
v_mfma_f32_16x16x32_bf16 v[164:167], a[204:207], a[124:127], v[164:167]
v_mfma_f32_16x16x32_bf16 v[212:215], a[200:203], a[128:131], v[212:215]
v_mfma_f32_16x16x32_bf16 v[212:215], a[204:207], a[132:135], v[212:215]
s_waitcnt lgkmcnt(8)
v_mfma_f32_16x16x32_bf16 v[72:75], a[208:211], a[104:107], v[72:75]
ds_read_b64_tr_b16 a[200:201], v26 offset:32896
ds_read_b64_tr_b16 a[202:203], v26 offset:34432
v_mfma_f32_16x16x32_bf16 v[72:75], a[212:215], a[108:111], v[72:75]
v_mfma_f32_16x16x32_bf16 v[120:123], a[208:211], a[112:115], v[120:123]
ds_read_b64_tr_b16 a[204:205], v26 offset:45184
ds_read_b64_tr_b16 a[206:207], v26 offset:46720
v_mfma_f32_16x16x32_bf16 v[120:123], a[212:215], a[116:119], v[120:123]
buffer_load_dwordx4 a[84:87], v37, s[16:19], s46 offen offset:1024 sc0 sc1
v_mfma_f32_16x16x32_bf16 v[168:171], a[208:211], a[120:123], v[168:171]
v_mfma_f32_16x16x32_bf16 v[168:171], a[212:215], a[124:127], v[168:171]
v_mfma_f32_16x16x32_bf16 v[216:219], a[208:211], a[128:131], v[216:219]
v_mfma_f32_16x16x32_bf16 v[216:219], a[212:215], a[132:135], v[216:219]
s_waitcnt lgkmcnt(8)
v_mfma_f32_16x16x32_bf16 v[76:79], a[216:219], a[104:107], v[76:79]
ds_read_b64_tr_b16 a[208:209], v26 offset:32904
ds_read_b64_tr_b16 a[210:211], v26 offset:34440
v_mfma_f32_16x16x32_bf16 v[76:79], a[220:223], a[108:111], v[76:79]
buffer_load_dwordx4 a[88:91], v38, s[16:19], s46 offen offset:0 sc0 sc1
v_mfma_f32_16x16x32_bf16 v[124:127], a[216:219], a[112:115], v[124:127]
ds_read_b64_tr_b16 a[212:213], v26 offset:45192
ds_read_b64_tr_b16 a[214:215], v26 offset:46728
v_mfma_f32_16x16x32_bf16 v[124:127], a[220:223], a[116:119], v[124:127]
v_mfma_f32_16x16x32_bf16 v[172:175], a[216:219], a[120:123], v[172:175]
v_mfma_f32_16x16x32_bf16 v[172:175], a[220:223], a[124:127], v[172:175]
buffer_load_dwordx4 a[92:95], v38, s[16:19], s46 offen offset:1024 sc0 sc1
v_mfma_f32_16x16x32_bf16 v[220:223], a[216:219], a[128:131], v[220:223]
v_mfma_f32_16x16x32_bf16 v[220:223], a[220:223], a[132:135], v[220:223]
s_waitcnt lgkmcnt(8)
v_mfma_f32_16x16x32_bf16 a[176:179], a[192:195], a[104:107], a[176:179]
ds_read_b64_tr_b16 a[216:217], v27 offset:32896
ds_read_b64_tr_b16 a[218:219], v27 offset:34432
v_mfma_f32_16x16x32_bf16 a[176:179], a[196:199], a[108:111], a[176:179]
v_mfma_f32_16x16x32_bf16 a[184:187], a[192:195], a[112:115], a[184:187]
ds_read_b64_tr_b16 a[220:221], v27 offset:45184
ds_read_b64_tr_b16 a[222:223], v27 offset:46720
v_mfma_f32_16x16x32_bf16 a[184:187], a[196:199], a[116:119], a[184:187]
s_waitcnt lgkmcnt(8)
v_mfma_f32_16x16x32_bf16 v[80:83], a[200:203], a[104:107], v[80:83]
ds_read_b64_tr_b16 a[192:193], v27 offset:32904
ds_read_b64_tr_b16 a[194:195], v27 offset:34440
v_mfma_f32_16x16x32_bf16 v[80:83], a[204:207], a[108:111], v[80:83]
buffer_load_dwordx4 a[96:99], v39, s[16:19], s46 offen offset:0 sc0 sc1
v_mfma_f32_16x16x32_bf16 v[128:131], a[200:203], a[112:115], v[128:131]
ds_read_b64_tr_b16 a[196:197], v27 offset:45192
ds_read_b64_tr_b16 a[198:199], v27 offset:46728
v_mfma_f32_16x16x32_bf16 v[128:131], a[204:207], a[116:119], v[128:131]
v_mfma_f32_16x16x32_bf16 v[176:179], a[200:203], a[120:123], v[176:179]
v_mfma_f32_16x16x32_bf16 v[176:179], a[204:207], a[124:127], v[176:179]
buffer_load_dwordx4 a[100:103], v39, s[16:19], s46 offen offset:1024 sc0 sc1
v_mfma_f32_16x16x32_bf16 v[224:227], a[200:203], a[128:131], v[224:227]
v_mfma_f32_16x16x32_bf16 v[224:227], a[204:207], a[132:135], v[224:227]
s_waitcnt lgkmcnt(8)
v_mfma_f32_16x16x32_bf16 v[84:87], a[208:211], a[104:107], v[84:87]
ds_read_b64_tr_b16 a[200:201], v26 offset:33024
ds_read_b64_tr_b16 a[202:203], v26 offset:34560
v_mfma_f32_16x16x32_bf16 v[84:87], a[212:215], a[108:111], v[84:87]
s_add_u32 m0, s26, 0
v_mfma_f32_16x16x32_bf16 v[132:135], a[208:211], a[112:115], v[132:135]
ds_read_b64_tr_b16 a[204:205], v26 offset:45312
ds_read_b64_tr_b16 a[206:207], v26 offset:46848
v_mfma_f32_16x16x32_bf16 v[132:135], a[212:215], a[116:119], v[132:135]
buffer_load_dwordx4 v32, s[28:31], s44 offen offset:0 lds
v_mfma_f32_16x16x32_bf16 v[180:183], a[208:211], a[120:123], v[180:183]
v_mfma_f32_16x16x32_bf16 v[180:183], a[212:215], a[124:127], v[180:183]
v_mfma_f32_16x16x32_bf16 v[228:231], a[208:211], a[128:131], v[228:231]
v_mfma_f32_16x16x32_bf16 v[228:231], a[212:215], a[132:135], v[228:231]
s_waitcnt lgkmcnt(8)
v_mfma_f32_16x16x32_bf16 v[88:91], a[216:219], a[104:107], v[88:91]
ds_read_b64_tr_b16 a[208:209], v31 offset:32768
ds_read_b64_tr_b16 a[210:211], v31 offset:33280
v_mfma_f32_16x16x32_bf16 v[88:91], a[220:223], a[108:111], v[88:91]
buffer_load_dwordx4 v33, s[28:31], s44 offen offset:1024 lds
v_mfma_f32_16x16x32_bf16 v[136:139], a[216:219], a[112:115], v[136:139]
ds_read_b64_tr_b16 a[212:213], v31 offset:36864
ds_read_b64_tr_b16 a[214:215], v31 offset:37376
v_mfma_f32_16x16x32_bf16 v[136:139], a[220:223], a[116:119], v[136:139]
v_mfma_f32_16x16x32_bf16 v[184:187], a[216:219], a[120:123], v[184:187]
v_mfma_f32_16x16x32_bf16 v[184:187], a[220:223], a[124:127], v[184:187]
v_mfma_f32_16x16x32_bf16 v[232:235], a[216:219], a[128:131], v[232:235]
buffer_load_dwordx4 v34, s[28:31], s44 offen offset:2048 lds
v_mfma_f32_16x16x32_bf16 v[232:235], a[220:223], a[132:135], v[232:235]
s_waitcnt lgkmcnt(8)
v_mfma_f32_16x16x32_bf16 v[92:95], a[192:195], a[104:107], v[92:95]
ds_read_b64_tr_b16 a[216:217], v26 offset:33032
ds_read_b64_tr_b16 a[218:219], v26 offset:34568
v_mfma_f32_16x16x32_bf16 v[92:95], a[196:199], a[108:111], v[92:95]
v_mfma_f32_16x16x32_bf16 v[140:143], a[192:195], a[112:115], v[140:143]
ds_read_b64_tr_b16 a[220:221], v26 offset:45320
ds_read_b64_tr_b16 a[222:223], v26 offset:46856
v_mfma_f32_16x16x32_bf16 v[140:143], a[196:199], a[116:119], v[140:143]
s_add_u32 s44, s44, 393216
s_add_u32 m0, s26, 12288
v_mfma_f32_16x16x32_bf16 v[188:191], a[192:195], a[120:123], v[188:191]
buffer_load_dwordx4 v32, s[28:31], s44 offen offset:0 lds
v_mfma_f32_16x16x32_bf16 v[188:191], a[196:199], a[124:127], v[188:191]
v_mfma_f32_16x16x32_bf16 v[236:239], a[192:195], a[128:131], v[236:239]
v_mfma_f32_16x16x32_bf16 v[236:239], a[196:199], a[132:135], v[236:239]
s_waitcnt lgkmcnt(8)
v_mfma_f32_16x16x32_bf16 v[96:99], a[200:203], a[104:107], v[96:99]
ds_read_b64_tr_b16 a[192:193], v27 offset:33024
ds_read_b64_tr_b16 a[194:195], v27 offset:34560
v_mfma_f32_16x16x32_bf16 v[96:99], a[204:207], a[108:111], v[96:99]
buffer_load_dwordx4 v33, s[28:31], s44 offen offset:1024 lds
v_mfma_f32_16x16x32_bf16 v[144:147], a[200:203], a[112:115], v[144:147]
ds_read_b64_tr_b16 a[196:197], v27 offset:45312
ds_read_b64_tr_b16 a[198:199], v27 offset:46848
v_mfma_f32_16x16x32_bf16 v[144:147], a[204:207], a[116:119], v[144:147]
v_mfma_f32_16x16x32_bf16 v[192:195], a[200:203], a[120:123], v[192:195]
v_mfma_f32_16x16x32_bf16 v[192:195], a[204:207], a[124:127], v[192:195]
v_mfma_f32_16x16x32_bf16 v[240:243], a[200:203], a[128:131], v[240:243]
v_mfma_f32_16x16x32_bf16 v[240:243], a[204:207], a[132:135], v[240:243]
s_waitcnt lgkmcnt(8)
v_mfma_f32_16x16x32_bf16 a[180:183], a[208:211], a[104:107], a[180:183]
ds_read_b64_tr_b16 a[200:201], v27 offset:33032
ds_read_b64_tr_b16 a[202:203], v27 offset:34568
v_mfma_f32_16x16x32_bf16 a[180:183], a[212:215], a[108:111], a[180:183]
buffer_load_dwordx4 v34, s[28:31], s44 offen offset:2048 lds
v_mfma_f32_16x16x32_bf16 a[188:191], a[208:211], a[112:115], a[188:191]
ds_read_b64_tr_b16 a[204:205], v27 offset:45320
ds_read_b64_tr_b16 a[206:207], v27 offset:46856
v_mfma_f32_16x16x32_bf16 a[188:191], a[212:215], a[116:119], a[188:191]
s_waitcnt lgkmcnt(8)
v_mfma_f32_16x16x32_bf16 v[100:103], a[216:219], a[104:107], v[100:103]
ds_read_b64_tr_b16 a[208:209], v28 offset:32768
ds_read_b64_tr_b16 a[210:211], v28 offset:33280
v_mfma_f32_16x16x32_bf16 v[100:103], a[220:223], a[108:111], v[100:103]
s_add_u32 s44, s44, 393216
s_add_u32 m0, s50, 0
v_mfma_f32_16x16x32_bf16 v[148:151], a[216:219], a[112:115], v[148:151]
ds_read_b64_tr_b16 a[212:213], v28 offset:36864
ds_read_b64_tr_b16 a[214:215], v28 offset:37376
v_mfma_f32_16x16x32_bf16 v[148:151], a[220:223], a[116:119], v[148:151]
buffer_load_dwordx4 v35, s[32:35], s45 offen lds
v_mfma_f32_16x16x32_bf16 v[196:199], a[216:219], a[120:123], v[196:199]
v_mfma_f32_16x16x32_bf16 v[196:199], a[220:223], a[124:127], v[196:199]
s_add_u32 s45, s45, 98304
s_add_u32 m0, s50, 4096
v_mfma_f32_16x16x32_bf16 v[244:247], a[216:219], a[128:131], v[244:247]
v_mfma_f32_16x16x32_bf16 v[244:247], a[220:223], a[132:135], v[244:247]
s_waitcnt lgkmcnt(8)
v_mfma_f32_16x16x32_bf16 v[104:107], a[192:195], a[104:107], v[104:107]
ds_read_b64_tr_b16 a[216:217], v29 offset:32768
ds_read_b64_tr_b16 a[218:219], v29 offset:33280
v_mfma_f32_16x16x32_bf16 v[104:107], a[196:199], a[108:111], v[104:107]
buffer_load_dwordx4 v35, s[32:35], s45 offen lds
v_mfma_f32_16x16x32_bf16 v[152:155], a[192:195], a[112:115], v[152:155]
ds_read_b64_tr_b16 a[220:221], v29 offset:36864
ds_read_b64_tr_b16 a[222:223], v29 offset:37376
v_mfma_f32_16x16x32_bf16 v[152:155], a[196:199], a[116:119], v[152:155]
v_add_u32 v26, 65536, v26
v_add_u32 v27, 65536, v27
v_mfma_f32_16x16x32_bf16 v[200:203], a[192:195], a[120:123], v[200:203]
v_add_u32 v28, 65536, v28
v_add_u32 v29, 65536, v29
v_mfma_f32_16x16x32_bf16 v[200:203], a[196:199], a[124:127], v[200:203]
v_add_u32 v30, 65536, v30
v_add_u32 v31, 65536, v31
v_mfma_f32_16x16x32_bf16 v[248:251], a[192:195], a[128:131], v[248:251]
s_add_u32 s45, s45, 98304
v_mfma_f32_16x16x32_bf16 v[248:251], a[196:199], a[132:135], v[248:251]
s_waitcnt lgkmcnt(8)
v_mfma_f32_16x16x32_bf16 v[108:111], a[200:203], a[104:107], v[108:111]
s_waitcnt vmcnt(36) lgkmcnt(0)
s_barrier
v_mfma_f32_16x16x32_bf16 v[108:111], a[204:207], a[108:111], v[108:111]
ds_read_b64_tr_b16 a[192:193], v26 offset:0
ds_read_b64_tr_b16 a[194:195], v26 offset:1536
v_mfma_f32_16x16x32_bf16 v[156:159], a[200:203], a[112:115], v[156:159]
buffer_store_dwordx4 a[0:3], v24, s[40:43], s38 offen offset:0 sc0 sc1
v_mfma_f32_16x16x32_bf16 v[156:159], a[204:207], a[116:119], v[156:159]
ds_read_b64_tr_b16 a[196:197], v26 offset:12288
ds_read_b64_tr_b16 a[198:199], v26 offset:13824
v_mfma_f32_16x16x32_bf16 v[204:207], a[200:203], a[120:123], v[204:207]
v_mfma_f32_16x16x32_bf16 v[204:207], a[204:207], a[124:127], v[204:207]
buffer_store_dwordx4 a[20:23], v24, s[40:43], s39 offen offset:0 sc0 sc1
v_mfma_f32_16x16x32_bf16 v[252:255], a[200:203], a[128:131], v[252:255]
v_mfma_f32_16x16x32_bf16 v[252:255], a[204:207], a[132:135], v[252:255]
v_mfma_f32_16x16x32_bf16 a[144:147], a[208:211], a[104:107], a[144:147]
ds_read_b64_tr_b16 a[200:201], v26 offset:8
ds_read_b64_tr_b16 a[202:203], v26 offset:1544
v_mfma_f32_16x16x32_bf16 a[144:147], a[212:215], a[108:111], a[144:147]
buffer_store_dwordx4 a[4:7], v24, s[40:43], s38 offen offset:1024 sc0 sc1
v_mfma_f32_16x16x32_bf16 a[152:155], a[208:211], a[112:115], a[152:155]
ds_read_b64_tr_b16 a[204:205], v26 offset:12296
ds_read_b64_tr_b16 a[206:207], v26 offset:13832
v_mfma_f32_16x16x32_bf16 a[152:155], a[212:215], a[116:119], a[152:155]
v_mfma_f32_16x16x32_bf16 a[160:163], a[208:211], a[120:123], a[160:163]
v_mfma_f32_16x16x32_bf16 a[160:163], a[212:215], a[124:127], a[160:163]
v_mfma_f32_16x16x32_bf16 a[168:171], a[208:211], a[128:131], a[168:171]
v_mfma_f32_16x16x32_bf16 a[168:171], a[212:215], a[132:135], a[168:171]
v_mfma_f32_16x16x32_bf16 a[148:151], a[216:219], a[104:107], a[148:151]
ds_read_b64_tr_b16 a[208:209], v27 offset:0
ds_read_b64_tr_b16 a[210:211], v27 offset:1536
v_mfma_f32_16x16x32_bf16 a[148:151], a[220:223], a[108:111], a[148:151]
v_mfma_f32_16x16x32_bf16 a[156:159], a[216:219], a[112:115], a[156:159]
ds_read_b64_tr_b16 a[212:213], v27 offset:12288
ds_read_b64_tr_b16 a[214:215], v27 offset:13824
v_mfma_f32_16x16x32_bf16 a[156:159], a[220:223], a[116:119], a[156:159]
v_mfma_f32_16x16x32_bf16 a[164:167], a[216:219], a[120:123], a[164:167]
v_mfma_f32_16x16x32_bf16 a[164:167], a[220:223], a[124:127], a[164:167]
v_mfma_f32_16x16x32_bf16 a[172:175], a[216:219], a[128:131], a[172:175]
v_mfma_f32_16x16x32_bf16 a[172:175], a[220:223], a[132:135], a[172:175]
s_waitcnt vmcnt(29) lgkmcnt(8)
v_mfma_f32_16x16x32_bf16 v[64:67], a[192:195], a[40:43], v[64:67]
ds_read_b64_tr_b16 a[216:217], v27 offset:8
ds_read_b64_tr_b16 a[218:219], v27 offset:1544
v_mfma_f32_16x16x32_bf16 v[64:67], a[196:199], a[44:47], v[64:67]
s_add_u32 s46, s46, 2048
v_mfma_f32_16x16x32_bf16 v[112:115], a[192:195], a[48:51], v[112:115]
ds_read_b64_tr_b16 a[220:221], v27 offset:12296
ds_read_b64_tr_b16 a[222:223], v27 offset:13832
v_mfma_f32_16x16x32_bf16 v[112:115], a[196:199], a[52:55], v[112:115]
buffer_load_dwordx4 a[104:107], v36, s[16:19], s46 offen offset:0 sc0 sc1
v_mfma_f32_16x16x32_bf16 v[160:163], a[192:195], a[56:59], v[160:163]
v_mfma_f32_16x16x32_bf16 v[160:163], a[196:199], a[60:63], v[160:163]
v_mfma_f32_16x16x32_bf16 v[208:211], a[192:195], a[64:67], v[208:211]
buffer_load_dwordx4 a[108:111], v36, s[16:19], s46 offen offset:1024 sc0 sc1
v_mfma_f32_16x16x32_bf16 v[208:211], a[196:199], a[68:71], v[208:211]
s_waitcnt lgkmcnt(8)
v_mfma_f32_16x16x32_bf16 v[68:71], a[200:203], a[40:43], v[68:71]
ds_read_b64_tr_b16 a[192:193], v30 offset:0
ds_read_b64_tr_b16 a[194:195], v30 offset:512
v_mfma_f32_16x16x32_bf16 v[68:71], a[204:207], a[44:47], v[68:71]
v_mfma_f32_16x16x32_bf16 v[116:119], a[200:203], a[48:51], v[116:119]
ds_read_b64_tr_b16 a[196:197], v30 offset:4096
ds_read_b64_tr_b16 a[198:199], v30 offset:4608
v_mfma_f32_16x16x32_bf16 v[116:119], a[204:207], a[52:55], v[116:119]
v_mfma_f32_16x16x32_bf16 v[164:167], a[200:203], a[56:59], v[164:167]
buffer_load_dwordx4 a[112:115], v37, s[16:19], s46 offen offset:0 sc0 sc1
v_mfma_f32_16x16x32_bf16 v[164:167], a[204:207], a[60:63], v[164:167]
v_mfma_f32_16x16x32_bf16 v[212:215], a[200:203], a[64:67], v[212:215]
v_mfma_f32_16x16x32_bf16 v[212:215], a[204:207], a[68:71], v[212:215]
s_waitcnt lgkmcnt(8)
v_mfma_f32_16x16x32_bf16 v[72:75], a[208:211], a[40:43], v[72:75]
ds_read_b64_tr_b16 a[200:201], v26 offset:128
ds_read_b64_tr_b16 a[202:203], v26 offset:1664
v_mfma_f32_16x16x32_bf16 v[72:75], a[212:215], a[44:47], v[72:75]
v_mfma_f32_16x16x32_bf16 v[120:123], a[208:211], a[48:51], v[120:123]
ds_read_b64_tr_b16 a[204:205], v26 offset:12416
ds_read_b64_tr_b16 a[206:207], v26 offset:13952
v_mfma_f32_16x16x32_bf16 v[120:123], a[212:215], a[52:55], v[120:123]
buffer_load_dwordx4 a[116:119], v37, s[16:19], s46 offen offset:1024 sc0 sc1
v_mfma_f32_16x16x32_bf16 v[168:171], a[208:211], a[56:59], v[168:171]
v_mfma_f32_16x16x32_bf16 v[168:171], a[212:215], a[60:63], v[168:171]
v_mfma_f32_16x16x32_bf16 v[216:219], a[208:211], a[64:67], v[216:219]
v_mfma_f32_16x16x32_bf16 v[216:219], a[212:215], a[68:71], v[216:219]
s_waitcnt lgkmcnt(8)
v_mfma_f32_16x16x32_bf16 v[76:79], a[216:219], a[40:43], v[76:79]
ds_read_b64_tr_b16 a[208:209], v26 offset:136
ds_read_b64_tr_b16 a[210:211], v26 offset:1672
v_mfma_f32_16x16x32_bf16 v[76:79], a[220:223], a[44:47], v[76:79]
buffer_load_dwordx4 a[120:123], v38, s[16:19], s46 offen offset:0 sc0 sc1
v_mfma_f32_16x16x32_bf16 v[124:127], a[216:219], a[48:51], v[124:127]
ds_read_b64_tr_b16 a[212:213], v26 offset:12424
ds_read_b64_tr_b16 a[214:215], v26 offset:13960
v_mfma_f32_16x16x32_bf16 v[124:127], a[220:223], a[52:55], v[124:127]
v_mfma_f32_16x16x32_bf16 v[172:175], a[216:219], a[56:59], v[172:175]
v_mfma_f32_16x16x32_bf16 v[172:175], a[220:223], a[60:63], v[172:175]
buffer_load_dwordx4 a[124:127], v38, s[16:19], s46 offen offset:1024 sc0 sc1
v_mfma_f32_16x16x32_bf16 v[220:223], a[216:219], a[64:67], v[220:223]
v_mfma_f32_16x16x32_bf16 v[220:223], a[220:223], a[68:71], v[220:223]
s_waitcnt lgkmcnt(8)
v_mfma_f32_16x16x32_bf16 a[176:179], a[192:195], a[40:43], a[176:179]
ds_read_b64_tr_b16 a[216:217], v27 offset:128
ds_read_b64_tr_b16 a[218:219], v27 offset:1664
v_mfma_f32_16x16x32_bf16 a[176:179], a[196:199], a[44:47], a[176:179]
v_mfma_f32_16x16x32_bf16 a[184:187], a[192:195], a[48:51], a[184:187]
ds_read_b64_tr_b16 a[220:221], v27 offset:12416
ds_read_b64_tr_b16 a[222:223], v27 offset:13952
v_mfma_f32_16x16x32_bf16 a[184:187], a[196:199], a[52:55], a[184:187]
s_waitcnt lgkmcnt(8)
v_mfma_f32_16x16x32_bf16 v[80:83], a[200:203], a[40:43], v[80:83]
ds_read_b64_tr_b16 a[192:193], v27 offset:136
ds_read_b64_tr_b16 a[194:195], v27 offset:1672
v_mfma_f32_16x16x32_bf16 v[80:83], a[204:207], a[44:47], v[80:83]
buffer_load_dwordx4 a[128:131], v39, s[16:19], s46 offen offset:0 sc0 sc1
v_mfma_f32_16x16x32_bf16 v[128:131], a[200:203], a[48:51], v[128:131]
ds_read_b64_tr_b16 a[196:197], v27 offset:12424
ds_read_b64_tr_b16 a[198:199], v27 offset:13960
v_mfma_f32_16x16x32_bf16 v[128:131], a[204:207], a[52:55], v[128:131]
v_mfma_f32_16x16x32_bf16 v[176:179], a[200:203], a[56:59], v[176:179]
v_mfma_f32_16x16x32_bf16 v[176:179], a[204:207], a[60:63], v[176:179]
buffer_load_dwordx4 a[132:135], v39, s[16:19], s46 offen offset:1024 sc0 sc1
v_mfma_f32_16x16x32_bf16 v[224:227], a[200:203], a[64:67], v[224:227]
v_mfma_f32_16x16x32_bf16 v[224:227], a[204:207], a[68:71], v[224:227]
s_waitcnt lgkmcnt(8)
v_mfma_f32_16x16x32_bf16 v[84:87], a[208:211], a[40:43], v[84:87]
ds_read_b64_tr_b16 a[200:201], v26 offset:256
ds_read_b64_tr_b16 a[202:203], v26 offset:1792
v_mfma_f32_16x16x32_bf16 v[84:87], a[212:215], a[44:47], v[84:87]
s_add_u32 m0, s26, 32768
v_mfma_f32_16x16x32_bf16 v[132:135], a[208:211], a[48:51], v[132:135]
ds_read_b64_tr_b16 a[204:205], v26 offset:12544
ds_read_b64_tr_b16 a[206:207], v26 offset:14080
v_mfma_f32_16x16x32_bf16 v[132:135], a[212:215], a[52:55], v[132:135]
buffer_load_dwordx4 v32, s[28:31], s44 offen offset:0 lds
v_mfma_f32_16x16x32_bf16 v[180:183], a[208:211], a[56:59], v[180:183]
v_mfma_f32_16x16x32_bf16 v[180:183], a[212:215], a[60:63], v[180:183]
v_mfma_f32_16x16x32_bf16 v[228:231], a[208:211], a[64:67], v[228:231]
v_mfma_f32_16x16x32_bf16 v[228:231], a[212:215], a[68:71], v[228:231]
s_waitcnt lgkmcnt(8)
v_mfma_f32_16x16x32_bf16 v[88:91], a[216:219], a[40:43], v[88:91]
ds_read_b64_tr_b16 a[208:209], v31 offset:0
ds_read_b64_tr_b16 a[210:211], v31 offset:512
v_mfma_f32_16x16x32_bf16 v[88:91], a[220:223], a[44:47], v[88:91]
buffer_load_dwordx4 v33, s[28:31], s44 offen offset:1024 lds
v_mfma_f32_16x16x32_bf16 v[136:139], a[216:219], a[48:51], v[136:139]
ds_read_b64_tr_b16 a[212:213], v31 offset:4096
ds_read_b64_tr_b16 a[214:215], v31 offset:4608
v_mfma_f32_16x16x32_bf16 v[136:139], a[220:223], a[52:55], v[136:139]
v_mfma_f32_16x16x32_bf16 v[184:187], a[216:219], a[56:59], v[184:187]
v_mfma_f32_16x16x32_bf16 v[184:187], a[220:223], a[60:63], v[184:187]
v_mfma_f32_16x16x32_bf16 v[232:235], a[216:219], a[64:67], v[232:235]
buffer_load_dwordx4 v34, s[28:31], s44 offen offset:2048 lds
v_mfma_f32_16x16x32_bf16 v[232:235], a[220:223], a[68:71], v[232:235]
s_waitcnt lgkmcnt(8)
v_mfma_f32_16x16x32_bf16 v[92:95], a[192:195], a[40:43], v[92:95]
ds_read_b64_tr_b16 a[216:217], v26 offset:264
ds_read_b64_tr_b16 a[218:219], v26 offset:1800
v_mfma_f32_16x16x32_bf16 v[92:95], a[196:199], a[44:47], v[92:95]
v_mfma_f32_16x16x32_bf16 v[140:143], a[192:195], a[48:51], v[140:143]
ds_read_b64_tr_b16 a[220:221], v26 offset:12552
ds_read_b64_tr_b16 a[222:223], v26 offset:14088
v_mfma_f32_16x16x32_bf16 v[140:143], a[196:199], a[52:55], v[140:143]
s_add_u32 s44, s44, 393216
s_add_u32 m0, s26, 45056
v_mfma_f32_16x16x32_bf16 v[188:191], a[192:195], a[56:59], v[188:191]
buffer_load_dwordx4 v32, s[28:31], s44 offen offset:0 lds
v_mfma_f32_16x16x32_bf16 v[188:191], a[196:199], a[60:63], v[188:191]
v_mfma_f32_16x16x32_bf16 v[236:239], a[192:195], a[64:67], v[236:239]
v_mfma_f32_16x16x32_bf16 v[236:239], a[196:199], a[68:71], v[236:239]
s_waitcnt lgkmcnt(8)
v_mfma_f32_16x16x32_bf16 v[96:99], a[200:203], a[40:43], v[96:99]
ds_read_b64_tr_b16 a[192:193], v27 offset:256
ds_read_b64_tr_b16 a[194:195], v27 offset:1792
v_mfma_f32_16x16x32_bf16 v[96:99], a[204:207], a[44:47], v[96:99]
buffer_load_dwordx4 v33, s[28:31], s44 offen offset:1024 lds
v_mfma_f32_16x16x32_bf16 v[144:147], a[200:203], a[48:51], v[144:147]
ds_read_b64_tr_b16 a[196:197], v27 offset:12544
ds_read_b64_tr_b16 a[198:199], v27 offset:14080
v_mfma_f32_16x16x32_bf16 v[144:147], a[204:207], a[52:55], v[144:147]
v_mfma_f32_16x16x32_bf16 v[192:195], a[200:203], a[56:59], v[192:195]
v_mfma_f32_16x16x32_bf16 v[192:195], a[204:207], a[60:63], v[192:195]
v_mfma_f32_16x16x32_bf16 v[240:243], a[200:203], a[64:67], v[240:243]
v_mfma_f32_16x16x32_bf16 v[240:243], a[204:207], a[68:71], v[240:243]
s_waitcnt lgkmcnt(8)
v_mfma_f32_16x16x32_bf16 a[180:183], a[208:211], a[40:43], a[180:183]
ds_read_b64_tr_b16 a[200:201], v27 offset:264
ds_read_b64_tr_b16 a[202:203], v27 offset:1800
v_mfma_f32_16x16x32_bf16 a[180:183], a[212:215], a[44:47], a[180:183]
buffer_load_dwordx4 v34, s[28:31], s44 offen offset:2048 lds
v_mfma_f32_16x16x32_bf16 a[188:191], a[208:211], a[48:51], a[188:191]
ds_read_b64_tr_b16 a[204:205], v27 offset:12552
ds_read_b64_tr_b16 a[206:207], v27 offset:14088
v_mfma_f32_16x16x32_bf16 a[188:191], a[212:215], a[52:55], a[188:191]
s_waitcnt lgkmcnt(8)
v_mfma_f32_16x16x32_bf16 v[100:103], a[216:219], a[40:43], v[100:103]
ds_read_b64_tr_b16 a[208:209], v28 offset:0
ds_read_b64_tr_b16 a[210:211], v28 offset:512
v_mfma_f32_16x16x32_bf16 v[100:103], a[220:223], a[44:47], v[100:103]
s_add_u32 s44, s44, 393216
s_add_u32 m0, s50, 32768
v_mfma_f32_16x16x32_bf16 v[148:151], a[216:219], a[48:51], v[148:151]
ds_read_b64_tr_b16 a[212:213], v28 offset:4096
ds_read_b64_tr_b16 a[214:215], v28 offset:4608
v_mfma_f32_16x16x32_bf16 v[148:151], a[220:223], a[52:55], v[148:151]
buffer_load_dwordx4 v35, s[32:35], s45 offen lds
v_mfma_f32_16x16x32_bf16 v[196:199], a[216:219], a[56:59], v[196:199]
v_mfma_f32_16x16x32_bf16 v[196:199], a[220:223], a[60:63], v[196:199]
s_add_u32 s45, s45, 98304
s_add_u32 m0, s50, 36864
v_mfma_f32_16x16x32_bf16 v[244:247], a[216:219], a[64:67], v[244:247]
v_mfma_f32_16x16x32_bf16 v[244:247], a[220:223], a[68:71], v[244:247]
s_waitcnt lgkmcnt(8)
v_mfma_f32_16x16x32_bf16 v[104:107], a[192:195], a[40:43], v[104:107]
ds_read_b64_tr_b16 a[216:217], v29 offset:0
ds_read_b64_tr_b16 a[218:219], v29 offset:512
v_mfma_f32_16x16x32_bf16 v[104:107], a[196:199], a[44:47], v[104:107]
buffer_load_dwordx4 v35, s[32:35], s45 offen lds
v_mfma_f32_16x16x32_bf16 v[152:155], a[192:195], a[48:51], v[152:155]
ds_read_b64_tr_b16 a[220:221], v29 offset:4096
ds_read_b64_tr_b16 a[222:223], v29 offset:4608
v_mfma_f32_16x16x32_bf16 v[152:155], a[196:199], a[52:55], v[152:155]
s_add_u32 s45, s45, 98304
v_mfma_f32_16x16x32_bf16 v[200:203], a[192:195], a[56:59], v[200:203]
buffer_store_dwordx4 a[24:27], v24, s[40:43], s39 offen offset:1024 sc0 sc1
v_mfma_f32_16x16x32_bf16 v[200:203], a[196:199], a[60:63], v[200:203]
v_mfma_f32_16x16x32_bf16 v[248:251], a[192:195], a[64:67], v[248:251]
v_mfma_f32_16x16x32_bf16 v[248:251], a[196:199], a[68:71], v[248:251]
s_waitcnt lgkmcnt(8)
v_mfma_f32_16x16x32_bf16 v[108:111], a[200:203], a[40:43], v[108:111]
s_waitcnt vmcnt(38) lgkmcnt(0)
s_barrier
v_mfma_f32_16x16x32_bf16 v[108:111], a[204:207], a[44:47], v[108:111]
ds_read_b64_tr_b16 a[192:193], v26 offset:32768
ds_read_b64_tr_b16 a[194:195], v26 offset:34304
v_mfma_f32_16x16x32_bf16 v[156:159], a[200:203], a[48:51], v[156:159]
v_mfma_f32_16x16x32_bf16 v[156:159], a[204:207], a[52:55], v[156:159]
ds_read_b64_tr_b16 a[196:197], v26 offset:45056
ds_read_b64_tr_b16 a[198:199], v26 offset:46592
v_mfma_f32_16x16x32_bf16 v[204:207], a[200:203], a[56:59], v[204:207]
buffer_store_dwordx4 a[8:11], v24, s[40:43], s38 offen offset:2048 sc0 sc1
v_mfma_f32_16x16x32_bf16 v[204:207], a[204:207], a[60:63], v[204:207]
v_mfma_f32_16x16x32_bf16 v[252:255], a[200:203], a[64:67], v[252:255]
v_mfma_f32_16x16x32_bf16 v[252:255], a[204:207], a[68:71], v[252:255]
v_mfma_f32_16x16x32_bf16 a[144:147], a[208:211], a[40:43], a[144:147]
ds_read_b64_tr_b16 a[200:201], v26 offset:32776
ds_read_b64_tr_b16 a[202:203], v26 offset:34312
v_mfma_f32_16x16x32_bf16 a[144:147], a[212:215], a[44:47], a[144:147]
buffer_store_dwordx4 a[28:31], v24, s[40:43], s39 offen offset:2048 sc0 sc1
v_mfma_f32_16x16x32_bf16 a[152:155], a[208:211], a[48:51], a[152:155]
ds_read_b64_tr_b16 a[204:205], v26 offset:45064
ds_read_b64_tr_b16 a[206:207], v26 offset:46600
v_mfma_f32_16x16x32_bf16 a[152:155], a[212:215], a[52:55], a[152:155]
v_mfma_f32_16x16x32_bf16 a[160:163], a[208:211], a[56:59], a[160:163]
v_mfma_f32_16x16x32_bf16 a[160:163], a[212:215], a[60:63], a[160:163]
v_mfma_f32_16x16x32_bf16 a[168:171], a[208:211], a[64:67], a[168:171]
v_mfma_f32_16x16x32_bf16 a[168:171], a[212:215], a[68:71], a[168:171]
v_mfma_f32_16x16x32_bf16 a[148:151], a[216:219], a[40:43], a[148:151]
ds_read_b64_tr_b16 a[208:209], v27 offset:32768
ds_read_b64_tr_b16 a[210:211], v27 offset:34304
v_mfma_f32_16x16x32_bf16 a[148:151], a[220:223], a[44:47], a[148:151]
v_mfma_f32_16x16x32_bf16 a[156:159], a[216:219], a[48:51], a[156:159]
ds_read_b64_tr_b16 a[212:213], v27 offset:45056
ds_read_b64_tr_b16 a[214:215], v27 offset:46592
v_mfma_f32_16x16x32_bf16 a[156:159], a[220:223], a[52:55], a[156:159]
v_mfma_f32_16x16x32_bf16 a[164:167], a[216:219], a[56:59], a[164:167]
v_mfma_f32_16x16x32_bf16 a[164:167], a[220:223], a[60:63], a[164:167]
v_mfma_f32_16x16x32_bf16 a[172:175], a[216:219], a[64:67], a[172:175]
v_mfma_f32_16x16x32_bf16 a[172:175], a[220:223], a[68:71], a[172:175]
s_waitcnt vmcnt(30) lgkmcnt(8)
v_mfma_f32_16x16x32_bf16 v[64:67], a[192:195], a[72:75], v[64:67]
ds_read_b64_tr_b16 a[216:217], v27 offset:32776
ds_read_b64_tr_b16 a[218:219], v27 offset:34312
v_mfma_f32_16x16x32_bf16 v[64:67], a[196:199], a[76:79], v[64:67]
s_add_u32 s46, s46, 2048
v_mfma_f32_16x16x32_bf16 v[112:115], a[192:195], a[80:83], v[112:115]
ds_read_b64_tr_b16 a[220:221], v27 offset:45064
ds_read_b64_tr_b16 a[222:223], v27 offset:46600
v_mfma_f32_16x16x32_bf16 v[112:115], a[196:199], a[84:87], v[112:115]
buffer_load_dwordx4 a[40:43], v36, s[16:19], s46 offen offset:0 sc0 sc1
v_mfma_f32_16x16x32_bf16 v[160:163], a[192:195], a[88:91], v[160:163]
v_mfma_f32_16x16x32_bf16 v[160:163], a[196:199], a[92:95], v[160:163]
v_mfma_f32_16x16x32_bf16 v[208:211], a[192:195], a[96:99], v[208:211]
v_mfma_f32_16x16x32_bf16 v[208:211], a[196:199], a[100:103], v[208:211]
s_waitcnt lgkmcnt(8)
v_mfma_f32_16x16x32_bf16 v[68:71], a[200:203], a[72:75], v[68:71]
ds_read_b64_tr_b16 a[192:193], v30 offset:32768
ds_read_b64_tr_b16 a[194:195], v30 offset:33280
v_mfma_f32_16x16x32_bf16 v[68:71], a[204:207], a[76:79], v[68:71]
buffer_load_dwordx4 a[44:47], v36, s[16:19], s46 offen offset:1024 sc0 sc1
v_mfma_f32_16x16x32_bf16 v[116:119], a[200:203], a[80:83], v[116:119]
ds_read_b64_tr_b16 a[196:197], v30 offset:36864
ds_read_b64_tr_b16 a[198:199], v30 offset:37376
v_mfma_f32_16x16x32_bf16 v[116:119], a[204:207], a[84:87], v[116:119]
v_mfma_f32_16x16x32_bf16 v[164:167], a[200:203], a[88:91], v[164:167]
v_mfma_f32_16x16x32_bf16 v[164:167], a[204:207], a[92:95], v[164:167]
v_mfma_f32_16x16x32_bf16 v[212:215], a[200:203], a[96:99], v[212:215]
v_mfma_f32_16x16x32_bf16 v[212:215], a[204:207], a[100:103], v[212:215]
s_waitcnt lgkmcnt(8)
v_mfma_f32_16x16x32_bf16 v[72:75], a[208:211], a[72:75], v[72:75]
ds_read_b64_tr_b16 a[200:201], v26 offset:32896
ds_read_b64_tr_b16 a[202:203], v26 offset:34432
v_mfma_f32_16x16x32_bf16 v[72:75], a[212:215], a[76:79], v[72:75]
buffer_load_dwordx4 a[48:51], v37, s[16:19], s46 offen offset:0 sc0 sc1
v_mfma_f32_16x16x32_bf16 v[120:123], a[208:211], a[80:83], v[120:123]
ds_read_b64_tr_b16 a[204:205], v26 offset:45184
ds_read_b64_tr_b16 a[206:207], v26 offset:46720
v_mfma_f32_16x16x32_bf16 v[120:123], a[212:215], a[84:87], v[120:123]
v_mfma_f32_16x16x32_bf16 v[168:171], a[208:211], a[88:91], v[168:171]
v_mfma_f32_16x16x32_bf16 v[168:171], a[212:215], a[92:95], v[168:171]
v_mfma_f32_16x16x32_bf16 v[216:219], a[208:211], a[96:99], v[216:219]
v_mfma_f32_16x16x32_bf16 v[216:219], a[212:215], a[100:103], v[216:219]
s_waitcnt lgkmcnt(8)
v_mfma_f32_16x16x32_bf16 v[76:79], a[216:219], a[72:75], v[76:79]
ds_read_b64_tr_b16 a[208:209], v26 offset:32904
ds_read_b64_tr_b16 a[210:211], v26 offset:34440
v_mfma_f32_16x16x32_bf16 v[76:79], a[220:223], a[76:79], v[76:79]
buffer_load_dwordx4 a[52:55], v37, s[16:19], s46 offen offset:1024 sc0 sc1
v_mfma_f32_16x16x32_bf16 v[124:127], a[216:219], a[80:83], v[124:127]
ds_read_b64_tr_b16 a[212:213], v26 offset:45192
ds_read_b64_tr_b16 a[214:215], v26 offset:46728
v_mfma_f32_16x16x32_bf16 v[124:127], a[220:223], a[84:87], v[124:127]
v_mfma_f32_16x16x32_bf16 v[172:175], a[216:219], a[88:91], v[172:175]
v_mfma_f32_16x16x32_bf16 v[172:175], a[220:223], a[92:95], v[172:175]
v_mfma_f32_16x16x32_bf16 v[220:223], a[216:219], a[96:99], v[220:223]
v_mfma_f32_16x16x32_bf16 v[220:223], a[220:223], a[100:103], v[220:223]
s_waitcnt lgkmcnt(8)
v_mfma_f32_16x16x32_bf16 a[176:179], a[192:195], a[72:75], a[176:179]
ds_read_b64_tr_b16 a[216:217], v27 offset:32896
ds_read_b64_tr_b16 a[218:219], v27 offset:34432
v_mfma_f32_16x16x32_bf16 a[176:179], a[196:199], a[76:79], a[176:179]
buffer_load_dwordx4 a[56:59], v38, s[16:19], s46 offen offset:0 sc0 sc1
v_mfma_f32_16x16x32_bf16 a[184:187], a[192:195], a[80:83], a[184:187]
ds_read_b64_tr_b16 a[220:221], v27 offset:45184
ds_read_b64_tr_b16 a[222:223], v27 offset:46720
v_mfma_f32_16x16x32_bf16 a[184:187], a[196:199], a[84:87], a[184:187]
s_waitcnt lgkmcnt(8)
v_mfma_f32_16x16x32_bf16 v[80:83], a[200:203], a[72:75], v[80:83]
ds_read_b64_tr_b16 a[192:193], v27 offset:32904
ds_read_b64_tr_b16 a[194:195], v27 offset:34440
v_mfma_f32_16x16x32_bf16 v[80:83], a[204:207], a[76:79], v[80:83]
v_mfma_f32_16x16x32_bf16 v[128:131], a[200:203], a[80:83], v[128:131]
ds_read_b64_tr_b16 a[196:197], v27 offset:45192
ds_read_b64_tr_b16 a[198:199], v27 offset:46728
v_mfma_f32_16x16x32_bf16 v[128:131], a[204:207], a[84:87], v[128:131]
buffer_load_dwordx4 a[60:63], v38, s[16:19], s46 offen offset:1024 sc0 sc1
v_mfma_f32_16x16x32_bf16 v[176:179], a[200:203], a[88:91], v[176:179]
v_mfma_f32_16x16x32_bf16 v[176:179], a[204:207], a[92:95], v[176:179]
v_mfma_f32_16x16x32_bf16 v[224:227], a[200:203], a[96:99], v[224:227]
v_mfma_f32_16x16x32_bf16 v[224:227], a[204:207], a[100:103], v[224:227]
s_waitcnt lgkmcnt(8)
v_mfma_f32_16x16x32_bf16 v[84:87], a[208:211], a[72:75], v[84:87]
ds_read_b64_tr_b16 a[200:201], v26 offset:33024
ds_read_b64_tr_b16 a[202:203], v26 offset:34560
v_mfma_f32_16x16x32_bf16 v[84:87], a[212:215], a[76:79], v[84:87]
v_mfma_f32_16x16x32_bf16 v[132:135], a[208:211], a[80:83], v[132:135]
ds_read_b64_tr_b16 a[204:205], v26 offset:45312
ds_read_b64_tr_b16 a[206:207], v26 offset:46848
v_mfma_f32_16x16x32_bf16 v[132:135], a[212:215], a[84:87], v[132:135]
buffer_load_dwordx4 a[64:67], v39, s[16:19], s46 offen offset:0 sc0 sc1
v_mfma_f32_16x16x32_bf16 v[180:183], a[208:211], a[88:91], v[180:183]
v_mfma_f32_16x16x32_bf16 v[180:183], a[212:215], a[92:95], v[180:183]
v_mfma_f32_16x16x32_bf16 v[228:231], a[208:211], a[96:99], v[228:231]
v_mfma_f32_16x16x32_bf16 v[228:231], a[212:215], a[100:103], v[228:231]
s_waitcnt lgkmcnt(8)
v_mfma_f32_16x16x32_bf16 v[88:91], a[216:219], a[72:75], v[88:91]
ds_read_b64_tr_b16 a[208:209], v31 offset:32768
ds_read_b64_tr_b16 a[210:211], v31 offset:33280
v_mfma_f32_16x16x32_bf16 v[88:91], a[220:223], a[76:79], v[88:91]
v_mfma_f32_16x16x32_bf16 v[136:139], a[216:219], a[80:83], v[136:139]
ds_read_b64_tr_b16 a[212:213], v31 offset:36864
ds_read_b64_tr_b16 a[214:215], v31 offset:37376
v_mfma_f32_16x16x32_bf16 v[136:139], a[220:223], a[84:87], v[136:139]
buffer_load_dwordx4 a[68:71], v39, s[16:19], s46 offen offset:1024 sc0 sc1
v_mfma_f32_16x16x32_bf16 v[184:187], a[216:219], a[88:91], v[184:187]
v_mfma_f32_16x16x32_bf16 v[184:187], a[220:223], a[92:95], v[184:187]
v_mfma_f32_16x16x32_bf16 v[232:235], a[216:219], a[96:99], v[232:235]
v_mfma_f32_16x16x32_bf16 v[232:235], a[220:223], a[100:103], v[232:235]
s_waitcnt lgkmcnt(8)
v_mfma_f32_16x16x32_bf16 v[92:95], a[192:195], a[72:75], v[92:95]
ds_read_b64_tr_b16 a[216:217], v26 offset:33032
ds_read_b64_tr_b16 a[218:219], v26 offset:34568
v_mfma_f32_16x16x32_bf16 v[92:95], a[196:199], a[76:79], v[92:95]
s_add_u32 m0, s22, 0
v_mfma_f32_16x16x32_bf16 v[140:143], a[192:195], a[80:83], v[140:143]
ds_read_b64_tr_b16 a[220:221], v26 offset:45320
ds_read_b64_tr_b16 a[222:223], v26 offset:46856
v_mfma_f32_16x16x32_bf16 v[140:143], a[196:199], a[84:87], v[140:143]
buffer_load_dwordx4 v8, s[8:11], s20 offen offset:0 lds
v_mfma_f32_16x16x32_bf16 v[188:191], a[192:195], a[88:91], v[188:191]
v_mfma_f32_16x16x32_bf16 v[188:191], a[196:199], a[92:95], v[188:191]
v_mfma_f32_16x16x32_bf16 v[236:239], a[192:195], a[96:99], v[236:239]
v_mfma_f32_16x16x32_bf16 v[236:239], a[196:199], a[100:103], v[236:239]
s_waitcnt lgkmcnt(8)
v_mfma_f32_16x16x32_bf16 v[96:99], a[200:203], a[72:75], v[96:99]
ds_read_b64_tr_b16 a[192:193], v27 offset:33024
ds_read_b64_tr_b16 a[194:195], v27 offset:34560
v_mfma_f32_16x16x32_bf16 v[96:99], a[204:207], a[76:79], v[96:99]
v_mfma_f32_16x16x32_bf16 v[144:147], a[200:203], a[80:83], v[144:147]
ds_read_b64_tr_b16 a[196:197], v27 offset:45312
ds_read_b64_tr_b16 a[198:199], v27 offset:46848
v_mfma_f32_16x16x32_bf16 v[144:147], a[204:207], a[84:87], v[144:147]
buffer_load_dwordx4 v9, s[8:11], s20 offen offset:1024 lds
v_mfma_f32_16x16x32_bf16 v[192:195], a[200:203], a[88:91], v[192:195]
v_mfma_f32_16x16x32_bf16 v[192:195], a[204:207], a[92:95], v[192:195]
v_mfma_f32_16x16x32_bf16 v[240:243], a[200:203], a[96:99], v[240:243]
v_mfma_f32_16x16x32_bf16 v[240:243], a[204:207], a[100:103], v[240:243]
s_waitcnt lgkmcnt(8)
v_mfma_f32_16x16x32_bf16 a[180:183], a[208:211], a[72:75], a[180:183]
ds_read_b64_tr_b16 a[200:201], v27 offset:33032
ds_read_b64_tr_b16 a[202:203], v27 offset:34568
v_mfma_f32_16x16x32_bf16 a[180:183], a[212:215], a[76:79], a[180:183]
v_mfma_f32_16x16x32_bf16 a[188:191], a[208:211], a[80:83], a[188:191]
ds_read_b64_tr_b16 a[204:205], v27 offset:45320
ds_read_b64_tr_b16 a[206:207], v27 offset:46856
v_mfma_f32_16x16x32_bf16 a[188:191], a[212:215], a[84:87], a[188:191]
s_waitcnt lgkmcnt(8)
v_mfma_f32_16x16x32_bf16 v[100:103], a[216:219], a[72:75], v[100:103]
ds_read_b64_tr_b16 a[208:209], v28 offset:32768
ds_read_b64_tr_b16 a[210:211], v28 offset:33280
v_mfma_f32_16x16x32_bf16 v[100:103], a[220:223], a[76:79], v[100:103]
buffer_load_dwordx4 v10, s[8:11], s20 offen offset:2048 lds
v_mfma_f32_16x16x32_bf16 v[148:151], a[216:219], a[80:83], v[148:151]
ds_read_b64_tr_b16 a[212:213], v28 offset:36864
ds_read_b64_tr_b16 a[214:215], v28 offset:37376
v_mfma_f32_16x16x32_bf16 v[148:151], a[220:223], a[84:87], v[148:151]
v_mfma_f32_16x16x32_bf16 v[196:199], a[216:219], a[88:91], v[196:199]
s_add_u32 s20, s20, 12288
v_mfma_f32_16x16x32_bf16 v[196:199], a[220:223], a[92:95], v[196:199]
v_mfma_f32_16x16x32_bf16 v[244:247], a[216:219], a[96:99], v[244:247]
buffer_store_dwordx4 a[12:15], v24, s[40:43], s38 offen offset:3072 sc0 sc1
v_mfma_f32_16x16x32_bf16 v[244:247], a[220:223], a[100:103], v[244:247]
s_waitcnt lgkmcnt(8)
v_mfma_f32_16x16x32_bf16 v[104:107], a[192:195], a[72:75], v[104:107]
ds_read_b64_tr_b16 a[216:217], v29 offset:32768
ds_read_b64_tr_b16 a[218:219], v29 offset:33280
v_mfma_f32_16x16x32_bf16 v[104:107], a[196:199], a[76:79], v[104:107]
v_mfma_f32_16x16x32_bf16 v[152:155], a[192:195], a[80:83], v[152:155]
ds_read_b64_tr_b16 a[220:221], v29 offset:36864
ds_read_b64_tr_b16 a[222:223], v29 offset:37376
v_mfma_f32_16x16x32_bf16 v[152:155], a[196:199], a[84:87], v[152:155]
v_add_u32 v26, 4294901760, v26
v_add_u32 v27, 4294901760, v27
v_mfma_f32_16x16x32_bf16 v[200:203], a[192:195], a[88:91], v[200:203]
v_add_u32 v28, 4294901760, v28
v_add_u32 v29, 4294901760, v29
v_mfma_f32_16x16x32_bf16 v[200:203], a[196:199], a[92:95], v[200:203]
v_add_u32 v30, 4294901760, v30
v_add_u32 v31, 4294901760, v31
v_mfma_f32_16x16x32_bf16 v[248:251], a[192:195], a[96:99], v[248:251]
v_mfma_f32_16x16x32_bf16 v[248:251], a[196:199], a[100:103], v[248:251]
s_waitcnt lgkmcnt(8)
v_mfma_f32_16x16x32_bf16 v[108:111], a[200:203], a[72:75], v[108:111]
s_waitcnt vmcnt(34) lgkmcnt(0)
s_barrier
v_mfma_f32_16x16x32_bf16 v[108:111], a[204:207], a[76:79], v[108:111]
ds_read_b64_tr_b16 a[192:193], v26 offset:0
ds_read_b64_tr_b16 a[194:195], v26 offset:1536
v_mfma_f32_16x16x32_bf16 v[156:159], a[200:203], a[80:83], v[156:159]
buffer_store_dwordx4 a[32:35], v24, s[40:43], s39 offen offset:3072 sc0 sc1
v_mfma_f32_16x16x32_bf16 v[156:159], a[204:207], a[84:87], v[156:159]
ds_read_b64_tr_b16 a[196:197], v26 offset:12288
ds_read_b64_tr_b16 a[198:199], v26 offset:13824
v_mfma_f32_16x16x32_bf16 v[204:207], a[200:203], a[88:91], v[204:207]
v_mfma_f32_16x16x32_bf16 v[204:207], a[204:207], a[92:95], v[204:207]
v_mfma_f32_16x16x32_bf16 v[252:255], a[200:203], a[96:99], v[252:255]
buffer_store_dwordx4 a[16:19], v23, s[40:43], s38 offen offset:0 sc0 sc1
v_mfma_f32_16x16x32_bf16 v[252:255], a[204:207], a[100:103], v[252:255]
v_mfma_f32_16x16x32_bf16 a[144:147], a[208:211], a[72:75], a[144:147]
ds_read_b64_tr_b16 a[200:201], v26 offset:8
ds_read_b64_tr_b16 a[202:203], v26 offset:1544
v_mfma_f32_16x16x32_bf16 a[144:147], a[212:215], a[76:79], a[144:147]
v_mfma_f32_16x16x32_bf16 a[152:155], a[208:211], a[80:83], a[152:155]
ds_read_b64_tr_b16 a[204:205], v26 offset:12296
ds_read_b64_tr_b16 a[206:207], v26 offset:13832
v_mfma_f32_16x16x32_bf16 a[152:155], a[212:215], a[84:87], a[152:155]
v_mfma_f32_16x16x32_bf16 a[160:163], a[208:211], a[88:91], a[160:163]
v_mfma_f32_16x16x32_bf16 a[160:163], a[212:215], a[92:95], a[160:163]
v_mfma_f32_16x16x32_bf16 a[168:171], a[208:211], a[96:99], a[168:171]
v_mfma_f32_16x16x32_bf16 a[168:171], a[212:215], a[100:103], a[168:171]
v_mfma_f32_16x16x32_bf16 a[148:151], a[216:219], a[72:75], a[148:151]
ds_read_b64_tr_b16 a[208:209], v27 offset:0
ds_read_b64_tr_b16 a[210:211], v27 offset:1536
v_mfma_f32_16x16x32_bf16 a[148:151], a[220:223], a[76:79], a[148:151]
v_mfma_f32_16x16x32_bf16 a[156:159], a[216:219], a[80:83], a[156:159]
ds_read_b64_tr_b16 a[212:213], v27 offset:12288
ds_read_b64_tr_b16 a[214:215], v27 offset:13824
v_mfma_f32_16x16x32_bf16 a[156:159], a[220:223], a[84:87], a[156:159]
v_mfma_f32_16x16x32_bf16 a[164:167], a[216:219], a[88:91], a[164:167]
v_mfma_f32_16x16x32_bf16 a[164:167], a[220:223], a[92:95], a[164:167]
v_mfma_f32_16x16x32_bf16 a[172:175], a[216:219], a[96:99], a[172:175]
v_mfma_f32_16x16x32_bf16 a[172:175], a[220:223], a[100:103], a[172:175]
s_waitcnt vmcnt(25) lgkmcnt(8)
v_mfma_f32_16x16x32_bf16 v[64:67], a[192:195], a[104:107], v[64:67]
ds_read_b64_tr_b16 a[216:217], v27 offset:8
ds_read_b64_tr_b16 a[218:219], v27 offset:1544
v_mfma_f32_16x16x32_bf16 v[64:67], a[196:199], a[108:111], v[64:67]
s_add_u32 m0, s22, 12288
v_mfma_f32_16x16x32_bf16 v[112:115], a[192:195], a[112:115], v[112:115]
ds_read_b64_tr_b16 a[220:221], v27 offset:12296
ds_read_b64_tr_b16 a[222:223], v27 offset:13832
v_mfma_f32_16x16x32_bf16 v[112:115], a[196:199], a[116:119], v[112:115]
buffer_load_dwordx4 v8, s[8:11], s20 offen offset:0 lds
v_mfma_f32_16x16x32_bf16 v[160:163], a[192:195], a[120:123], v[160:163]
v_mfma_f32_16x16x32_bf16 v[160:163], a[196:199], a[124:127], v[160:163]
v_mfma_f32_16x16x32_bf16 v[208:211], a[192:195], a[128:131], v[208:211]
v_mfma_f32_16x16x32_bf16 v[208:211], a[196:199], a[132:135], v[208:211]
s_waitcnt lgkmcnt(8)
v_mfma_f32_16x16x32_bf16 v[68:71], a[200:203], a[104:107], v[68:71]
ds_read_b64_tr_b16 a[192:193], v30 offset:0
ds_read_b64_tr_b16 a[194:195], v30 offset:512
v_mfma_f32_16x16x32_bf16 v[68:71], a[204:207], a[108:111], v[68:71]
v_mfma_f32_16x16x32_bf16 v[116:119], a[200:203], a[112:115], v[116:119]
ds_read_b64_tr_b16 a[196:197], v30 offset:4096
ds_read_b64_tr_b16 a[198:199], v30 offset:4608
v_mfma_f32_16x16x32_bf16 v[116:119], a[204:207], a[116:119], v[116:119]
v_mfma_f32_16x16x32_bf16 v[164:167], a[200:203], a[120:123], v[164:167]
v_mfma_f32_16x16x32_bf16 v[164:167], a[204:207], a[124:127], v[164:167]
v_mfma_f32_16x16x32_bf16 v[212:215], a[200:203], a[128:131], v[212:215]
v_mfma_f32_16x16x32_bf16 v[212:215], a[204:207], a[132:135], v[212:215]
s_waitcnt lgkmcnt(8)
v_mfma_f32_16x16x32_bf16 v[72:75], a[208:211], a[104:107], v[72:75]
ds_read_b64_tr_b16 a[200:201], v26 offset:128
ds_read_b64_tr_b16 a[202:203], v26 offset:1664
v_mfma_f32_16x16x32_bf16 v[72:75], a[212:215], a[108:111], v[72:75]
v_mfma_f32_16x16x32_bf16 v[120:123], a[208:211], a[112:115], v[120:123]
ds_read_b64_tr_b16 a[204:205], v26 offset:12416
ds_read_b64_tr_b16 a[206:207], v26 offset:13952
v_mfma_f32_16x16x32_bf16 v[120:123], a[212:215], a[116:119], v[120:123]
v_mfma_f32_16x16x32_bf16 v[168:171], a[208:211], a[120:123], v[168:171]
v_mfma_f32_16x16x32_bf16 v[168:171], a[212:215], a[124:127], v[168:171]
v_mfma_f32_16x16x32_bf16 v[216:219], a[208:211], a[128:131], v[216:219]
v_mfma_f32_16x16x32_bf16 v[216:219], a[212:215], a[132:135], v[216:219]
s_waitcnt lgkmcnt(8)
v_mfma_f32_16x16x32_bf16 v[76:79], a[216:219], a[104:107], v[76:79]
ds_read_b64_tr_b16 a[208:209], v26 offset:136
ds_read_b64_tr_b16 a[210:211], v26 offset:1672
v_mfma_f32_16x16x32_bf16 v[76:79], a[220:223], a[108:111], v[76:79]
v_mfma_f32_16x16x32_bf16 v[124:127], a[216:219], a[112:115], v[124:127]
ds_read_b64_tr_b16 a[212:213], v26 offset:12424
ds_read_b64_tr_b16 a[214:215], v26 offset:13960
v_mfma_f32_16x16x32_bf16 v[124:127], a[220:223], a[116:119], v[124:127]
v_mfma_f32_16x16x32_bf16 v[172:175], a[216:219], a[120:123], v[172:175]
buffer_load_dwordx4 v9, s[8:11], s20 offen offset:1024 lds
v_mfma_f32_16x16x32_bf16 v[172:175], a[220:223], a[124:127], v[172:175]
v_mfma_f32_16x16x32_bf16 v[220:223], a[216:219], a[128:131], v[220:223]
v_mfma_f32_16x16x32_bf16 v[220:223], a[220:223], a[132:135], v[220:223]
s_waitcnt lgkmcnt(8)
v_mfma_f32_16x16x32_bf16 a[176:179], a[192:195], a[104:107], a[176:179]
ds_read_b64_tr_b16 a[216:217], v27 offset:128
ds_read_b64_tr_b16 a[218:219], v27 offset:1664
v_mfma_f32_16x16x32_bf16 a[176:179], a[196:199], a[108:111], a[176:179]
v_mfma_f32_16x16x32_bf16 a[184:187], a[192:195], a[112:115], a[184:187]
ds_read_b64_tr_b16 a[220:221], v27 offset:12416
ds_read_b64_tr_b16 a[222:223], v27 offset:13952
v_mfma_f32_16x16x32_bf16 a[184:187], a[196:199], a[116:119], a[184:187]
s_waitcnt lgkmcnt(8)
v_mfma_f32_16x16x32_bf16 v[80:83], a[200:203], a[104:107], v[80:83]
ds_read_b64_tr_b16 a[192:193], v27 offset:136
ds_read_b64_tr_b16 a[194:195], v27 offset:1672
v_mfma_f32_16x16x32_bf16 v[80:83], a[204:207], a[108:111], v[80:83]
v_mfma_f32_16x16x32_bf16 v[128:131], a[200:203], a[112:115], v[128:131]
ds_read_b64_tr_b16 a[196:197], v27 offset:12424
ds_read_b64_tr_b16 a[198:199], v27 offset:13960
v_mfma_f32_16x16x32_bf16 v[128:131], a[204:207], a[116:119], v[128:131]
v_mfma_f32_16x16x32_bf16 v[176:179], a[200:203], a[120:123], v[176:179]
v_mfma_f32_16x16x32_bf16 v[176:179], a[204:207], a[124:127], v[176:179]
v_mfma_f32_16x16x32_bf16 v[224:227], a[200:203], a[128:131], v[224:227]
v_mfma_f32_16x16x32_bf16 v[224:227], a[204:207], a[132:135], v[224:227]
s_waitcnt lgkmcnt(8)
v_mfma_f32_16x16x32_bf16 v[84:87], a[208:211], a[104:107], v[84:87]
ds_read_b64_tr_b16 a[200:201], v26 offset:256
ds_read_b64_tr_b16 a[202:203], v26 offset:1792
v_mfma_f32_16x16x32_bf16 v[84:87], a[212:215], a[108:111], v[84:87]
v_mfma_f32_16x16x32_bf16 v[132:135], a[208:211], a[112:115], v[132:135]
ds_read_b64_tr_b16 a[204:205], v26 offset:12544
ds_read_b64_tr_b16 a[206:207], v26 offset:14080
v_mfma_f32_16x16x32_bf16 v[132:135], a[212:215], a[116:119], v[132:135]
v_mfma_f32_16x16x32_bf16 v[180:183], a[208:211], a[120:123], v[180:183]
v_mfma_f32_16x16x32_bf16 v[180:183], a[212:215], a[124:127], v[180:183]
v_mfma_f32_16x16x32_bf16 v[228:231], a[208:211], a[128:131], v[228:231]
v_mfma_f32_16x16x32_bf16 v[228:231], a[212:215], a[132:135], v[228:231]
s_waitcnt lgkmcnt(8)
v_mfma_f32_16x16x32_bf16 v[88:91], a[216:219], a[104:107], v[88:91]
ds_read_b64_tr_b16 a[208:209], v31 offset:0
ds_read_b64_tr_b16 a[210:211], v31 offset:512
v_mfma_f32_16x16x32_bf16 v[88:91], a[220:223], a[108:111], v[88:91]
v_mfma_f32_16x16x32_bf16 v[136:139], a[216:219], a[112:115], v[136:139]
ds_read_b64_tr_b16 a[212:213], v31 offset:4096
ds_read_b64_tr_b16 a[214:215], v31 offset:4608
v_mfma_f32_16x16x32_bf16 v[136:139], a[220:223], a[116:119], v[136:139]
buffer_load_dwordx4 v10, s[8:11], s20 offen offset:2048 lds
v_mfma_f32_16x16x32_bf16 v[184:187], a[216:219], a[120:123], v[184:187]
v_mfma_f32_16x16x32_bf16 v[184:187], a[220:223], a[124:127], v[184:187]
v_mfma_f32_16x16x32_bf16 v[232:235], a[216:219], a[128:131], v[232:235]
v_mfma_f32_16x16x32_bf16 v[232:235], a[220:223], a[132:135], v[232:235]
s_waitcnt lgkmcnt(8)
v_mfma_f32_16x16x32_bf16 v[92:95], a[192:195], a[104:107], v[92:95]
ds_read_b64_tr_b16 a[216:217], v26 offset:264
ds_read_b64_tr_b16 a[218:219], v26 offset:1800
v_mfma_f32_16x16x32_bf16 v[92:95], a[196:199], a[108:111], v[92:95]
v_mfma_f32_16x16x32_bf16 v[140:143], a[192:195], a[112:115], v[140:143]
ds_read_b64_tr_b16 a[220:221], v26 offset:12552
ds_read_b64_tr_b16 a[222:223], v26 offset:14088
v_mfma_f32_16x16x32_bf16 v[140:143], a[196:199], a[116:119], v[140:143]
v_mfma_f32_16x16x32_bf16 v[188:191], a[192:195], a[120:123], v[188:191]
v_mfma_f32_16x16x32_bf16 v[188:191], a[196:199], a[124:127], v[188:191]
v_mfma_f32_16x16x32_bf16 v[236:239], a[192:195], a[128:131], v[236:239]
v_mfma_f32_16x16x32_bf16 v[236:239], a[196:199], a[132:135], v[236:239]
s_waitcnt lgkmcnt(8)
v_mfma_f32_16x16x32_bf16 v[96:99], a[200:203], a[104:107], v[96:99]
ds_read_b64_tr_b16 a[192:193], v27 offset:256
ds_read_b64_tr_b16 a[194:195], v27 offset:1792
v_mfma_f32_16x16x32_bf16 v[96:99], a[204:207], a[108:111], v[96:99]
v_mfma_f32_16x16x32_bf16 v[144:147], a[200:203], a[112:115], v[144:147]
ds_read_b64_tr_b16 a[196:197], v27 offset:12544
ds_read_b64_tr_b16 a[198:199], v27 offset:14080
v_mfma_f32_16x16x32_bf16 v[144:147], a[204:207], a[116:119], v[144:147]
v_mfma_f32_16x16x32_bf16 v[192:195], a[200:203], a[120:123], v[192:195]
v_mfma_f32_16x16x32_bf16 v[192:195], a[204:207], a[124:127], v[192:195]
v_mfma_f32_16x16x32_bf16 v[240:243], a[200:203], a[128:131], v[240:243]
v_mfma_f32_16x16x32_bf16 v[240:243], a[204:207], a[132:135], v[240:243]
s_waitcnt lgkmcnt(8)
v_mfma_f32_16x16x32_bf16 a[180:183], a[208:211], a[104:107], a[180:183]
ds_read_b64_tr_b16 a[200:201], v27 offset:264
ds_read_b64_tr_b16 a[202:203], v27 offset:1800
v_mfma_f32_16x16x32_bf16 a[180:183], a[212:215], a[108:111], a[180:183]
v_mfma_f32_16x16x32_bf16 a[188:191], a[208:211], a[112:115], a[188:191]
ds_read_b64_tr_b16 a[204:205], v27 offset:12552
ds_read_b64_tr_b16 a[206:207], v27 offset:14088
v_mfma_f32_16x16x32_bf16 a[188:191], a[212:215], a[116:119], a[188:191]
s_waitcnt lgkmcnt(8)
v_mfma_f32_16x16x32_bf16 v[100:103], a[216:219], a[104:107], v[100:103]
ds_read_b64_tr_b16 a[208:209], v28 offset:0
ds_read_b64_tr_b16 a[210:211], v28 offset:512
v_mfma_f32_16x16x32_bf16 v[100:103], a[220:223], a[108:111], v[100:103]
s_add_u32 s20, s20, 12288
v_mfma_f32_16x16x32_bf16 v[148:151], a[216:219], a[112:115], v[148:151]
ds_read_b64_tr_b16 a[212:213], v28 offset:4096
ds_read_b64_tr_b16 a[214:215], v28 offset:4608
v_mfma_f32_16x16x32_bf16 v[148:151], a[220:223], a[116:119], v[148:151]
buffer_store_dwordx4 a[36:39], v23, s[40:43], s39 offen offset:0 sc0 sc1
v_mfma_f32_16x16x32_bf16 v[196:199], a[216:219], a[120:123], v[196:199]
v_mfma_f32_16x16x32_bf16 v[196:199], a[220:223], a[124:127], v[196:199]
v_mfma_f32_16x16x32_bf16 v[244:247], a[216:219], a[128:131], v[244:247]
v_mfma_f32_16x16x32_bf16 v[244:247], a[220:223], a[132:135], v[244:247]
s_waitcnt lgkmcnt(8)
v_mfma_f32_16x16x32_bf16 v[104:107], a[192:195], a[104:107], v[104:107]
ds_read_b64_tr_b16 a[216:217], v29 offset:0
ds_read_b64_tr_b16 a[218:219], v29 offset:512
v_mfma_f32_16x16x32_bf16 v[104:107], a[196:199], a[108:111], v[104:107]
v_mfma_f32_16x16x32_bf16 v[152:155], a[192:195], a[112:115], v[152:155]
ds_read_b64_tr_b16 a[220:221], v29 offset:4096
ds_read_b64_tr_b16 a[222:223], v29 offset:4608
v_mfma_f32_16x16x32_bf16 v[152:155], a[196:199], a[116:119], v[152:155]
v_mfma_f32_16x16x32_bf16 v[200:203], a[192:195], a[120:123], v[200:203]
v_mfma_f32_16x16x32_bf16 v[200:203], a[196:199], a[124:127], v[200:203]
v_mfma_f32_16x16x32_bf16 v[248:251], a[192:195], a[128:131], v[248:251]
v_mfma_f32_16x16x32_bf16 v[248:251], a[196:199], a[132:135], v[248:251]
s_waitcnt lgkmcnt(8)
v_mfma_f32_16x16x32_bf16 v[108:111], a[200:203], a[104:107], v[108:111]
s_waitcnt vmcnt(21) lgkmcnt(0)
s_barrier
v_mfma_f32_16x16x32_bf16 v[108:111], a[204:207], a[108:111], v[108:111]
ds_read_b64_tr_b16 a[192:193], v26 offset:32768
ds_read_b64_tr_b16 a[194:195], v26 offset:34304
v_mfma_f32_16x16x32_bf16 v[156:159], a[200:203], a[112:115], v[156:159]
v_mfma_f32_16x16x32_bf16 v[156:159], a[204:207], a[116:119], v[156:159]
ds_read_b64_tr_b16 a[196:197], v26 offset:45056
ds_read_b64_tr_b16 a[198:199], v26 offset:46592
v_mfma_f32_16x16x32_bf16 v[204:207], a[200:203], a[120:123], v[204:207]
v_mfma_f32_16x16x32_bf16 v[204:207], a[204:207], a[124:127], v[204:207]
v_mfma_f32_16x16x32_bf16 v[252:255], a[200:203], a[128:131], v[252:255]
v_mfma_f32_16x16x32_bf16 v[252:255], a[204:207], a[132:135], v[252:255]
v_mfma_f32_16x16x32_bf16 a[144:147], a[208:211], a[104:107], a[144:147]
ds_read_b64_tr_b16 a[200:201], v26 offset:32776
ds_read_b64_tr_b16 a[202:203], v26 offset:34312
v_mfma_f32_16x16x32_bf16 a[144:147], a[212:215], a[108:111], a[144:147]
v_mfma_f32_16x16x32_bf16 a[152:155], a[208:211], a[112:115], a[152:155]
ds_read_b64_tr_b16 a[204:205], v26 offset:45064
ds_read_b64_tr_b16 a[206:207], v26 offset:46600
v_mfma_f32_16x16x32_bf16 a[152:155], a[212:215], a[116:119], a[152:155]
v_mfma_f32_16x16x32_bf16 a[160:163], a[208:211], a[120:123], a[160:163]
v_mfma_f32_16x16x32_bf16 a[160:163], a[212:215], a[124:127], a[160:163]
v_mfma_f32_16x16x32_bf16 a[168:171], a[208:211], a[128:131], a[168:171]
v_mfma_f32_16x16x32_bf16 a[168:171], a[212:215], a[132:135], a[168:171]
v_mfma_f32_16x16x32_bf16 a[148:151], a[216:219], a[104:107], a[148:151]
ds_read_b64_tr_b16 a[208:209], v27 offset:32768
ds_read_b64_tr_b16 a[210:211], v27 offset:34304
v_mfma_f32_16x16x32_bf16 a[148:151], a[220:223], a[108:111], a[148:151]
v_mfma_f32_16x16x32_bf16 a[156:159], a[216:219], a[112:115], a[156:159]
ds_read_b64_tr_b16 a[212:213], v27 offset:45056
ds_read_b64_tr_b16 a[214:215], v27 offset:46592
v_mfma_f32_16x16x32_bf16 a[156:159], a[220:223], a[116:119], a[156:159]
v_mfma_f32_16x16x32_bf16 a[164:167], a[216:219], a[120:123], a[164:167]
v_mfma_f32_16x16x32_bf16 a[164:167], a[220:223], a[124:127], a[164:167]
v_mfma_f32_16x16x32_bf16 a[172:175], a[216:219], a[128:131], a[172:175]
v_mfma_f32_16x16x32_bf16 a[172:175], a[220:223], a[132:135], a[172:175]
s_waitcnt vmcnt(10) lgkmcnt(8)
v_mfma_f32_16x16x32_bf16 v[64:67], a[192:195], a[40:43], v[64:67]
ds_read_b64_tr_b16 a[216:217], v27 offset:32776
ds_read_b64_tr_b16 a[218:219], v27 offset:34312
v_mfma_f32_16x16x32_bf16 v[64:67], a[196:199], a[44:47], v[64:67]
s_add_u32 m0, s23, 0
v_mfma_f32_16x16x32_bf16 v[112:115], a[192:195], a[48:51], v[112:115]
ds_read_b64_tr_b16 a[220:221], v27 offset:45064
ds_read_b64_tr_b16 a[222:223], v27 offset:46600
v_mfma_f32_16x16x32_bf16 v[112:115], a[196:199], a[52:55], v[112:115]
buffer_load_dwordx4 v11, s[12:15], s21 offen offset:0 lds
v_mfma_f32_16x16x32_bf16 v[160:163], a[192:195], a[56:59], v[160:163]
v_mfma_f32_16x16x32_bf16 v[160:163], a[196:199], a[60:63], v[160:163]
v_mfma_f32_16x16x32_bf16 v[208:211], a[192:195], a[64:67], v[208:211]
v_mfma_f32_16x16x32_bf16 v[208:211], a[196:199], a[68:71], v[208:211]
s_waitcnt lgkmcnt(8)
v_mfma_f32_16x16x32_bf16 v[68:71], a[200:203], a[40:43], v[68:71]
ds_read_b64_tr_b16 a[192:193], v30 offset:32768
ds_read_b64_tr_b16 a[194:195], v30 offset:33280
v_mfma_f32_16x16x32_bf16 v[68:71], a[204:207], a[44:47], v[68:71]
v_mfma_f32_16x16x32_bf16 v[116:119], a[200:203], a[48:51], v[116:119]
ds_read_b64_tr_b16 a[196:197], v30 offset:36864
ds_read_b64_tr_b16 a[198:199], v30 offset:37376
v_mfma_f32_16x16x32_bf16 v[116:119], a[204:207], a[52:55], v[116:119]
v_mfma_f32_16x16x32_bf16 v[164:167], a[200:203], a[56:59], v[164:167]
v_mfma_f32_16x16x32_bf16 v[164:167], a[204:207], a[60:63], v[164:167]
v_mfma_f32_16x16x32_bf16 v[212:215], a[200:203], a[64:67], v[212:215]
v_mfma_f32_16x16x32_bf16 v[212:215], a[204:207], a[68:71], v[212:215]
s_waitcnt lgkmcnt(8)
v_mfma_f32_16x16x32_bf16 v[72:75], a[208:211], a[40:43], v[72:75]
ds_read_b64_tr_b16 a[200:201], v26 offset:32896
ds_read_b64_tr_b16 a[202:203], v26 offset:34432
v_mfma_f32_16x16x32_bf16 v[72:75], a[212:215], a[44:47], v[72:75]
buffer_load_dwordx4 v12, s[12:15], s21 offen offset:1024 lds
v_mfma_f32_16x16x32_bf16 v[120:123], a[208:211], a[48:51], v[120:123]
ds_read_b64_tr_b16 a[204:205], v26 offset:45184
ds_read_b64_tr_b16 a[206:207], v26 offset:46720
v_mfma_f32_16x16x32_bf16 v[120:123], a[212:215], a[52:55], v[120:123]
v_mfma_f32_16x16x32_bf16 v[168:171], a[208:211], a[56:59], v[168:171]
v_mfma_f32_16x16x32_bf16 v[168:171], a[212:215], a[60:63], v[168:171]
v_mfma_f32_16x16x32_bf16 v[216:219], a[208:211], a[64:67], v[216:219]
v_mfma_f32_16x16x32_bf16 v[216:219], a[212:215], a[68:71], v[216:219]
s_waitcnt lgkmcnt(8)
v_mfma_f32_16x16x32_bf16 v[76:79], a[216:219], a[40:43], v[76:79]
ds_read_b64_tr_b16 a[208:209], v26 offset:32904
ds_read_b64_tr_b16 a[210:211], v26 offset:34440
v_mfma_f32_16x16x32_bf16 v[76:79], a[220:223], a[44:47], v[76:79]
v_mfma_f32_16x16x32_bf16 v[124:127], a[216:219], a[48:51], v[124:127]
ds_read_b64_tr_b16 a[212:213], v26 offset:45192
ds_read_b64_tr_b16 a[214:215], v26 offset:46728
v_mfma_f32_16x16x32_bf16 v[124:127], a[220:223], a[52:55], v[124:127]
v_mfma_f32_16x16x32_bf16 v[172:175], a[216:219], a[56:59], v[172:175]
v_mfma_f32_16x16x32_bf16 v[172:175], a[220:223], a[60:63], v[172:175]
v_mfma_f32_16x16x32_bf16 v[220:223], a[216:219], a[64:67], v[220:223]
v_mfma_f32_16x16x32_bf16 v[220:223], a[220:223], a[68:71], v[220:223]
s_waitcnt lgkmcnt(8)
v_mfma_f32_16x16x32_bf16 a[176:179], a[192:195], a[40:43], a[176:179]
ds_read_b64_tr_b16 a[216:217], v27 offset:32896
ds_read_b64_tr_b16 a[218:219], v27 offset:34432
v_mfma_f32_16x16x32_bf16 a[176:179], a[196:199], a[44:47], a[176:179]
buffer_load_dwordx4 v13, s[12:15], s21 offen offset:2048 lds
v_mfma_f32_16x16x32_bf16 a[184:187], a[192:195], a[48:51], a[184:187]
ds_read_b64_tr_b16 a[220:221], v27 offset:45184
ds_read_b64_tr_b16 a[222:223], v27 offset:46720
v_mfma_f32_16x16x32_bf16 a[184:187], a[196:199], a[52:55], a[184:187]
s_waitcnt lgkmcnt(8)
v_mfma_f32_16x16x32_bf16 v[80:83], a[200:203], a[40:43], v[80:83]
ds_read_b64_tr_b16 a[192:193], v27 offset:32904
ds_read_b64_tr_b16 a[194:195], v27 offset:34440
v_mfma_f32_16x16x32_bf16 v[80:83], a[204:207], a[44:47], v[80:83]
v_mfma_f32_16x16x32_bf16 v[128:131], a[200:203], a[48:51], v[128:131]
ds_read_b64_tr_b16 a[196:197], v27 offset:45192
ds_read_b64_tr_b16 a[198:199], v27 offset:46728
v_mfma_f32_16x16x32_bf16 v[128:131], a[204:207], a[52:55], v[128:131]
v_mfma_f32_16x16x32_bf16 v[176:179], a[200:203], a[56:59], v[176:179]
v_mfma_f32_16x16x32_bf16 v[176:179], a[204:207], a[60:63], v[176:179]
v_mfma_f32_16x16x32_bf16 v[224:227], a[200:203], a[64:67], v[224:227]
v_mfma_f32_16x16x32_bf16 v[224:227], a[204:207], a[68:71], v[224:227]
s_waitcnt lgkmcnt(8)
v_mfma_f32_16x16x32_bf16 v[84:87], a[208:211], a[40:43], v[84:87]
ds_read_b64_tr_b16 a[200:201], v26 offset:33024
ds_read_b64_tr_b16 a[202:203], v26 offset:34560
v_mfma_f32_16x16x32_bf16 v[84:87], a[212:215], a[44:47], v[84:87]
s_add_u32 s21, s21, 12288
s_add_u32 m0, s22, 24576
v_mfma_f32_16x16x32_bf16 v[132:135], a[208:211], a[48:51], v[132:135]
ds_read_b64_tr_b16 a[204:205], v26 offset:45312
ds_read_b64_tr_b16 a[206:207], v26 offset:46848
v_mfma_f32_16x16x32_bf16 v[132:135], a[212:215], a[52:55], v[132:135]
buffer_load_dwordx4 v8, s[8:11], s20 offen offset:0 lds
v_mfma_f32_16x16x32_bf16 v[180:183], a[208:211], a[56:59], v[180:183]
v_mfma_f32_16x16x32_bf16 v[180:183], a[212:215], a[60:63], v[180:183]
v_mfma_f32_16x16x32_bf16 v[228:231], a[208:211], a[64:67], v[228:231]
v_mfma_f32_16x16x32_bf16 v[228:231], a[212:215], a[68:71], v[228:231]
s_waitcnt lgkmcnt(8)
v_mfma_f32_16x16x32_bf16 v[88:91], a[216:219], a[40:43], v[88:91]
ds_read_b64_tr_b16 a[208:209], v31 offset:32768
ds_read_b64_tr_b16 a[210:211], v31 offset:33280
v_mfma_f32_16x16x32_bf16 v[88:91], a[220:223], a[44:47], v[88:91]
v_mfma_f32_16x16x32_bf16 v[136:139], a[216:219], a[48:51], v[136:139]
ds_read_b64_tr_b16 a[212:213], v31 offset:36864
ds_read_b64_tr_b16 a[214:215], v31 offset:37376
v_mfma_f32_16x16x32_bf16 v[136:139], a[220:223], a[52:55], v[136:139]
v_mfma_f32_16x16x32_bf16 v[184:187], a[216:219], a[56:59], v[184:187]
v_mfma_f32_16x16x32_bf16 v[184:187], a[220:223], a[60:63], v[184:187]
v_mfma_f32_16x16x32_bf16 v[232:235], a[216:219], a[64:67], v[232:235]
v_mfma_f32_16x16x32_bf16 v[232:235], a[220:223], a[68:71], v[232:235]
s_waitcnt lgkmcnt(8)
v_mfma_f32_16x16x32_bf16 v[92:95], a[192:195], a[40:43], v[92:95]
ds_read_b64_tr_b16 a[216:217], v26 offset:33032
ds_read_b64_tr_b16 a[218:219], v26 offset:34568
v_mfma_f32_16x16x32_bf16 v[92:95], a[196:199], a[44:47], v[92:95]
v_mfma_f32_16x16x32_bf16 v[140:143], a[192:195], a[48:51], v[140:143]
ds_read_b64_tr_b16 a[220:221], v26 offset:45320
ds_read_b64_tr_b16 a[222:223], v26 offset:46856
v_mfma_f32_16x16x32_bf16 v[140:143], a[196:199], a[52:55], v[140:143]
buffer_load_dwordx4 v9, s[8:11], s20 offen offset:1024 lds
v_mfma_f32_16x16x32_bf16 v[188:191], a[192:195], a[56:59], v[188:191]
v_mfma_f32_16x16x32_bf16 v[188:191], a[196:199], a[60:63], v[188:191]
v_mfma_f32_16x16x32_bf16 v[236:239], a[192:195], a[64:67], v[236:239]
v_mfma_f32_16x16x32_bf16 v[236:239], a[196:199], a[68:71], v[236:239]
s_waitcnt lgkmcnt(8)
v_mfma_f32_16x16x32_bf16 v[96:99], a[200:203], a[40:43], v[96:99]
ds_read_b64_tr_b16 a[192:193], v27 offset:33024
ds_read_b64_tr_b16 a[194:195], v27 offset:34560
v_mfma_f32_16x16x32_bf16 v[96:99], a[204:207], a[44:47], v[96:99]
v_mfma_f32_16x16x32_bf16 v[144:147], a[200:203], a[48:51], v[144:147]
ds_read_b64_tr_b16 a[196:197], v27 offset:45312
ds_read_b64_tr_b16 a[198:199], v27 offset:46848
v_mfma_f32_16x16x32_bf16 v[144:147], a[204:207], a[52:55], v[144:147]
v_mfma_f32_16x16x32_bf16 v[192:195], a[200:203], a[56:59], v[192:195]
v_mfma_f32_16x16x32_bf16 v[192:195], a[204:207], a[60:63], v[192:195]
v_mfma_f32_16x16x32_bf16 v[240:243], a[200:203], a[64:67], v[240:243]
v_mfma_f32_16x16x32_bf16 v[240:243], a[204:207], a[68:71], v[240:243]
s_waitcnt lgkmcnt(8)
v_mfma_f32_16x16x32_bf16 a[180:183], a[208:211], a[40:43], a[180:183]
ds_read_b64_tr_b16 a[200:201], v27 offset:33032
ds_read_b64_tr_b16 a[202:203], v27 offset:34568
v_mfma_f32_16x16x32_bf16 a[180:183], a[212:215], a[44:47], a[180:183]
v_mfma_f32_16x16x32_bf16 a[188:191], a[208:211], a[48:51], a[188:191]
ds_read_b64_tr_b16 a[204:205], v27 offset:45320
ds_read_b64_tr_b16 a[206:207], v27 offset:46856
v_mfma_f32_16x16x32_bf16 a[188:191], a[212:215], a[52:55], a[188:191]
s_waitcnt lgkmcnt(8)
v_mfma_f32_16x16x32_bf16 v[100:103], a[216:219], a[40:43], v[100:103]
ds_read_b64_tr_b16 a[208:209], v28 offset:32768
ds_read_b64_tr_b16 a[210:211], v28 offset:33280
v_mfma_f32_16x16x32_bf16 v[100:103], a[220:223], a[44:47], v[100:103]
buffer_load_dwordx4 v10, s[8:11], s20 offen offset:2048 lds
v_mfma_f32_16x16x32_bf16 v[148:151], a[216:219], a[48:51], v[148:151]
ds_read_b64_tr_b16 a[212:213], v28 offset:36864
ds_read_b64_tr_b16 a[214:215], v28 offset:37376
v_mfma_f32_16x16x32_bf16 v[148:151], a[220:223], a[52:55], v[148:151]
v_mfma_f32_16x16x32_bf16 v[196:199], a[216:219], a[56:59], v[196:199]
v_mfma_f32_16x16x32_bf16 v[196:199], a[220:223], a[60:63], v[196:199]
v_mfma_f32_16x16x32_bf16 v[244:247], a[216:219], a[64:67], v[244:247]
v_mfma_f32_16x16x32_bf16 v[244:247], a[220:223], a[68:71], v[244:247]
s_waitcnt lgkmcnt(8)
v_mfma_f32_16x16x32_bf16 v[104:107], a[192:195], a[40:43], v[104:107]
ds_read_b64_tr_b16 a[216:217], v29 offset:32768
ds_read_b64_tr_b16 a[218:219], v29 offset:33280
v_mfma_f32_16x16x32_bf16 v[104:107], a[196:199], a[44:47], v[104:107]
v_mfma_f32_16x16x32_bf16 v[152:155], a[192:195], a[48:51], v[152:155]
ds_read_b64_tr_b16 a[220:221], v29 offset:36864
ds_read_b64_tr_b16 a[222:223], v29 offset:37376
v_mfma_f32_16x16x32_bf16 v[152:155], a[196:199], a[52:55], v[152:155]
v_mfma_f32_16x16x32_bf16 v[200:203], a[192:195], a[56:59], v[200:203]
s_add_u32 s20, s20, 12288
v_mfma_f32_16x16x32_bf16 v[200:203], a[196:199], a[60:63], v[200:203]
v_mfma_f32_16x16x32_bf16 v[248:251], a[192:195], a[64:67], v[248:251]
v_mfma_f32_16x16x32_bf16 v[248:251], a[196:199], a[68:71], v[248:251]
s_waitcnt lgkmcnt(8)
v_mfma_f32_16x16x32_bf16 v[108:111], a[200:203], a[40:43], v[108:111]
v_mfma_f32_16x16x32_bf16 v[108:111], a[204:207], a[44:47], v[108:111]
v_mfma_f32_16x16x32_bf16 v[156:159], a[200:203], a[48:51], v[156:159]
v_mfma_f32_16x16x32_bf16 v[156:159], a[204:207], a[52:55], v[156:159]
v_mfma_f32_16x16x32_bf16 v[204:207], a[200:203], a[56:59], v[204:207]
v_mfma_f32_16x16x32_bf16 v[204:207], a[204:207], a[60:63], v[204:207]
v_mfma_f32_16x16x32_bf16 v[252:255], a[200:203], a[64:67], v[252:255]
v_mfma_f32_16x16x32_bf16 v[252:255], a[204:207], a[68:71], v[252:255]
s_waitcnt lgkmcnt(4)
v_mfma_f32_16x16x32_bf16 a[144:147], a[208:211], a[40:43], a[144:147]
v_mfma_f32_16x16x32_bf16 a[144:147], a[212:215], a[44:47], a[144:147]
v_mfma_f32_16x16x32_bf16 a[152:155], a[208:211], a[48:51], a[152:155]
v_mfma_f32_16x16x32_bf16 a[152:155], a[212:215], a[52:55], a[152:155]
v_mfma_f32_16x16x32_bf16 a[160:163], a[208:211], a[56:59], a[160:163]
v_mfma_f32_16x16x32_bf16 a[160:163], a[212:215], a[60:63], a[160:163]
v_mfma_f32_16x16x32_bf16 a[168:171], a[208:211], a[64:67], a[168:171]
v_mfma_f32_16x16x32_bf16 a[168:171], a[212:215], a[68:71], a[168:171]
s_waitcnt lgkmcnt(0)
v_mfma_f32_16x16x32_bf16 a[148:151], a[216:219], a[40:43], a[148:151]
v_mfma_f32_16x16x32_bf16 a[148:151], a[220:223], a[44:47], a[148:151]
v_mfma_f32_16x16x32_bf16 a[156:159], a[216:219], a[48:51], a[156:159]
v_mfma_f32_16x16x32_bf16 a[156:159], a[220:223], a[52:55], a[156:159]
v_mfma_f32_16x16x32_bf16 a[164:167], a[216:219], a[56:59], a[164:167]
v_mfma_f32_16x16x32_bf16 a[164:167], a[220:223], a[60:63], a[164:167]
v_mfma_f32_16x16x32_bf16 a[172:175], a[216:219], a[64:67], a[172:175]
v_mfma_f32_16x16x32_bf16 a[172:175], a[220:223], a[68:71], a[172:175]
s_nop 7
.p2align 3
v_cvt_pk_bf16_f32 v64, v64, v65
v_cvt_pk_bf16_f32 v65, v66, v67
v_cvt_pk_bf16_f32 v66, v68, v69
v_cvt_pk_bf16_f32 v67, v70, v71
v_accvgpr_write_b32 a192, v64
v_accvgpr_write_b32 a193, v65
v_accvgpr_write_b32 a194, v66
v_accvgpr_write_b32 a195, v67
v_cvt_pk_bf16_f32 v72, v72, v73
v_cvt_pk_bf16_f32 v73, v74, v75
v_cvt_pk_bf16_f32 v74, v76, v77
v_cvt_pk_bf16_f32 v75, v78, v79
v_accvgpr_write_b32 a196, v72
v_accvgpr_write_b32 a197, v73
v_accvgpr_write_b32 a198, v74
v_accvgpr_write_b32 a199, v75
v_cvt_pk_bf16_f32 v80, v80, v81
v_cvt_pk_bf16_f32 v81, v82, v83
v_cvt_pk_bf16_f32 v82, v84, v85
v_cvt_pk_bf16_f32 v83, v86, v87
v_accvgpr_write_b32 a200, v80
v_accvgpr_write_b32 a201, v81
v_accvgpr_write_b32 a202, v82
v_accvgpr_write_b32 a203, v83
v_cvt_pk_bf16_f32 v88, v88, v89
v_cvt_pk_bf16_f32 v89, v90, v91
v_cvt_pk_bf16_f32 v90, v92, v93
v_cvt_pk_bf16_f32 v91, v94, v95
v_accvgpr_write_b32 a204, v88
v_accvgpr_write_b32 a205, v89
v_accvgpr_write_b32 a206, v90
v_accvgpr_write_b32 a207, v91
v_cvt_pk_bf16_f32 v96, v96, v97
v_cvt_pk_bf16_f32 v97, v98, v99
v_cvt_pk_bf16_f32 v98, v100, v101
v_cvt_pk_bf16_f32 v99, v102, v103
v_accvgpr_write_b32 a208, v96
v_accvgpr_write_b32 a209, v97
v_accvgpr_write_b32 a210, v98
v_accvgpr_write_b32 a211, v99
v_cvt_pk_bf16_f32 v104, v104, v105
v_cvt_pk_bf16_f32 v105, v106, v107
v_cvt_pk_bf16_f32 v106, v108, v109
v_cvt_pk_bf16_f32 v107, v110, v111
v_accvgpr_write_b32 a212, v104
v_accvgpr_write_b32 a213, v105
v_accvgpr_write_b32 a214, v106
v_accvgpr_write_b32 a215, v107
v_cvt_pk_bf16_f32 v112, v112, v113
v_cvt_pk_bf16_f32 v113, v114, v115
v_cvt_pk_bf16_f32 v114, v116, v117
v_cvt_pk_bf16_f32 v115, v118, v119
v_accvgpr_write_b32 a216, v112
v_accvgpr_write_b32 a217, v113
v_accvgpr_write_b32 a218, v114
v_accvgpr_write_b32 a219, v115
v_cvt_pk_bf16_f32 v120, v120, v121
v_cvt_pk_bf16_f32 v121, v122, v123
v_cvt_pk_bf16_f32 v122, v124, v125
v_cvt_pk_bf16_f32 v123, v126, v127
v_accvgpr_write_b32 a220, v120
v_accvgpr_write_b32 a221, v121
v_accvgpr_write_b32 a222, v122
v_accvgpr_write_b32 a223, v123
v_cvt_pk_bf16_f32 v128, v128, v129
v_cvt_pk_bf16_f32 v129, v130, v131
v_cvt_pk_bf16_f32 v130, v132, v133
v_cvt_pk_bf16_f32 v131, v134, v135
v_accvgpr_write_b32 a224, v128
v_accvgpr_write_b32 a225, v129
v_accvgpr_write_b32 a226, v130
v_accvgpr_write_b32 a227, v131
v_cvt_pk_bf16_f32 v136, v136, v137
v_cvt_pk_bf16_f32 v137, v138, v139
v_cvt_pk_bf16_f32 v138, v140, v141
v_cvt_pk_bf16_f32 v139, v142, v143
v_accvgpr_write_b32 a228, v136
v_accvgpr_write_b32 a229, v137
v_accvgpr_write_b32 a230, v138
v_accvgpr_write_b32 a231, v139
v_cvt_pk_bf16_f32 v144, v144, v145
v_cvt_pk_bf16_f32 v145, v146, v147
v_cvt_pk_bf16_f32 v146, v148, v149
v_cvt_pk_bf16_f32 v147, v150, v151
v_accvgpr_write_b32 a232, v144
v_accvgpr_write_b32 a233, v145
v_accvgpr_write_b32 a234, v146
v_accvgpr_write_b32 a235, v147
v_cvt_pk_bf16_f32 v152, v152, v153
v_cvt_pk_bf16_f32 v153, v154, v155
v_cvt_pk_bf16_f32 v154, v156, v157
v_cvt_pk_bf16_f32 v155, v158, v159
v_accvgpr_write_b32 a236, v152
v_accvgpr_write_b32 a237, v153
v_accvgpr_write_b32 a238, v154
v_accvgpr_write_b32 a239, v155
v_cvt_pk_bf16_f32 v160, v160, v161
v_cvt_pk_bf16_f32 v161, v162, v163
v_cvt_pk_bf16_f32 v162, v164, v165
v_cvt_pk_bf16_f32 v163, v166, v167
v_accvgpr_write_b32 a240, v160
v_accvgpr_write_b32 a241, v161
v_accvgpr_write_b32 a242, v162
v_accvgpr_write_b32 a243, v163
v_cvt_pk_bf16_f32 v168, v168, v169
v_cvt_pk_bf16_f32 v169, v170, v171
v_cvt_pk_bf16_f32 v170, v172, v173
v_cvt_pk_bf16_f32 v171, v174, v175
v_accvgpr_write_b32 a244, v168
v_accvgpr_write_b32 a245, v169
v_accvgpr_write_b32 a246, v170
v_accvgpr_write_b32 a247, v171
v_cvt_pk_bf16_f32 v176, v176, v177
v_cvt_pk_bf16_f32 v177, v178, v179
v_cvt_pk_bf16_f32 v178, v180, v181
v_cvt_pk_bf16_f32 v179, v182, v183
v_accvgpr_write_b32 a248, v176
v_accvgpr_write_b32 a249, v177
v_accvgpr_write_b32 a250, v178
v_accvgpr_write_b32 a251, v179
v_cvt_pk_bf16_f32 v184, v184, v185
v_cvt_pk_bf16_f32 v185, v186, v187
v_cvt_pk_bf16_f32 v186, v188, v189
v_cvt_pk_bf16_f32 v187, v190, v191
v_accvgpr_write_b32 a252, v184
v_accvgpr_write_b32 a253, v185
v_accvgpr_write_b32 a254, v186
v_accvgpr_write_b32 a255, v187
v_cvt_pk_bf16_f32 v64, v192, v193
v_cvt_pk_bf16_f32 v65, v194, v195
v_cvt_pk_bf16_f32 v66, v196, v197
v_cvt_pk_bf16_f32 v67, v198, v199
v_cvt_pk_bf16_f32 v68, v200, v201
v_cvt_pk_bf16_f32 v69, v202, v203
v_cvt_pk_bf16_f32 v70, v204, v205
v_cvt_pk_bf16_f32 v71, v206, v207
v_cvt_pk_bf16_f32 v72, v208, v209
v_cvt_pk_bf16_f32 v73, v210, v211
v_cvt_pk_bf16_f32 v74, v212, v213
v_cvt_pk_bf16_f32 v75, v214, v215
v_cvt_pk_bf16_f32 v76, v216, v217
v_cvt_pk_bf16_f32 v77, v218, v219
v_cvt_pk_bf16_f32 v78, v220, v221
v_cvt_pk_bf16_f32 v79, v222, v223
v_cvt_pk_bf16_f32 v80, v224, v225
v_cvt_pk_bf16_f32 v81, v226, v227
v_cvt_pk_bf16_f32 v82, v228, v229
v_cvt_pk_bf16_f32 v83, v230, v231
v_cvt_pk_bf16_f32 v84, v232, v233
v_cvt_pk_bf16_f32 v85, v234, v235
v_cvt_pk_bf16_f32 v86, v236, v237
v_cvt_pk_bf16_f32 v87, v238, v239
v_cvt_pk_bf16_f32 v88, v240, v241
v_cvt_pk_bf16_f32 v89, v242, v243
v_cvt_pk_bf16_f32 v90, v244, v245
v_cvt_pk_bf16_f32 v91, v246, v247
v_cvt_pk_bf16_f32 v92, v248, v249
v_cvt_pk_bf16_f32 v93, v250, v251
v_cvt_pk_bf16_f32 v94, v252, v253
v_cvt_pk_bf16_f32 v95, v254, v255
v_lshlrev_b32 v26, 4, v1
s_xor_b32 s3, s54, 0
s_mul_i32 s3, s3, 245760
v_add_u32 v28, s3, v26
s_xor_b32 s3, s54, 1
s_mul_i32 s3, s3, 245760
v_add_u32 v29, s3, v26
s_xor_b32 s3, s54, 2
s_mul_i32 s3, s3, 245760
v_add_u32 v30, s3, v26
s_xor_b32 s3, s54, 3
s_mul_i32 s3, s3, 245760
v_add_u32 v31, s3, v26
s_waitcnt vmcnt(7)
s_barrier
.p2align 3
ds_read_b128 v[176:179], v2 offset:0
ds_read_b128 v[180:183], v3 offset:0
ds_read_b128 v[184:187], v2 offset:128
ds_read_b128 v[188:191], v3 offset:128
ds_read_b128 v[192:195], v2 offset:256
ds_read_b128 v[196:199], v3 offset:256
s_waitcnt lgkmcnt(0)
v_mfma_f32_16x16x32_bf16 v[96:99], v[176:179], a[192:195], 0
v_accvgpr_read_b32 v40, a144
v_accvgpr_read_b32 v41, a145
v_accvgpr_read_b32 v42, a146
v_mfma_f32_16x16x32_bf16 v[96:99], v[180:183], a[196:199], v[96:99]
v_accvgpr_read_b32 v43, a147
v_accvgpr_read_b32 v44, a148
v_accvgpr_read_b32 v45, a149
v_mfma_f32_16x16x32_bf16 v[96:99], v[184:187], a[200:203], v[96:99]
v_accvgpr_read_b32 v46, a150
v_accvgpr_read_b32 v47, a151
v_cvt_pk_bf16_f32 v224, v40, v41
v_mfma_f32_16x16x32_bf16 v[96:99], v[188:191], a[204:207], v[96:99]
s_add_u32 m0, s22, 36864
v_mfma_f32_16x16x32_bf16 v[96:99], v[192:195], a[208:211], v[96:99]
buffer_load_dwordx4 v8, s[8:11], s20 offen offset:0 lds
v_mfma_f32_16x16x32_bf16 v[96:99], v[196:199], a[212:215], v[96:99]
v_cvt_pk_bf16_f32 v225, v42, v43
v_cvt_pk_bf16_f32 v226, v44, v45
v_cvt_pk_bf16_f32 v227, v46, v47
v_mfma_f32_16x16x32_bf16 v[104:107], v[176:179], a[216:219], 0
v_pk_max_i16 v224, v224, 0
v_pk_max_i16 v225, v225, 0
v_pk_max_i16 v226, v226, 0
v_mfma_f32_16x16x32_bf16 v[104:107], v[180:183], a[220:223], v[104:107]
buffer_load_dwordx4 v9, s[8:11], s20 offen offset:1024 lds
v_mfma_f32_16x16x32_bf16 v[104:107], v[184:187], a[224:227], v[104:107]
v_pk_max_i16 v227, v227, 0
v_accvgpr_read_b32 v48, a152
v_accvgpr_read_b32 v49, a153
v_mfma_f32_16x16x32_bf16 v[104:107], v[188:191], a[228:231], v[104:107]
v_accvgpr_read_b32 v50, a154
v_accvgpr_read_b32 v51, a155
v_accvgpr_read_b32 v52, a156
v_mfma_f32_16x16x32_bf16 v[104:107], v[192:195], a[232:235], v[104:107]
buffer_load_dwordx4 v10, s[8:11], s20 offen offset:2048 lds
v_mfma_f32_16x16x32_bf16 v[104:107], v[196:199], a[236:239], v[104:107]
s_add_u32 s20, s20, 12288
v_mfma_f32_16x16x32_bf16 v[112:115], v[176:179], a[240:243], 0
ds_read_b128 v[200:203], v2 offset:6144
ds_read_b128 v[204:207], v3 offset:6144
v_mfma_f32_16x16x32_bf16 v[112:115], v[180:183], a[244:247], v[112:115]
s_add_u32 m0, s23, 12288
v_mfma_f32_16x16x32_bf16 v[112:115], v[184:187], a[248:251], v[112:115]
ds_read_b128 v[208:211], v2 offset:6272
ds_read_b128 v[212:215], v3 offset:6272
v_mfma_f32_16x16x32_bf16 v[112:115], v[188:191], a[252:255], v[112:115]
buffer_load_dwordx4 v11, s[12:15], s21 offen offset:0 lds
v_mfma_f32_16x16x32_bf16 v[112:115], v[192:195], v[64:67], v[112:115]
ds_read_b128 v[216:219], v2 offset:6400
ds_read_b128 v[220:223], v3 offset:6400
v_mfma_f32_16x16x32_bf16 v[112:115], v[196:199], v[68:71], v[112:115]
v_accvgpr_read_b32 v53, a157
v_accvgpr_read_b32 v54, a158
v_accvgpr_read_b32 v55, a159
v_mfma_f32_16x16x32_bf16 v[120:123], v[176:179], v[72:75], 0
buffer_load_dwordx4 v12, s[12:15], s21 offen offset:1024 lds
v_mfma_f32_16x16x32_bf16 v[120:123], v[180:183], v[76:79], v[120:123]
v_cvt_pk_bf16_f32 v228, v48, v49
v_cvt_pk_bf16_f32 v229, v50, v51
v_cvt_pk_bf16_f32 v230, v52, v53
v_mfma_f32_16x16x32_bf16 v[120:123], v[184:187], v[80:83], v[120:123]
v_cvt_pk_bf16_f32 v231, v54, v55
v_pk_max_i16 v228, v228, 0
v_pk_max_i16 v229, v229, 0
v_mfma_f32_16x16x32_bf16 v[120:123], v[188:191], v[84:87], v[120:123]
buffer_load_dwordx4 v13, s[12:15], s21 offen offset:2048 lds
v_mfma_f32_16x16x32_bf16 v[120:123], v[192:195], v[88:91], v[120:123]
s_add_u32 s21, s21, 12288
v_mfma_f32_16x16x32_bf16 v[120:123], v[196:199], v[92:95], v[120:123]
s_waitcnt lgkmcnt(0)
v_mfma_f32_16x16x32_bf16 v[100:103], v[200:203], a[192:195], 0
v_pk_max_i16 v230, v230, 0
v_pk_max_i16 v231, v231, 0
v_accvgpr_read_b32 v40, a160
v_mfma_f32_16x16x32_bf16 v[100:103], v[204:207], a[196:199], v[100:103]
v_accvgpr_read_b32 v41, a161
v_accvgpr_read_b32 v42, a162
v_accvgpr_read_b32 v43, a163
v_mfma_f32_16x16x32_bf16 v[100:103], v[208:211], a[200:203], v[100:103]
v_accvgpr_read_b32 v44, a164
v_accvgpr_read_b32 v45, a165
v_accvgpr_read_b32 v46, a166
v_mfma_f32_16x16x32_bf16 v[100:103], v[212:215], a[204:207], v[100:103]
v_accvgpr_read_b32 v47, a167
v_cvt_pk_bf16_f32 v232, v40, v41
v_cvt_pk_bf16_f32 v233, v42, v43
v_mfma_f32_16x16x32_bf16 v[100:103], v[216:219], a[208:211], v[100:103]
v_cvt_pk_bf16_f32 v234, v44, v45
v_cvt_pk_bf16_f32 v235, v46, v47
v_pk_max_i16 v232, v232, 0
v_mfma_f32_16x16x32_bf16 v[100:103], v[220:223], a[212:215], v[100:103]
v_pk_max_i16 v233, v233, 0
v_pk_max_i16 v234, v234, 0
v_pk_max_i16 v235, v235, 0
v_mfma_f32_16x16x32_bf16 v[108:111], v[200:203], a[216:219], 0
v_accvgpr_read_b32 v48, a168
v_accvgpr_read_b32 v49, a169
v_accvgpr_read_b32 v50, a170
v_mfma_f32_16x16x32_bf16 v[108:111], v[204:207], a[220:223], v[108:111]
v_accvgpr_read_b32 v51, a171
v_accvgpr_read_b32 v52, a172
v_accvgpr_read_b32 v53, a173
v_mfma_f32_16x16x32_bf16 v[108:111], v[208:211], a[224:227], v[108:111]
v_accvgpr_read_b32 v54, a174
v_accvgpr_read_b32 v55, a175
v_cvt_pk_bf16_f32 v236, v48, v49
v_mfma_f32_16x16x32_bf16 v[108:111], v[212:215], a[228:231], v[108:111]
v_cvt_pk_bf16_f32 v237, v50, v51
v_cvt_pk_bf16_f32 v238, v52, v53
v_cvt_pk_bf16_f32 v239, v54, v55
v_mfma_f32_16x16x32_bf16 v[108:111], v[216:219], a[232:235], v[108:111]
v_pk_max_i16 v236, v236, 0
v_pk_max_i16 v237, v237, 0
v_pk_max_i16 v238, v238, 0
v_mfma_f32_16x16x32_bf16 v[108:111], v[220:223], a[236:239], v[108:111]
v_pk_max_i16 v239, v239, 0
v_accvgpr_read_b32 v40, a176
v_accvgpr_read_b32 v41, a177
v_mfma_f32_16x16x32_bf16 v[116:119], v[200:203], a[240:243], 0
v_accvgpr_read_b32 v42, a178
v_accvgpr_read_b32 v43, a179
v_accvgpr_read_b32 v44, a180
v_mfma_f32_16x16x32_bf16 v[116:119], v[204:207], a[244:247], v[116:119]
v_accvgpr_read_b32 v45, a181
v_accvgpr_read_b32 v46, a182
v_accvgpr_read_b32 v47, a183
v_mfma_f32_16x16x32_bf16 v[116:119], v[208:211], a[248:251], v[116:119]
v_cvt_pk_bf16_f32 v240, v40, v41
v_cvt_pk_bf16_f32 v241, v42, v43
v_cvt_pk_bf16_f32 v242, v44, v45
v_mfma_f32_16x16x32_bf16 v[116:119], v[212:215], a[252:255], v[116:119]
v_cvt_pk_bf16_f32 v243, v46, v47
v_pk_max_i16 v240, v240, 0
v_pk_max_i16 v241, v241, 0
v_mfma_f32_16x16x32_bf16 v[116:119], v[216:219], v[64:67], v[116:119]
v_pk_max_i16 v242, v242, 0
v_pk_max_i16 v243, v243, 0
v_accvgpr_read_b32 v48, a184
v_mfma_f32_16x16x32_bf16 v[116:119], v[220:223], v[68:71], v[116:119]
v_accvgpr_read_b32 v49, a185
v_accvgpr_read_b32 v50, a186
v_accvgpr_read_b32 v51, a187
v_mfma_f32_16x16x32_bf16 v[124:127], v[200:203], v[72:75], 0
v_accvgpr_read_b32 v52, a188
v_accvgpr_read_b32 v53, a189
v_accvgpr_read_b32 v54, a190
v_mfma_f32_16x16x32_bf16 v[124:127], v[204:207], v[76:79], v[124:127]
v_accvgpr_read_b32 v55, a191
v_cvt_pk_bf16_f32 v244, v48, v49
v_cvt_pk_bf16_f32 v245, v50, v51
v_mfma_f32_16x16x32_bf16 v[124:127], v[208:211], v[80:83], v[124:127]
v_cvt_pk_bf16_f32 v246, v52, v53
v_cvt_pk_bf16_f32 v247, v54, v55
v_pk_max_i16 v244, v244, 0
v_mfma_f32_16x16x32_bf16 v[124:127], v[212:215], v[84:87], v[124:127]
v_pk_max_i16 v245, v245, 0
v_pk_max_i16 v246, v246, 0
v_pk_max_i16 v247, v247, 0
v_mfma_f32_16x16x32_bf16 v[124:127], v[216:219], v[88:91], v[124:127]
v_mfma_f32_16x16x32_bf16 v[124:127], v[220:223], v[92:95], v[124:127]
s_nop 7
v_max3_f32 v18, v96, v97, v98
v_max3_f32 v18, v18, v99, v100
v_max3_f32 v18, v18, v101, v102
v_max_f32 v18, v18, v103
v_max3_f32 v19, v104, v105, v106
v_max3_f32 v19, v19, v107, v108
v_max3_f32 v19, v19, v109, v110
v_max_f32 v19, v19, v111
v_max3_f32 v20, v112, v113, v114
v_max3_f32 v20, v20, v115, v116
v_max3_f32 v20, v20, v117, v118
v_max_f32 v20, v20, v119
v_max3_f32 v21, v120, v121, v122
v_max3_f32 v21, v21, v123, v124
v_max3_f32 v21, v21, v125, v126
v_max_f32 v21, v21, v127
v_mov_b32 v22, v18
s_nop 1
v_permlane16_swap_b32 v18, v22
v_max_f32 v18, v18, v22
v_mov_b32 v22, v18
s_nop 1
v_permlane32_swap_b32 v18, v22
v_max_f32 v18, v18, v22
v_mov_b32 v22, v19
s_nop 1
v_permlane16_swap_b32 v19, v22
v_max_f32 v19, v19, v22
v_mov_b32 v22, v19
s_nop 1
v_permlane32_swap_b32 v19, v22
v_max_f32 v19, v19, v22
v_mov_b32 v22, v20
s_nop 1
v_permlane16_swap_b32 v20, v22
v_max_f32 v20, v20, v22
v_mov_b32 v22, v20
s_nop 1
v_permlane32_swap_b32 v20, v22
v_max_f32 v20, v20, v22
v_mov_b32 v22, v21
s_nop 1
v_permlane16_swap_b32 v21, v22
v_max_f32 v21, v21, v22
v_mov_b32 v22, v21
s_nop 1
v_permlane32_swap_b32 v21, v22
v_max_f32 v21, v21, v22
v_sub_f32 v96, v96, v18
v_sub_f32 v97, v97, v18
v_sub_f32 v98, v98, v18
v_sub_f32 v99, v99, v18
v_sub_f32 v100, v100, v18
v_sub_f32 v101, v101, v18
v_sub_f32 v102, v102, v18
v_sub_f32 v103, v103, v18
v_sub_f32 v160, 0, v18
v_sub_f32 v161, 0, v18
v_sub_f32 v162, 0, v18
v_sub_f32 v163, 0, v18
v_sub_f32 v104, v104, v19
v_sub_f32 v105, v105, v19
v_sub_f32 v106, v106, v19
v_sub_f32 v107, v107, v19
v_sub_f32 v108, v108, v19
v_sub_f32 v109, v109, v19
v_sub_f32 v110, v110, v19
v_sub_f32 v111, v111, v19
v_sub_f32 v164, 0, v19
v_sub_f32 v165, 0, v19
v_sub_f32 v166, 0, v19
v_sub_f32 v167, 0, v19
v_sub_f32 v112, v112, v20
v_sub_f32 v113, v113, v20
v_sub_f32 v114, v114, v20
v_sub_f32 v115, v115, v20
v_sub_f32 v116, v116, v20
v_sub_f32 v117, v117, v20
v_sub_f32 v118, v118, v20
v_sub_f32 v119, v119, v20
v_sub_f32 v168, 0, v20
v_sub_f32 v169, 0, v20
v_sub_f32 v170, 0, v20
v_sub_f32 v171, 0, v20
v_sub_f32 v120, v120, v21
v_sub_f32 v121, v121, v21
v_sub_f32 v122, v122, v21
v_sub_f32 v123, v123, v21
v_sub_f32 v124, v124, v21
v_sub_f32 v125, v125, v21
v_sub_f32 v126, v126, v21
v_sub_f32 v127, v127, v21
v_sub_f32 v172, 0, v21
v_sub_f32 v173, 0, v21
v_sub_f32 v174, 0, v21
v_sub_f32 v175, 0, v21
v_exp_f32 v96, v96
v_exp_f32 v97, v97
v_add_f32 v14, v14, v96
v_add_f32 v14, v14, v97
v_exp_f32 v98, v98
v_cvt_pk_bf16_f32 v96, v96, v97
v_exp_f32 v99, v99
v_add_f32 v14, v14, v98
v_exp_f32 v104, v104
v_add_f32 v14, v14, v99
v_cvt_pk_bf16_f32 v97, v98, v99
v_exp_f32 v105, v105
s_lshr_b32 s3, s36, 1
s_mul_i32 s3, s3, 3
s_mul_i32 s38, s53, 240
s_add_u32 s38, s38, s3
s_add_u32 s39, s38, 193
s_add_u32 s38, s38, s54
s_add_u32 s38, s38, 192
s_lshl_b32 s38, s38, 10
s_lshl_b32 s39, s39, 10
s_add_u32 s38, s38, 4194304
s_add_u32 s39, s39, 4194304
buffer_store_dwordx4 v[224:227], v28, s[40:43], s38 offen sc0 sc1
v_add_f32 v15, v15, v104
v_add_f32 v15, v15, v105
v_exp_f32 v106, v106
v_cvt_pk_bf16_f32 v104, v104, v105
v_exp_f32 v107, v107
v_add_f32 v15, v15, v106
v_add_f32 v15, v15, v107
v_exp_f32 v112, v112
v_cvt_pk_bf16_f32 v105, v106, v107
v_exp_f32 v113, v113
buffer_store_dwordx4 v[228:231], v29, s[40:43], s38 offen sc0 sc1
v_add_f32 v16, v16, v112
v_add_f32 v16, v16, v113
v_cvt_pk_bf16_f32 v112, v112, v113
v_exp_f32 v114, v114
v_exp_f32 v115, v115
v_add_f32 v16, v16, v114
v_add_f32 v16, v16, v115
v_cvt_pk_bf16_f32 v113, v114, v115
v_exp_f32 v120, v120
v_exp_f32 v121, v121
v_add_f32 v17, v17, v120
v_add_f32 v17, v17, v121
v_exp_f32 v122, v122
v_cvt_pk_bf16_f32 v120, v120, v121
v_exp_f32 v123, v123
v_add_f32 v17, v17, v122
v_add_f32 v17, v17, v123
buffer_store_dwordx4 v[232:235], v30, s[40:43], s38 offen sc0 sc1
v_exp_f32 v100, v100
v_cvt_pk_bf16_f32 v121, v122, v123
v_exp_f32 v101, v101
v_add_f32 v14, v14, v100
v_add_f32 v14, v14, v101
v_cvt_pk_bf16_f32 v98, v100, v101
ds_read_b128 v[176:179], v2 offset:12288
ds_read_b128 v[180:183], v3 offset:12288
v_exp_f32 v102, v102
ds_read_b128 v[184:187], v2 offset:12416
ds_read_b128 v[188:191], v3 offset:12416
v_exp_f32 v103, v103
ds_read_b128 v[192:195], v2 offset:12544
ds_read_b128 v[196:199], v3 offset:12544
v_add_f32 v14, v14, v102
v_add_f32 v14, v14, v103
v_cvt_pk_bf16_f32 v99, v102, v103
v_exp_f32 v108, v108
v_exp_f32 v109, v109
v_add_f32 v15, v15, v108
v_add_f32 v15, v15, v109
v_cvt_pk_bf16_f32 v106, v108, v109
s_waitcnt lgkmcnt(0)
v_mfma_f32_16x16x32_bf16 v[128:131], v[176:179], a[192:195], v[160:163]
v_exp_f32 v110, v110
v_mfma_f32_16x16x32_bf16 v[128:131], v[180:183], a[196:199], v[128:131]
v_exp_f32 v111, v111
v_mfma_f32_16x16x32_bf16 v[128:131], v[184:187], a[200:203], v[128:131]
s_waitcnt vmcnt(9)
s_barrier
v_mfma_f32_16x16x32_bf16 v[128:131], v[188:191], a[204:207], v[128:131]
v_add_f32 v15, v15, v110
s_add_u32 m0, s22, 0
v_mfma_f32_16x16x32_bf16 v[128:131], v[192:195], a[208:211], v[128:131]
buffer_load_dwordx4 v8, s[8:11], s20 offen offset:0 lds
v_mfma_f32_16x16x32_bf16 v[128:131], v[196:199], a[212:215], v[128:131]
v_add_f32 v15, v15, v111
v_cvt_pk_bf16_f32 v107, v110, v111
v_mfma_f32_16x16x32_bf16 v[136:139], v[176:179], a[216:219], v[164:167]
v_exp_f32 v116, v116
v_mfma_f32_16x16x32_bf16 v[136:139], v[180:183], a[220:223], v[136:139]
buffer_load_dwordx4 v9, s[8:11], s20 offen offset:1024 lds
v_mfma_f32_16x16x32_bf16 v[136:139], v[184:187], a[224:227], v[136:139]
v_exp_f32 v117, v117
v_mfma_f32_16x16x32_bf16 v[136:139], v[188:191], a[228:231], v[136:139]
v_add_f32 v16, v16, v116
v_add_f32 v16, v16, v117
v_mfma_f32_16x16x32_bf16 v[136:139], v[192:195], a[232:235], v[136:139]
buffer_load_dwordx4 v10, s[8:11], s20 offen offset:2048 lds
v_mfma_f32_16x16x32_bf16 v[136:139], v[196:199], a[236:239], v[136:139]
v_cvt_pk_bf16_f32 v114, v116, v117
s_add_u32 s20, s20, 12288
v_mfma_f32_16x16x32_bf16 v[144:147], v[176:179], a[240:243], v[168:171]
ds_read_b128 v[200:203], v2 offset:18432
ds_read_b128 v[204:207], v3 offset:18432
v_mfma_f32_16x16x32_bf16 v[144:147], v[180:183], a[244:247], v[144:147]
s_add_u32 m0, s23, 24576
v_mfma_f32_16x16x32_bf16 v[144:147], v[184:187], a[248:251], v[144:147]
ds_read_b128 v[208:211], v2 offset:18560
ds_read_b128 v[212:215], v3 offset:18560
v_mfma_f32_16x16x32_bf16 v[144:147], v[188:191], a[252:255], v[144:147]
buffer_load_dwordx4 v11, s[12:15], s21 offen offset:0 lds
v_mfma_f32_16x16x32_bf16 v[144:147], v[192:195], v[64:67], v[144:147]
ds_read_b128 v[216:219], v2 offset:18688
ds_read_b128 v[220:223], v3 offset:18688
v_mfma_f32_16x16x32_bf16 v[144:147], v[196:199], v[68:71], v[144:147]
v_exp_f32 v118, v118
v_mfma_f32_16x16x32_bf16 v[152:155], v[176:179], v[72:75], v[172:175]
buffer_load_dwordx4 v12, s[12:15], s21 offen offset:1024 lds
v_mfma_f32_16x16x32_bf16 v[152:155], v[180:183], v[76:79], v[152:155]
v_exp_f32 v119, v119
v_mfma_f32_16x16x32_bf16 v[152:155], v[184:187], v[80:83], v[152:155]
v_add_f32 v16, v16, v118
v_add_f32 v16, v16, v119
v_mfma_f32_16x16x32_bf16 v[152:155], v[188:191], v[84:87], v[152:155]
buffer_load_dwordx4 v13, s[12:15], s21 offen offset:2048 lds
v_mfma_f32_16x16x32_bf16 v[152:155], v[192:195], v[88:91], v[152:155]
v_cvt_pk_bf16_f32 v115, v118, v119
s_add_u32 s21, s21, 12288
v_mfma_f32_16x16x32_bf16 v[152:155], v[196:199], v[92:95], v[152:155]
s_waitcnt lgkmcnt(0)
v_mfma_f32_16x16x32_bf16 v[132:135], v[200:203], a[192:195], v[160:163]
v_exp_f32 v124, v124
v_mfma_f32_16x16x32_bf16 v[132:135], v[204:207], a[196:199], v[132:135]
v_exp_f32 v125, v125
v_mfma_f32_16x16x32_bf16 v[132:135], v[208:211], a[200:203], v[132:135]
v_add_f32 v17, v17, v124
v_add_f32 v17, v17, v125
v_mfma_f32_16x16x32_bf16 v[132:135], v[212:215], a[204:207], v[132:135]
v_cvt_pk_bf16_f32 v122, v124, v125
s_load_dwordx2 s[48:49], s[0:1], 0
s_load_dwordx2 s[84:85], s[0:1], 64
s_and_b32 s3, s25, 1
v_mfma_f32_16x16x32_bf16 v[132:135], v[216:219], a[208:211], v[132:135]
v_exp_f32 v126, v126
v_mfma_f32_16x16x32_bf16 v[132:135], v[220:223], a[212:215], v[132:135]
v_exp_f32 v127, v127
v_mfma_f32_16x16x32_bf16 v[140:143], v[200:203], a[216:219], v[164:167]
ds_read_b64_tr_b16 v[176:177], v4 offset:0
ds_read_b64_tr_b16 v[178:179], v4 offset:6144
v_mfma_f32_16x16x32_bf16 v[140:143], v[204:207], a[220:223], v[140:143]
v_add_f32 v17, v17, v126
v_add_f32 v17, v17, v127
v_mfma_f32_16x16x32_bf16 v[140:143], v[208:211], a[224:227], v[140:143]
ds_read_b64_tr_b16 v[180:181], v5 offset:0
ds_read_b64_tr_b16 v[182:183], v5 offset:6144
v_mfma_f32_16x16x32_bf16 v[140:143], v[212:215], a[228:231], v[140:143]
v_cvt_pk_bf16_f32 v123, v126, v127
s_lshl_b32 s58, s61, 1
s_add_u32 s58, s58, s3
s_mul_i32 s58, s58, 240
v_mfma_f32_16x16x32_bf16 v[140:143], v[216:219], a[232:235], v[140:143]
ds_read_b64_tr_b16 v[184:185], v6 offset:0
ds_read_b64_tr_b16 v[186:187], v6 offset:6144
v_mfma_f32_16x16x32_bf16 v[140:143], v[220:223], a[236:239], v[140:143]
s_lshr_b32 s59, s25, 1
s_add_u32 s58, s58, s59
s_mul_i32 s55, s60, 24
s_add_u32 s58, s58, s55
v_mfma_f32_16x16x32_bf16 v[148:151], v[200:203], a[240:243], v[168:171]
ds_read_b64_tr_b16 v[188:189], v7 offset:0
ds_read_b64_tr_b16 v[190:191], v7 offset:6144
v_mfma_f32_16x16x32_bf16 v[148:151], v[204:207], a[244:247], v[148:151]
s_mul_i32 s58, s58, 5120
s_mul_i32 s3, s61, 30720
s_add_u32 s62, s58, s3
s_mul_i32 s3, s53, 240
v_mfma_f32_16x16x32_bf16 v[148:151], v[208:211], a[248:251], v[148:151]
ds_read_b64_tr_b16 v[192:193], v4 offset:128
ds_read_b64_tr_b16 v[194:195], v4 offset:6272
v_mfma_f32_16x16x32_bf16 v[148:151], v[212:215], a[252:255], v[148:151]
s_add_u32 s3, s3, s55
s_lshl_b32 s59, s3, 10
s_cmp_le_u32 s61, 0
s_cselect_b32 s3, 6, 0
v_mfma_f32_16x16x32_bf16 v[148:151], v[216:219], v[64:67], v[148:151]
ds_read_b64_tr_b16 v[196:197], v5 offset:128
ds_read_b64_tr_b16 v[198:199], v5 offset:6272
v_mfma_f32_16x16x32_bf16 v[148:151], v[220:223], v[68:71], v[148:151]
v_exp_f32 v128, v128
v_mfma_f32_16x16x32_bf16 v[156:159], v[200:203], v[72:75], v[172:175]
v_exp_f32 v129, v129
v_mfma_f32_16x16x32_bf16 v[156:159], v[204:207], v[76:79], v[156:159]
v_add_f32 v14, v14, v128
v_add_f32 v14, v14, v129
v_mfma_f32_16x16x32_bf16 v[156:159], v[208:211], v[80:83], v[156:159]
v_exp_f32 v130, v130
v_mfma_f32_16x16x32_bf16 v[156:159], v[212:215], v[84:87], v[156:159]
v_cvt_pk_bf16_f32 v128, v128, v129
s_lshl_b32 s55, s3, 10
s_add_u32 s67, s59, s55
s_mul_i32 s3, s3, 5120
v_mfma_f32_16x16x32_bf16 v[156:159], v[216:219], v[88:91], v[156:159]
v_exp_f32 v131, v131
v_mfma_f32_16x16x32_bf16 v[156:159], v[220:223], v[92:95], v[156:159]
v_add_f32 v14, v14, v130
s_waitcnt lgkmcnt(0)
v_mfma_f32_16x16x32_bf16 a[0:3], v[176:179], v[96:99], 0
v_exp_f32 v136, v136
v_mfma_f32_16x16x32_bf16 a[48:51], v[176:179], v[104:107], 0
v_add_f32 v14, v14, v131
v_cvt_pk_bf16_f32 v129, v130, v131
v_mfma_f32_16x16x32_bf16 a[96:99], v[176:179], v[112:115], 0
v_exp_f32 v137, v137
buffer_store_dwordx4 v[236:239], v31, s[40:43], s38 offen sc0 sc1
v_mfma_f32_16x16x32_bf16 a[144:147], v[176:179], v[120:123], 0
v_add_f32 v15, v15, v136
v_add_f32 v15, v15, v137
v_mfma_f32_16x16x32_bf16 a[4:7], v[180:183], v[96:99], 0
v_exp_f32 v138, v138
v_mfma_f32_16x16x32_bf16 a[52:55], v[180:183], v[104:107], 0
v_cvt_pk_bf16_f32 v136, v136, v137
s_add_u32 s63, s58, s3
s_cmp_le_u32 s61, 1
s_cselect_b32 s3, 12, 6
v_mfma_f32_16x16x32_bf16 a[100:103], v[180:183], v[112:115], 0
ds_read_b64_tr_b16 v[200:201], v6 offset:128
ds_read_b64_tr_b16 v[202:203], v6 offset:6272
v_mfma_f32_16x16x32_bf16 a[148:151], v[180:183], v[120:123], 0
v_exp_f32 v139, v139
v_mfma_f32_16x16x32_bf16 a[8:11], v[184:187], v[96:99], 0
ds_read_b64_tr_b16 v[204:205], v7 offset:128
ds_read_b64_tr_b16 v[206:207], v7 offset:6272
v_mfma_f32_16x16x32_bf16 a[56:59], v[184:187], v[104:107], 0
v_add_f32 v15, v15, v138
v_add_f32 v15, v15, v139
v_mfma_f32_16x16x32_bf16 a[104:107], v[184:187], v[112:115], 0
ds_read_b64_tr_b16 v[208:209], v4 offset:256
ds_read_b64_tr_b16 v[210:211], v4 offset:6400
v_mfma_f32_16x16x32_bf16 a[152:155], v[184:187], v[120:123], 0
v_exp_f32 v144, v144
v_mfma_f32_16x16x32_bf16 a[12:15], v[188:191], v[96:99], 0
ds_read_b64_tr_b16 v[212:213], v5 offset:256
ds_read_b64_tr_b16 v[214:215], v5 offset:6400
v_mfma_f32_16x16x32_bf16 a[60:63], v[188:191], v[104:107], 0
v_cvt_pk_bf16_f32 v137, v138, v139
s_lshl_b32 s55, s3, 10
s_add_u32 s68, s59, s55
s_mul_i32 s3, s3, 5120
v_mfma_f32_16x16x32_bf16 a[108:111], v[188:191], v[112:115], 0
ds_read_b64_tr_b16 v[216:217], v6 offset:256
ds_read_b64_tr_b16 v[218:219], v6 offset:6400
v_mfma_f32_16x16x32_bf16 a[156:159], v[188:191], v[120:123], 0
v_exp_f32 v145, v145
v_mfma_f32_16x16x32_bf16 a[16:19], v[192:195], v[96:99], 0
ds_read_b64_tr_b16 v[220:221], v7 offset:256
ds_read_b64_tr_b16 v[222:223], v7 offset:6400
buffer_store_dwordx4 v[240:243], v28, s[40:43], s39 offen sc0 sc1
v_mfma_f32_16x16x32_bf16 a[64:67], v[192:195], v[104:107], 0
v_add_f32 v16, v16, v144
v_add_f32 v16, v16, v145
v_mfma_f32_16x16x32_bf16 a[112:115], v[192:195], v[112:115], 0
v_cvt_pk_bf16_f32 v144, v144, v145
s_add_u32 s64, s58, s3
s_cmp_le_u32 s61, 2
s_cselect_b32 s3, 18, 12
v_mfma_f32_16x16x32_bf16 a[160:163], v[192:195], v[120:123], 0
v_exp_f32 v146, v146
v_mfma_f32_16x16x32_bf16 a[20:23], v[196:199], v[96:99], 0
v_exp_f32 v147, v147
v_mfma_f32_16x16x32_bf16 a[68:71], v[196:199], v[104:107], 0
v_add_f32 v16, v16, v146
v_add_f32 v16, v16, v147
v_mfma_f32_16x16x32_bf16 a[116:119], v[196:199], v[112:115], 0
v_cvt_pk_bf16_f32 v145, v146, v147
s_lshl_b32 s55, s3, 10
s_add_u32 s69, s59, s55
s_mul_i32 s3, s3, 5120
v_mfma_f32_16x16x32_bf16 a[164:167], v[196:199], v[120:123], 0
s_add_u32 s65, s58, s3
s_and_b32 s3, s60, 1
s_lshl_b32 s58, s61, 1
s_waitcnt lgkmcnt(0)
v_mfma_f32_16x16x32_bf16 a[24:27], v[200:203], v[96:99], 0
v_exp_f32 v152, v152
v_mfma_f32_16x16x32_bf16 a[72:75], v[200:203], v[104:107], 0
v_exp_f32 v153, v153
v_mfma_f32_16x16x32_bf16 a[120:123], v[200:203], v[112:115], 0
v_add_f32 v17, v17, v152
v_add_f32 v17, v17, v153
v_mfma_f32_16x16x32_bf16 a[168:171], v[200:203], v[120:123], 0
v_exp_f32 v154, v154
v_mfma_f32_16x16x32_bf16 a[28:31], v[204:207], v[96:99], 0
v_cvt_pk_bf16_f32 v152, v152, v153
s_add_u32 s58, s58, s3
s_mul_i32 s93, s58, 160
s_mul_i32 s58, s58, 240
v_mfma_f32_16x16x32_bf16 a[76:79], v[204:207], v[104:107], 0
v_exp_f32 v155, v155
v_mfma_f32_16x16x32_bf16 a[124:127], v[204:207], v[112:115], 0
v_add_f32 v17, v17, v154
v_add_f32 v17, v17, v155
buffer_store_dwordx4 v[244:247], v29, s[40:43], s39 offen sc0 sc1
v_mfma_f32_16x16x32_bf16 a[172:175], v[204:207], v[120:123], 0
v_exp_f32 v132, v132
v_mfma_f32_16x16x32_bf16 a[32:35], v[208:211], v[96:99], 0
v_cvt_pk_bf16_f32 v153, v154, v155
s_mul_i32 s59, s25, 12
s_add_u32 s58, s58, s59
s_add_u32 s58, s58, 192
v_mfma_f32_16x16x32_bf16 a[80:83], v[208:211], v[104:107], 0
v_exp_f32 v133, v133
v_mfma_f32_16x16x32_bf16 a[128:131], v[208:211], v[112:115], 0
v_add_f32 v14, v14, v132
v_add_f32 v14, v14, v133
v_mfma_f32_16x16x32_bf16 a[176:179], v[208:211], v[120:123], 0
v_cvt_pk_bf16_f32 v130, v132, v133
s_mul_i32 s66, s58, 5120
s_lshr_b32 s3, s60, 1
s_lshl_b32 s3, s3, 2
v_mfma_f32_16x16x32_bf16 a[36:39], v[212:215], v[96:99], 0
ds_read_b128 v[176:179], v2 offset:24576
ds_read_b128 v[180:183], v3 offset:24576
v_mfma_f32_16x16x32_bf16 a[84:87], v[212:215], v[104:107], 0
v_exp_f32 v134, v134
v_mfma_f32_16x16x32_bf16 a[132:135], v[212:215], v[112:115], 0
ds_read_b128 v[184:187], v2 offset:24704
ds_read_b128 v[188:191], v3 offset:24704
v_mfma_f32_16x16x32_bf16 a[180:183], v[212:215], v[120:123], 0
v_exp_f32 v135, v135
v_mfma_f32_16x16x32_bf16 a[40:43], v[216:219], v[96:99], 0
ds_read_b128 v[192:195], v2 offset:24832
ds_read_b128 v[196:199], v3 offset:24832
v_mfma_f32_16x16x32_bf16 a[88:91], v[216:219], v[104:107], 0
v_add_f32 v14, v14, v134
v_add_f32 v14, v14, v135
v_mfma_f32_16x16x32_bf16 a[136:139], v[216:219], v[112:115], 0
v_cvt_pk_bf16_f32 v131, v134, v135
s_lshl_b32 s94, s37, 4
s_add_u32 s94, s94, s3
s_mul_i32 s3, s94, 240
v_mfma_f32_16x16x32_bf16 a[184:187], v[216:219], v[120:123], 0
v_exp_f32 v140, v140
v_mfma_f32_16x16x32_bf16 a[44:47], v[220:223], v[96:99], 0
v_exp_f32 v141, v141
v_mfma_f32_16x16x32_bf16 a[92:95], v[220:223], v[104:107], 0
v_add_f32 v15, v15, v140
v_add_f32 v15, v15, v141
v_mfma_f32_16x16x32_bf16 a[140:143], v[220:223], v[112:115], 0
v_cvt_pk_bf16_f32 v138, v140, v141
v_mfma_f32_16x16x32_bf16 a[188:191], v[220:223], v[120:123], 0
s_waitcnt lgkmcnt(0)
v_mfma_f32_16x16x32_bf16 v[96:99], v[176:179], a[192:195], v[160:163]
v_exp_f32 v142, v142
v_mfma_f32_16x16x32_bf16 v[96:99], v[180:183], a[196:199], v[96:99]
v_exp_f32 v143, v143
v_mfma_f32_16x16x32_bf16 v[96:99], v[184:187], a[200:203], v[96:99]
s_waitcnt vmcnt(12)
s_barrier
v_mfma_f32_16x16x32_bf16 v[96:99], v[188:191], a[204:207], v[96:99]
v_add_f32 v15, v15, v142
s_add_u32 m0, s22, 12288
v_mfma_f32_16x16x32_bf16 v[96:99], v[192:195], a[208:211], v[96:99]
buffer_load_dwordx4 v8, s[8:11], s20 offen offset:0 lds
v_mfma_f32_16x16x32_bf16 v[96:99], v[196:199], a[212:215], v[96:99]
v_add_f32 v15, v15, v143
v_cvt_pk_bf16_f32 v139, v142, v143
v_mfma_f32_16x16x32_bf16 v[104:107], v[176:179], a[216:219], v[164:167]
v_exp_f32 v148, v148
v_mfma_f32_16x16x32_bf16 v[104:107], v[180:183], a[220:223], v[104:107]
buffer_load_dwordx4 v9, s[8:11], s20 offen offset:1024 lds
v_mfma_f32_16x16x32_bf16 v[104:107], v[184:187], a[224:227], v[104:107]
v_exp_f32 v149, v149
v_mfma_f32_16x16x32_bf16 v[104:107], v[188:191], a[228:231], v[104:107]
v_add_f32 v16, v16, v148
v_add_f32 v16, v16, v149
v_mfma_f32_16x16x32_bf16 v[104:107], v[192:195], a[232:235], v[104:107]
buffer_load_dwordx4 v10, s[8:11], s20 offen offset:2048 lds
v_mfma_f32_16x16x32_bf16 v[104:107], v[196:199], a[236:239], v[104:107]
v_cvt_pk_bf16_f32 v146, v148, v149
s_add_u32 s20, s20, 12288
v_mfma_f32_16x16x32_bf16 v[112:115], v[176:179], a[240:243], v[168:171]
ds_read_b128 v[200:203], v2 offset:30720
ds_read_b128 v[204:207], v3 offset:30720
v_mfma_f32_16x16x32_bf16 v[112:115], v[180:183], a[244:247], v[112:115]
s_add_u32 m0, s23, 36864
v_mfma_f32_16x16x32_bf16 v[112:115], v[184:187], a[248:251], v[112:115]
ds_read_b128 v[208:211], v2 offset:30848
ds_read_b128 v[212:215], v3 offset:30848
v_mfma_f32_16x16x32_bf16 v[112:115], v[188:191], a[252:255], v[112:115]
buffer_load_dwordx4 v11, s[12:15], s21 offen offset:0 lds
v_mfma_f32_16x16x32_bf16 v[112:115], v[192:195], v[64:67], v[112:115]
ds_read_b128 v[216:219], v2 offset:30976
ds_read_b128 v[220:223], v3 offset:30976
v_mfma_f32_16x16x32_bf16 v[112:115], v[196:199], v[68:71], v[112:115]
v_exp_f32 v150, v150
v_mfma_f32_16x16x32_bf16 v[120:123], v[176:179], v[72:75], v[172:175]
buffer_load_dwordx4 v12, s[12:15], s21 offen offset:1024 lds
v_mfma_f32_16x16x32_bf16 v[120:123], v[180:183], v[76:79], v[120:123]
v_exp_f32 v151, v151
v_mfma_f32_16x16x32_bf16 v[120:123], v[184:187], v[80:83], v[120:123]
v_add_f32 v16, v16, v150
v_add_f32 v16, v16, v151
v_mfma_f32_16x16x32_bf16 v[120:123], v[188:191], v[84:87], v[120:123]
buffer_load_dwordx4 v13, s[12:15], s21 offen offset:2048 lds
v_mfma_f32_16x16x32_bf16 v[120:123], v[192:195], v[88:91], v[120:123]
v_cvt_pk_bf16_f32 v147, v150, v151
s_add_u32 s21, s21, 12288
v_mfma_f32_16x16x32_bf16 v[120:123], v[196:199], v[92:95], v[120:123]
s_waitcnt lgkmcnt(0)
v_mfma_f32_16x16x32_bf16 v[100:103], v[200:203], a[192:195], v[160:163]
v_exp_f32 v156, v156
v_mfma_f32_16x16x32_bf16 v[100:103], v[204:207], a[196:199], v[100:103]
v_exp_f32 v157, v157
v_mfma_f32_16x16x32_bf16 v[100:103], v[208:211], a[200:203], v[100:103]
v_add_f32 v17, v17, v156
v_add_f32 v17, v17, v157
v_mfma_f32_16x16x32_bf16 v[100:103], v[212:215], a[204:207], v[100:103]
v_cvt_pk_bf16_f32 v154, v156, v157
s_add_u32 s3, s3, s59
s_add_u32 s3, s3, 192
s_lshl_b32 s44, s3, 10
v_mfma_f32_16x16x32_bf16 v[100:103], v[216:219], a[208:211], v[100:103]
v_exp_f32 v158, v158
v_mfma_f32_16x16x32_bf16 v[100:103], v[220:223], a[212:215], v[100:103]
v_exp_f32 v159, v159
v_mfma_f32_16x16x32_bf16 v[108:111], v[200:203], a[216:219], v[164:167]
ds_read_b64_tr_b16 v[176:177], v4 offset:12288
ds_read_b64_tr_b16 v[178:179], v4 offset:18432
v_mfma_f32_16x16x32_bf16 v[108:111], v[204:207], a[220:223], v[108:111]
v_add_f32 v17, v17, v158
v_add_f32 v17, v17, v159
v_mfma_f32_16x16x32_bf16 v[108:111], v[208:211], a[224:227], v[108:111]
ds_read_b64_tr_b16 v[180:181], v5 offset:12288
ds_read_b64_tr_b16 v[182:183], v5 offset:18432
v_mfma_f32_16x16x32_bf16 v[108:111], v[212:215], a[228:231], v[108:111]
v_cvt_pk_bf16_f32 v155, v158, v159
s_lshl_b32 s3, s37, 2
s_add_u32 s3, s3, s61
s_lshl_b32 s95, s3, 6
v_mfma_f32_16x16x32_bf16 v[108:111], v[216:219], a[232:235], v[108:111]
ds_read_b64_tr_b16 v[184:185], v6 offset:12288
ds_read_b64_tr_b16 v[186:187], v6 offset:18432
v_mfma_f32_16x16x32_bf16 v[108:111], v[220:223], a[236:239], v[108:111]
s_add_u32 s28, s56, 41943040
s_addc_u32 s29, s57, 0
s_mov_b32 s30, 9830400
s_mov_b32 s31, 0x00020000
v_mfma_f32_16x16x32_bf16 v[116:119], v[200:203], a[240:243], v[168:171]
ds_read_b64_tr_b16 v[188:189], v7 offset:12288
ds_read_b64_tr_b16 v[190:191], v7 offset:18432
v_mfma_f32_16x16x32_bf16 v[116:119], v[204:207], a[244:247], v[116:119]
s_add_u32 s32, s56, 4194304
s_addc_u32 s33, s57, 0
s_mov_b32 s34, 31457280
s_mov_b32 s35, 0x00020000
v_mfma_f32_16x16x32_bf16 v[116:119], v[208:211], a[248:251], v[116:119]
ds_read_b64_tr_b16 v[192:193], v4 offset:12416
ds_read_b64_tr_b16 v[194:195], v4 offset:18560
v_mfma_f32_16x16x32_bf16 v[116:119], v[212:215], a[252:255], v[116:119]
s_mul_i32 s45, s25, 5120
v_add_u32 v27, 4096, v26
v_lshrrev_b32 v36, 2, v1
v_mul_u32_u24 v36, 160, v36
v_mfma_f32_16x16x32_bf16 v[116:119], v[216:219], v[64:67], v[116:119]
ds_read_b64_tr_b16 v[196:197], v5 offset:12416
ds_read_b64_tr_b16 v[198:199], v5 offset:18560
v_mfma_f32_16x16x32_bf16 v[116:119], v[220:223], v[68:71], v[116:119]
v_exp_f32 v96, v96
v_mfma_f32_16x16x32_bf16 v[124:127], v[200:203], v[72:75], v[172:175]
v_exp_f32 v97, v97
v_mfma_f32_16x16x32_bf16 v[124:127], v[204:207], v[76:79], v[124:127]
v_add_f32 v14, v14, v96
v_add_f32 v14, v14, v97
v_mfma_f32_16x16x32_bf16 v[124:127], v[208:211], v[80:83], v[124:127]
v_exp_f32 v98, v98
v_mfma_f32_16x16x32_bf16 v[124:127], v[212:215], v[84:87], v[124:127]
v_cvt_pk_bf16_f32 v96, v96, v97
v_and_b32 v37, 3, v1
v_lshl_add_u32 v36, v37, 3, v36
v_mov_b32 v32, v36
v_mfma_f32_16x16x32_bf16 v[124:127], v[216:219], v[88:91], v[124:127]
v_exp_f32 v99, v99
v_mfma_f32_16x16x32_bf16 v[124:127], v[220:223], v[92:95], v[124:127]
v_add_f32 v14, v14, v98
s_waitcnt lgkmcnt(0)
v_mfma_f32_16x16x32_bf16 a[0:3], v[176:179], v[128:131], a[0:3]
v_exp_f32 v104, v104
v_mfma_f32_16x16x32_bf16 a[48:51], v[176:179], v[136:139], a[48:51]
v_add_f32 v14, v14, v99
v_cvt_pk_bf16_f32 v97, v98, v99
v_mfma_f32_16x16x32_bf16 a[96:99], v[176:179], v[144:147], a[96:99]
v_exp_f32 v105, v105
v_mfma_f32_16x16x32_bf16 a[144:147], v[176:179], v[152:155], a[144:147]
v_add_f32 v15, v15, v104
v_add_f32 v15, v15, v105
v_mfma_f32_16x16x32_bf16 a[4:7], v[180:183], v[128:131], a[4:7]
v_exp_f32 v106, v106
v_mfma_f32_16x16x32_bf16 a[52:55], v[180:183], v[136:139], a[52:55]
v_cvt_pk_bf16_f32 v104, v104, v105
v_add_u32 v33, 49152, v36
v_add_u32 v34, 102144, v36
s_lshl_b32 s3, s25, 4
v_mfma_f32_16x16x32_bf16 a[100:103], v[180:183], v[144:147], a[100:103]
ds_read_b64_tr_b16 v[200:201], v6 offset:12416
ds_read_b64_tr_b16 v[202:203], v6 offset:18560
v_mfma_f32_16x16x32_bf16 a[148:151], v[180:183], v[152:155], a[148:151]
v_exp_f32 v107, v107
v_mfma_f32_16x16x32_bf16 a[8:11], v[184:187], v[128:131], a[8:11]
ds_read_b64_tr_b16 v[204:205], v7 offset:12416
ds_read_b64_tr_b16 v[206:207], v7 offset:18560
v_mfma_f32_16x16x32_bf16 a[56:59], v[184:187], v[136:139], a[56:59]
v_add_f32 v15, v15, v106
v_add_f32 v15, v15, v107
v_mfma_f32_16x16x32_bf16 a[104:107], v[184:187], v[144:147], a[104:107]
ds_read_b64_tr_b16 v[208:209], v4 offset:12544
ds_read_b64_tr_b16 v[210:211], v4 offset:18688
v_mfma_f32_16x16x32_bf16 a[152:155], v[184:187], v[152:155], a[152:155]
v_exp_f32 v112, v112
v_mfma_f32_16x16x32_bf16 a[12:15], v[188:191], v[128:131], a[12:15]
ds_read_b64_tr_b16 v[212:213], v5 offset:12544
ds_read_b64_tr_b16 v[214:215], v5 offset:18688
v_mfma_f32_16x16x32_bf16 a[60:63], v[188:191], v[136:139], a[60:63]
v_cvt_pk_bf16_f32 v105, v106, v107
v_lshl_add_u32 v38, v37, 2, s3
v_and_b32 v39, 7, v1
v_lshlrev_b32 v39, 2, v39
v_mfma_f32_16x16x32_bf16 a[108:111], v[188:191], v[144:147], a[108:111]
ds_read_b64_tr_b16 v[216:217], v6 offset:12544
ds_read_b64_tr_b16 v[218:219], v6 offset:18688
v_mfma_f32_16x16x32_bf16 a[156:159], v[188:191], v[152:155], a[156:159]
v_exp_f32 v113, v113
v_mfma_f32_16x16x32_bf16 a[16:19], v[192:195], v[128:131], a[16:19]
ds_read_b64_tr_b16 v[220:221], v7 offset:12544
ds_read_b64_tr_b16 v[222:223], v7 offset:18688
v_mfma_f32_16x16x32_bf16 a[64:67], v[192:195], v[136:139], a[64:67]
v_add_f32 v16, v16, v112
v_add_f32 v16, v16, v113
v_mfma_f32_16x16x32_bf16 a[112:115], v[192:195], v[144:147], a[112:115]
v_cvt_pk_bf16_f32 v112, v112, v113
s_lshl_b32 s3, s2, 9
s_add_u32 s51, s3, 92274688
v_mfma_f32_16x16x32_bf16 a[160:163], v[192:195], v[152:155], a[160:163]
v_exp_f32 v114, v114
v_mfma_f32_16x16x32_bf16 a[20:23], v[196:199], v[128:131], a[20:23]
v_exp_f32 v115, v115
v_mfma_f32_16x16x32_bf16 a[68:71], v[196:199], v[136:139], a[68:71]
v_add_f32 v16, v16, v114
v_add_f32 v16, v16, v115
v_mfma_f32_16x16x32_bf16 a[116:119], v[196:199], v[144:147], a[116:119]
v_cvt_pk_bf16_f32 v113, v114, v115
v_mfma_f32_16x16x32_bf16 a[164:167], v[196:199], v[152:155], a[164:167]
s_waitcnt lgkmcnt(0)
v_mfma_f32_16x16x32_bf16 a[24:27], v[200:203], v[128:131], a[24:27]
v_exp_f32 v120, v120
v_mfma_f32_16x16x32_bf16 a[72:75], v[200:203], v[136:139], a[72:75]
v_exp_f32 v121, v121
v_mfma_f32_16x16x32_bf16 a[120:123], v[200:203], v[144:147], a[120:123]
v_add_f32 v17, v17, v120
v_add_f32 v17, v17, v121
v_mfma_f32_16x16x32_bf16 a[168:171], v[200:203], v[152:155], a[168:171]
v_exp_f32 v122, v122
v_mfma_f32_16x16x32_bf16 a[28:31], v[204:207], v[128:131], a[28:31]
v_cvt_pk_bf16_f32 v120, v120, v121
v_mfma_f32_16x16x32_bf16 a[76:79], v[204:207], v[136:139], a[76:79]
v_exp_f32 v123, v123
v_mfma_f32_16x16x32_bf16 a[124:127], v[204:207], v[144:147], a[124:127]
v_add_f32 v17, v17, v122
v_add_f32 v17, v17, v123
v_mfma_f32_16x16x32_bf16 a[172:175], v[204:207], v[152:155], a[172:175]
v_exp_f32 v100, v100
v_mfma_f32_16x16x32_bf16 a[32:35], v[208:211], v[128:131], a[32:35]
v_cvt_pk_bf16_f32 v121, v122, v123
v_mfma_f32_16x16x32_bf16 a[80:83], v[208:211], v[136:139], a[80:83]
v_exp_f32 v101, v101
v_mfma_f32_16x16x32_bf16 a[128:131], v[208:211], v[144:147], a[128:131]
v_add_f32 v14, v14, v100
v_add_f32 v14, v14, v101
v_mfma_f32_16x16x32_bf16 a[176:179], v[208:211], v[152:155], a[176:179]
v_cvt_pk_bf16_f32 v98, v100, v101
v_mfma_f32_16x16x32_bf16 a[36:39], v[212:215], v[128:131], a[36:39]
ds_read_b128 v[176:179], v2 offset:36864
ds_read_b128 v[180:183], v3 offset:36864
v_mfma_f32_16x16x32_bf16 a[84:87], v[212:215], v[136:139], a[84:87]
v_exp_f32 v102, v102
v_mfma_f32_16x16x32_bf16 a[132:135], v[212:215], v[144:147], a[132:135]
ds_read_b128 v[184:187], v2 offset:36992
ds_read_b128 v[188:191], v3 offset:36992
v_mfma_f32_16x16x32_bf16 a[180:183], v[212:215], v[152:155], a[180:183]
v_exp_f32 v103, v103
v_mfma_f32_16x16x32_bf16 a[40:43], v[216:219], v[128:131], a[40:43]
ds_read_b128 v[192:195], v2 offset:37120
ds_read_b128 v[196:199], v3 offset:37120
v_mfma_f32_16x16x32_bf16 a[88:91], v[216:219], v[136:139], a[88:91]
v_add_f32 v14, v14, v102
v_add_f32 v14, v14, v103
v_mfma_f32_16x16x32_bf16 a[136:139], v[216:219], v[144:147], a[136:139]
v_cvt_pk_bf16_f32 v99, v102, v103
v_mfma_f32_16x16x32_bf16 a[184:187], v[216:219], v[152:155], a[184:187]
v_exp_f32 v108, v108
v_mfma_f32_16x16x32_bf16 a[44:47], v[220:223], v[128:131], a[44:47]
v_exp_f32 v109, v109
v_mfma_f32_16x16x32_bf16 a[92:95], v[220:223], v[136:139], a[92:95]
v_add_f32 v15, v15, v108
v_add_f32 v15, v15, v109
v_mfma_f32_16x16x32_bf16 a[140:143], v[220:223], v[144:147], a[140:143]
v_cvt_pk_bf16_f32 v106, v108, v109
v_mfma_f32_16x16x32_bf16 a[188:191], v[220:223], v[152:155], a[188:191]
s_mov_b32 s24, 16
.p2align 3
L_k2_loop:
s_waitcnt lgkmcnt(0)
v_mfma_f32_16x16x32_bf16 v[128:131], v[176:179], a[192:195], v[160:163]
v_exp_f32 v110, v110
v_mfma_f32_16x16x32_bf16 v[128:131], v[180:183], a[196:199], v[128:131]
v_exp_f32 v111, v111
v_mfma_f32_16x16x32_bf16 v[128:131], v[184:187], a[200:203], v[128:131]
s_waitcnt vmcnt(6)
s_barrier
v_mfma_f32_16x16x32_bf16 v[128:131], v[188:191], a[204:207], v[128:131]
v_add_f32 v15, v15, v110
s_add_u32 m0, s22, 24576
v_mfma_f32_16x16x32_bf16 v[128:131], v[192:195], a[208:211], v[128:131]
buffer_load_dwordx4 v8, s[8:11], s20 offen offset:0 lds
v_mfma_f32_16x16x32_bf16 v[128:131], v[196:199], a[212:215], v[128:131]
v_add_f32 v15, v15, v111
v_cvt_pk_bf16_f32 v107, v110, v111
v_mfma_f32_16x16x32_bf16 v[136:139], v[176:179], a[216:219], v[164:167]
v_exp_f32 v116, v116
v_mfma_f32_16x16x32_bf16 v[136:139], v[180:183], a[220:223], v[136:139]
buffer_load_dwordx4 v9, s[8:11], s20 offen offset:1024 lds
v_mfma_f32_16x16x32_bf16 v[136:139], v[184:187], a[224:227], v[136:139]
v_exp_f32 v117, v117
v_mfma_f32_16x16x32_bf16 v[136:139], v[188:191], a[228:231], v[136:139]
v_add_f32 v16, v16, v116
v_add_f32 v16, v16, v117
v_mfma_f32_16x16x32_bf16 v[136:139], v[192:195], a[232:235], v[136:139]
buffer_load_dwordx4 v10, s[8:11], s20 offen offset:2048 lds
v_mfma_f32_16x16x32_bf16 v[136:139], v[196:199], a[236:239], v[136:139]
v_cvt_pk_bf16_f32 v114, v116, v117
s_add_u32 s20, s20, 12288
v_mfma_f32_16x16x32_bf16 v[144:147], v[176:179], a[240:243], v[168:171]
ds_read_b128 v[200:203], v2 offset:43008
ds_read_b128 v[204:207], v3 offset:43008
v_mfma_f32_16x16x32_bf16 v[144:147], v[180:183], a[244:247], v[144:147]
s_add_u32 m0, s23, 0
v_mfma_f32_16x16x32_bf16 v[144:147], v[184:187], a[248:251], v[144:147]
ds_read_b128 v[208:211], v2 offset:43136
ds_read_b128 v[212:215], v3 offset:43136
v_mfma_f32_16x16x32_bf16 v[144:147], v[188:191], a[252:255], v[144:147]
buffer_load_dwordx4 v11, s[12:15], s21 offen offset:0 lds
v_mfma_f32_16x16x32_bf16 v[144:147], v[192:195], v[64:67], v[144:147]
ds_read_b128 v[216:219], v2 offset:43264
ds_read_b128 v[220:223], v3 offset:43264
v_mfma_f32_16x16x32_bf16 v[144:147], v[196:199], v[68:71], v[144:147]
v_exp_f32 v118, v118
v_mfma_f32_16x16x32_bf16 v[152:155], v[176:179], v[72:75], v[172:175]
buffer_load_dwordx4 v12, s[12:15], s21 offen offset:1024 lds
v_mfma_f32_16x16x32_bf16 v[152:155], v[180:183], v[76:79], v[152:155]
v_exp_f32 v119, v119
v_mfma_f32_16x16x32_bf16 v[152:155], v[184:187], v[80:83], v[152:155]
v_add_f32 v16, v16, v118
v_add_f32 v16, v16, v119
v_mfma_f32_16x16x32_bf16 v[152:155], v[188:191], v[84:87], v[152:155]
buffer_load_dwordx4 v13, s[12:15], s21 offen offset:2048 lds
v_mfma_f32_16x16x32_bf16 v[152:155], v[192:195], v[88:91], v[152:155]
v_cvt_pk_bf16_f32 v115, v118, v119
s_add_u32 s21, s21, 12288
v_mfma_f32_16x16x32_bf16 v[152:155], v[196:199], v[92:95], v[152:155]
s_waitcnt lgkmcnt(0)
v_mfma_f32_16x16x32_bf16 v[132:135], v[200:203], a[192:195], v[160:163]
v_exp_f32 v124, v124
v_mfma_f32_16x16x32_bf16 v[132:135], v[204:207], a[196:199], v[132:135]
v_exp_f32 v125, v125
v_mfma_f32_16x16x32_bf16 v[132:135], v[208:211], a[200:203], v[132:135]
v_add_f32 v17, v17, v124
v_add_f32 v17, v17, v125
v_mfma_f32_16x16x32_bf16 v[132:135], v[212:215], a[204:207], v[132:135]
v_cvt_pk_bf16_f32 v122, v124, v125
v_mfma_f32_16x16x32_bf16 v[132:135], v[216:219], a[208:211], v[132:135]
v_exp_f32 v126, v126
v_mfma_f32_16x16x32_bf16 v[132:135], v[220:223], a[212:215], v[132:135]
v_exp_f32 v127, v127
v_mfma_f32_16x16x32_bf16 v[140:143], v[200:203], a[216:219], v[164:167]
ds_read_b64_tr_b16 v[176:177], v4 offset:24576
ds_read_b64_tr_b16 v[178:179], v4 offset:30720
v_mfma_f32_16x16x32_bf16 v[140:143], v[204:207], a[220:223], v[140:143]
v_add_f32 v17, v17, v126
v_add_f32 v17, v17, v127
v_mfma_f32_16x16x32_bf16 v[140:143], v[208:211], a[224:227], v[140:143]
ds_read_b64_tr_b16 v[180:181], v5 offset:24576
ds_read_b64_tr_b16 v[182:183], v5 offset:30720
v_mfma_f32_16x16x32_bf16 v[140:143], v[212:215], a[228:231], v[140:143]
v_cvt_pk_bf16_f32 v123, v126, v127
v_mfma_f32_16x16x32_bf16 v[140:143], v[216:219], a[232:235], v[140:143]
ds_read_b64_tr_b16 v[184:185], v6 offset:24576
ds_read_b64_tr_b16 v[186:187], v6 offset:30720
v_mfma_f32_16x16x32_bf16 v[140:143], v[220:223], a[236:239], v[140:143]
v_mfma_f32_16x16x32_bf16 v[148:151], v[200:203], a[240:243], v[168:171]
ds_read_b64_tr_b16 v[188:189], v7 offset:24576
ds_read_b64_tr_b16 v[190:191], v7 offset:30720
v_mfma_f32_16x16x32_bf16 v[148:151], v[204:207], a[244:247], v[148:151]
v_mfma_f32_16x16x32_bf16 v[148:151], v[208:211], a[248:251], v[148:151]
ds_read_b64_tr_b16 v[192:193], v4 offset:24704
ds_read_b64_tr_b16 v[194:195], v4 offset:30848
v_mfma_f32_16x16x32_bf16 v[148:151], v[212:215], a[252:255], v[148:151]
v_mfma_f32_16x16x32_bf16 v[148:151], v[216:219], v[64:67], v[148:151]
ds_read_b64_tr_b16 v[196:197], v5 offset:24704
ds_read_b64_tr_b16 v[198:199], v5 offset:30848
v_mfma_f32_16x16x32_bf16 v[148:151], v[220:223], v[68:71], v[148:151]
v_exp_f32 v128, v128
v_mfma_f32_16x16x32_bf16 v[156:159], v[200:203], v[72:75], v[172:175]
v_exp_f32 v129, v129
v_mfma_f32_16x16x32_bf16 v[156:159], v[204:207], v[76:79], v[156:159]
v_add_f32 v14, v14, v128
v_add_f32 v14, v14, v129
v_mfma_f32_16x16x32_bf16 v[156:159], v[208:211], v[80:83], v[156:159]
v_exp_f32 v130, v130
v_mfma_f32_16x16x32_bf16 v[156:159], v[212:215], v[84:87], v[156:159]
v_cvt_pk_bf16_f32 v128, v128, v129
v_mfma_f32_16x16x32_bf16 v[156:159], v[216:219], v[88:91], v[156:159]
v_exp_f32 v131, v131
v_mfma_f32_16x16x32_bf16 v[156:159], v[220:223], v[92:95], v[156:159]
v_add_f32 v14, v14, v130
s_waitcnt lgkmcnt(0)
v_mfma_f32_16x16x32_bf16 a[0:3], v[176:179], v[96:99], a[0:3]
v_exp_f32 v136, v136
v_mfma_f32_16x16x32_bf16 a[48:51], v[176:179], v[104:107], a[48:51]
v_add_f32 v14, v14, v131
v_cvt_pk_bf16_f32 v129, v130, v131
v_mfma_f32_16x16x32_bf16 a[96:99], v[176:179], v[112:115], a[96:99]
v_exp_f32 v137, v137
v_mfma_f32_16x16x32_bf16 a[144:147], v[176:179], v[120:123], a[144:147]
v_add_f32 v15, v15, v136
v_add_f32 v15, v15, v137
v_mfma_f32_16x16x32_bf16 a[4:7], v[180:183], v[96:99], a[4:7]
v_exp_f32 v138, v138
v_mfma_f32_16x16x32_bf16 a[52:55], v[180:183], v[104:107], a[52:55]
v_cvt_pk_bf16_f32 v136, v136, v137
v_mfma_f32_16x16x32_bf16 a[100:103], v[180:183], v[112:115], a[100:103]
ds_read_b64_tr_b16 v[200:201], v6 offset:24704
ds_read_b64_tr_b16 v[202:203], v6 offset:30848
v_mfma_f32_16x16x32_bf16 a[148:151], v[180:183], v[120:123], a[148:151]
v_exp_f32 v139, v139
v_mfma_f32_16x16x32_bf16 a[8:11], v[184:187], v[96:99], a[8:11]
ds_read_b64_tr_b16 v[204:205], v7 offset:24704
ds_read_b64_tr_b16 v[206:207], v7 offset:30848
v_mfma_f32_16x16x32_bf16 a[56:59], v[184:187], v[104:107], a[56:59]
v_add_f32 v15, v15, v138
v_add_f32 v15, v15, v139
v_mfma_f32_16x16x32_bf16 a[104:107], v[184:187], v[112:115], a[104:107]
ds_read_b64_tr_b16 v[208:209], v4 offset:24832
ds_read_b64_tr_b16 v[210:211], v4 offset:30976
v_mfma_f32_16x16x32_bf16 a[152:155], v[184:187], v[120:123], a[152:155]
v_exp_f32 v144, v144
v_mfma_f32_16x16x32_bf16 a[12:15], v[188:191], v[96:99], a[12:15]
ds_read_b64_tr_b16 v[212:213], v5 offset:24832
ds_read_b64_tr_b16 v[214:215], v5 offset:30976
v_mfma_f32_16x16x32_bf16 a[60:63], v[188:191], v[104:107], a[60:63]
v_cvt_pk_bf16_f32 v137, v138, v139
v_mfma_f32_16x16x32_bf16 a[108:111], v[188:191], v[112:115], a[108:111]
ds_read_b64_tr_b16 v[216:217], v6 offset:24832
ds_read_b64_tr_b16 v[218:219], v6 offset:30976
v_mfma_f32_16x16x32_bf16 a[156:159], v[188:191], v[120:123], a[156:159]
v_exp_f32 v145, v145
v_mfma_f32_16x16x32_bf16 a[16:19], v[192:195], v[96:99], a[16:19]
ds_read_b64_tr_b16 v[220:221], v7 offset:24832
ds_read_b64_tr_b16 v[222:223], v7 offset:30976
v_mfma_f32_16x16x32_bf16 a[64:67], v[192:195], v[104:107], a[64:67]
v_add_f32 v16, v16, v144
v_add_f32 v16, v16, v145
v_mfma_f32_16x16x32_bf16 a[112:115], v[192:195], v[112:115], a[112:115]
v_cvt_pk_bf16_f32 v144, v144, v145
v_mfma_f32_16x16x32_bf16 a[160:163], v[192:195], v[120:123], a[160:163]
v_exp_f32 v146, v146
v_mfma_f32_16x16x32_bf16 a[20:23], v[196:199], v[96:99], a[20:23]
v_exp_f32 v147, v147
v_mfma_f32_16x16x32_bf16 a[68:71], v[196:199], v[104:107], a[68:71]
v_add_f32 v16, v16, v146
v_add_f32 v16, v16, v147
v_mfma_f32_16x16x32_bf16 a[116:119], v[196:199], v[112:115], a[116:119]
v_cvt_pk_bf16_f32 v145, v146, v147
v_mfma_f32_16x16x32_bf16 a[164:167], v[196:199], v[120:123], a[164:167]
s_waitcnt lgkmcnt(0)
v_mfma_f32_16x16x32_bf16 a[24:27], v[200:203], v[96:99], a[24:27]
v_exp_f32 v152, v152
v_mfma_f32_16x16x32_bf16 a[72:75], v[200:203], v[104:107], a[72:75]
v_exp_f32 v153, v153
v_mfma_f32_16x16x32_bf16 a[120:123], v[200:203], v[112:115], a[120:123]
v_add_f32 v17, v17, v152
v_add_f32 v17, v17, v153
v_mfma_f32_16x16x32_bf16 a[168:171], v[200:203], v[120:123], a[168:171]
v_exp_f32 v154, v154
v_mfma_f32_16x16x32_bf16 a[28:31], v[204:207], v[96:99], a[28:31]
v_cvt_pk_bf16_f32 v152, v152, v153
v_mfma_f32_16x16x32_bf16 a[76:79], v[204:207], v[104:107], a[76:79]
v_exp_f32 v155, v155
v_mfma_f32_16x16x32_bf16 a[124:127], v[204:207], v[112:115], a[124:127]
v_add_f32 v17, v17, v154
v_add_f32 v17, v17, v155
v_mfma_f32_16x16x32_bf16 a[172:175], v[204:207], v[120:123], a[172:175]
v_exp_f32 v132, v132
v_mfma_f32_16x16x32_bf16 a[32:35], v[208:211], v[96:99], a[32:35]
v_cvt_pk_bf16_f32 v153, v154, v155
v_mfma_f32_16x16x32_bf16 a[80:83], v[208:211], v[104:107], a[80:83]
v_exp_f32 v133, v133
v_mfma_f32_16x16x32_bf16 a[128:131], v[208:211], v[112:115], a[128:131]
v_add_f32 v14, v14, v132
v_add_f32 v14, v14, v133
v_mfma_f32_16x16x32_bf16 a[176:179], v[208:211], v[120:123], a[176:179]
v_cvt_pk_bf16_f32 v130, v132, v133
v_mfma_f32_16x16x32_bf16 a[36:39], v[212:215], v[96:99], a[36:39]
ds_read_b128 v[176:179], v2 offset:0
ds_read_b128 v[180:183], v3 offset:0
v_mfma_f32_16x16x32_bf16 a[84:87], v[212:215], v[104:107], a[84:87]
v_exp_f32 v134, v134
v_mfma_f32_16x16x32_bf16 a[132:135], v[212:215], v[112:115], a[132:135]
ds_read_b128 v[184:187], v2 offset:128
ds_read_b128 v[188:191], v3 offset:128
v_mfma_f32_16x16x32_bf16 a[180:183], v[212:215], v[120:123], a[180:183]
v_exp_f32 v135, v135
v_mfma_f32_16x16x32_bf16 a[40:43], v[216:219], v[96:99], a[40:43]
ds_read_b128 v[192:195], v2 offset:256
ds_read_b128 v[196:199], v3 offset:256
v_mfma_f32_16x16x32_bf16 a[88:91], v[216:219], v[104:107], a[88:91]
v_add_f32 v14, v14, v134
v_add_f32 v14, v14, v135
v_mfma_f32_16x16x32_bf16 a[136:139], v[216:219], v[112:115], a[136:139]
v_cvt_pk_bf16_f32 v131, v134, v135
v_mfma_f32_16x16x32_bf16 a[184:187], v[216:219], v[120:123], a[184:187]
v_exp_f32 v140, v140
v_mfma_f32_16x16x32_bf16 a[44:47], v[220:223], v[96:99], a[44:47]
v_exp_f32 v141, v141
v_mfma_f32_16x16x32_bf16 a[92:95], v[220:223], v[104:107], a[92:95]
v_add_f32 v15, v15, v140
v_add_f32 v15, v15, v141
v_mfma_f32_16x16x32_bf16 a[140:143], v[220:223], v[112:115], a[140:143]
v_cvt_pk_bf16_f32 v138, v140, v141
v_mfma_f32_16x16x32_bf16 a[188:191], v[220:223], v[120:123], a[188:191]
s_waitcnt lgkmcnt(0)
v_mfma_f32_16x16x32_bf16 v[96:99], v[176:179], a[192:195], v[160:163]
v_exp_f32 v142, v142
v_mfma_f32_16x16x32_bf16 v[96:99], v[180:183], a[196:199], v[96:99]
v_exp_f32 v143, v143
v_mfma_f32_16x16x32_bf16 v[96:99], v[184:187], a[200:203], v[96:99]
s_waitcnt vmcnt(6)
s_barrier
v_mfma_f32_16x16x32_bf16 v[96:99], v[188:191], a[204:207], v[96:99]
v_add_f32 v15, v15, v142
s_add_u32 m0, s22, 36864
v_mfma_f32_16x16x32_bf16 v[96:99], v[192:195], a[208:211], v[96:99]
buffer_load_dwordx4 v8, s[8:11], s20 offen offset:0 lds
v_mfma_f32_16x16x32_bf16 v[96:99], v[196:199], a[212:215], v[96:99]
v_add_f32 v15, v15, v143
v_cvt_pk_bf16_f32 v139, v142, v143
v_mfma_f32_16x16x32_bf16 v[104:107], v[176:179], a[216:219], v[164:167]
v_exp_f32 v148, v148
v_mfma_f32_16x16x32_bf16 v[104:107], v[180:183], a[220:223], v[104:107]
buffer_load_dwordx4 v9, s[8:11], s20 offen offset:1024 lds
v_mfma_f32_16x16x32_bf16 v[104:107], v[184:187], a[224:227], v[104:107]
v_exp_f32 v149, v149
v_mfma_f32_16x16x32_bf16 v[104:107], v[188:191], a[228:231], v[104:107]
v_add_f32 v16, v16, v148
v_add_f32 v16, v16, v149
v_mfma_f32_16x16x32_bf16 v[104:107], v[192:195], a[232:235], v[104:107]
buffer_load_dwordx4 v10, s[8:11], s20 offen offset:2048 lds
v_mfma_f32_16x16x32_bf16 v[104:107], v[196:199], a[236:239], v[104:107]
v_cvt_pk_bf16_f32 v146, v148, v149
s_add_u32 s20, s20, 12288
v_mfma_f32_16x16x32_bf16 v[112:115], v[176:179], a[240:243], v[168:171]
ds_read_b128 v[200:203], v2 offset:6144
ds_read_b128 v[204:207], v3 offset:6144
v_mfma_f32_16x16x32_bf16 v[112:115], v[180:183], a[244:247], v[112:115]
s_add_u32 m0, s23, 12288
v_mfma_f32_16x16x32_bf16 v[112:115], v[184:187], a[248:251], v[112:115]
ds_read_b128 v[208:211], v2 offset:6272
ds_read_b128 v[212:215], v3 offset:6272
v_mfma_f32_16x16x32_bf16 v[112:115], v[188:191], a[252:255], v[112:115]
buffer_load_dwordx4 v11, s[12:15], s21 offen offset:0 lds
v_mfma_f32_16x16x32_bf16 v[112:115], v[192:195], v[64:67], v[112:115]
ds_read_b128 v[216:219], v2 offset:6400
ds_read_b128 v[220:223], v3 offset:6400
v_mfma_f32_16x16x32_bf16 v[112:115], v[196:199], v[68:71], v[112:115]
v_exp_f32 v150, v150
v_mfma_f32_16x16x32_bf16 v[120:123], v[176:179], v[72:75], v[172:175]
buffer_load_dwordx4 v12, s[12:15], s21 offen offset:1024 lds
v_mfma_f32_16x16x32_bf16 v[120:123], v[180:183], v[76:79], v[120:123]
v_exp_f32 v151, v151
v_mfma_f32_16x16x32_bf16 v[120:123], v[184:187], v[80:83], v[120:123]
v_add_f32 v16, v16, v150
v_add_f32 v16, v16, v151
v_mfma_f32_16x16x32_bf16 v[120:123], v[188:191], v[84:87], v[120:123]
buffer_load_dwordx4 v13, s[12:15], s21 offen offset:2048 lds
v_mfma_f32_16x16x32_bf16 v[120:123], v[192:195], v[88:91], v[120:123]
v_cvt_pk_bf16_f32 v147, v150, v151
s_add_u32 s21, s21, 12288
v_mfma_f32_16x16x32_bf16 v[120:123], v[196:199], v[92:95], v[120:123]
s_waitcnt lgkmcnt(0)
v_mfma_f32_16x16x32_bf16 v[100:103], v[200:203], a[192:195], v[160:163]
v_exp_f32 v156, v156
v_mfma_f32_16x16x32_bf16 v[100:103], v[204:207], a[196:199], v[100:103]
v_exp_f32 v157, v157
v_mfma_f32_16x16x32_bf16 v[100:103], v[208:211], a[200:203], v[100:103]
v_add_f32 v17, v17, v156
v_add_f32 v17, v17, v157
v_mfma_f32_16x16x32_bf16 v[100:103], v[212:215], a[204:207], v[100:103]
v_cvt_pk_bf16_f32 v154, v156, v157
v_mfma_f32_16x16x32_bf16 v[100:103], v[216:219], a[208:211], v[100:103]
v_exp_f32 v158, v158
v_mfma_f32_16x16x32_bf16 v[100:103], v[220:223], a[212:215], v[100:103]
v_exp_f32 v159, v159
v_mfma_f32_16x16x32_bf16 v[108:111], v[200:203], a[216:219], v[164:167]
ds_read_b64_tr_b16 v[176:177], v4 offset:36864
ds_read_b64_tr_b16 v[178:179], v4 offset:43008
v_mfma_f32_16x16x32_bf16 v[108:111], v[204:207], a[220:223], v[108:111]
v_add_f32 v17, v17, v158
v_add_f32 v17, v17, v159
v_mfma_f32_16x16x32_bf16 v[108:111], v[208:211], a[224:227], v[108:111]
ds_read_b64_tr_b16 v[180:181], v5 offset:36864
ds_read_b64_tr_b16 v[182:183], v5 offset:43008
v_mfma_f32_16x16x32_bf16 v[108:111], v[212:215], a[228:231], v[108:111]
v_cvt_pk_bf16_f32 v155, v158, v159
v_mfma_f32_16x16x32_bf16 v[108:111], v[216:219], a[232:235], v[108:111]
ds_read_b64_tr_b16 v[184:185], v6 offset:36864
ds_read_b64_tr_b16 v[186:187], v6 offset:43008
v_mfma_f32_16x16x32_bf16 v[108:111], v[220:223], a[236:239], v[108:111]
v_mfma_f32_16x16x32_bf16 v[116:119], v[200:203], a[240:243], v[168:171]
ds_read_b64_tr_b16 v[188:189], v7 offset:36864
ds_read_b64_tr_b16 v[190:191], v7 offset:43008
v_mfma_f32_16x16x32_bf16 v[116:119], v[204:207], a[244:247], v[116:119]
v_mfma_f32_16x16x32_bf16 v[116:119], v[208:211], a[248:251], v[116:119]
ds_read_b64_tr_b16 v[192:193], v4 offset:36992
ds_read_b64_tr_b16 v[194:195], v4 offset:43136
v_mfma_f32_16x16x32_bf16 v[116:119], v[212:215], a[252:255], v[116:119]
v_mfma_f32_16x16x32_bf16 v[116:119], v[216:219], v[64:67], v[116:119]
ds_read_b64_tr_b16 v[196:197], v5 offset:36992
ds_read_b64_tr_b16 v[198:199], v5 offset:43136
v_mfma_f32_16x16x32_bf16 v[116:119], v[220:223], v[68:71], v[116:119]
v_exp_f32 v96, v96
v_mfma_f32_16x16x32_bf16 v[124:127], v[200:203], v[72:75], v[172:175]
v_exp_f32 v97, v97
v_mfma_f32_16x16x32_bf16 v[124:127], v[204:207], v[76:79], v[124:127]
v_add_f32 v14, v14, v96
v_add_f32 v14, v14, v97
v_mfma_f32_16x16x32_bf16 v[124:127], v[208:211], v[80:83], v[124:127]
v_exp_f32 v98, v98
v_mfma_f32_16x16x32_bf16 v[124:127], v[212:215], v[84:87], v[124:127]
v_cvt_pk_bf16_f32 v96, v96, v97
v_mfma_f32_16x16x32_bf16 v[124:127], v[216:219], v[88:91], v[124:127]
v_exp_f32 v99, v99
v_mfma_f32_16x16x32_bf16 v[124:127], v[220:223], v[92:95], v[124:127]
v_add_f32 v14, v14, v98
s_waitcnt lgkmcnt(0)
v_mfma_f32_16x16x32_bf16 a[0:3], v[176:179], v[128:131], a[0:3]
v_exp_f32 v104, v104
v_mfma_f32_16x16x32_bf16 a[48:51], v[176:179], v[136:139], a[48:51]
v_add_f32 v14, v14, v99
v_cvt_pk_bf16_f32 v97, v98, v99
v_mfma_f32_16x16x32_bf16 a[96:99], v[176:179], v[144:147], a[96:99]
v_exp_f32 v105, v105
v_mfma_f32_16x16x32_bf16 a[144:147], v[176:179], v[152:155], a[144:147]
v_add_f32 v15, v15, v104
v_add_f32 v15, v15, v105
v_mfma_f32_16x16x32_bf16 a[4:7], v[180:183], v[128:131], a[4:7]
v_exp_f32 v106, v106
v_mfma_f32_16x16x32_bf16 a[52:55], v[180:183], v[136:139], a[52:55]
v_cvt_pk_bf16_f32 v104, v104, v105
v_mfma_f32_16x16x32_bf16 a[100:103], v[180:183], v[144:147], a[100:103]
ds_read_b64_tr_b16 v[200:201], v6 offset:36992
ds_read_b64_tr_b16 v[202:203], v6 offset:43136
v_mfma_f32_16x16x32_bf16 a[148:151], v[180:183], v[152:155], a[148:151]
v_exp_f32 v107, v107
v_mfma_f32_16x16x32_bf16 a[8:11], v[184:187], v[128:131], a[8:11]
ds_read_b64_tr_b16 v[204:205], v7 offset:36992
ds_read_b64_tr_b16 v[206:207], v7 offset:43136
v_mfma_f32_16x16x32_bf16 a[56:59], v[184:187], v[136:139], a[56:59]
v_add_f32 v15, v15, v106
v_add_f32 v15, v15, v107
v_mfma_f32_16x16x32_bf16 a[104:107], v[184:187], v[144:147], a[104:107]
ds_read_b64_tr_b16 v[208:209], v4 offset:37120
ds_read_b64_tr_b16 v[210:211], v4 offset:43264
v_mfma_f32_16x16x32_bf16 a[152:155], v[184:187], v[152:155], a[152:155]
v_exp_f32 v112, v112
v_mfma_f32_16x16x32_bf16 a[12:15], v[188:191], v[128:131], a[12:15]
ds_read_b64_tr_b16 v[212:213], v5 offset:37120
ds_read_b64_tr_b16 v[214:215], v5 offset:43264
v_mfma_f32_16x16x32_bf16 a[60:63], v[188:191], v[136:139], a[60:63]
v_cvt_pk_bf16_f32 v105, v106, v107
v_mfma_f32_16x16x32_bf16 a[108:111], v[188:191], v[144:147], a[108:111]
ds_read_b64_tr_b16 v[216:217], v6 offset:37120
ds_read_b64_tr_b16 v[218:219], v6 offset:43264
v_mfma_f32_16x16x32_bf16 a[156:159], v[188:191], v[152:155], a[156:159]
v_exp_f32 v113, v113
v_mfma_f32_16x16x32_bf16 a[16:19], v[192:195], v[128:131], a[16:19]
ds_read_b64_tr_b16 v[220:221], v7 offset:37120
ds_read_b64_tr_b16 v[222:223], v7 offset:43264
v_mfma_f32_16x16x32_bf16 a[64:67], v[192:195], v[136:139], a[64:67]
v_add_f32 v16, v16, v112
v_add_f32 v16, v16, v113
v_mfma_f32_16x16x32_bf16 a[112:115], v[192:195], v[144:147], a[112:115]
v_cvt_pk_bf16_f32 v112, v112, v113
v_mfma_f32_16x16x32_bf16 a[160:163], v[192:195], v[152:155], a[160:163]
v_exp_f32 v114, v114
v_mfma_f32_16x16x32_bf16 a[20:23], v[196:199], v[128:131], a[20:23]
v_exp_f32 v115, v115
v_mfma_f32_16x16x32_bf16 a[68:71], v[196:199], v[136:139], a[68:71]
v_add_f32 v16, v16, v114
v_add_f32 v16, v16, v115
v_mfma_f32_16x16x32_bf16 a[116:119], v[196:199], v[144:147], a[116:119]
v_cvt_pk_bf16_f32 v113, v114, v115
v_mfma_f32_16x16x32_bf16 a[164:167], v[196:199], v[152:155], a[164:167]
s_waitcnt lgkmcnt(0)
v_mfma_f32_16x16x32_bf16 a[24:27], v[200:203], v[128:131], a[24:27]
v_exp_f32 v120, v120
v_mfma_f32_16x16x32_bf16 a[72:75], v[200:203], v[136:139], a[72:75]
v_exp_f32 v121, v121
v_mfma_f32_16x16x32_bf16 a[120:123], v[200:203], v[144:147], a[120:123]
v_add_f32 v17, v17, v120
v_add_f32 v17, v17, v121
v_mfma_f32_16x16x32_bf16 a[168:171], v[200:203], v[152:155], a[168:171]
v_exp_f32 v122, v122
v_mfma_f32_16x16x32_bf16 a[28:31], v[204:207], v[128:131], a[28:31]
v_cvt_pk_bf16_f32 v120, v120, v121
v_mfma_f32_16x16x32_bf16 a[76:79], v[204:207], v[136:139], a[76:79]
v_exp_f32 v123, v123
v_mfma_f32_16x16x32_bf16 a[124:127], v[204:207], v[144:147], a[124:127]
v_add_f32 v17, v17, v122
v_add_f32 v17, v17, v123
v_mfma_f32_16x16x32_bf16 a[172:175], v[204:207], v[152:155], a[172:175]
v_exp_f32 v100, v100
v_mfma_f32_16x16x32_bf16 a[32:35], v[208:211], v[128:131], a[32:35]
v_cvt_pk_bf16_f32 v121, v122, v123
v_mfma_f32_16x16x32_bf16 a[80:83], v[208:211], v[136:139], a[80:83]
v_exp_f32 v101, v101
v_mfma_f32_16x16x32_bf16 a[128:131], v[208:211], v[144:147], a[128:131]
v_add_f32 v14, v14, v100
v_add_f32 v14, v14, v101
v_mfma_f32_16x16x32_bf16 a[176:179], v[208:211], v[152:155], a[176:179]
v_cvt_pk_bf16_f32 v98, v100, v101
v_mfma_f32_16x16x32_bf16 a[36:39], v[212:215], v[128:131], a[36:39]
ds_read_b128 v[176:179], v2 offset:12288
ds_read_b128 v[180:183], v3 offset:12288
v_mfma_f32_16x16x32_bf16 a[84:87], v[212:215], v[136:139], a[84:87]
v_exp_f32 v102, v102
v_mfma_f32_16x16x32_bf16 a[132:135], v[212:215], v[144:147], a[132:135]
ds_read_b128 v[184:187], v2 offset:12416
ds_read_b128 v[188:191], v3 offset:12416
v_mfma_f32_16x16x32_bf16 a[180:183], v[212:215], v[152:155], a[180:183]
v_exp_f32 v103, v103
v_mfma_f32_16x16x32_bf16 a[40:43], v[216:219], v[128:131], a[40:43]
ds_read_b128 v[192:195], v2 offset:12544
ds_read_b128 v[196:199], v3 offset:12544
v_mfma_f32_16x16x32_bf16 a[88:91], v[216:219], v[136:139], a[88:91]
v_add_f32 v14, v14, v102
v_add_f32 v14, v14, v103
v_mfma_f32_16x16x32_bf16 a[136:139], v[216:219], v[144:147], a[136:139]
v_cvt_pk_bf16_f32 v99, v102, v103
v_mfma_f32_16x16x32_bf16 a[184:187], v[216:219], v[152:155], a[184:187]
v_exp_f32 v108, v108
v_mfma_f32_16x16x32_bf16 a[44:47], v[220:223], v[128:131], a[44:47]
v_exp_f32 v109, v109
v_mfma_f32_16x16x32_bf16 a[92:95], v[220:223], v[136:139], a[92:95]
v_add_f32 v15, v15, v108
v_add_f32 v15, v15, v109
v_mfma_f32_16x16x32_bf16 a[140:143], v[220:223], v[144:147], a[140:143]
v_cvt_pk_bf16_f32 v106, v108, v109
v_mfma_f32_16x16x32_bf16 a[188:191], v[220:223], v[152:155], a[188:191]
s_waitcnt lgkmcnt(0)
v_mfma_f32_16x16x32_bf16 v[128:131], v[176:179], a[192:195], v[160:163]
v_exp_f32 v110, v110
v_mfma_f32_16x16x32_bf16 v[128:131], v[180:183], a[196:199], v[128:131]
v_exp_f32 v111, v111
v_mfma_f32_16x16x32_bf16 v[128:131], v[184:187], a[200:203], v[128:131]
s_waitcnt vmcnt(6)
s_barrier
v_mfma_f32_16x16x32_bf16 v[128:131], v[188:191], a[204:207], v[128:131]
v_add_f32 v15, v15, v110
s_add_u32 m0, s22, 0
v_mfma_f32_16x16x32_bf16 v[128:131], v[192:195], a[208:211], v[128:131]
buffer_load_dwordx4 v8, s[8:11], s20 offen offset:0 lds
v_mfma_f32_16x16x32_bf16 v[128:131], v[196:199], a[212:215], v[128:131]
v_add_f32 v15, v15, v111
v_cvt_pk_bf16_f32 v107, v110, v111
v_mfma_f32_16x16x32_bf16 v[136:139], v[176:179], a[216:219], v[164:167]
v_exp_f32 v116, v116
v_mfma_f32_16x16x32_bf16 v[136:139], v[180:183], a[220:223], v[136:139]
buffer_load_dwordx4 v9, s[8:11], s20 offen offset:1024 lds
v_mfma_f32_16x16x32_bf16 v[136:139], v[184:187], a[224:227], v[136:139]
v_exp_f32 v117, v117
v_mfma_f32_16x16x32_bf16 v[136:139], v[188:191], a[228:231], v[136:139]
v_add_f32 v16, v16, v116
v_add_f32 v16, v16, v117
v_mfma_f32_16x16x32_bf16 v[136:139], v[192:195], a[232:235], v[136:139]
buffer_load_dwordx4 v10, s[8:11], s20 offen offset:2048 lds
v_mfma_f32_16x16x32_bf16 v[136:139], v[196:199], a[236:239], v[136:139]
v_cvt_pk_bf16_f32 v114, v116, v117
s_add_u32 s20, s20, 12288
v_mfma_f32_16x16x32_bf16 v[144:147], v[176:179], a[240:243], v[168:171]
ds_read_b128 v[200:203], v2 offset:18432
ds_read_b128 v[204:207], v3 offset:18432
v_mfma_f32_16x16x32_bf16 v[144:147], v[180:183], a[244:247], v[144:147]
s_add_u32 m0, s23, 24576
v_mfma_f32_16x16x32_bf16 v[144:147], v[184:187], a[248:251], v[144:147]
ds_read_b128 v[208:211], v2 offset:18560
ds_read_b128 v[212:215], v3 offset:18560
v_mfma_f32_16x16x32_bf16 v[144:147], v[188:191], a[252:255], v[144:147]
buffer_load_dwordx4 v11, s[12:15], s21 offen offset:0 lds
v_mfma_f32_16x16x32_bf16 v[144:147], v[192:195], v[64:67], v[144:147]
ds_read_b128 v[216:219], v2 offset:18688
ds_read_b128 v[220:223], v3 offset:18688
v_mfma_f32_16x16x32_bf16 v[144:147], v[196:199], v[68:71], v[144:147]
v_exp_f32 v118, v118
v_mfma_f32_16x16x32_bf16 v[152:155], v[176:179], v[72:75], v[172:175]
buffer_load_dwordx4 v12, s[12:15], s21 offen offset:1024 lds
v_mfma_f32_16x16x32_bf16 v[152:155], v[180:183], v[76:79], v[152:155]
v_exp_f32 v119, v119
v_mfma_f32_16x16x32_bf16 v[152:155], v[184:187], v[80:83], v[152:155]
v_add_f32 v16, v16, v118
v_add_f32 v16, v16, v119
v_mfma_f32_16x16x32_bf16 v[152:155], v[188:191], v[84:87], v[152:155]
buffer_load_dwordx4 v13, s[12:15], s21 offen offset:2048 lds
v_mfma_f32_16x16x32_bf16 v[152:155], v[192:195], v[88:91], v[152:155]
v_cvt_pk_bf16_f32 v115, v118, v119
s_add_u32 s21, s21, 12288
v_mfma_f32_16x16x32_bf16 v[152:155], v[196:199], v[92:95], v[152:155]
s_waitcnt lgkmcnt(0)
v_mfma_f32_16x16x32_bf16 v[132:135], v[200:203], a[192:195], v[160:163]
v_exp_f32 v124, v124
v_mfma_f32_16x16x32_bf16 v[132:135], v[204:207], a[196:199], v[132:135]
v_exp_f32 v125, v125
v_mfma_f32_16x16x32_bf16 v[132:135], v[208:211], a[200:203], v[132:135]
v_add_f32 v17, v17, v124
v_add_f32 v17, v17, v125
v_mfma_f32_16x16x32_bf16 v[132:135], v[212:215], a[204:207], v[132:135]
v_cvt_pk_bf16_f32 v122, v124, v125
v_mfma_f32_16x16x32_bf16 v[132:135], v[216:219], a[208:211], v[132:135]
v_exp_f32 v126, v126
v_mfma_f32_16x16x32_bf16 v[132:135], v[220:223], a[212:215], v[132:135]
v_exp_f32 v127, v127
v_mfma_f32_16x16x32_bf16 v[140:143], v[200:203], a[216:219], v[164:167]
ds_read_b64_tr_b16 v[176:177], v4 offset:0
ds_read_b64_tr_b16 v[178:179], v4 offset:6144
v_mfma_f32_16x16x32_bf16 v[140:143], v[204:207], a[220:223], v[140:143]
v_add_f32 v17, v17, v126
v_add_f32 v17, v17, v127
v_mfma_f32_16x16x32_bf16 v[140:143], v[208:211], a[224:227], v[140:143]
ds_read_b64_tr_b16 v[180:181], v5 offset:0
ds_read_b64_tr_b16 v[182:183], v5 offset:6144
v_mfma_f32_16x16x32_bf16 v[140:143], v[212:215], a[228:231], v[140:143]
v_cvt_pk_bf16_f32 v123, v126, v127
v_mfma_f32_16x16x32_bf16 v[140:143], v[216:219], a[232:235], v[140:143]
ds_read_b64_tr_b16 v[184:185], v6 offset:0
ds_read_b64_tr_b16 v[186:187], v6 offset:6144
v_mfma_f32_16x16x32_bf16 v[140:143], v[220:223], a[236:239], v[140:143]
v_mfma_f32_16x16x32_bf16 v[148:151], v[200:203], a[240:243], v[168:171]
ds_read_b64_tr_b16 v[188:189], v7 offset:0
ds_read_b64_tr_b16 v[190:191], v7 offset:6144
v_mfma_f32_16x16x32_bf16 v[148:151], v[204:207], a[244:247], v[148:151]
v_mfma_f32_16x16x32_bf16 v[148:151], v[208:211], a[248:251], v[148:151]
ds_read_b64_tr_b16 v[192:193], v4 offset:128
ds_read_b64_tr_b16 v[194:195], v4 offset:6272
v_mfma_f32_16x16x32_bf16 v[148:151], v[212:215], a[252:255], v[148:151]
v_mfma_f32_16x16x32_bf16 v[148:151], v[216:219], v[64:67], v[148:151]
ds_read_b64_tr_b16 v[196:197], v5 offset:128
ds_read_b64_tr_b16 v[198:199], v5 offset:6272
v_mfma_f32_16x16x32_bf16 v[148:151], v[220:223], v[68:71], v[148:151]
v_exp_f32 v128, v128
v_mfma_f32_16x16x32_bf16 v[156:159], v[200:203], v[72:75], v[172:175]
v_exp_f32 v129, v129
v_mfma_f32_16x16x32_bf16 v[156:159], v[204:207], v[76:79], v[156:159]
v_add_f32 v14, v14, v128
v_add_f32 v14, v14, v129
v_mfma_f32_16x16x32_bf16 v[156:159], v[208:211], v[80:83], v[156:159]
v_exp_f32 v130, v130
v_mfma_f32_16x16x32_bf16 v[156:159], v[212:215], v[84:87], v[156:159]
v_cvt_pk_bf16_f32 v128, v128, v129
v_mfma_f32_16x16x32_bf16 v[156:159], v[216:219], v[88:91], v[156:159]
v_exp_f32 v131, v131
v_mfma_f32_16x16x32_bf16 v[156:159], v[220:223], v[92:95], v[156:159]
v_add_f32 v14, v14, v130
s_waitcnt lgkmcnt(0)
v_mfma_f32_16x16x32_bf16 a[0:3], v[176:179], v[96:99], a[0:3]
v_exp_f32 v136, v136
v_mfma_f32_16x16x32_bf16 a[48:51], v[176:179], v[104:107], a[48:51]
v_add_f32 v14, v14, v131
v_cvt_pk_bf16_f32 v129, v130, v131
v_mfma_f32_16x16x32_bf16 a[96:99], v[176:179], v[112:115], a[96:99]
v_exp_f32 v137, v137
v_mfma_f32_16x16x32_bf16 a[144:147], v[176:179], v[120:123], a[144:147]
v_add_f32 v15, v15, v136
v_add_f32 v15, v15, v137
v_mfma_f32_16x16x32_bf16 a[4:7], v[180:183], v[96:99], a[4:7]
v_exp_f32 v138, v138
v_mfma_f32_16x16x32_bf16 a[52:55], v[180:183], v[104:107], a[52:55]
v_cvt_pk_bf16_f32 v136, v136, v137
v_mfma_f32_16x16x32_bf16 a[100:103], v[180:183], v[112:115], a[100:103]
ds_read_b64_tr_b16 v[200:201], v6 offset:128
ds_read_b64_tr_b16 v[202:203], v6 offset:6272
v_mfma_f32_16x16x32_bf16 a[148:151], v[180:183], v[120:123], a[148:151]
v_exp_f32 v139, v139
v_mfma_f32_16x16x32_bf16 a[8:11], v[184:187], v[96:99], a[8:11]
ds_read_b64_tr_b16 v[204:205], v7 offset:128
ds_read_b64_tr_b16 v[206:207], v7 offset:6272
v_mfma_f32_16x16x32_bf16 a[56:59], v[184:187], v[104:107], a[56:59]
v_add_f32 v15, v15, v138
v_add_f32 v15, v15, v139
v_mfma_f32_16x16x32_bf16 a[104:107], v[184:187], v[112:115], a[104:107]
ds_read_b64_tr_b16 v[208:209], v4 offset:256
ds_read_b64_tr_b16 v[210:211], v4 offset:6400
v_mfma_f32_16x16x32_bf16 a[152:155], v[184:187], v[120:123], a[152:155]
v_exp_f32 v144, v144
v_mfma_f32_16x16x32_bf16 a[12:15], v[188:191], v[96:99], a[12:15]
ds_read_b64_tr_b16 v[212:213], v5 offset:256
ds_read_b64_tr_b16 v[214:215], v5 offset:6400
v_mfma_f32_16x16x32_bf16 a[60:63], v[188:191], v[104:107], a[60:63]
v_cvt_pk_bf16_f32 v137, v138, v139
v_mfma_f32_16x16x32_bf16 a[108:111], v[188:191], v[112:115], a[108:111]
ds_read_b64_tr_b16 v[216:217], v6 offset:256
ds_read_b64_tr_b16 v[218:219], v6 offset:6400
v_mfma_f32_16x16x32_bf16 a[156:159], v[188:191], v[120:123], a[156:159]
v_exp_f32 v145, v145
v_mfma_f32_16x16x32_bf16 a[16:19], v[192:195], v[96:99], a[16:19]
ds_read_b64_tr_b16 v[220:221], v7 offset:256
ds_read_b64_tr_b16 v[222:223], v7 offset:6400
v_mfma_f32_16x16x32_bf16 a[64:67], v[192:195], v[104:107], a[64:67]
v_add_f32 v16, v16, v144
v_add_f32 v16, v16, v145
v_mfma_f32_16x16x32_bf16 a[112:115], v[192:195], v[112:115], a[112:115]
v_cvt_pk_bf16_f32 v144, v144, v145
v_mfma_f32_16x16x32_bf16 a[160:163], v[192:195], v[120:123], a[160:163]
v_exp_f32 v146, v146
v_mfma_f32_16x16x32_bf16 a[20:23], v[196:199], v[96:99], a[20:23]
v_exp_f32 v147, v147
v_mfma_f32_16x16x32_bf16 a[68:71], v[196:199], v[104:107], a[68:71]
v_add_f32 v16, v16, v146
v_add_f32 v16, v16, v147
v_mfma_f32_16x16x32_bf16 a[116:119], v[196:199], v[112:115], a[116:119]
v_cvt_pk_bf16_f32 v145, v146, v147
v_mfma_f32_16x16x32_bf16 a[164:167], v[196:199], v[120:123], a[164:167]
s_waitcnt lgkmcnt(0)
v_mfma_f32_16x16x32_bf16 a[24:27], v[200:203], v[96:99], a[24:27]
v_exp_f32 v152, v152
v_mfma_f32_16x16x32_bf16 a[72:75], v[200:203], v[104:107], a[72:75]
v_exp_f32 v153, v153
v_mfma_f32_16x16x32_bf16 a[120:123], v[200:203], v[112:115], a[120:123]
v_add_f32 v17, v17, v152
v_add_f32 v17, v17, v153
v_mfma_f32_16x16x32_bf16 a[168:171], v[200:203], v[120:123], a[168:171]
v_exp_f32 v154, v154
v_mfma_f32_16x16x32_bf16 a[28:31], v[204:207], v[96:99], a[28:31]
v_cvt_pk_bf16_f32 v152, v152, v153
v_mfma_f32_16x16x32_bf16 a[76:79], v[204:207], v[104:107], a[76:79]
v_exp_f32 v155, v155
v_mfma_f32_16x16x32_bf16 a[124:127], v[204:207], v[112:115], a[124:127]
v_add_f32 v17, v17, v154
v_add_f32 v17, v17, v155
v_mfma_f32_16x16x32_bf16 a[172:175], v[204:207], v[120:123], a[172:175]
v_exp_f32 v132, v132
v_mfma_f32_16x16x32_bf16 a[32:35], v[208:211], v[96:99], a[32:35]
v_cvt_pk_bf16_f32 v153, v154, v155
v_mfma_f32_16x16x32_bf16 a[80:83], v[208:211], v[104:107], a[80:83]
v_exp_f32 v133, v133
v_mfma_f32_16x16x32_bf16 a[128:131], v[208:211], v[112:115], a[128:131]
v_add_f32 v14, v14, v132
v_add_f32 v14, v14, v133
v_mfma_f32_16x16x32_bf16 a[176:179], v[208:211], v[120:123], a[176:179]
v_cvt_pk_bf16_f32 v130, v132, v133
v_mfma_f32_16x16x32_bf16 a[36:39], v[212:215], v[96:99], a[36:39]
ds_read_b128 v[176:179], v2 offset:24576
ds_read_b128 v[180:183], v3 offset:24576
v_mfma_f32_16x16x32_bf16 a[84:87], v[212:215], v[104:107], a[84:87]
v_exp_f32 v134, v134
v_mfma_f32_16x16x32_bf16 a[132:135], v[212:215], v[112:115], a[132:135]
ds_read_b128 v[184:187], v2 offset:24704
ds_read_b128 v[188:191], v3 offset:24704
v_mfma_f32_16x16x32_bf16 a[180:183], v[212:215], v[120:123], a[180:183]
v_exp_f32 v135, v135
v_mfma_f32_16x16x32_bf16 a[40:43], v[216:219], v[96:99], a[40:43]
ds_read_b128 v[192:195], v2 offset:24832
ds_read_b128 v[196:199], v3 offset:24832
v_mfma_f32_16x16x32_bf16 a[88:91], v[216:219], v[104:107], a[88:91]
v_add_f32 v14, v14, v134
v_add_f32 v14, v14, v135
v_mfma_f32_16x16x32_bf16 a[136:139], v[216:219], v[112:115], a[136:139]
v_cvt_pk_bf16_f32 v131, v134, v135
v_mfma_f32_16x16x32_bf16 a[184:187], v[216:219], v[120:123], a[184:187]
v_exp_f32 v140, v140
v_mfma_f32_16x16x32_bf16 a[44:47], v[220:223], v[96:99], a[44:47]
v_exp_f32 v141, v141
v_mfma_f32_16x16x32_bf16 a[92:95], v[220:223], v[104:107], a[92:95]
v_add_f32 v15, v15, v140
v_add_f32 v15, v15, v141
v_mfma_f32_16x16x32_bf16 a[140:143], v[220:223], v[112:115], a[140:143]
v_cvt_pk_bf16_f32 v138, v140, v141
v_mfma_f32_16x16x32_bf16 a[188:191], v[220:223], v[120:123], a[188:191]
s_sub_u32 s24, s24, 1
s_cmp_eq_u32 s24, 1
s_cbranch_scc1 L_k2_tail0
s_waitcnt lgkmcnt(0)
v_mfma_f32_16x16x32_bf16 v[96:99], v[176:179], a[192:195], v[160:163]
v_exp_f32 v142, v142
v_mfma_f32_16x16x32_bf16 v[96:99], v[180:183], a[196:199], v[96:99]
v_exp_f32 v143, v143
v_mfma_f32_16x16x32_bf16 v[96:99], v[184:187], a[200:203], v[96:99]
s_waitcnt vmcnt(6)
s_barrier
v_mfma_f32_16x16x32_bf16 v[96:99], v[188:191], a[204:207], v[96:99]
v_add_f32 v15, v15, v142
s_add_u32 m0, s22, 12288
v_mfma_f32_16x16x32_bf16 v[96:99], v[192:195], a[208:211], v[96:99]
buffer_load_dwordx4 v8, s[8:11], s20 offen offset:0 lds
v_mfma_f32_16x16x32_bf16 v[96:99], v[196:199], a[212:215], v[96:99]
v_add_f32 v15, v15, v143
v_cvt_pk_bf16_f32 v139, v142, v143
v_mfma_f32_16x16x32_bf16 v[104:107], v[176:179], a[216:219], v[164:167]
v_exp_f32 v148, v148
v_mfma_f32_16x16x32_bf16 v[104:107], v[180:183], a[220:223], v[104:107]
buffer_load_dwordx4 v9, s[8:11], s20 offen offset:1024 lds
v_mfma_f32_16x16x32_bf16 v[104:107], v[184:187], a[224:227], v[104:107]
v_exp_f32 v149, v149
v_mfma_f32_16x16x32_bf16 v[104:107], v[188:191], a[228:231], v[104:107]
v_add_f32 v16, v16, v148
v_add_f32 v16, v16, v149
v_mfma_f32_16x16x32_bf16 v[104:107], v[192:195], a[232:235], v[104:107]
buffer_load_dwordx4 v10, s[8:11], s20 offen offset:2048 lds
v_mfma_f32_16x16x32_bf16 v[104:107], v[196:199], a[236:239], v[104:107]
v_cvt_pk_bf16_f32 v146, v148, v149
s_add_u32 s20, s20, 12288
v_mfma_f32_16x16x32_bf16 v[112:115], v[176:179], a[240:243], v[168:171]
ds_read_b128 v[200:203], v2 offset:30720
ds_read_b128 v[204:207], v3 offset:30720
v_mfma_f32_16x16x32_bf16 v[112:115], v[180:183], a[244:247], v[112:115]
s_add_u32 m0, s23, 36864
v_mfma_f32_16x16x32_bf16 v[112:115], v[184:187], a[248:251], v[112:115]
ds_read_b128 v[208:211], v2 offset:30848
ds_read_b128 v[212:215], v3 offset:30848
v_mfma_f32_16x16x32_bf16 v[112:115], v[188:191], a[252:255], v[112:115]
buffer_load_dwordx4 v11, s[12:15], s21 offen offset:0 lds
v_mfma_f32_16x16x32_bf16 v[112:115], v[192:195], v[64:67], v[112:115]
ds_read_b128 v[216:219], v2 offset:30976
ds_read_b128 v[220:223], v3 offset:30976
v_mfma_f32_16x16x32_bf16 v[112:115], v[196:199], v[68:71], v[112:115]
v_exp_f32 v150, v150
v_mfma_f32_16x16x32_bf16 v[120:123], v[176:179], v[72:75], v[172:175]
buffer_load_dwordx4 v12, s[12:15], s21 offen offset:1024 lds
v_mfma_f32_16x16x32_bf16 v[120:123], v[180:183], v[76:79], v[120:123]
v_exp_f32 v151, v151
v_mfma_f32_16x16x32_bf16 v[120:123], v[184:187], v[80:83], v[120:123]
v_add_f32 v16, v16, v150
v_add_f32 v16, v16, v151
v_mfma_f32_16x16x32_bf16 v[120:123], v[188:191], v[84:87], v[120:123]
buffer_load_dwordx4 v13, s[12:15], s21 offen offset:2048 lds
v_mfma_f32_16x16x32_bf16 v[120:123], v[192:195], v[88:91], v[120:123]
v_cvt_pk_bf16_f32 v147, v150, v151
s_add_u32 s21, s21, 12288
v_mfma_f32_16x16x32_bf16 v[120:123], v[196:199], v[92:95], v[120:123]
s_waitcnt lgkmcnt(0)
v_mfma_f32_16x16x32_bf16 v[100:103], v[200:203], a[192:195], v[160:163]
v_exp_f32 v156, v156
v_mfma_f32_16x16x32_bf16 v[100:103], v[204:207], a[196:199], v[100:103]
v_exp_f32 v157, v157
v_mfma_f32_16x16x32_bf16 v[100:103], v[208:211], a[200:203], v[100:103]
v_add_f32 v17, v17, v156
v_add_f32 v17, v17, v157
v_mfma_f32_16x16x32_bf16 v[100:103], v[212:215], a[204:207], v[100:103]
v_cvt_pk_bf16_f32 v154, v156, v157
v_mfma_f32_16x16x32_bf16 v[100:103], v[216:219], a[208:211], v[100:103]
v_exp_f32 v158, v158
v_mfma_f32_16x16x32_bf16 v[100:103], v[220:223], a[212:215], v[100:103]
v_exp_f32 v159, v159
v_mfma_f32_16x16x32_bf16 v[108:111], v[200:203], a[216:219], v[164:167]
ds_read_b64_tr_b16 v[176:177], v4 offset:12288
ds_read_b64_tr_b16 v[178:179], v4 offset:18432
v_mfma_f32_16x16x32_bf16 v[108:111], v[204:207], a[220:223], v[108:111]
v_add_f32 v17, v17, v158
v_add_f32 v17, v17, v159
v_mfma_f32_16x16x32_bf16 v[108:111], v[208:211], a[224:227], v[108:111]
ds_read_b64_tr_b16 v[180:181], v5 offset:12288
ds_read_b64_tr_b16 v[182:183], v5 offset:18432
v_mfma_f32_16x16x32_bf16 v[108:111], v[212:215], a[228:231], v[108:111]
v_cvt_pk_bf16_f32 v155, v158, v159
v_mfma_f32_16x16x32_bf16 v[108:111], v[216:219], a[232:235], v[108:111]
ds_read_b64_tr_b16 v[184:185], v6 offset:12288
ds_read_b64_tr_b16 v[186:187], v6 offset:18432
v_mfma_f32_16x16x32_bf16 v[108:111], v[220:223], a[236:239], v[108:111]
v_mfma_f32_16x16x32_bf16 v[116:119], v[200:203], a[240:243], v[168:171]
ds_read_b64_tr_b16 v[188:189], v7 offset:12288
ds_read_b64_tr_b16 v[190:191], v7 offset:18432
v_mfma_f32_16x16x32_bf16 v[116:119], v[204:207], a[244:247], v[116:119]
v_mfma_f32_16x16x32_bf16 v[116:119], v[208:211], a[248:251], v[116:119]
ds_read_b64_tr_b16 v[192:193], v4 offset:12416
ds_read_b64_tr_b16 v[194:195], v4 offset:18560
v_mfma_f32_16x16x32_bf16 v[116:119], v[212:215], a[252:255], v[116:119]
v_mfma_f32_16x16x32_bf16 v[116:119], v[216:219], v[64:67], v[116:119]
ds_read_b64_tr_b16 v[196:197], v5 offset:12416
ds_read_b64_tr_b16 v[198:199], v5 offset:18560
v_mfma_f32_16x16x32_bf16 v[116:119], v[220:223], v[68:71], v[116:119]
v_exp_f32 v96, v96
v_mfma_f32_16x16x32_bf16 v[124:127], v[200:203], v[72:75], v[172:175]
v_exp_f32 v97, v97
v_mfma_f32_16x16x32_bf16 v[124:127], v[204:207], v[76:79], v[124:127]
v_add_f32 v14, v14, v96
v_add_f32 v14, v14, v97
v_mfma_f32_16x16x32_bf16 v[124:127], v[208:211], v[80:83], v[124:127]
v_exp_f32 v98, v98
v_mfma_f32_16x16x32_bf16 v[124:127], v[212:215], v[84:87], v[124:127]
v_cvt_pk_bf16_f32 v96, v96, v97
v_mfma_f32_16x16x32_bf16 v[124:127], v[216:219], v[88:91], v[124:127]
v_exp_f32 v99, v99
v_mfma_f32_16x16x32_bf16 v[124:127], v[220:223], v[92:95], v[124:127]
v_add_f32 v14, v14, v98
s_waitcnt lgkmcnt(0)
v_mfma_f32_16x16x32_bf16 a[0:3], v[176:179], v[128:131], a[0:3]
v_exp_f32 v104, v104
v_mfma_f32_16x16x32_bf16 a[48:51], v[176:179], v[136:139], a[48:51]
v_add_f32 v14, v14, v99
v_cvt_pk_bf16_f32 v97, v98, v99
v_mfma_f32_16x16x32_bf16 a[96:99], v[176:179], v[144:147], a[96:99]
v_exp_f32 v105, v105
v_mfma_f32_16x16x32_bf16 a[144:147], v[176:179], v[152:155], a[144:147]
v_add_f32 v15, v15, v104
v_add_f32 v15, v15, v105
v_mfma_f32_16x16x32_bf16 a[4:7], v[180:183], v[128:131], a[4:7]
v_exp_f32 v106, v106
v_mfma_f32_16x16x32_bf16 a[52:55], v[180:183], v[136:139], a[52:55]
v_cvt_pk_bf16_f32 v104, v104, v105
v_mfma_f32_16x16x32_bf16 a[100:103], v[180:183], v[144:147], a[100:103]
ds_read_b64_tr_b16 v[200:201], v6 offset:12416
ds_read_b64_tr_b16 v[202:203], v6 offset:18560
v_mfma_f32_16x16x32_bf16 a[148:151], v[180:183], v[152:155], a[148:151]
v_exp_f32 v107, v107
v_mfma_f32_16x16x32_bf16 a[8:11], v[184:187], v[128:131], a[8:11]
ds_read_b64_tr_b16 v[204:205], v7 offset:12416
ds_read_b64_tr_b16 v[206:207], v7 offset:18560
v_mfma_f32_16x16x32_bf16 a[56:59], v[184:187], v[136:139], a[56:59]
v_add_f32 v15, v15, v106
v_add_f32 v15, v15, v107
v_mfma_f32_16x16x32_bf16 a[104:107], v[184:187], v[144:147], a[104:107]
ds_read_b64_tr_b16 v[208:209], v4 offset:12544
ds_read_b64_tr_b16 v[210:211], v4 offset:18688
v_mfma_f32_16x16x32_bf16 a[152:155], v[184:187], v[152:155], a[152:155]
v_exp_f32 v112, v112
v_mfma_f32_16x16x32_bf16 a[12:15], v[188:191], v[128:131], a[12:15]
ds_read_b64_tr_b16 v[212:213], v5 offset:12544
ds_read_b64_tr_b16 v[214:215], v5 offset:18688
v_mfma_f32_16x16x32_bf16 a[60:63], v[188:191], v[136:139], a[60:63]
v_cvt_pk_bf16_f32 v105, v106, v107
v_mfma_f32_16x16x32_bf16 a[108:111], v[188:191], v[144:147], a[108:111]
ds_read_b64_tr_b16 v[216:217], v6 offset:12544
ds_read_b64_tr_b16 v[218:219], v6 offset:18688
v_mfma_f32_16x16x32_bf16 a[156:159], v[188:191], v[152:155], a[156:159]
v_exp_f32 v113, v113
v_mfma_f32_16x16x32_bf16 a[16:19], v[192:195], v[128:131], a[16:19]
ds_read_b64_tr_b16 v[220:221], v7 offset:12544
ds_read_b64_tr_b16 v[222:223], v7 offset:18688
v_mfma_f32_16x16x32_bf16 a[64:67], v[192:195], v[136:139], a[64:67]
v_add_f32 v16, v16, v112
v_add_f32 v16, v16, v113
v_mfma_f32_16x16x32_bf16 a[112:115], v[192:195], v[144:147], a[112:115]
v_cvt_pk_bf16_f32 v112, v112, v113
v_mfma_f32_16x16x32_bf16 a[160:163], v[192:195], v[152:155], a[160:163]
v_exp_f32 v114, v114
v_mfma_f32_16x16x32_bf16 a[20:23], v[196:199], v[128:131], a[20:23]
v_exp_f32 v115, v115
v_mfma_f32_16x16x32_bf16 a[68:71], v[196:199], v[136:139], a[68:71]
v_add_f32 v16, v16, v114
v_add_f32 v16, v16, v115
v_mfma_f32_16x16x32_bf16 a[116:119], v[196:199], v[144:147], a[116:119]
v_cvt_pk_bf16_f32 v113, v114, v115
v_mfma_f32_16x16x32_bf16 a[164:167], v[196:199], v[152:155], a[164:167]
s_waitcnt lgkmcnt(0)
v_mfma_f32_16x16x32_bf16 a[24:27], v[200:203], v[128:131], a[24:27]
v_exp_f32 v120, v120
v_mfma_f32_16x16x32_bf16 a[72:75], v[200:203], v[136:139], a[72:75]
v_exp_f32 v121, v121
v_mfma_f32_16x16x32_bf16 a[120:123], v[200:203], v[144:147], a[120:123]
v_add_f32 v17, v17, v120
v_add_f32 v17, v17, v121
v_mfma_f32_16x16x32_bf16 a[168:171], v[200:203], v[152:155], a[168:171]
v_exp_f32 v122, v122
v_mfma_f32_16x16x32_bf16 a[28:31], v[204:207], v[128:131], a[28:31]
v_cvt_pk_bf16_f32 v120, v120, v121
v_mfma_f32_16x16x32_bf16 a[76:79], v[204:207], v[136:139], a[76:79]
v_exp_f32 v123, v123
v_mfma_f32_16x16x32_bf16 a[124:127], v[204:207], v[144:147], a[124:127]
v_add_f32 v17, v17, v122
v_add_f32 v17, v17, v123
v_mfma_f32_16x16x32_bf16 a[172:175], v[204:207], v[152:155], a[172:175]
v_exp_f32 v100, v100
v_mfma_f32_16x16x32_bf16 a[32:35], v[208:211], v[128:131], a[32:35]
v_cvt_pk_bf16_f32 v121, v122, v123
v_mfma_f32_16x16x32_bf16 a[80:83], v[208:211], v[136:139], a[80:83]
v_exp_f32 v101, v101
v_mfma_f32_16x16x32_bf16 a[128:131], v[208:211], v[144:147], a[128:131]
v_add_f32 v14, v14, v100
v_add_f32 v14, v14, v101
v_mfma_f32_16x16x32_bf16 a[176:179], v[208:211], v[152:155], a[176:179]
v_cvt_pk_bf16_f32 v98, v100, v101
v_mfma_f32_16x16x32_bf16 a[36:39], v[212:215], v[128:131], a[36:39]
ds_read_b128 v[176:179], v2 offset:36864
ds_read_b128 v[180:183], v3 offset:36864
v_mfma_f32_16x16x32_bf16 a[84:87], v[212:215], v[136:139], a[84:87]
v_exp_f32 v102, v102
v_mfma_f32_16x16x32_bf16 a[132:135], v[212:215], v[144:147], a[132:135]
ds_read_b128 v[184:187], v2 offset:36992
ds_read_b128 v[188:191], v3 offset:36992
v_mfma_f32_16x16x32_bf16 a[180:183], v[212:215], v[152:155], a[180:183]
v_exp_f32 v103, v103
v_mfma_f32_16x16x32_bf16 a[40:43], v[216:219], v[128:131], a[40:43]
ds_read_b128 v[192:195], v2 offset:37120
ds_read_b128 v[196:199], v3 offset:37120
v_mfma_f32_16x16x32_bf16 a[88:91], v[216:219], v[136:139], a[88:91]
v_add_f32 v14, v14, v102
v_add_f32 v14, v14, v103
v_mfma_f32_16x16x32_bf16 a[136:139], v[216:219], v[144:147], a[136:139]
v_cvt_pk_bf16_f32 v99, v102, v103
v_mfma_f32_16x16x32_bf16 a[184:187], v[216:219], v[152:155], a[184:187]
v_exp_f32 v108, v108
v_mfma_f32_16x16x32_bf16 a[44:47], v[220:223], v[128:131], a[44:47]
v_exp_f32 v109, v109
v_mfma_f32_16x16x32_bf16 a[92:95], v[220:223], v[136:139], a[92:95]
v_add_f32 v15, v15, v108
v_add_f32 v15, v15, v109
v_mfma_f32_16x16x32_bf16 a[140:143], v[220:223], v[144:147], a[140:143]
v_cvt_pk_bf16_f32 v106, v108, v109
v_mfma_f32_16x16x32_bf16 a[188:191], v[220:223], v[152:155], a[188:191]
s_bitcmp1_b32 0x8140, s24
s_cbranch_scc1 L_hook
L_hook_back:
s_branch L_k2_loop
L_k2_tail0:
s_waitcnt lgkmcnt(0)
v_mfma_f32_16x16x32_bf16 v[96:99], v[176:179], a[192:195], v[160:163]
v_exp_f32 v142, v142
v_mfma_f32_16x16x32_bf16 v[96:99], v[180:183], a[196:199], v[96:99]
v_exp_f32 v143, v143
v_mfma_f32_16x16x32_bf16 v[96:99], v[184:187], a[200:203], v[96:99]
s_waitcnt vmcnt(6)
s_barrier
v_mfma_f32_16x16x32_bf16 v[96:99], v[188:191], a[204:207], v[96:99]
v_add_f32 v15, v15, v142
v_mfma_f32_16x16x32_bf16 v[96:99], v[192:195], a[208:211], v[96:99]
v_mfma_f32_16x16x32_bf16 v[96:99], v[196:199], a[212:215], v[96:99]
v_add_f32 v15, v15, v143
v_cvt_pk_bf16_f32 v139, v142, v143
v_mfma_f32_16x16x32_bf16 v[104:107], v[176:179], a[216:219], v[164:167]
v_exp_f32 v148, v148
v_mfma_f32_16x16x32_bf16 v[104:107], v[180:183], a[220:223], v[104:107]
v_mfma_f32_16x16x32_bf16 v[104:107], v[184:187], a[224:227], v[104:107]
v_exp_f32 v149, v149
v_mfma_f32_16x16x32_bf16 v[104:107], v[188:191], a[228:231], v[104:107]
v_add_f32 v16, v16, v148
v_add_f32 v16, v16, v149
v_mfma_f32_16x16x32_bf16 v[104:107], v[192:195], a[232:235], v[104:107]
v_mfma_f32_16x16x32_bf16 v[104:107], v[196:199], a[236:239], v[104:107]
v_cvt_pk_bf16_f32 v146, v148, v149
v_mfma_f32_16x16x32_bf16 v[112:115], v[176:179], a[240:243], v[168:171]
ds_read_b128 v[200:203], v2 offset:30720
ds_read_b128 v[204:207], v3 offset:30720
v_mfma_f32_16x16x32_bf16 v[112:115], v[180:183], a[244:247], v[112:115]
s_add_u32 m0, s23, 36864
v_mfma_f32_16x16x32_bf16 v[112:115], v[184:187], a[248:251], v[112:115]
ds_read_b128 v[208:211], v2 offset:30848
ds_read_b128 v[212:215], v3 offset:30848
v_mfma_f32_16x16x32_bf16 v[112:115], v[188:191], a[252:255], v[112:115]
buffer_load_dwordx4 v11, s[12:15], s21 offen offset:0 lds
v_mfma_f32_16x16x32_bf16 v[112:115], v[192:195], v[64:67], v[112:115]
ds_read_b128 v[216:219], v2 offset:30976
ds_read_b128 v[220:223], v3 offset:30976
v_mfma_f32_16x16x32_bf16 v[112:115], v[196:199], v[68:71], v[112:115]
v_exp_f32 v150, v150
v_mfma_f32_16x16x32_bf16 v[120:123], v[176:179], v[72:75], v[172:175]
buffer_load_dwordx4 v12, s[12:15], s21 offen offset:1024 lds
v_mfma_f32_16x16x32_bf16 v[120:123], v[180:183], v[76:79], v[120:123]
v_exp_f32 v151, v151
v_mfma_f32_16x16x32_bf16 v[120:123], v[184:187], v[80:83], v[120:123]
v_add_f32 v16, v16, v150
v_add_f32 v16, v16, v151
v_mfma_f32_16x16x32_bf16 v[120:123], v[188:191], v[84:87], v[120:123]
buffer_load_dwordx4 v13, s[12:15], s21 offen offset:2048 lds
v_mfma_f32_16x16x32_bf16 v[120:123], v[192:195], v[88:91], v[120:123]
v_cvt_pk_bf16_f32 v147, v150, v151
s_add_u32 s21, s21, 12288
v_mfma_f32_16x16x32_bf16 v[120:123], v[196:199], v[92:95], v[120:123]
s_waitcnt lgkmcnt(0)
v_mfma_f32_16x16x32_bf16 v[100:103], v[200:203], a[192:195], v[160:163]
v_exp_f32 v156, v156
v_mfma_f32_16x16x32_bf16 v[100:103], v[204:207], a[196:199], v[100:103]
v_exp_f32 v157, v157
v_mfma_f32_16x16x32_bf16 v[100:103], v[208:211], a[200:203], v[100:103]
v_add_f32 v17, v17, v156
v_add_f32 v17, v17, v157
s_add_u32 s46, s62, 0
s_add_u32 m0, s45, 102144
v_mfma_f32_16x16x32_bf16 v[100:103], v[212:215], a[204:207], v[100:103]
v_cvt_pk_bf16_f32 v154, v156, v157
buffer_load_dwordx4 v26, s[28:31], s46 offen offset:0 sc0 sc1 lds
v_mfma_f32_16x16x32_bf16 v[100:103], v[216:219], a[208:211], v[100:103]
v_exp_f32 v158, v158
v_mfma_f32_16x16x32_bf16 v[100:103], v[220:223], a[212:215], v[100:103]
v_exp_f32 v159, v159
v_mfma_f32_16x16x32_bf16 v[108:111], v[200:203], a[216:219], v[164:167]
ds_read_b64_tr_b16 v[176:177], v4 offset:12288
ds_read_b64_tr_b16 v[178:179], v4 offset:18432
v_mfma_f32_16x16x32_bf16 v[108:111], v[204:207], a[220:223], v[108:111]
v_add_f32 v17, v17, v158
v_add_f32 v17, v17, v159
v_mfma_f32_16x16x32_bf16 v[108:111], v[208:211], a[224:227], v[108:111]
ds_read_b64_tr_b16 v[180:181], v5 offset:12288
ds_read_b64_tr_b16 v[182:183], v5 offset:18432
v_mfma_f32_16x16x32_bf16 v[108:111], v[212:215], a[228:231], v[108:111]
v_cvt_pk_bf16_f32 v155, v158, v159
v_mfma_f32_16x16x32_bf16 v[108:111], v[216:219], a[232:235], v[108:111]
ds_read_b64_tr_b16 v[184:185], v6 offset:12288
ds_read_b64_tr_b16 v[186:187], v6 offset:18432
v_mfma_f32_16x16x32_bf16 v[108:111], v[220:223], a[236:239], v[108:111]
buffer_load_dwordx4 v26, s[28:31], s46 offen offset:1024 sc0 sc1 lds
v_mfma_f32_16x16x32_bf16 v[116:119], v[200:203], a[240:243], v[168:171]
ds_read_b64_tr_b16 v[188:189], v7 offset:12288
ds_read_b64_tr_b16 v[190:191], v7 offset:18432
v_mfma_f32_16x16x32_bf16 v[116:119], v[204:207], a[244:247], v[116:119]
buffer_load_dwordx4 v26, s[28:31], s46 offen offset:2048 sc0 sc1 lds
v_mfma_f32_16x16x32_bf16 v[116:119], v[208:211], a[248:251], v[116:119]
ds_read_b64_tr_b16 v[192:193], v4 offset:12416
ds_read_b64_tr_b16 v[194:195], v4 offset:18560
v_mfma_f32_16x16x32_bf16 v[116:119], v[212:215], a[252:255], v[116:119]
buffer_load_dwordx4 v26, s[28:31], s46 offen offset:3072 sc0 sc1 lds
v_mfma_f32_16x16x32_bf16 v[116:119], v[216:219], v[64:67], v[116:119]
ds_read_b64_tr_b16 v[196:197], v5 offset:12416
ds_read_b64_tr_b16 v[198:199], v5 offset:18560
v_mfma_f32_16x16x32_bf16 v[116:119], v[220:223], v[68:71], v[116:119]
v_exp_f32 v96, v96
v_mfma_f32_16x16x32_bf16 v[124:127], v[200:203], v[72:75], v[172:175]
v_exp_f32 v97, v97
v_mfma_f32_16x16x32_bf16 v[124:127], v[204:207], v[76:79], v[124:127]
v_add_f32 v14, v14, v96
v_add_f32 v14, v14, v97
v_mfma_f32_16x16x32_bf16 v[124:127], v[208:211], v[80:83], v[124:127]
v_exp_f32 v98, v98
s_add_u32 m0, s45, 106240
v_mfma_f32_16x16x32_bf16 v[124:127], v[212:215], v[84:87], v[124:127]
v_cvt_pk_bf16_f32 v96, v96, v97
buffer_load_dwordx4 v27, s[28:31], s46 offen sc0 sc1 lds
v_mfma_f32_16x16x32_bf16 v[124:127], v[216:219], v[88:91], v[124:127]
v_exp_f32 v99, v99
v_mfma_f32_16x16x32_bf16 v[124:127], v[220:223], v[92:95], v[124:127]
v_add_f32 v14, v14, v98
s_waitcnt lgkmcnt(0)
v_mfma_f32_16x16x32_bf16 a[0:3], v[176:179], v[128:131], a[0:3]
v_exp_f32 v104, v104
v_mfma_f32_16x16x32_bf16 a[48:51], v[176:179], v[136:139], a[48:51]
v_add_f32 v14, v14, v99
v_cvt_pk_bf16_f32 v97, v98, v99
v_mfma_f32_16x16x32_bf16 a[96:99], v[176:179], v[144:147], a[96:99]
v_exp_f32 v105, v105
v_mfma_f32_16x16x32_bf16 a[144:147], v[176:179], v[152:155], a[144:147]
v_add_f32 v15, v15, v104
v_add_f32 v15, v15, v105
v_mfma_f32_16x16x32_bf16 a[4:7], v[180:183], v[128:131], a[4:7]
v_exp_f32 v106, v106
v_mfma_f32_16x16x32_bf16 a[52:55], v[180:183], v[136:139], a[52:55]
v_cvt_pk_bf16_f32 v104, v104, v105
v_mfma_f32_16x16x32_bf16 a[100:103], v[180:183], v[144:147], a[100:103]
ds_read_b64_tr_b16 v[200:201], v6 offset:12416
ds_read_b64_tr_b16 v[202:203], v6 offset:18560
v_mfma_f32_16x16x32_bf16 a[148:151], v[180:183], v[152:155], a[148:151]
v_exp_f32 v107, v107
v_mfma_f32_16x16x32_bf16 a[8:11], v[184:187], v[128:131], a[8:11]
ds_read_b64_tr_b16 v[204:205], v7 offset:12416
ds_read_b64_tr_b16 v[206:207], v7 offset:18560
v_mfma_f32_16x16x32_bf16 a[56:59], v[184:187], v[136:139], a[56:59]
v_add_f32 v15, v15, v106
v_add_f32 v15, v15, v107
v_mfma_f32_16x16x32_bf16 a[104:107], v[184:187], v[144:147], a[104:107]
ds_read_b64_tr_b16 v[208:209], v4 offset:12544
ds_read_b64_tr_b16 v[210:211], v4 offset:18688
v_mfma_f32_16x16x32_bf16 a[152:155], v[184:187], v[152:155], a[152:155]
v_exp_f32 v112, v112
v_mfma_f32_16x16x32_bf16 a[12:15], v[188:191], v[128:131], a[12:15]
ds_read_b64_tr_b16 v[212:213], v5 offset:12544
ds_read_b64_tr_b16 v[214:215], v5 offset:18688
v_mfma_f32_16x16x32_bf16 a[60:63], v[188:191], v[136:139], a[60:63]
v_cvt_pk_bf16_f32 v105, v106, v107
v_mfma_f32_16x16x32_bf16 a[108:111], v[188:191], v[144:147], a[108:111]
ds_read_b64_tr_b16 v[216:217], v6 offset:12544
ds_read_b64_tr_b16 v[218:219], v6 offset:18688
v_mfma_f32_16x16x32_bf16 a[156:159], v[188:191], v[152:155], a[156:159]
v_exp_f32 v113, v113
v_mfma_f32_16x16x32_bf16 a[16:19], v[192:195], v[128:131], a[16:19]
ds_read_b64_tr_b16 v[220:221], v7 offset:12544
ds_read_b64_tr_b16 v[222:223], v7 offset:18688
v_mfma_f32_16x16x32_bf16 a[64:67], v[192:195], v[136:139], a[64:67]
v_add_f32 v16, v16, v112
v_add_f32 v16, v16, v113
v_mfma_f32_16x16x32_bf16 a[112:115], v[192:195], v[144:147], a[112:115]
v_cvt_pk_bf16_f32 v112, v112, v113
v_mfma_f32_16x16x32_bf16 a[160:163], v[192:195], v[152:155], a[160:163]
v_exp_f32 v114, v114
v_mfma_f32_16x16x32_bf16 a[20:23], v[196:199], v[128:131], a[20:23]
v_exp_f32 v115, v115
v_mfma_f32_16x16x32_bf16 a[68:71], v[196:199], v[136:139], a[68:71]
v_add_f32 v16, v16, v114
v_add_f32 v16, v16, v115
v_mfma_f32_16x16x32_bf16 a[116:119], v[196:199], v[144:147], a[116:119]
v_cvt_pk_bf16_f32 v113, v114, v115
v_mfma_f32_16x16x32_bf16 a[164:167], v[196:199], v[152:155], a[164:167]
s_waitcnt lgkmcnt(0)
v_mfma_f32_16x16x32_bf16 a[24:27], v[200:203], v[128:131], a[24:27]
v_exp_f32 v120, v120
v_mfma_f32_16x16x32_bf16 a[72:75], v[200:203], v[136:139], a[72:75]
v_exp_f32 v121, v121
v_mfma_f32_16x16x32_bf16 a[120:123], v[200:203], v[144:147], a[120:123]
v_add_f32 v17, v17, v120
v_add_f32 v17, v17, v121
v_mfma_f32_16x16x32_bf16 a[168:171], v[200:203], v[152:155], a[168:171]
v_exp_f32 v122, v122
v_mfma_f32_16x16x32_bf16 a[28:31], v[204:207], v[128:131], a[28:31]
v_cvt_pk_bf16_f32 v120, v120, v121
v_mfma_f32_16x16x32_bf16 a[76:79], v[204:207], v[136:139], a[76:79]
v_exp_f32 v123, v123
v_mfma_f32_16x16x32_bf16 a[124:127], v[204:207], v[144:147], a[124:127]
v_add_f32 v17, v17, v122
v_add_f32 v17, v17, v123
v_mfma_f32_16x16x32_bf16 a[172:175], v[204:207], v[152:155], a[172:175]
v_exp_f32 v100, v100
v_mfma_f32_16x16x32_bf16 a[32:35], v[208:211], v[128:131], a[32:35]
v_cvt_pk_bf16_f32 v121, v122, v123
v_mfma_f32_16x16x32_bf16 a[80:83], v[208:211], v[136:139], a[80:83]
v_exp_f32 v101, v101
v_mfma_f32_16x16x32_bf16 a[128:131], v[208:211], v[144:147], a[128:131]
v_add_f32 v14, v14, v100
v_add_f32 v14, v14, v101
v_mfma_f32_16x16x32_bf16 a[176:179], v[208:211], v[152:155], a[176:179]
v_cvt_pk_bf16_f32 v98, v100, v101
v_mfma_f32_16x16x32_bf16 a[36:39], v[212:215], v[128:131], a[36:39]
ds_read_b128 v[176:179], v2 offset:36864
ds_read_b128 v[180:183], v3 offset:36864
v_mfma_f32_16x16x32_bf16 a[84:87], v[212:215], v[136:139], a[84:87]
v_exp_f32 v102, v102
v_mfma_f32_16x16x32_bf16 a[132:135], v[212:215], v[144:147], a[132:135]
ds_read_b128 v[184:187], v2 offset:36992
ds_read_b128 v[188:191], v3 offset:36992
v_mfma_f32_16x16x32_bf16 a[180:183], v[212:215], v[152:155], a[180:183]
v_exp_f32 v103, v103
v_mfma_f32_16x16x32_bf16 a[40:43], v[216:219], v[128:131], a[40:43]
ds_read_b128 v[192:195], v2 offset:37120
ds_read_b128 v[196:199], v3 offset:37120
v_mfma_f32_16x16x32_bf16 a[88:91], v[216:219], v[136:139], a[88:91]
v_add_f32 v14, v14, v102
v_add_f32 v14, v14, v103
v_mfma_f32_16x16x32_bf16 a[136:139], v[216:219], v[144:147], a[136:139]
v_cvt_pk_bf16_f32 v99, v102, v103
v_mfma_f32_16x16x32_bf16 a[184:187], v[216:219], v[152:155], a[184:187]
v_exp_f32 v108, v108
v_mfma_f32_16x16x32_bf16 a[44:47], v[220:223], v[128:131], a[44:47]
v_exp_f32 v109, v109
v_mfma_f32_16x16x32_bf16 a[92:95], v[220:223], v[136:139], a[92:95]
v_add_f32 v15, v15, v108
v_add_f32 v15, v15, v109
v_mfma_f32_16x16x32_bf16 a[140:143], v[220:223], v[144:147], a[140:143]
v_cvt_pk_bf16_f32 v106, v108, v109
v_mfma_f32_16x16x32_bf16 a[188:191], v[220:223], v[152:155], a[188:191]
s_waitcnt lgkmcnt(0)
v_mfma_f32_16x16x32_bf16 v[128:131], v[176:179], a[192:195], v[160:163]
v_exp_f32 v110, v110
v_mfma_f32_16x16x32_bf16 v[128:131], v[180:183], a[196:199], v[128:131]
v_exp_f32 v111, v111
v_mfma_f32_16x16x32_bf16 v[128:131], v[184:187], a[200:203], v[128:131]
s_waitcnt vmcnt(8)
s_barrier
v_mfma_f32_16x16x32_bf16 v[128:131], v[188:191], a[204:207], v[128:131]
v_add_f32 v15, v15, v110
s_add_u32 s46, s62, 10240
s_add_u32 m0, s45, 122624
v_mfma_f32_16x16x32_bf16 v[128:131], v[192:195], a[208:211], v[128:131]
buffer_load_dwordx4 v26, s[28:31], s46 offen offset:0 sc0 sc1 lds
v_mfma_f32_16x16x32_bf16 v[128:131], v[196:199], a[212:215], v[128:131]
v_add_f32 v15, v15, v111
v_cvt_pk_bf16_f32 v107, v110, v111
v_mfma_f32_16x16x32_bf16 v[136:139], v[176:179], a[216:219], v[164:167]
v_exp_f32 v116, v116
v_mfma_f32_16x16x32_bf16 v[136:139], v[180:183], a[220:223], v[136:139]
buffer_load_dwordx4 v26, s[28:31], s46 offen offset:1024 sc0 sc1 lds
v_mfma_f32_16x16x32_bf16 v[136:139], v[184:187], a[224:227], v[136:139]
v_exp_f32 v117, v117
v_mfma_f32_16x16x32_bf16 v[136:139], v[188:191], a[228:231], v[136:139]
v_add_f32 v16, v16, v116
v_add_f32 v16, v16, v117
v_mfma_f32_16x16x32_bf16 v[136:139], v[192:195], a[232:235], v[136:139]
buffer_load_dwordx4 v26, s[28:31], s46 offen offset:2048 sc0 sc1 lds
v_mfma_f32_16x16x32_bf16 v[136:139], v[196:199], a[236:239], v[136:139]
v_cvt_pk_bf16_f32 v114, v116, v117
v_mfma_f32_16x16x32_bf16 v[144:147], v[176:179], a[240:243], v[168:171]
ds_read_b128 v[200:203], v2 offset:43008
ds_read_b128 v[204:207], v3 offset:43008
v_mfma_f32_16x16x32_bf16 v[144:147], v[180:183], a[244:247], v[144:147]
v_mfma_f32_16x16x32_bf16 v[144:147], v[184:187], a[248:251], v[144:147]
ds_read_b128 v[208:211], v2 offset:43136
ds_read_b128 v[212:215], v3 offset:43136
v_mfma_f32_16x16x32_bf16 v[144:147], v[188:191], a[252:255], v[144:147]
buffer_load_dwordx4 v26, s[28:31], s46 offen offset:3072 sc0 sc1 lds
v_mfma_f32_16x16x32_bf16 v[144:147], v[192:195], v[64:67], v[144:147]
ds_read_b128 v[216:219], v2 offset:43264
ds_read_b128 v[220:223], v3 offset:43264
v_mfma_f32_16x16x32_bf16 v[144:147], v[196:199], v[68:71], v[144:147]
v_exp_f32 v118, v118
s_add_u32 m0, s45, 126720
v_mfma_f32_16x16x32_bf16 v[152:155], v[176:179], v[72:75], v[172:175]
buffer_load_dwordx4 v27, s[28:31], s46 offen sc0 sc1 lds
v_mfma_f32_16x16x32_bf16 v[152:155], v[180:183], v[76:79], v[152:155]
v_exp_f32 v119, v119
v_mfma_f32_16x16x32_bf16 v[152:155], v[184:187], v[80:83], v[152:155]
v_add_f32 v16, v16, v118
v_add_f32 v16, v16, v119
v_mfma_f32_16x16x32_bf16 v[152:155], v[188:191], v[84:87], v[152:155]
v_mfma_f32_16x16x32_bf16 v[152:155], v[192:195], v[88:91], v[152:155]
v_cvt_pk_bf16_f32 v115, v118, v119
v_mfma_f32_16x16x32_bf16 v[152:155], v[196:199], v[92:95], v[152:155]
s_waitcnt lgkmcnt(0)
v_mfma_f32_16x16x32_bf16 v[132:135], v[200:203], a[192:195], v[160:163]
v_exp_f32 v124, v124
v_mfma_f32_16x16x32_bf16 v[132:135], v[204:207], a[196:199], v[132:135]
v_exp_f32 v125, v125
v_mfma_f32_16x16x32_bf16 v[132:135], v[208:211], a[200:203], v[132:135]
v_add_f32 v17, v17, v124
v_add_f32 v17, v17, v125
s_add_u32 s46, s62, 20480
s_add_u32 m0, s45, 143104
v_mfma_f32_16x16x32_bf16 v[132:135], v[212:215], a[204:207], v[132:135]
v_cvt_pk_bf16_f32 v122, v124, v125
buffer_load_dwordx4 v26, s[28:31], s46 offen offset:0 sc0 sc1 lds
v_mfma_f32_16x16x32_bf16 v[132:135], v[216:219], a[208:211], v[132:135]
v_exp_f32 v126, v126
v_mfma_f32_16x16x32_bf16 v[132:135], v[220:223], a[212:215], v[132:135]
v_exp_f32 v127, v127
v_mfma_f32_16x16x32_bf16 v[140:143], v[200:203], a[216:219], v[164:167]
ds_read_b64_tr_b16 v[176:177], v4 offset:24576
ds_read_b64_tr_b16 v[178:179], v4 offset:30720
v_mfma_f32_16x16x32_bf16 v[140:143], v[204:207], a[220:223], v[140:143]
v_add_f32 v17, v17, v126
v_add_f32 v17, v17, v127
v_mfma_f32_16x16x32_bf16 v[140:143], v[208:211], a[224:227], v[140:143]
ds_read_b64_tr_b16 v[180:181], v5 offset:24576
ds_read_b64_tr_b16 v[182:183], v5 offset:30720
v_mfma_f32_16x16x32_bf16 v[140:143], v[212:215], a[228:231], v[140:143]
v_cvt_pk_bf16_f32 v123, v126, v127
v_mfma_f32_16x16x32_bf16 v[140:143], v[216:219], a[232:235], v[140:143]
ds_read_b64_tr_b16 v[184:185], v6 offset:24576
ds_read_b64_tr_b16 v[186:187], v6 offset:30720
v_mfma_f32_16x16x32_bf16 v[140:143], v[220:223], a[236:239], v[140:143]
buffer_load_dwordx4 v26, s[28:31], s46 offen offset:1024 sc0 sc1 lds
v_mfma_f32_16x16x32_bf16 v[148:151], v[200:203], a[240:243], v[168:171]
ds_read_b64_tr_b16 v[188:189], v7 offset:24576
ds_read_b64_tr_b16 v[190:191], v7 offset:30720
v_mfma_f32_16x16x32_bf16 v[148:151], v[204:207], a[244:247], v[148:151]
buffer_load_dwordx4 v26, s[28:31], s46 offen offset:2048 sc0 sc1 lds
v_mfma_f32_16x16x32_bf16 v[148:151], v[208:211], a[248:251], v[148:151]
ds_read_b64_tr_b16 v[192:193], v4 offset:24704
ds_read_b64_tr_b16 v[194:195], v4 offset:30848
v_mfma_f32_16x16x32_bf16 v[148:151], v[212:215], a[252:255], v[148:151]
buffer_load_dwordx4 v26, s[28:31], s46 offen offset:3072 sc0 sc1 lds
v_mfma_f32_16x16x32_bf16 v[148:151], v[216:219], v[64:67], v[148:151]
ds_read_b64_tr_b16 v[196:197], v5 offset:24704
ds_read_b64_tr_b16 v[198:199], v5 offset:30848
v_mfma_f32_16x16x32_bf16 v[148:151], v[220:223], v[68:71], v[148:151]
v_exp_f32 v128, v128
v_mfma_f32_16x16x32_bf16 v[156:159], v[200:203], v[72:75], v[172:175]
v_exp_f32 v129, v129
v_mfma_f32_16x16x32_bf16 v[156:159], v[204:207], v[76:79], v[156:159]
v_add_f32 v14, v14, v128
v_add_f32 v14, v14, v129
v_mfma_f32_16x16x32_bf16 v[156:159], v[208:211], v[80:83], v[156:159]
v_exp_f32 v130, v130
s_add_u32 m0, s45, 147200
v_mfma_f32_16x16x32_bf16 v[156:159], v[212:215], v[84:87], v[156:159]
v_cvt_pk_bf16_f32 v128, v128, v129
buffer_load_dwordx4 v27, s[28:31], s46 offen sc0 sc1 lds
v_mfma_f32_16x16x32_bf16 v[156:159], v[216:219], v[88:91], v[156:159]
v_exp_f32 v131, v131
v_mfma_f32_16x16x32_bf16 v[156:159], v[220:223], v[92:95], v[156:159]
v_add_f32 v14, v14, v130
s_waitcnt lgkmcnt(0)
v_mfma_f32_16x16x32_bf16 a[0:3], v[176:179], v[96:99], a[0:3]
v_exp_f32 v136, v136
v_mfma_f32_16x16x32_bf16 a[48:51], v[176:179], v[104:107], a[48:51]
v_add_f32 v14, v14, v131
v_cvt_pk_bf16_f32 v129, v130, v131
v_mfma_f32_16x16x32_bf16 a[96:99], v[176:179], v[112:115], a[96:99]
v_exp_f32 v137, v137
v_mfma_f32_16x16x32_bf16 a[144:147], v[176:179], v[120:123], a[144:147]
v_add_f32 v15, v15, v136
v_add_f32 v15, v15, v137
v_mfma_f32_16x16x32_bf16 a[4:7], v[180:183], v[96:99], a[4:7]
v_exp_f32 v138, v138
v_mfma_f32_16x16x32_bf16 a[52:55], v[180:183], v[104:107], a[52:55]
v_cvt_pk_bf16_f32 v136, v136, v137
v_mfma_f32_16x16x32_bf16 a[100:103], v[180:183], v[112:115], a[100:103]
ds_read_b64_tr_b16 v[200:201], v6 offset:24704
ds_read_b64_tr_b16 v[202:203], v6 offset:30848
v_mfma_f32_16x16x32_bf16 a[148:151], v[180:183], v[120:123], a[148:151]
v_exp_f32 v139, v139
v_mfma_f32_16x16x32_bf16 a[8:11], v[184:187], v[96:99], a[8:11]
ds_read_b64_tr_b16 v[204:205], v7 offset:24704
ds_read_b64_tr_b16 v[206:207], v7 offset:30848
v_mfma_f32_16x16x32_bf16 a[56:59], v[184:187], v[104:107], a[56:59]
v_add_f32 v15, v15, v138
v_add_f32 v15, v15, v139
v_mfma_f32_16x16x32_bf16 a[104:107], v[184:187], v[112:115], a[104:107]
ds_read_b64_tr_b16 v[208:209], v4 offset:24832
ds_read_b64_tr_b16 v[210:211], v4 offset:30976
v_mfma_f32_16x16x32_bf16 a[152:155], v[184:187], v[120:123], a[152:155]
v_exp_f32 v144, v144
v_mfma_f32_16x16x32_bf16 a[12:15], v[188:191], v[96:99], a[12:15]
ds_read_b64_tr_b16 v[212:213], v5 offset:24832
ds_read_b64_tr_b16 v[214:215], v5 offset:30976
v_mfma_f32_16x16x32_bf16 a[60:63], v[188:191], v[104:107], a[60:63]
v_cvt_pk_bf16_f32 v137, v138, v139
v_mfma_f32_16x16x32_bf16 a[108:111], v[188:191], v[112:115], a[108:111]
ds_read_b64_tr_b16 v[216:217], v6 offset:24832
ds_read_b64_tr_b16 v[218:219], v6 offset:30976
v_mfma_f32_16x16x32_bf16 a[156:159], v[188:191], v[120:123], a[156:159]
v_exp_f32 v145, v145
v_mfma_f32_16x16x32_bf16 a[16:19], v[192:195], v[96:99], a[16:19]
ds_read_b64_tr_b16 v[220:221], v7 offset:24832
ds_read_b64_tr_b16 v[222:223], v7 offset:30976
v_mfma_f32_16x16x32_bf16 a[64:67], v[192:195], v[104:107], a[64:67]
v_add_f32 v16, v16, v144
v_add_f32 v16, v16, v145
v_mfma_f32_16x16x32_bf16 a[112:115], v[192:195], v[112:115], a[112:115]
v_cvt_pk_bf16_f32 v144, v144, v145
v_mfma_f32_16x16x32_bf16 a[160:163], v[192:195], v[120:123], a[160:163]
v_exp_f32 v146, v146
v_mfma_f32_16x16x32_bf16 a[20:23], v[196:199], v[96:99], a[20:23]
v_exp_f32 v147, v147
v_mfma_f32_16x16x32_bf16 a[68:71], v[196:199], v[104:107], a[68:71]
v_add_f32 v16, v16, v146
v_add_f32 v16, v16, v147
v_mfma_f32_16x16x32_bf16 a[116:119], v[196:199], v[112:115], a[116:119]
v_cvt_pk_bf16_f32 v145, v146, v147
v_mfma_f32_16x16x32_bf16 a[164:167], v[196:199], v[120:123], a[164:167]
s_waitcnt lgkmcnt(0)
v_mfma_f32_16x16x32_bf16 a[24:27], v[200:203], v[96:99], a[24:27]
v_exp_f32 v152, v152
v_mfma_f32_16x16x32_bf16 a[72:75], v[200:203], v[104:107], a[72:75]
v_exp_f32 v153, v153
v_mfma_f32_16x16x32_bf16 a[120:123], v[200:203], v[112:115], a[120:123]
v_add_f32 v17, v17, v152
v_add_f32 v17, v17, v153
v_mfma_f32_16x16x32_bf16 a[168:171], v[200:203], v[120:123], a[168:171]
v_exp_f32 v154, v154
v_mfma_f32_16x16x32_bf16 a[28:31], v[204:207], v[96:99], a[28:31]
v_cvt_pk_bf16_f32 v152, v152, v153
v_mfma_f32_16x16x32_bf16 a[76:79], v[204:207], v[104:107], a[76:79]
v_exp_f32 v155, v155
v_mfma_f32_16x16x32_bf16 a[124:127], v[204:207], v[112:115], a[124:127]
v_add_f32 v17, v17, v154
v_add_f32 v17, v17, v155
v_mfma_f32_16x16x32_bf16 a[172:175], v[204:207], v[120:123], a[172:175]
v_exp_f32 v132, v132
v_mfma_f32_16x16x32_bf16 a[32:35], v[208:211], v[96:99], a[32:35]
v_cvt_pk_bf16_f32 v153, v154, v155
v_mfma_f32_16x16x32_bf16 a[80:83], v[208:211], v[104:107], a[80:83]
v_exp_f32 v133, v133
v_mfma_f32_16x16x32_bf16 a[128:131], v[208:211], v[112:115], a[128:131]
v_add_f32 v14, v14, v132
v_add_f32 v14, v14, v133
v_mfma_f32_16x16x32_bf16 a[176:179], v[208:211], v[120:123], a[176:179]
v_cvt_pk_bf16_f32 v130, v132, v133
v_mfma_f32_16x16x32_bf16 a[36:39], v[212:215], v[96:99], a[36:39]
ds_read_b128 v[176:179], v2 offset:0
ds_read_b128 v[180:183], v3 offset:0
v_mfma_f32_16x16x32_bf16 a[84:87], v[212:215], v[104:107], a[84:87]
v_exp_f32 v134, v134
v_mfma_f32_16x16x32_bf16 a[132:135], v[212:215], v[112:115], a[132:135]
ds_read_b128 v[184:187], v2 offset:128
ds_read_b128 v[188:191], v3 offset:128
v_mfma_f32_16x16x32_bf16 a[180:183], v[212:215], v[120:123], a[180:183]
v_exp_f32 v135, v135
v_mfma_f32_16x16x32_bf16 a[40:43], v[216:219], v[96:99], a[40:43]
ds_read_b128 v[192:195], v2 offset:256
ds_read_b128 v[196:199], v3 offset:256
v_mfma_f32_16x16x32_bf16 a[88:91], v[216:219], v[104:107], a[88:91]
v_add_f32 v14, v14, v134
v_add_f32 v14, v14, v135
v_mfma_f32_16x16x32_bf16 a[136:139], v[216:219], v[112:115], a[136:139]
v_cvt_pk_bf16_f32 v131, v134, v135
v_mfma_f32_16x16x32_bf16 a[184:187], v[216:219], v[120:123], a[184:187]
v_exp_f32 v140, v140
v_mfma_f32_16x16x32_bf16 a[44:47], v[220:223], v[96:99], a[44:47]
v_exp_f32 v141, v141
v_mfma_f32_16x16x32_bf16 a[92:95], v[220:223], v[104:107], a[92:95]
v_add_f32 v15, v15, v140
v_add_f32 v15, v15, v141
v_mfma_f32_16x16x32_bf16 a[140:143], v[220:223], v[112:115], a[140:143]
v_cvt_pk_bf16_f32 v138, v140, v141
v_mfma_f32_16x16x32_bf16 a[188:191], v[220:223], v[120:123], a[188:191]
L_k2_tail:
v_exp_f32 v142, v142
v_exp_f32 v143, v143
s_waitcnt vmcnt(15)
s_barrier
v_add_f32 v15, v15, v142
s_add_u32 s46, s63, 0
s_add_u32 m0, s45, 0
s_nop 0
buffer_load_dwordx4 v26, s[28:31], s46 offen offset:0 sc0 sc1 lds
v_add_f32 v15, v15, v143
v_cvt_pk_bf16_f32 v139, v142, v143
v_exp_f32 v148, v148
v_exp_f32 v149, v149
v_add_f32 v16, v16, v148
v_add_f32 v16, v16, v149
v_cvt_pk_bf16_f32 v146, v148, v149
buffer_load_dwordx4 v26, s[28:31], s46 offen offset:1024 sc0 sc1 lds
v_exp_f32 v150, v150
v_exp_f32 v151, v151
v_add_f32 v16, v16, v150
v_add_f32 v16, v16, v151
buffer_load_dwordx4 v26, s[28:31], s46 offen offset:2048 sc0 sc1 lds
v_cvt_pk_bf16_f32 v147, v150, v151
v_exp_f32 v156, v156
v_exp_f32 v157, v157
v_add_f32 v17, v17, v156
v_add_f32 v17, v17, v157
v_cvt_pk_bf16_f32 v154, v156, v157
v_exp_f32 v158, v158
buffer_load_dwordx4 v26, s[28:31], s46 offen offset:3072 sc0 sc1 lds
v_exp_f32 v159, v159
ds_read_b64_tr_b16 v[176:177], v4 offset:36864
ds_read_b64_tr_b16 v[178:179], v4 offset:43008
v_add_f32 v17, v17, v158
v_add_f32 v17, v17, v159
.p2align 3
ds_read_b64_tr_b16 v[180:181], v5 offset:36864
ds_read_b64_tr_b16 v[182:183], v5 offset:43008
v_cvt_pk_bf16_f32 v155, v158, v159
ds_read_b64_tr_b16 v[184:185], v6 offset:36864
ds_read_b64_tr_b16 v[186:187], v6 offset:43008
s_add_u32 m0, s45, 4096
ds_read_b64_tr_b16 v[188:189], v7 offset:36864
ds_read_b64_tr_b16 v[190:191], v7 offset:43008
buffer_load_dwordx4 v27, s[28:31], s46 offen sc0 sc1 lds
ds_read_b64_tr_b16 v[192:193], v4 offset:36992
ds_read_b64_tr_b16 v[194:195], v4 offset:43136
ds_read_b64_tr_b16 v[196:197], v5 offset:36992
ds_read_b64_tr_b16 v[198:199], v5 offset:43136
s_waitcnt lgkmcnt(0)
v_mfma_f32_16x16x32_bf16 a[0:3], v[176:179], v[128:131], a[0:3]
v_mfma_f32_16x16x32_bf16 a[48:51], v[176:179], v[136:139], a[48:51]
v_mov_b32 v22, v14
s_nop 1
v_mfma_f32_16x16x32_bf16 a[96:99], v[176:179], v[144:147], a[96:99]
v_permlane16_swap_b32 v14, v22
v_add_f32 v14, v14, v22
v_mfma_f32_16x16x32_bf16 a[144:147], v[176:179], v[152:155], a[144:147]
s_add_u32 s46, s66, 0
s_add_u32 m0, s45, 49152
v_mfma_f32_16x16x32_bf16 a[4:7], v[180:183], v[128:131], a[4:7]
buffer_load_dwordx4 v26, s[28:31], s46 offen offset:0 sc0 sc1 lds
v_mfma_f32_16x16x32_bf16 a[52:55], v[180:183], v[136:139], a[52:55]
v_mov_b32 v22, v14
s_nop 1
v_mfma_f32_16x16x32_bf16 a[100:103], v[180:183], v[144:147], a[100:103]
ds_read_b64_tr_b16 v[200:201], v6 offset:36992
ds_read_b64_tr_b16 v[202:203], v6 offset:43136
v_permlane32_swap_b32 v14, v22
v_add_f32 v14, v14, v22
v_mfma_f32_16x16x32_bf16 a[148:151], v[180:183], v[152:155], a[148:151]
v_mov_b32 v22, v15
s_nop 1
v_mfma_f32_16x16x32_bf16 a[8:11], v[184:187], v[128:131], a[8:11]
ds_read_b64_tr_b16 v[204:205], v7 offset:36992
ds_read_b64_tr_b16 v[206:207], v7 offset:43136
v_permlane16_swap_b32 v15, v22
v_add_f32 v15, v15, v22
v_mfma_f32_16x16x32_bf16 a[56:59], v[184:187], v[136:139], a[56:59]
v_mov_b32 v22, v15
s_nop 1
v_mfma_f32_16x16x32_bf16 a[104:107], v[184:187], v[144:147], a[104:107]
ds_read_b64_tr_b16 v[208:209], v4 offset:37120
ds_read_b64_tr_b16 v[210:211], v4 offset:43264
v_permlane32_swap_b32 v15, v22
v_add_f32 v15, v15, v22
v_mfma_f32_16x16x32_bf16 a[152:155], v[184:187], v[152:155], a[152:155]
v_mov_b32 v22, v16
s_nop 1
v_mfma_f32_16x16x32_bf16 a[12:15], v[188:191], v[128:131], a[12:15]
ds_read_b64_tr_b16 v[212:213], v5 offset:37120
ds_read_b64_tr_b16 v[214:215], v5 offset:43264
buffer_load_dwordx4 v26, s[28:31], s46 offen offset:1024 sc0 sc1 lds
v_mfma_f32_16x16x32_bf16 a[60:63], v[188:191], v[136:139], a[60:63]
v_permlane16_swap_b32 v16, v22
v_add_f32 v16, v16, v22
v_mfma_f32_16x16x32_bf16 a[108:111], v[188:191], v[144:147], a[108:111]
ds_read_b64_tr_b16 v[216:217], v6 offset:37120
ds_read_b64_tr_b16 v[218:219], v6 offset:43264
v_mov_b32 v22, v16
s_nop 1
v_mfma_f32_16x16x32_bf16 a[156:159], v[188:191], v[152:155], a[156:159]
v_permlane32_swap_b32 v16, v22
v_add_f32 v16, v16, v22
v_mfma_f32_16x16x32_bf16 a[16:19], v[192:195], v[128:131], a[16:19]
ds_read_b64_tr_b16 v[220:221], v7 offset:37120
ds_read_b64_tr_b16 v[222:223], v7 offset:43264
v_mov_b32 v22, v17
s_nop 1
v_mfma_f32_16x16x32_bf16 a[64:67], v[192:195], v[136:139], a[64:67]
v_permlane16_swap_b32 v17, v22
v_add_f32 v17, v17, v22
v_mfma_f32_16x16x32_bf16 a[112:115], v[192:195], v[144:147], a[112:115]
v_mov_b32 v22, v17
s_nop 1
v_mfma_f32_16x16x32_bf16 a[160:163], v[192:195], v[152:155], a[160:163]
v_permlane32_swap_b32 v17, v22
v_add_f32 v17, v17, v22
v_mfma_f32_16x16x32_bf16 a[20:23], v[196:199], v[128:131], a[20:23]
buffer_load_dwordx4 v26, s[28:31], s46 offen offset:2048 sc0 sc1 lds
v_mfma_f32_16x16x32_bf16 a[68:71], v[196:199], v[136:139], a[68:71]
v_rcp_f32 v18, v14
v_rcp_f32 v20, v15
v_mfma_f32_16x16x32_bf16 a[116:119], v[196:199], v[144:147], a[116:119]
v_rcp_f32 v22, v16
v_rcp_f32 v24, v17
v_mfma_f32_16x16x32_bf16 a[164:167], v[196:199], v[152:155], a[164:167]
s_mov_b32 s3, 0x5d800000
s_mov_b64 s[54:55], 0
s_waitcnt lgkmcnt(0)
v_mfma_f32_16x16x32_bf16 a[24:27], v[200:203], v[128:131], a[24:27]
v_cmp_ngt_f32 vcc, s3, v14
s_nop 0
v_mfma_f32_16x16x32_bf16 a[72:75], v[200:203], v[136:139], a[72:75]
s_or_b64 s[54:55], s[54:55], vcc
v_cmp_ngt_f32 vcc, s3, v15
v_mfma_f32_16x16x32_bf16 a[120:123], v[200:203], v[144:147], a[120:123]
s_nop 0
s_or_b64 s[54:55], s[54:55], vcc
v_mfma_f32_16x16x32_bf16 a[168:171], v[200:203], v[152:155], a[168:171]
v_cmp_ngt_f32 vcc, s3, v16
s_nop 0
v_mfma_f32_16x16x32_bf16 a[28:31], v[204:207], v[128:131], a[28:31]
buffer_load_dwordx4 v26, s[28:31], s46 offen offset:3072 sc0 sc1 lds
v_mfma_f32_16x16x32_bf16 a[76:79], v[204:207], v[136:139], a[76:79]
s_or_b64 s[54:55], s[54:55], vcc
v_cmp_ngt_f32 vcc, s3, v17
v_mfma_f32_16x16x32_bf16 a[124:127], v[204:207], v[144:147], a[124:127]
s_nop 0
s_or_b64 s[54:55], s[54:55], vcc
v_mfma_f32_16x16x32_bf16 a[172:175], v[204:207], v[152:155], a[172:175]
s_cmp_lg_u64 s[54:55], 0
s_cselect_b32 s3, 1, 0
v_mfma_f32_16x16x32_bf16 a[32:35], v[208:211], v[128:131], a[32:35]
v_mov_b32 v35, s3
s_lshl_b32 s3, s25, 2
v_mfma_f32_16x16x32_bf16 a[80:83], v[208:211], v[136:139], a[80:83]
s_add_u32 s3, s3, 163776
v_mov_b32 v19, s3
v_mfma_f32_16x16x32_bf16 a[128:131], v[208:211], v[144:147], a[128:131]
ds_write_b32 v19, v35
v_mov_b32 v19, 163776
v_mfma_f32_16x16x32_bf16 a[176:179], v[208:211], v[152:155], a[176:179]
s_add_u32 m0, s45, 53248
v_mfma_f32_16x16x32_bf16 a[36:39], v[212:215], v[128:131], a[36:39]
buffer_load_dwordx4 v27, s[28:31], s46 offen sc0 sc1 lds
v_mfma_f32_16x16x32_bf16 a[84:87], v[212:215], v[136:139], a[84:87]
v_mfma_f32_16x16x32_bf16 a[132:135], v[212:215], v[144:147], a[132:135]
v_mfma_f32_16x16x32_bf16 a[180:183], v[212:215], v[152:155], a[180:183]
v_mfma_f32_16x16x32_bf16 a[40:43], v[216:219], v[128:131], a[40:43]
v_mfma_f32_16x16x32_bf16 a[88:91], v[216:219], v[136:139], a[88:91]
v_mfma_f32_16x16x32_bf16 a[136:139], v[216:219], v[144:147], a[136:139]
v_mfma_f32_16x16x32_bf16 a[184:187], v[216:219], v[152:155], a[184:187]
v_mfma_f32_16x16x32_bf16 a[44:47], v[220:223], v[128:131], a[44:47]
v_mfma_f32_16x16x32_bf16 a[92:95], v[220:223], v[136:139], a[92:95]
v_mfma_f32_16x16x32_bf16 a[140:143], v[220:223], v[144:147], a[140:143]
v_mfma_f32_16x16x32_bf16 a[188:191], v[220:223], v[152:155], a[188:191]
L_k2_epi:
s_waitcnt vmcnt(20)
s_waitcnt lgkmcnt(0)
s_barrier
ds_read_b128 v[40:43], v19
s_waitcnt lgkmcnt(0)
v_or_b32 v35, v40, v41
v_or3_b32 v35, v35, v42, v43
s_nop 0
v_readfirstlane_b32 s3, v35
s_nop 0
s_cmp_lg_u32 s3, 0
s_cbranch_scc1 L_k2_slow
L_k2_conv:
.p2align 3
ds_read_b64_tr_b16 v[40:41], v34 offset:0
ds_read_b64_tr_b16 v[42:43], v34 offset:2560
ds_read_b64_tr_b16 v[44:45], v34 offset:10240
ds_read_b64_tr_b16 v[46:47], v34 offset:12800
ds_read_b64_tr_b16 v[48:49], v34 offset:32
ds_read_b64_tr_b16 v[50:51], v34 offset:2592
ds_read_b64_tr_b16 v[52:53], v34 offset:10272
ds_read_b64_tr_b16 v[54:55], v34 offset:12832
v_mov_b32 v19, v18
v_mov_b32 v21, v20
v_mov_b32 v23, v22
v_mov_b32 v25, v24
s_mul_i32 s38, s53, 245760
s_mul_i32 s39, s36, 6144
s_add_u32 s38, s38, s39
.p2align 3
s_add_u32 s38, s38, 4194304
s_add_u32 s39, s38, 4096
v_accvgpr_read_b32 v64, a0
v_accvgpr_read_b32 v65, a1
v_accvgpr_read_b32 v66, a2
v_accvgpr_read_b32 v67, a3
v_accvgpr_read_b32 v68, a4
v_accvgpr_read_b32 v69, a5
v_accvgpr_read_b32 v70, a6
v_accvgpr_read_b32 v71, a7
v_pk_mul_f32 v[64:65], v[64:65], v[18:19]
v_pk_mul_f32 v[66:67], v[66:67], v[18:19]
v_pk_mul_f32 v[68:69], v[68:69], v[18:19]
v_pk_mul_f32 v[70:71], v[70:71], v[18:19]
v_cvt_pk_bf16_f32 v64, v64, v65
v_cvt_pk_bf16_f32 v65, v66, v67
v_cvt_pk_bf16_f32 v66, v68, v69
v_cvt_pk_bf16_f32 v67, v70, v71
v_accvgpr_write_b32 a0, v64
v_accvgpr_write_b32 a1, v65
v_accvgpr_write_b32 a2, v66
v_accvgpr_write_b32 a3, v67
buffer_store_dwordx4 v[64:67], v28, s[40:43], s38 offen offset:0 sc0 sc1
v_accvgpr_read_b32 v72, a48
v_accvgpr_read_b32 v73, a49
v_accvgpr_read_b32 v74, a50
v_accvgpr_read_b32 v75, a51
v_accvgpr_read_b32 v76, a52
v_accvgpr_read_b32 v77, a53
v_accvgpr_read_b32 v78, a54
v_accvgpr_read_b32 v79, a55
v_pk_mul_f32 v[72:73], v[72:73], v[20:21]
v_pk_mul_f32 v[74:75], v[74:75], v[20:21]
v_pk_mul_f32 v[76:77], v[76:77], v[20:21]
v_pk_mul_f32 v[78:79], v[78:79], v[20:21]
v_cvt_pk_bf16_f32 v72, v72, v73
v_cvt_pk_bf16_f32 v73, v74, v75
v_cvt_pk_bf16_f32 v74, v76, v77
v_cvt_pk_bf16_f32 v75, v78, v79
v_accvgpr_write_b32 a48, v72
v_accvgpr_write_b32 a49, v73
v_accvgpr_write_b32 a50, v74
v_accvgpr_write_b32 a51, v75
buffer_store_dwordx4 v[72:75], v29, s[40:43], s38 offen offset:0 sc0 sc1
v_accvgpr_read_b32 v80, a96
v_accvgpr_read_b32 v81, a97
v_accvgpr_read_b32 v82, a98
v_accvgpr_read_b32 v83, a99
v_accvgpr_read_b32 v84, a100
v_accvgpr_read_b32 v85, a101
v_accvgpr_read_b32 v86, a102
v_accvgpr_read_b32 v87, a103
v_pk_mul_f32 v[80:81], v[80:81], v[22:23]
v_pk_mul_f32 v[82:83], v[82:83], v[22:23]
v_pk_mul_f32 v[84:85], v[84:85], v[22:23]
v_pk_mul_f32 v[86:87], v[86:87], v[22:23]
v_cvt_pk_bf16_f32 v80, v80, v81
v_cvt_pk_bf16_f32 v81, v82, v83
v_cvt_pk_bf16_f32 v82, v84, v85
v_cvt_pk_bf16_f32 v83, v86, v87
v_accvgpr_write_b32 a96, v80
v_accvgpr_write_b32 a97, v81
v_accvgpr_write_b32 a98, v82
v_accvgpr_write_b32 a99, v83
buffer_store_dwordx4 v[80:83], v30, s[40:43], s38 offen offset:0 sc0 sc1
v_accvgpr_read_b32 v64, a144
v_accvgpr_read_b32 v65, a145
v_accvgpr_read_b32 v66, a146
v_accvgpr_read_b32 v67, a147
v_accvgpr_read_b32 v68, a148
v_accvgpr_read_b32 v69, a149
v_accvgpr_read_b32 v70, a150
v_accvgpr_read_b32 v71, a151
v_pk_mul_f32 v[64:65], v[64:65], v[24:25]
v_pk_mul_f32 v[66:67], v[66:67], v[24:25]
v_pk_mul_f32 v[68:69], v[68:69], v[24:25]
v_pk_mul_f32 v[70:71], v[70:71], v[24:25]
v_cvt_pk_bf16_f32 v64, v64, v65
v_cvt_pk_bf16_f32 v65, v66, v67
v_cvt_pk_bf16_f32 v66, v68, v69
v_cvt_pk_bf16_f32 v67, v70, v71
v_accvgpr_write_b32 a144, v64
v_accvgpr_write_b32 a145, v65
v_accvgpr_write_b32 a146, v66
v_accvgpr_write_b32 a147, v67
buffer_store_dwordx4 v[64:67], v31, s[40:43], s38 offen offset:0 sc0 sc1
v_accvgpr_read_b32 v72, a8
v_accvgpr_read_b32 v73, a9
v_accvgpr_read_b32 v74, a10
v_accvgpr_read_b32 v75, a11
v_accvgpr_read_b32 v76, a12
v_accvgpr_read_b32 v77, a13
v_accvgpr_read_b32 v78, a14
v_accvgpr_read_b32 v79, a15
v_pk_mul_f32 v[72:73], v[72:73], v[18:19]
v_pk_mul_f32 v[74:75], v[74:75], v[18:19]
v_pk_mul_f32 v[76:77], v[76:77], v[18:19]
v_pk_mul_f32 v[78:79], v[78:79], v[18:19]
v_cvt_pk_bf16_f32 v72, v72, v73
v_cvt_pk_bf16_f32 v73, v74, v75
v_cvt_pk_bf16_f32 v74, v76, v77
v_cvt_pk_bf16_f32 v75, v78, v79
v_accvgpr_write_b32 a4, v72
v_accvgpr_write_b32 a5, v73
v_accvgpr_write_b32 a6, v74
v_accvgpr_write_b32 a7, v75
v_accvgpr_read_b32 v80, a56
v_accvgpr_read_b32 v81, a57
v_accvgpr_read_b32 v82, a58
v_accvgpr_read_b32 v83, a59
v_accvgpr_read_b32 v84, a60
v_accvgpr_read_b32 v85, a61
v_accvgpr_read_b32 v86, a62
v_accvgpr_read_b32 v87, a63
v_pk_mul_f32 v[80:81], v[80:81], v[20:21]
v_pk_mul_f32 v[82:83], v[82:83], v[20:21]
v_pk_mul_f32 v[84:85], v[84:85], v[20:21]
v_pk_mul_f32 v[86:87], v[86:87], v[20:21]
v_cvt_pk_bf16_f32 v80, v80, v81
v_cvt_pk_bf16_f32 v81, v82, v83
v_cvt_pk_bf16_f32 v82, v84, v85
v_cvt_pk_bf16_f32 v83, v86, v87
v_accvgpr_write_b32 a52, v80
v_accvgpr_write_b32 a53, v81
v_accvgpr_write_b32 a54, v82
v_accvgpr_write_b32 a55, v83
v_accvgpr_read_b32 v64, a104
v_accvgpr_read_b32 v65, a105
v_accvgpr_read_b32 v66, a106
v_accvgpr_read_b32 v67, a107
v_accvgpr_read_b32 v68, a108
v_accvgpr_read_b32 v69, a109
v_accvgpr_read_b32 v70, a110
v_accvgpr_read_b32 v71, a111
v_pk_mul_f32 v[64:65], v[64:65], v[22:23]
v_pk_mul_f32 v[66:67], v[66:67], v[22:23]
v_pk_mul_f32 v[68:69], v[68:69], v[22:23]
v_pk_mul_f32 v[70:71], v[70:71], v[22:23]
v_cvt_pk_bf16_f32 v64, v64, v65
v_cvt_pk_bf16_f32 v65, v66, v67
v_cvt_pk_bf16_f32 v66, v68, v69
v_cvt_pk_bf16_f32 v67, v70, v71
v_accvgpr_write_b32 a100, v64
v_accvgpr_write_b32 a101, v65
v_accvgpr_write_b32 a102, v66
v_accvgpr_write_b32 a103, v67
v_accvgpr_read_b32 v72, a152
v_accvgpr_read_b32 v73, a153
v_accvgpr_read_b32 v74, a154
v_accvgpr_read_b32 v75, a155
v_accvgpr_read_b32 v76, a156
v_accvgpr_read_b32 v77, a157
v_accvgpr_read_b32 v78, a158
v_accvgpr_read_b32 v79, a159
v_pk_mul_f32 v[72:73], v[72:73], v[24:25]
v_pk_mul_f32 v[74:75], v[74:75], v[24:25]
v_pk_mul_f32 v[76:77], v[76:77], v[24:25]
v_pk_mul_f32 v[78:79], v[78:79], v[24:25]
v_cvt_pk_bf16_f32 v72, v72, v73
v_cvt_pk_bf16_f32 v73, v74, v75
v_cvt_pk_bf16_f32 v74, v76, v77
v_cvt_pk_bf16_f32 v75, v78, v79
v_accvgpr_write_b32 a148, v72
v_accvgpr_write_b32 a149, v73
v_accvgpr_write_b32 a150, v74
v_accvgpr_write_b32 a151, v75
s_waitcnt lgkmcnt(4)
v_mfma_f32_16x16x32_bf16 v[96:99], v[40:43], a[0:3], 0
ds_read_b64_tr_b16 v[56:57], v34 offset:64
ds_read_b64_tr_b16 v[58:59], v34 offset:2624
v_mfma_f32_16x16x32_bf16 v[96:99], v[44:47], a[4:7], v[96:99]
s_add_u32 s46, s66, 5120
s_add_u32 m0, s45, 69632
v_accvgpr_read_b32 v64, a16
v_accvgpr_read_b32 v65, a17
v_mfma_f32_16x16x32_bf16 v[100:103], v[40:43], a[48:51], 0
ds_read_b64_tr_b16 v[60:61], v34 offset:10304
ds_read_b64_tr_b16 v[62:63], v34 offset:12864
v_accvgpr_read_b32 v66, a18
v_accvgpr_read_b32 v67, a19
v_mfma_f32_16x16x32_bf16 v[100:103], v[44:47], a[52:55], v[100:103]
buffer_load_dwordx4 v26, s[28:31], s46 offen offset:0 sc0 sc1 lds
v_mfma_f32_16x16x32_bf16 v[104:107], v[40:43], a[96:99], 0
v_accvgpr_read_b32 v68, a20
v_accvgpr_read_b32 v69, a21
v_accvgpr_read_b32 v70, a22
v_accvgpr_read_b32 v71, a23
v_mfma_f32_16x16x32_bf16 v[104:107], v[44:47], a[100:103], v[104:107]
v_mul_f32 v64, v64, v18
v_mul_f32 v65, v65, v18
v_mul_f32 v66, v66, v18
v_mul_f32 v67, v67, v18
v_mfma_f32_16x16x32_bf16 v[108:111], v[40:43], a[144:147], 0
v_mul_f32 v68, v68, v18
v_mul_f32 v69, v69, v18
v_mul_f32 v70, v70, v18
v_mul_f32 v71, v71, v18
v_mfma_f32_16x16x32_bf16 v[108:111], v[44:47], a[148:151], v[108:111]
v_cvt_pk_bf16_f32 v64, v64, v65
v_cvt_pk_bf16_f32 v65, v66, v67
v_cvt_pk_bf16_f32 v66, v68, v69
s_waitcnt lgkmcnt(4)
v_mfma_f32_16x16x32_bf16 v[112:115], v[48:51], a[0:3], 0
ds_read_b64_tr_b16 v[40:41], v34 offset:96
ds_read_b64_tr_b16 v[42:43], v34 offset:2656
v_cvt_pk_bf16_f32 v67, v70, v71
v_accvgpr_write_b32 a16, v64
v_mfma_f32_16x16x32_bf16 v[112:115], v[52:55], a[4:7], v[112:115]
buffer_store_dwordx4 a[4:7], v28, s[40:43], s38 offen offset:1024 sc0 sc1
v_mfma_f32_16x16x32_bf16 v[116:119], v[48:51], a[48:51], 0
ds_read_b64_tr_b16 v[44:45], v34 offset:10336
ds_read_b64_tr_b16 v[46:47], v34 offset:12896
v_accvgpr_write_b32 a17, v65
v_accvgpr_write_b32 a18, v66
v_mfma_f32_16x16x32_bf16 v[116:119], v[52:55], a[52:55], v[116:119]
buffer_load_dwordx4 v26, s[28:31], s46 offen offset:1024 sc0 sc1 lds
v_mfma_f32_16x16x32_bf16 v[120:123], v[48:51], a[96:99], 0
v_accvgpr_write_b32 a19, v67
v_accvgpr_read_b32 v72, a64
v_accvgpr_read_b32 v73, a65
v_accvgpr_read_b32 v74, a66
v_mfma_f32_16x16x32_bf16 v[120:123], v[52:55], a[100:103], v[120:123]
v_accvgpr_read_b32 v75, a67
v_accvgpr_read_b32 v76, a68
v_accvgpr_read_b32 v77, a69
v_accvgpr_read_b32 v78, a70
v_mfma_f32_16x16x32_bf16 v[124:127], v[48:51], a[144:147], 0
v_accvgpr_read_b32 v79, a71
v_mul_f32 v72, v72, v20
v_mul_f32 v73, v73, v20
v_mul_f32 v74, v74, v20
v_mfma_f32_16x16x32_bf16 v[124:127], v[52:55], a[148:151], v[124:127]
v_mul_f32 v75, v75, v20
v_mul_f32 v76, v76, v20
v_mul_f32 v77, v77, v20
s_waitcnt lgkmcnt(4)
v_mfma_f32_16x16x32_bf16 v[128:131], v[56:59], a[0:3], 0
ds_read_b64_tr_b16 v[48:49], v34 offset:128
ds_read_b64_tr_b16 v[50:51], v34 offset:2688
v_mul_f32 v78, v78, v20
v_mul_f32 v79, v79, v20
v_mfma_f32_16x16x32_bf16 v[128:131], v[60:63], a[4:7], v[128:131]
buffer_load_dwordx4 v26, s[28:31], s46 offen offset:2048 sc0 sc1 lds
v_mfma_f32_16x16x32_bf16 v[132:135], v[56:59], a[48:51], 0
ds_read_b64_tr_b16 v[52:53], v34 offset:10368
ds_read_b64_tr_b16 v[54:55], v34 offset:12928
v_cvt_pk_bf16_f32 v72, v72, v73
v_cvt_pk_bf16_f32 v73, v74, v75
v_mfma_f32_16x16x32_bf16 v[132:135], v[60:63], a[52:55], v[132:135]
v_cvt_pk_bf16_f32 v74, v76, v77
v_cvt_pk_bf16_f32 v75, v78, v79
v_accvgpr_write_b32 a64, v72
v_accvgpr_write_b32 a65, v73
v_mfma_f32_16x16x32_bf16 v[136:139], v[56:59], a[96:99], 0
v_accvgpr_write_b32 a66, v74
v_accvgpr_write_b32 a67, v75
v_accvgpr_read_b32 v80, a112
v_accvgpr_read_b32 v81, a113
v_mfma_f32_16x16x32_bf16 v[136:139], v[60:63], a[100:103], v[136:139]
v_accvgpr_read_b32 v82, a114
v_accvgpr_read_b32 v83, a115
v_accvgpr_read_b32 v84, a116
v_accvgpr_read_b32 v85, a117
v_mfma_f32_16x16x32_bf16 v[140:143], v[56:59], a[144:147], 0
v_accvgpr_read_b32 v86, a118
v_accvgpr_read_b32 v87, a119
v_mul_f32 v80, v80, v22
v_mul_f32 v81, v81, v22
v_mfma_f32_16x16x32_bf16 v[140:143], v[60:63], a[148:151], v[140:143]
v_mul_f32 v82, v82, v22
v_mul_f32 v83, v83, v22
v_mul_f32 v84, v84, v22
s_waitcnt lgkmcnt(4)
v_mfma_f32_16x16x32_bf16 v[144:147], v[40:43], a[0:3], 0
ds_read_b64_tr_b16 v[56:57], v34 offset:5120
ds_read_b64_tr_b16 v[58:59], v34 offset:7680
v_mul_f32 v85, v85, v22
v_mul_f32 v86, v86, v22
v_mfma_f32_16x16x32_bf16 v[144:147], v[44:47], a[4:7], v[144:147]
buffer_store_dwordx4 a[52:55], v29, s[40:43], s38 offen offset:1024 sc0 sc1
v_mfma_f32_16x16x32_bf16 v[148:151], v[40:43], a[48:51], 0
ds_read_b64_tr_b16 v[60:61], v34 offset:15360
ds_read_b64_tr_b16 v[62:63], v34 offset:17920
v_mul_f32 v87, v87, v22
v_cvt_pk_bf16_f32 v80, v80, v81
v_mfma_f32_16x16x32_bf16 v[148:151], v[44:47], a[52:55], v[148:151]
buffer_load_dwordx4 v26, s[28:31], s46 offen offset:3072 sc0 sc1 lds
v_mfma_f32_16x16x32_bf16 v[152:155], v[40:43], a[96:99], 0
v_cvt_pk_bf16_f32 v81, v82, v83
v_cvt_pk_bf16_f32 v82, v84, v85
v_cvt_pk_bf16_f32 v83, v86, v87
v_accvgpr_write_b32 a112, v80
v_mfma_f32_16x16x32_bf16 v[152:155], v[44:47], a[100:103], v[152:155]
v_accvgpr_write_b32 a113, v81
v_accvgpr_write_b32 a114, v82
v_accvgpr_write_b32 a115, v83
v_accvgpr_read_b32 v64, a160
v_mfma_f32_16x16x32_bf16 v[156:159], v[40:43], a[144:147], 0
s_add_u32 m0, s45, 73728
v_accvgpr_read_b32 v65, a161
v_accvgpr_read_b32 v66, a162
v_accvgpr_read_b32 v67, a163
v_mfma_f32_16x16x32_bf16 v[156:159], v[44:47], a[148:151], v[156:159]
v_accvgpr_read_b32 v68, a164
v_accvgpr_read_b32 v69, a165
v_accvgpr_read_b32 v70, a166
s_waitcnt lgkmcnt(4)
v_mfma_f32_16x16x32_bf16 v[160:163], v[48:51], a[0:3], 0
ds_read_b64_tr_b16 v[40:41], v34 offset:5152
ds_read_b64_tr_b16 v[42:43], v34 offset:7712
v_accvgpr_read_b32 v71, a167
v_mul_f32 v64, v64, v24
v_mfma_f32_16x16x32_bf16 v[160:163], v[52:55], a[4:7], v[160:163]
buffer_load_dwordx4 v27, s[28:31], s46 offen sc0 sc1 lds
v_mfma_f32_16x16x32_bf16 v[164:167], v[48:51], a[48:51], 0
ds_read_b64_tr_b16 v[44:45], v34 offset:15392
ds_read_b64_tr_b16 v[46:47], v34 offset:17952
v_mul_f32 v65, v65, v24
v_mul_f32 v66, v66, v24
v_mfma_f32_16x16x32_bf16 v[164:167], v[52:55], a[52:55], v[164:167]
v_mul_f32 v67, v67, v24
v_mul_f32 v68, v68, v24
v_mul_f32 v69, v69, v24
v_mul_f32 v70, v70, v24
v_mfma_f32_16x16x32_bf16 v[168:171], v[48:51], a[96:99], 0
v_mul_f32 v71, v71, v24
v_cvt_pk_bf16_f32 v64, v64, v65
v_cvt_pk_bf16_f32 v65, v66, v67
v_cvt_pk_bf16_f32 v66, v68, v69
v_mfma_f32_16x16x32_bf16 v[168:171], v[52:55], a[100:103], v[168:171]
v_cvt_pk_bf16_f32 v67, v70, v71
v_accvgpr_write_b32 a160, v64
v_accvgpr_write_b32 a161, v65
v_accvgpr_write_b32 a162, v66
v_mfma_f32_16x16x32_bf16 v[172:175], v[48:51], a[144:147], 0
v_accvgpr_write_b32 a163, v67
v_accvgpr_read_b32 v72, a24
v_accvgpr_read_b32 v73, a25
v_accvgpr_read_b32 v74, a26
v_mfma_f32_16x16x32_bf16 v[172:175], v[52:55], a[148:151], v[172:175]
v_accvgpr_read_b32 v75, a27
v_accvgpr_read_b32 v76, a28
v_accvgpr_read_b32 v77, a29
s_waitcnt lgkmcnt(4)
v_mfma_f32_16x16x32_bf16 v[176:179], v[56:59], a[0:3], 0
ds_read_b64_tr_b16 v[48:49], v34 offset:5184
ds_read_b64_tr_b16 v[50:51], v34 offset:7744
v_accvgpr_read_b32 v78, a30
v_accvgpr_read_b32 v79, a31
v_mfma_f32_16x16x32_bf16 v[176:179], v[60:63], a[4:7], v[176:179]
buffer_store_dwordx4 a[100:103], v30, s[40:43], s38 offen offset:1024 sc0 sc1
v_mfma_f32_16x16x32_bf16 v[180:183], v[56:59], a[48:51], 0
ds_read_b64_tr_b16 v[52:53], v34 offset:15424
ds_read_b64_tr_b16 v[54:55], v34 offset:17984
v_mul_f32 v72, v72, v18
v_mul_f32 v73, v73, v18
v_mfma_f32_16x16x32_bf16 v[180:183], v[60:63], a[52:55], v[180:183]
v_mul_f32 v74, v74, v18
v_mul_f32 v75, v75, v18
v_mul_f32 v76, v76, v18
v_mul_f32 v77, v77, v18
v_mfma_f32_16x16x32_bf16 v[184:187], v[56:59], a[96:99], 0
v_mul_f32 v78, v78, v18
v_mul_f32 v79, v79, v18
v_cvt_pk_bf16_f32 v72, v72, v73
v_cvt_pk_bf16_f32 v73, v74, v75
v_mfma_f32_16x16x32_bf16 v[184:187], v[60:63], a[100:103], v[184:187]
v_cvt_pk_bf16_f32 v74, v76, v77
v_cvt_pk_bf16_f32 v75, v78, v79
v_accvgpr_write_b32 a20, v72
v_accvgpr_write_b32 a21, v73
v_mfma_f32_16x16x32_bf16 v[188:191], v[56:59], a[144:147], 0
v_accvgpr_write_b32 a22, v74
v_accvgpr_write_b32 a23, v75
v_accvgpr_read_b32 v80, a72
v_accvgpr_read_b32 v81, a73
v_mfma_f32_16x16x32_bf16 v[188:191], v[60:63], a[148:151], v[188:191]
v_accvgpr_read_b32 v82, a74
v_accvgpr_read_b32 v83, a75
v_accvgpr_read_b32 v84, a76
s_waitcnt lgkmcnt(4)
v_mfma_f32_16x16x32_bf16 v[192:195], v[40:43], a[0:3], 0
ds_read_b64_tr_b16 v[56:57], v34 offset:5216
ds_read_b64_tr_b16 v[58:59], v34 offset:7776
v_accvgpr_read_b32 v85, a77
v_accvgpr_read_b32 v86, a78
v_mfma_f32_16x16x32_bf16 v[192:195], v[44:47], a[4:7], v[192:195]
v_accvgpr_read_b32 v87, a79
v_mul_f32 v80, v80, v20
v_mul_f32 v81, v81, v20
v_mul_f32 v82, v82, v20
v_mfma_f32_16x16x32_bf16 v[196:199], v[40:43], a[48:51], 0
ds_read_b64_tr_b16 v[60:61], v34 offset:15456
ds_read_b64_tr_b16 v[62:63], v34 offset:18016
v_mul_f32 v83, v83, v20
v_mul_f32 v84, v84, v20
v_mfma_f32_16x16x32_bf16 v[196:199], v[44:47], a[52:55], v[196:199]
v_mul_f32 v85, v85, v20
v_mul_f32 v86, v86, v20
v_mul_f32 v87, v87, v20
v_cvt_pk_bf16_f32 v80, v80, v81
v_mfma_f32_16x16x32_bf16 v[200:203], v[40:43], a[96:99], 0
v_cvt_pk_bf16_f32 v81, v82, v83
v_cvt_pk_bf16_f32 v82, v84, v85
v_cvt_pk_bf16_f32 v83, v86, v87
v_accvgpr_write_b32 a68, v80
v_mfma_f32_16x16x32_bf16 v[200:203], v[44:47], a[100:103], v[200:203]
v_accvgpr_write_b32 a69, v81
v_accvgpr_write_b32 a70, v82
v_accvgpr_write_b32 a71, v83
v_accvgpr_read_b32 v64, a120
v_mfma_f32_16x16x32_bf16 v[204:207], v[40:43], a[144:147], 0
v_accvgpr_read_b32 v65, a121
v_accvgpr_read_b32 v66, a122
v_accvgpr_read_b32 v67, a123
v_accvgpr_read_b32 v68, a124
v_mfma_f32_16x16x32_bf16 v[204:207], v[44:47], a[148:151], v[204:207]
v_accvgpr_read_b32 v69, a125
v_accvgpr_read_b32 v70, a126
v_accvgpr_read_b32 v71, a127
s_waitcnt lgkmcnt(4)
v_mfma_f32_16x16x32_bf16 v[208:211], v[48:51], a[0:3], 0
ds_read_b64_tr_b16 v[40:41], v34 offset:5248
ds_read_b64_tr_b16 v[42:43], v34 offset:7808
v_mul_f32 v64, v64, v22
v_mul_f32 v65, v65, v22
v_mfma_f32_16x16x32_bf16 v[208:211], v[52:55], a[4:7], v[208:211]
buffer_store_dwordx4 a[148:151], v31, s[40:43], s38 offen offset:1024 sc0 sc1
v_mfma_f32_16x16x32_bf16 v[212:215], v[48:51], a[48:51], 0
ds_read_b64_tr_b16 v[44:45], v34 offset:15488
ds_read_b64_tr_b16 v[46:47], v34 offset:18048
v_mul_f32 v66, v66, v22
v_mul_f32 v67, v67, v22
v_mfma_f32_16x16x32_bf16 v[212:215], v[52:55], a[52:55], v[212:215]
v_mul_f32 v68, v68, v22
v_mul_f32 v69, v69, v22
v_mul_f32 v70, v70, v22
v_mul_f32 v71, v71, v22
v_mfma_f32_16x16x32_bf16 v[216:219], v[48:51], a[96:99], 0
v_cvt_pk_bf16_f32 v64, v64, v65
v_cvt_pk_bf16_f32 v65, v66, v67
v_cvt_pk_bf16_f32 v66, v68, v69
v_cvt_pk_bf16_f32 v67, v70, v71
v_mfma_f32_16x16x32_bf16 v[216:219], v[52:55], a[100:103], v[216:219]
v_accvgpr_write_b32 a116, v64
v_accvgpr_write_b32 a117, v65
v_accvgpr_write_b32 a118, v66
v_accvgpr_write_b32 a119, v67
v_mfma_f32_16x16x32_bf16 v[220:223], v[48:51], a[144:147], 0
v_accvgpr_read_b32 v72, a168
v_accvgpr_read_b32 v73, a169
v_accvgpr_read_b32 v74, a170
v_accvgpr_read_b32 v75, a171
v_mfma_f32_16x16x32_bf16 v[220:223], v[52:55], a[148:151], v[220:223]
v_accvgpr_read_b32 v76, a172
v_accvgpr_read_b32 v77, a173
v_accvgpr_read_b32 v78, a174
s_waitcnt lgkmcnt(4)
v_mfma_f32_16x16x32_bf16 v[224:227], v[56:59], a[0:3], 0
s_waitcnt vmcnt(28) lgkmcnt(0)
s_barrier
v_accvgpr_read_b32 v79, a175
v_mul_f32 v72, v72, v24
v_mfma_f32_16x16x32_bf16 v[224:227], v[60:63], a[4:7], v[224:227]
ds_read_b64_tr_b16 v[48:49], v34 offset:20480
ds_read_b64_tr_b16 v[50:51], v34 offset:23040
v_mul_f32 v73, v73, v24
v_mul_f32 v74, v74, v24
v_mfma_f32_16x16x32_bf16 v[228:231], v[56:59], a[48:51], 0
v_mul_f32 v75, v75, v24
v_mul_f32 v76, v76, v24
v_mul_f32 v77, v77, v24
v_mul_f32 v78, v78, v24
v_mfma_f32_16x16x32_bf16 v[228:231], v[60:63], a[52:55], v[228:231]
ds_read_b64_tr_b16 v[52:53], v34 offset:30720
ds_read_b64_tr_b16 v[54:55], v34 offset:33280
v_mul_f32 v79, v79, v24
v_cvt_pk_bf16_f32 v72, v72, v73
v_mfma_f32_16x16x32_bf16 v[232:235], v[56:59], a[96:99], 0
v_cvt_pk_bf16_f32 v73, v74, v75
v_cvt_pk_bf16_f32 v74, v76, v77
v_cvt_pk_bf16_f32 v75, v78, v79
v_accvgpr_write_b32 a164, v72
v_mfma_f32_16x16x32_bf16 v[232:235], v[60:63], a[100:103], v[232:235]
v_accvgpr_write_b32 a165, v73
v_accvgpr_write_b32 a166, v74
v_accvgpr_write_b32 a167, v75
v_mfma_f32_16x16x32_bf16 v[236:239], v[56:59], a[144:147], 0
v_mfma_f32_16x16x32_bf16 v[236:239], v[60:63], a[148:151], v[236:239]
v_mfma_f32_16x16x32_bf16 v[240:243], v[40:43], a[0:3], 0
ds_read_b64_tr_b16 v[56:57], v34 offset:20512
ds_read_b64_tr_b16 v[58:59], v34 offset:23072
v_mfma_f32_16x16x32_bf16 v[240:243], v[44:47], a[4:7], v[240:243]
buffer_store_dwordx4 a[16:19], v28, s[40:43], s38 offen offset:2048 sc0 sc1
v_mfma_f32_16x16x32_bf16 v[244:247], v[40:43], a[48:51], 0
ds_read_b64_tr_b16 v[60:61], v34 offset:30752
ds_read_b64_tr_b16 v[62:63], v34 offset:33312
v_mfma_f32_16x16x32_bf16 v[244:247], v[44:47], a[52:55], v[244:247]
v_mfma_f32_16x16x32_bf16 v[248:251], v[40:43], a[96:99], 0
v_mfma_f32_16x16x32_bf16 v[248:251], v[44:47], a[100:103], v[248:251]
v_mfma_f32_16x16x32_bf16 v[252:255], v[40:43], a[144:147], 0
v_mfma_f32_16x16x32_bf16 v[252:255], v[44:47], a[148:151], v[252:255]
s_waitcnt lgkmcnt(4)
v_mfma_f32_16x16x32_bf16 v[96:99], v[48:51], a[16:19], v[96:99]
ds_read_b64_tr_b16 v[40:41], v34 offset:20544
ds_read_b64_tr_b16 v[42:43], v34 offset:23104
v_mfma_f32_16x16x32_bf16 v[96:99], v[52:55], a[20:23], v[96:99]
v_accvgpr_read_b32 v64, a32
v_accvgpr_read_b32 v65, a33
v_accvgpr_read_b32 v66, a34
v_accvgpr_read_b32 v67, a35
v_mfma_f32_16x16x32_bf16 v[100:103], v[48:51], a[64:67], v[100:103]
ds_read_b64_tr_b16 v[44:45], v34 offset:30784
ds_read_b64_tr_b16 v[46:47], v34 offset:33344
v_accvgpr_read_b32 v68, a36
v_accvgpr_read_b32 v69, a37
v_mfma_f32_16x16x32_bf16 v[100:103], v[52:55], a[68:71], v[100:103]
v_accvgpr_read_b32 v70, a38
v_accvgpr_read_b32 v71, a39
v_mul_f32 v64, v64, v18
v_mul_f32 v65, v65, v18
v_mfma_f32_16x16x32_bf16 v[104:107], v[48:51], a[112:115], v[104:107]
v_mul_f32 v66, v66, v18
v_mul_f32 v67, v67, v18
v_mul_f32 v68, v68, v18
v_mul_f32 v69, v69, v18
v_mfma_f32_16x16x32_bf16 v[104:107], v[52:55], a[116:119], v[104:107]
v_mul_f32 v70, v70, v18
v_mul_f32 v71, v71, v18
v_cvt_pk_bf16_f32 v64, v64, v65
v_cvt_pk_bf16_f32 v65, v66, v67
v_mfma_f32_16x16x32_bf16 v[108:111], v[48:51], a[160:163], v[108:111]
v_cvt_pk_bf16_f32 v66, v68, v69
v_cvt_pk_bf16_f32 v67, v70, v71
v_accvgpr_write_b32 a32, v64
v_accvgpr_write_b32 a33, v65
v_mfma_f32_16x16x32_bf16 v[108:111], v[52:55], a[164:167], v[108:111]
v_accvgpr_write_b32 a34, v66
v_accvgpr_write_b32 a35, v67
v_accvgpr_read_b32 v72, a80
s_waitcnt lgkmcnt(4)
v_mfma_f32_16x16x32_bf16 v[112:115], v[56:59], a[16:19], v[112:115]
ds_read_b64_tr_b16 v[48:49], v34 offset:20576
ds_read_b64_tr_b16 v[50:51], v34 offset:23136
v_accvgpr_read_b32 v73, a81
v_accvgpr_read_b32 v74, a82
v_mfma_f32_16x16x32_bf16 v[112:115], v[60:63], a[20:23], v[112:115]
buffer_store_dwordx4 a[64:67], v29, s[40:43], s38 offen offset:2048 sc0 sc1
v_mfma_f32_16x16x32_bf16 v[116:119], v[56:59], a[64:67], v[116:119]
ds_read_b64_tr_b16 v[52:53], v34 offset:30816
ds_read_b64_tr_b16 v[54:55], v34 offset:33376
v_accvgpr_read_b32 v75, a83
v_accvgpr_read_b32 v76, a84
v_mfma_f32_16x16x32_bf16 v[116:119], v[60:63], a[68:71], v[116:119]
v_accvgpr_read_b32 v77, a85
v_accvgpr_read_b32 v78, a86
v_accvgpr_read_b32 v79, a87
v_mul_f32 v72, v72, v20
v_mfma_f32_16x16x32_bf16 v[120:123], v[56:59], a[112:115], v[120:123]
v_mul_f32 v73, v73, v20
v_mul_f32 v74, v74, v20
v_mul_f32 v75, v75, v20
v_mul_f32 v76, v76, v20
v_mfma_f32_16x16x32_bf16 v[120:123], v[60:63], a[116:119], v[120:123]
v_mul_f32 v77, v77, v20
v_mul_f32 v78, v78, v20
v_mul_f32 v79, v79, v20
v_cvt_pk_bf16_f32 v72, v72, v73
v_mfma_f32_16x16x32_bf16 v[124:127], v[56:59], a[160:163], v[124:127]
v_cvt_pk_bf16_f32 v73, v74, v75
v_cvt_pk_bf16_f32 v74, v76, v77
v_cvt_pk_bf16_f32 v75, v78, v79
v_accvgpr_write_b32 a80, v72
v_mfma_f32_16x16x32_bf16 v[124:127], v[60:63], a[164:167], v[124:127]
v_accvgpr_write_b32 a81, v73
v_accvgpr_write_b32 a82, v74
v_accvgpr_write_b32 a83, v75
s_waitcnt lgkmcnt(4)
v_mfma_f32_16x16x32_bf16 v[128:131], v[40:43], a[16:19], v[128:131]
ds_read_b64_tr_b16 v[56:57], v34 offset:20608
ds_read_b64_tr_b16 v[58:59], v34 offset:23168
v_accvgpr_read_b32 v80, a128
v_accvgpr_read_b32 v81, a129
v_mfma_f32_16x16x32_bf16 v[128:131], v[44:47], a[20:23], v[128:131]
v_accvgpr_read_b32 v82, a130
v_accvgpr_read_b32 v83, a131
v_accvgpr_read_b32 v84, a132
v_accvgpr_read_b32 v85, a133
v_mfma_f32_16x16x32_bf16 v[132:135], v[40:43], a[64:67], v[132:135]
ds_read_b64_tr_b16 v[60:61], v34 offset:30848
ds_read_b64_tr_b16 v[62:63], v34 offset:33408
v_accvgpr_read_b32 v86, a134
v_accvgpr_read_b32 v87, a135
v_mfma_f32_16x16x32_bf16 v[132:135], v[44:47], a[68:71], v[132:135]
v_mul_f32 v80, v80, v22
v_mul_f32 v81, v81, v22
v_mul_f32 v82, v82, v22
v_mul_f32 v83, v83, v22
v_mfma_f32_16x16x32_bf16 v[136:139], v[40:43], a[112:115], v[136:139]
v_mul_f32 v84, v84, v22
v_mul_f32 v85, v85, v22
v_mul_f32 v86, v86, v22
v_mul_f32 v87, v87, v22
v_mfma_f32_16x16x32_bf16 v[136:139], v[44:47], a[116:119], v[136:139]
v_cvt_pk_bf16_f32 v80, v80, v81
v_cvt_pk_bf16_f32 v81, v82, v83
v_cvt_pk_bf16_f32 v82, v84, v85
v_cvt_pk_bf16_f32 v83, v86, v87
v_mfma_f32_16x16x32_bf16 v[140:143], v[40:43], a[160:163], v[140:143]
v_accvgpr_write_b32 a128, v80
v_accvgpr_write_b32 a129, v81
v_accvgpr_write_b32 a130, v82
v_accvgpr_write_b32 a131, v83
v_mfma_f32_16x16x32_bf16 v[140:143], v[44:47], a[164:167], v[140:143]
v_accvgpr_read_b32 v64, a176
v_accvgpr_read_b32 v65, a177
v_accvgpr_read_b32 v66, a178
s_waitcnt lgkmcnt(4)
v_mfma_f32_16x16x32_bf16 v[144:147], v[48:51], a[16:19], v[144:147]
ds_read_b64_tr_b16 v[40:41], v34 offset:25600
ds_read_b64_tr_b16 v[42:43], v34 offset:28160
v_accvgpr_read_b32 v67, a179
v_accvgpr_read_b32 v68, a180
v_mfma_f32_16x16x32_bf16 v[144:147], v[52:55], a[20:23], v[144:147]
buffer_store_dwordx4 a[112:115], v30, s[40:43], s38 offen offset:2048 sc0 sc1
v_mfma_f32_16x16x32_bf16 v[148:151], v[48:51], a[64:67], v[148:151]
ds_read_b64_tr_b16 v[44:45], v34 offset:35840
ds_read_b64_tr_b16 v[46:47], v34 offset:38400
v_accvgpr_read_b32 v69, a181
v_accvgpr_read_b32 v70, a182
v_mfma_f32_16x16x32_bf16 v[148:151], v[52:55], a[68:71], v[148:151]
v_accvgpr_read_b32 v71, a183
v_mul_f32 v64, v64, v24
v_mul_f32 v65, v65, v24
v_mul_f32 v66, v66, v24
v_mfma_f32_16x16x32_bf16 v[152:155], v[48:51], a[112:115], v[152:155]
v_mul_f32 v67, v67, v24
v_mul_f32 v68, v68, v24
v_mul_f32 v69, v69, v24
v_mul_f32 v70, v70, v24
v_mfma_f32_16x16x32_bf16 v[152:155], v[52:55], a[116:119], v[152:155]
v_mul_f32 v71, v71, v24
v_cvt_pk_bf16_f32 v64, v64, v65
v_cvt_pk_bf16_f32 v65, v66, v67
v_cvt_pk_bf16_f32 v66, v68, v69
v_mfma_f32_16x16x32_bf16 v[156:159], v[48:51], a[160:163], v[156:159]
v_cvt_pk_bf16_f32 v67, v70, v71
v_accvgpr_write_b32 a176, v64
v_accvgpr_write_b32 a177, v65
v_accvgpr_write_b32 a178, v66
v_mfma_f32_16x16x32_bf16 v[156:159], v[52:55], a[164:167], v[156:159]
v_accvgpr_write_b32 a179, v67
v_accvgpr_read_b32 v72, a40
v_accvgpr_read_b32 v73, a41
s_waitcnt lgkmcnt(4)
v_mfma_f32_16x16x32_bf16 v[160:163], v[56:59], a[16:19], v[160:163]
ds_read_b64_tr_b16 v[48:49], v34 offset:25632
ds_read_b64_tr_b16 v[50:51], v34 offset:28192
v_accvgpr_read_b32 v74, a42
v_accvgpr_read_b32 v75, a43
v_mfma_f32_16x16x32_bf16 v[160:163], v[60:63], a[20:23], v[160:163]
v_accvgpr_read_b32 v76, a44
v_accvgpr_read_b32 v77, a45
v_accvgpr_read_b32 v78, a46
v_accvgpr_read_b32 v79, a47
v_mfma_f32_16x16x32_bf16 v[164:167], v[56:59], a[64:67], v[164:167]
ds_read_b64_tr_b16 v[52:53], v34 offset:35872
ds_read_b64_tr_b16 v[54:55], v34 offset:38432
v_mul_f32 v72, v72, v18
v_mul_f32 v73, v73, v18
v_mfma_f32_16x16x32_bf16 v[164:167], v[60:63], a[68:71], v[164:167]
v_mul_f32 v74, v74, v18
v_mul_f32 v75, v75, v18
v_mul_f32 v76, v76, v18
v_mul_f32 v77, v77, v18
v_mfma_f32_16x16x32_bf16 v[168:171], v[56:59], a[112:115], v[168:171]
v_mul_f32 v78, v78, v18
v_mul_f32 v79, v79, v18
v_cvt_pk_bf16_f32 v72, v72, v73
v_cvt_pk_bf16_f32 v73, v74, v75
v_mfma_f32_16x16x32_bf16 v[168:171], v[60:63], a[116:119], v[168:171]
v_cvt_pk_bf16_f32 v74, v76, v77
v_cvt_pk_bf16_f32 v75, v78, v79
v_accvgpr_write_b32 a36, v72
v_accvgpr_write_b32 a37, v73
v_mfma_f32_16x16x32_bf16 v[172:175], v[56:59], a[160:163], v[172:175]
v_accvgpr_write_b32 a38, v74
v_accvgpr_write_b32 a39, v75
v_accvgpr_read_b32 v80, a88
v_accvgpr_read_b32 v81, a89
v_mfma_f32_16x16x32_bf16 v[172:175], v[60:63], a[164:167], v[172:175]
v_accvgpr_read_b32 v82, a90
v_accvgpr_read_b32 v83, a91
v_accvgpr_read_b32 v84, a92
s_waitcnt lgkmcnt(4)
v_mfma_f32_16x16x32_bf16 v[176:179], v[40:43], a[16:19], v[176:179]
ds_read_b64_tr_b16 v[56:57], v34 offset:25664
ds_read_b64_tr_b16 v[58:59], v34 offset:28224
v_accvgpr_read_b32 v85, a93
v_accvgpr_read_b32 v86, a94
v_mfma_f32_16x16x32_bf16 v[176:179], v[44:47], a[20:23], v[176:179]
buffer_store_dwordx4 a[160:163], v31, s[40:43], s38 offen offset:2048 sc0 sc1
v_mfma_f32_16x16x32_bf16 v[180:183], v[40:43], a[64:67], v[180:183]
ds_read_b64_tr_b16 v[60:61], v34 offset:35904
ds_read_b64_tr_b16 v[62:63], v34 offset:38464
v_accvgpr_read_b32 v87, a95
v_mul_f32 v80, v80, v20
v_mfma_f32_16x16x32_bf16 v[180:183], v[44:47], a[68:71], v[180:183]
v_mul_f32 v81, v81, v20
v_mul_f32 v82, v82, v20
v_mul_f32 v83, v83, v20
v_mul_f32 v84, v84, v20
v_mfma_f32_16x16x32_bf16 v[184:187], v[40:43], a[112:115], v[184:187]
s_waitcnt vmcnt(4)
v_lshlrev_b32 v36, 6, v1
s_and_b32 s3, s2, 63
v_add_u32 v36, s3, v36
v_lshlrev_b32 v36, 9, v36
s_lshl_b32 s3, s25, 2
s_add_u32 s3, s3, s61
s_lshl_b32 s3, s3, 2
s_add_u32 s3, s3, 92274688
v_mov_b32 v37, 1
s_mov_b64 exec, 15
buffer_store_dword v37, v36, s[40:43], s3 offen sc0 sc1
s_mov_b64 exec, -1
v_mfma_f32_16x16x32_bf16 v[184:187], v[44:47], a[116:119], v[184:187]
v_mul_f32 v85, v85, v20
v_mul_f32 v86, v86, v20
v_mul_f32 v87, v87, v20
v_cvt_pk_bf16_f32 v80, v80, v81
v_mfma_f32_16x16x32_bf16 v[188:191], v[40:43], a[160:163], v[188:191]
v_cvt_pk_bf16_f32 v81, v82, v83
v_cvt_pk_bf16_f32 v82, v84, v85
v_cvt_pk_bf16_f32 v83, v86, v87
v_accvgpr_write_b32 a84, v80
v_mfma_f32_16x16x32_bf16 v[188:191], v[44:47], a[164:167], v[188:191]
v_accvgpr_write_b32 a85, v81
v_accvgpr_write_b32 a86, v82
v_accvgpr_write_b32 a87, v83
s_waitcnt lgkmcnt(4)
v_mfma_f32_16x16x32_bf16 v[192:195], v[48:51], a[16:19], v[192:195]
ds_read_b64_tr_b16 v[40:41], v34 offset:25696
ds_read_b64_tr_b16 v[42:43], v34 offset:28256
v_accvgpr_read_b32 v64, a136
v_accvgpr_read_b32 v65, a137
v_mfma_f32_16x16x32_bf16 v[192:195], v[52:55], a[20:23], v[192:195]
v_accvgpr_read_b32 v66, a138
v_accvgpr_read_b32 v67, a139
v_accvgpr_read_b32 v68, a140
v_accvgpr_read_b32 v69, a141
v_mfma_f32_16x16x32_bf16 v[196:199], v[48:51], a[64:67], v[196:199]
ds_read_b64_tr_b16 v[44:45], v34 offset:35936
ds_read_b64_tr_b16 v[46:47], v34 offset:38496
v_accvgpr_read_b32 v70, a142
v_accvgpr_read_b32 v71, a143
v_mfma_f32_16x16x32_bf16 v[196:199], v[52:55], a[68:71], v[196:199]
v_mul_f32 v64, v64, v22
v_mul_f32 v65, v65, v22
v_mul_f32 v66, v66, v22
v_mul_f32 v67, v67, v22
v_mfma_f32_16x16x32_bf16 v[200:203], v[48:51], a[112:115], v[200:203]
v_mul_f32 v68, v68, v22
v_mul_f32 v69, v69, v22
v_mul_f32 v70, v70, v22
v_mul_f32 v71, v71, v22
v_mfma_f32_16x16x32_bf16 v[200:203], v[52:55], a[116:119], v[200:203]
v_cvt_pk_bf16_f32 v64, v64, v65
v_cvt_pk_bf16_f32 v65, v66, v67
v_cvt_pk_bf16_f32 v66, v68, v69
v_cvt_pk_bf16_f32 v67, v70, v71
v_mfma_f32_16x16x32_bf16 v[204:207], v[48:51], a[160:163], v[204:207]
v_accvgpr_write_b32 a132, v64
v_accvgpr_write_b32 a133, v65
v_accvgpr_write_b32 a134, v66
v_accvgpr_write_b32 a135, v67
v_mfma_f32_16x16x32_bf16 v[204:207], v[52:55], a[164:167], v[204:207]
v_accvgpr_read_b32 v72, a184
v_accvgpr_read_b32 v73, a185
v_accvgpr_read_b32 v74, a186
s_waitcnt lgkmcnt(4)
v_mfma_f32_16x16x32_bf16 v[208:211], v[56:59], a[16:19], v[208:211]
ds_read_b64_tr_b16 v[48:49], v34 offset:25728
ds_read_b64_tr_b16 v[50:51], v34 offset:28288
v_accvgpr_read_b32 v75, a187
v_accvgpr_read_b32 v76, a188
v_mfma_f32_16x16x32_bf16 v[208:211], v[60:63], a[20:23], v[208:211]
buffer_store_dwordx4 a[20:23], v28, s[40:43], s38 offen offset:3072 sc0 sc1
v_mfma_f32_16x16x32_bf16 v[212:215], v[56:59], a[64:67], v[212:215]
ds_read_b64_tr_b16 v[52:53], v34 offset:35968
ds_read_b64_tr_b16 v[54:55], v34 offset:38528
v_accvgpr_read_b32 v77, a189
v_accvgpr_read_b32 v78, a190
v_mfma_f32_16x16x32_bf16 v[212:215], v[60:63], a[68:71], v[212:215]
v_accvgpr_read_b32 v79, a191
v_mul_f32 v72, v72, v24
v_mul_f32 v73, v73, v24
v_mul_f32 v74, v74, v24
v_mfma_f32_16x16x32_bf16 v[216:219], v[56:59], a[112:115], v[216:219]
v_mul_f32 v75, v75, v24
v_mul_f32 v76, v76, v24
v_mul_f32 v77, v77, v24
v_mul_f32 v78, v78, v24
v_mfma_f32_16x16x32_bf16 v[216:219], v[60:63], a[116:119], v[216:219]
v_mul_f32 v79, v79, v24
v_cvt_pk_bf16_f32 v72, v72, v73
v_cvt_pk_bf16_f32 v73, v74, v75
v_cvt_pk_bf16_f32 v74, v76, v77
v_mfma_f32_16x16x32_bf16 v[220:223], v[56:59], a[160:163], v[220:223]
v_cvt_pk_bf16_f32 v75, v78, v79
v_accvgpr_write_b32 a180, v72
v_accvgpr_write_b32 a181, v73
v_accvgpr_write_b32 a182, v74
v_mfma_f32_16x16x32_bf16 v[220:223], v[60:63], a[164:167], v[220:223]
v_accvgpr_write_b32 a183, v75
s_add_u32 s3, s25, 0
s_and_b32 s3, s3, 3
s_waitcnt lgkmcnt(4)
v_mfma_f32_16x16x32_bf16 v[224:227], v[40:43], a[16:19], v[224:227]
s_waitcnt lgkmcnt(0)
s_barrier
s_mul_i32 s3, s3, 245760
v_add_u32 v88, s3, v26
v_mfma_f32_16x16x32_bf16 v[224:227], v[44:47], a[20:23], v[224:227]
ds_read_b64_tr_b16 v[56:57], v34 offset:40960
ds_read_b64_tr_b16 v[58:59], v34 offset:43520
s_add_u32 s3, s25, 1
s_and_b32 s3, s3, 3
v_mfma_f32_16x16x32_bf16 v[228:231], v[40:43], a[64:67], v[228:231]
s_mul_i32 s3, s3, 245760
v_add_u32 v89, s3, v26
s_add_u32 s3, s25, 2
s_and_b32 s3, s3, 3
v_mfma_f32_16x16x32_bf16 v[228:231], v[44:47], a[68:71], v[228:231]
ds_read_b64_tr_b16 v[60:61], v34 offset:51200
ds_read_b64_tr_b16 v[62:63], v34 offset:53760
s_mul_i32 s3, s3, 245760
v_add_u32 v90, s3, v26
v_mfma_f32_16x16x32_bf16 v[232:235], v[40:43], a[112:115], v[232:235]
s_add_u32 s3, s25, 3
s_and_b32 s3, s3, 3
s_mul_i32 s3, s3, 245760
v_add_u32 v91, s3, v26
v_mfma_f32_16x16x32_bf16 v[232:235], v[44:47], a[116:119], v[232:235]
s_mul_i32 s3, s25, 5120
v_add_u32 v92, s3, v32
v_add_u32 v93, s3, v33
v_add_u32 v94, s3, v34
v_mfma_f32_16x16x32_bf16 v[236:239], v[40:43], a[160:163], v[236:239]
v_mfma_f32_16x16x32_bf16 v[236:239], v[44:47], a[164:167], v[236:239]
v_mfma_f32_16x16x32_bf16 v[240:243], v[48:51], a[16:19], v[240:243]
ds_read_b64_tr_b16 v[40:41], v34 offset:40992
ds_read_b64_tr_b16 v[42:43], v34 offset:43552
v_mfma_f32_16x16x32_bf16 v[240:243], v[52:55], a[20:23], v[240:243]
buffer_store_dwordx4 a[68:71], v29, s[40:43], s38 offen offset:3072 sc0 sc1
v_mfma_f32_16x16x32_bf16 v[244:247], v[48:51], a[64:67], v[244:247]
ds_read_b64_tr_b16 v[44:45], v34 offset:51232
ds_read_b64_tr_b16 v[46:47], v34 offset:53792
v_mfma_f32_16x16x32_bf16 v[244:247], v[52:55], a[68:71], v[244:247]
v_mfma_f32_16x16x32_bf16 v[248:251], v[48:51], a[112:115], v[248:251]
v_mfma_f32_16x16x32_bf16 v[248:251], v[52:55], a[116:119], v[248:251]
v_mfma_f32_16x16x32_bf16 v[252:255], v[48:51], a[160:163], v[252:255]
v_mfma_f32_16x16x32_bf16 v[252:255], v[52:55], a[164:167], v[252:255]
s_waitcnt lgkmcnt(4)
v_mfma_f32_16x16x32_bf16 v[96:99], v[56:59], a[32:35], v[96:99]
ds_read_b64_tr_b16 v[48:49], v34 offset:41024
ds_read_b64_tr_b16 v[50:51], v34 offset:43584
v_mfma_f32_16x16x32_bf16 v[96:99], v[60:63], a[36:39], v[96:99]
v_mfma_f32_16x16x32_bf16 v[100:103], v[56:59], a[80:83], v[100:103]
ds_read_b64_tr_b16 v[52:53], v34 offset:51264
ds_read_b64_tr_b16 v[54:55], v34 offset:53824
v_mfma_f32_16x16x32_bf16 v[100:103], v[60:63], a[84:87], v[100:103]
buffer_load_dword v35, v38, s[40:43], s51 offen offset:0 sc0 sc1
v_mfma_f32_16x16x32_bf16 v[104:107], v[56:59], a[128:131], v[104:107]
v_mfma_f32_16x16x32_bf16 v[104:107], v[60:63], a[132:135], v[104:107]
v_mfma_f32_16x16x32_bf16 v[108:111], v[56:59], a[176:179], v[108:111]
v_mfma_f32_16x16x32_bf16 v[108:111], v[60:63], a[180:183], v[108:111]
s_waitcnt lgkmcnt(4)
v_mfma_f32_16x16x32_bf16 v[112:115], v[40:43], a[32:35], v[112:115]
ds_read_b64_tr_b16 v[56:57], v34 offset:41056
ds_read_b64_tr_b16 v[58:59], v34 offset:43616
v_mfma_f32_16x16x32_bf16 v[112:115], v[44:47], a[36:39], v[112:115]
buffer_store_dwordx4 a[116:119], v30, s[40:43], s38 offen offset:3072 sc0 sc1
v_mfma_f32_16x16x32_bf16 v[116:119], v[40:43], a[80:83], v[116:119]
ds_read_b64_tr_b16 v[60:61], v34 offset:51296
ds_read_b64_tr_b16 v[62:63], v34 offset:53856
v_mfma_f32_16x16x32_bf16 v[116:119], v[44:47], a[84:87], v[116:119]
s_add_u32 s50, s44, 0
v_mfma_f32_16x16x32_bf16 v[120:123], v[40:43], a[128:131], v[120:123]
buffer_load_dwordx4 a[12:15], v88, s[32:35], s50 offen sc0 sc1
v_mfma_f32_16x16x32_bf16 v[120:123], v[44:47], a[132:135], v[120:123]
buffer_load_dwordx4 a[60:63], v89, s[32:35], s50 offen sc0 sc1
v_mfma_f32_16x16x32_bf16 v[124:127], v[40:43], a[176:179], v[124:127]
v_mfma_f32_16x16x32_bf16 v[124:127], v[44:47], a[180:183], v[124:127]
s_waitcnt lgkmcnt(4)
v_mfma_f32_16x16x32_bf16 v[128:131], v[48:51], a[32:35], v[128:131]
ds_read_b64_tr_b16 v[40:41], v34 offset:41088
ds_read_b64_tr_b16 v[42:43], v34 offset:43648
v_mfma_f32_16x16x32_bf16 v[128:131], v[52:55], a[36:39], v[128:131]
buffer_load_dwordx4 a[108:111], v90, s[32:35], s50 offen sc0 sc1
v_mfma_f32_16x16x32_bf16 v[132:135], v[48:51], a[80:83], v[132:135]
ds_read_b64_tr_b16 v[44:45], v34 offset:51328
ds_read_b64_tr_b16 v[46:47], v34 offset:53888
v_mfma_f32_16x16x32_bf16 v[132:135], v[52:55], a[84:87], v[132:135]
buffer_load_dwordx4 a[156:159], v91, s[32:35], s50 offen sc0 sc1
v_mfma_f32_16x16x32_bf16 v[136:139], v[48:51], a[128:131], v[136:139]
s_add_u32 s46, s66, 10240
s_add_u32 m0, s45, 20480
v_mfma_f32_16x16x32_bf16 v[136:139], v[52:55], a[132:135], v[136:139]
v_mfma_f32_16x16x32_bf16 v[140:143], v[48:51], a[176:179], v[140:143]
buffer_load_dwordx4 v26, s[28:31], s46 offen offset:0 sc0 sc1 lds
v_mfma_f32_16x16x32_bf16 v[140:143], v[52:55], a[180:183], v[140:143]
s_waitcnt lgkmcnt(4)
v_mfma_f32_16x16x32_bf16 v[144:147], v[56:59], a[32:35], v[144:147]
ds_read_b64_tr_b16 v[48:49], v34 offset:46080
ds_read_b64_tr_b16 v[50:51], v34 offset:48640
v_mfma_f32_16x16x32_bf16 v[144:147], v[60:63], a[36:39], v[144:147]
buffer_store_dwordx4 a[164:167], v31, s[40:43], s38 offen offset:3072 sc0 sc1
v_mfma_f32_16x16x32_bf16 v[148:151], v[56:59], a[80:83], v[148:151]
ds_read_b64_tr_b16 v[52:53], v34 offset:56320
ds_read_b64_tr_b16 v[54:55], v34 offset:58880
v_mfma_f32_16x16x32_bf16 v[148:151], v[60:63], a[84:87], v[148:151]
buffer_load_dwordx4 v26, s[28:31], s46 offen offset:1024 sc0 sc1 lds
v_mfma_f32_16x16x32_bf16 v[152:155], v[56:59], a[128:131], v[152:155]
buffer_load_dwordx4 v26, s[28:31], s46 offen offset:2048 sc0 sc1 lds
v_mfma_f32_16x16x32_bf16 v[152:155], v[60:63], a[132:135], v[152:155]
v_mfma_f32_16x16x32_bf16 v[156:159], v[56:59], a[176:179], v[156:159]
buffer_load_dwordx4 v26, s[28:31], s46 offen offset:3072 sc0 sc1 lds
v_mfma_f32_16x16x32_bf16 v[156:159], v[60:63], a[180:183], v[156:159]
s_waitcnt lgkmcnt(4)
v_mfma_f32_16x16x32_bf16 v[160:163], v[40:43], a[32:35], v[160:163]
ds_read_b64_tr_b16 v[56:57], v34 offset:46112
ds_read_b64_tr_b16 v[58:59], v34 offset:48672
v_mfma_f32_16x16x32_bf16 v[160:163], v[44:47], a[36:39], v[160:163]
s_add_u32 m0, s45, 24576
v_mfma_f32_16x16x32_bf16 v[164:167], v[40:43], a[80:83], v[164:167]
ds_read_b64_tr_b16 v[60:61], v34 offset:56352
ds_read_b64_tr_b16 v[62:63], v34 offset:58912
v_mfma_f32_16x16x32_bf16 v[164:167], v[44:47], a[84:87], v[164:167]
buffer_load_dwordx4 v27, s[28:31], s46 offen sc0 sc1 lds
v_mfma_f32_16x16x32_bf16 v[168:171], v[40:43], a[128:131], v[168:171]
s_add_u32 s46, s64, 0
s_add_u32 m0, s45, 102144
v_mfma_f32_16x16x32_bf16 v[168:171], v[44:47], a[132:135], v[168:171]
buffer_load_dwordx4 v26, s[28:31], s46 offen offset:0 sc0 sc1 lds
v_mfma_f32_16x16x32_bf16 v[172:175], v[40:43], a[176:179], v[172:175]
v_mfma_f32_16x16x32_bf16 v[172:175], v[44:47], a[180:183], v[172:175]
s_waitcnt lgkmcnt(4)
v_mfma_f32_16x16x32_bf16 v[176:179], v[48:51], a[32:35], v[176:179]
ds_read_b64_tr_b16 v[40:41], v34 offset:46144
ds_read_b64_tr_b16 v[42:43], v34 offset:48704
v_mfma_f32_16x16x32_bf16 v[176:179], v[52:55], a[36:39], v[176:179]
buffer_load_dwordx4 v26, s[28:31], s46 offen offset:1024 sc0 sc1 lds
v_mfma_f32_16x16x32_bf16 v[180:183], v[48:51], a[80:83], v[180:183]
ds_read_b64_tr_b16 v[44:45], v34 offset:56384
ds_read_b64_tr_b16 v[46:47], v34 offset:58944
v_mfma_f32_16x16x32_bf16 v[180:183], v[52:55], a[84:87], v[180:183]
buffer_load_dwordx4 v26, s[28:31], s46 offen offset:2048 sc0 sc1 lds
v_mfma_f32_16x16x32_bf16 v[184:187], v[48:51], a[128:131], v[184:187]
v_mfma_f32_16x16x32_bf16 v[184:187], v[52:55], a[132:135], v[184:187]
buffer_load_dwordx4 v26, s[28:31], s46 offen offset:3072 sc0 sc1 lds
v_mfma_f32_16x16x32_bf16 v[188:191], v[48:51], a[176:179], v[188:191]
s_add_u32 m0, s45, 106240
v_mfma_f32_16x16x32_bf16 v[188:191], v[52:55], a[180:183], v[188:191]
s_waitcnt lgkmcnt(4)
v_mfma_f32_16x16x32_bf16 v[192:195], v[56:59], a[32:35], v[192:195]
ds_read_b64_tr_b16 v[48:49], v34 offset:46176
ds_read_b64_tr_b16 v[50:51], v34 offset:48736
v_mfma_f32_16x16x32_bf16 v[192:195], v[60:63], a[36:39], v[192:195]
buffer_load_dwordx4 v27, s[28:31], s46 offen sc0 sc1 lds
v_mfma_f32_16x16x32_bf16 v[196:199], v[56:59], a[80:83], v[196:199]
ds_read_b64_tr_b16 v[52:53], v34 offset:56416
ds_read_b64_tr_b16 v[54:55], v34 offset:58976
v_mfma_f32_16x16x32_bf16 v[196:199], v[60:63], a[84:87], v[196:199]
s_add_u32 s50, s44, 1024
v_mfma_f32_16x16x32_bf16 v[200:203], v[56:59], a[128:131], v[200:203]
buffer_load_dwordx4 a[24:27], v88, s[32:35], s50 offen sc0 sc1
v_mfma_f32_16x16x32_bf16 v[200:203], v[60:63], a[132:135], v[200:203]
buffer_load_dwordx4 a[72:75], v89, s[32:35], s50 offen sc0 sc1
v_mfma_f32_16x16x32_bf16 v[204:207], v[56:59], a[176:179], v[204:207]
v_mfma_f32_16x16x32_bf16 v[204:207], v[60:63], a[180:183], v[204:207]
s_waitcnt lgkmcnt(4)
v_mfma_f32_16x16x32_bf16 v[208:211], v[40:43], a[32:35], v[208:211]
ds_read_b64_tr_b16 v[56:57], v34 offset:46208
ds_read_b64_tr_b16 v[58:59], v34 offset:48768
v_mfma_f32_16x16x32_bf16 v[208:211], v[44:47], a[36:39], v[208:211]
buffer_load_dwordx4 a[120:123], v90, s[32:35], s50 offen sc0 sc1
v_mfma_f32_16x16x32_bf16 v[212:215], v[40:43], a[80:83], v[212:215]
ds_read_b64_tr_b16 v[60:61], v34 offset:56448
ds_read_b64_tr_b16 v[62:63], v34 offset:59008
v_mfma_f32_16x16x32_bf16 v[212:215], v[44:47], a[84:87], v[212:215]
buffer_load_dwordx4 a[168:171], v91, s[32:35], s50 offen sc0 sc1
v_mfma_f32_16x16x32_bf16 v[216:219], v[40:43], a[128:131], v[216:219]
v_mfma_f32_16x16x32_bf16 v[216:219], v[44:47], a[132:135], v[216:219]
v_mfma_f32_16x16x32_bf16 v[220:223], v[40:43], a[176:179], v[220:223]
v_mfma_f32_16x16x32_bf16 v[220:223], v[44:47], a[180:183], v[220:223]
s_waitcnt lgkmcnt(4)
v_mfma_f32_16x16x32_bf16 v[224:227], v[48:51], a[32:35], v[224:227]
s_waitcnt lgkmcnt(0)
s_barrier
v_mfma_f32_16x16x32_bf16 v[224:227], v[52:55], a[36:39], v[224:227]
v_mfma_f32_16x16x32_bf16 v[228:231], v[48:51], a[80:83], v[228:231]
ds_read_b64_tr_b16 v[64:65], v93 offset:0
ds_read_b64_tr_b16 v[66:67], v93 offset:2560
v_mfma_f32_16x16x32_bf16 v[228:231], v[52:55], a[84:87], v[228:231]
v_mfma_f32_16x16x32_bf16 v[232:235], v[48:51], a[128:131], v[232:235]
ds_read_b64_tr_b16 v[68:69], v93 offset:32
ds_read_b64_tr_b16 v[70:71], v93 offset:2592
v_mfma_f32_16x16x32_bf16 v[232:235], v[52:55], a[132:135], v[232:235]
v_mfma_f32_16x16x32_bf16 v[236:239], v[48:51], a[176:179], v[236:239]
ds_read_b64_tr_b16 v[72:73], v93 offset:64
ds_read_b64_tr_b16 v[74:75], v93 offset:2624
v_mfma_f32_16x16x32_bf16 v[236:239], v[52:55], a[180:183], v[236:239]
v_mfma_f32_16x16x32_bf16 v[240:243], v[56:59], a[32:35], v[240:243]
v_mfma_f32_16x16x32_bf16 v[240:243], v[60:63], a[36:39], v[240:243]
ds_read_b64_tr_b16 v[76:77], v93 offset:96
ds_read_b64_tr_b16 v[78:79], v93 offset:2656
v_mfma_f32_16x16x32_bf16 v[244:247], v[56:59], a[80:83], v[244:247]
v_mfma_f32_16x16x32_bf16 v[244:247], v[60:63], a[84:87], v[244:247]
ds_read_b64_tr_b16 v[80:81], v93 offset:128
ds_read_b64_tr_b16 v[82:83], v93 offset:2688
v_mfma_f32_16x16x32_bf16 v[248:251], v[56:59], a[128:131], v[248:251]
s_waitcnt vmcnt(20)
v_cmp_ne_u32 vcc, 1, v35
s_nop 0
s_cmp_eq_u64 vcc, 0
s_cbranch_scc0 L_c_p0_spin
L_c_p0_ok:
v_mfma_f32_16x16x32_bf16 v[248:251], v[60:63], a[132:135], v[248:251]
v_mfma_f32_16x16x32_bf16 v[252:255], v[56:59], a[176:179], v[252:255]
v_mfma_f32_16x16x32_bf16 v[252:255], v[60:63], a[180:183], v[252:255]
s_waitcnt vmcnt(15) lgkmcnt(0)
v_mfma_f32_16x16x32_bf16 a[192:195], v[64:67], a[12:15], 0
v_mfma_f32_16x16x32_bf16 a[196:199], v[68:71], a[12:15], 0
ds_read_b64_tr_b16 v[2:3], v93 offset:20480
ds_read_b64_tr_b16 v[4:5], v93 offset:23040
v_mfma_f32_16x16x32_bf16 a[200:203], v[72:75], a[12:15], 0
v_mfma_f32_16x16x32_bf16 a[204:207], v[76:79], a[12:15], 0
ds_read_b64_tr_b16 v[6:7], v93 offset:20512
ds_read_b64_tr_b16 v[8:9], v93 offset:23072
v_mfma_f32_16x16x32_bf16 a[8:11], v[80:83], a[12:15], 0
v_mfma_f32_16x16x32_bf16 a[208:211], v[64:67], a[60:63], 0
ds_read_b64_tr_b16 v[10:11], v93 offset:20544
ds_read_b64_tr_b16 v[12:13], v93 offset:23104
v_mfma_f32_16x16x32_bf16 a[212:215], v[68:71], a[60:63], 0
v_mfma_f32_16x16x32_bf16 a[216:219], v[72:75], a[60:63], 0
ds_read_b64_tr_b16 v[14:15], v93 offset:20576
ds_read_b64_tr_b16 v[16:17], v93 offset:23136
v_mfma_f32_16x16x32_bf16 a[220:223], v[76:79], a[60:63], 0
v_mfma_f32_16x16x32_bf16 a[56:59], v[80:83], a[60:63], 0
ds_read_b64_tr_b16 v[84:85], v93 offset:20608
ds_read_b64_tr_b16 v[86:87], v93 offset:23168
v_mfma_f32_16x16x32_bf16 a[224:227], v[64:67], a[108:111], 0
s_add_u32 s47, s67, 0
v_mfma_f32_16x16x32_bf16 a[228:231], v[68:71], a[108:111], 0
buffer_load_dwordx4 a[0:3], v28, s[32:35], s47 offen offset:0 sc0 sc1
v_mfma_f32_16x16x32_bf16 a[232:235], v[72:75], a[108:111], 0
buffer_load_dwordx4 a[4:7], v28, s[32:35], s47 offen offset:1024 sc0 sc1
v_mfma_f32_16x16x32_bf16 a[236:239], v[76:79], a[108:111], 0
buffer_load_dwordx4 a[48:51], v29, s[32:35], s47 offen offset:0 sc0 sc1
v_mfma_f32_16x16x32_bf16 a[104:107], v[80:83], a[108:111], 0
buffer_load_dwordx4 a[52:55], v29, s[32:35], s47 offen offset:1024 sc0 sc1
v_mfma_f32_16x16x32_bf16 a[240:243], v[64:67], a[156:159], 0
buffer_load_dwordx4 a[96:99], v30, s[32:35], s47 offen offset:0 sc0 sc1
v_mfma_f32_16x16x32_bf16 a[244:247], v[68:71], a[156:159], 0
buffer_load_dwordx4 a[100:103], v30, s[32:35], s47 offen offset:1024 sc0 sc1
v_mfma_f32_16x16x32_bf16 a[248:251], v[72:75], a[156:159], 0
buffer_load_dwordx4 a[144:147], v31, s[32:35], s47 offen offset:0 sc0 sc1
v_mfma_f32_16x16x32_bf16 a[252:255], v[76:79], a[156:159], 0
buffer_load_dwordx4 a[148:151], v31, s[32:35], s47 offen offset:1024 sc0 sc1
v_mfma_f32_16x16x32_bf16 a[152:155], v[80:83], a[156:159], 0
s_waitcnt vmcnt(8) lgkmcnt(0)
v_mfma_f32_16x16x32_bf16 a[192:195], v[2:5], a[24:27], a[192:195]
v_mfma_f32_16x16x32_bf16 a[196:199], v[6:9], a[24:27], a[196:199]
ds_read_b64_tr_b16 v[40:41], v32 offset:0
ds_read_b64_tr_b16 v[42:43], v32 offset:2560
v_mfma_f32_16x16x32_bf16 a[200:203], v[10:13], a[24:27], a[200:203]
v_mfma_f32_16x16x32_bf16 a[204:207], v[14:17], a[24:27], a[204:207]
ds_read_b64_tr_b16 v[44:45], v32 offset:10240
ds_read_b64_tr_b16 v[46:47], v32 offset:12800
v_mfma_f32_16x16x32_bf16 a[8:11], v[84:87], a[24:27], a[8:11]
v_mfma_f32_16x16x32_bf16 a[208:211], v[2:5], a[72:75], a[208:211]
v_mfma_f32_16x16x32_bf16 a[212:215], v[6:9], a[72:75], a[212:215]
v_mfma_f32_16x16x32_bf16 a[216:219], v[10:13], a[72:75], a[216:219]
ds_read_b64_tr_b16 v[48:49], v32 offset:32
ds_read_b64_tr_b16 v[50:51], v32 offset:2592
v_mfma_f32_16x16x32_bf16 a[220:223], v[14:17], a[72:75], a[220:223]
v_mfma_f32_16x16x32_bf16 a[56:59], v[84:87], a[72:75], a[56:59]
ds_read_b64_tr_b16 v[52:53], v32 offset:10272
ds_read_b64_tr_b16 v[54:55], v32 offset:12832
v_mfma_f32_16x16x32_bf16 a[224:227], v[2:5], a[120:123], a[224:227]
s_add_u32 s47, s68, 0
v_mfma_f32_16x16x32_bf16 a[228:231], v[6:9], a[120:123], a[228:231]
buffer_load_dwordx4 a[16:19], v28, s[32:35], s47 offen offset:0 sc0 sc1
v_mfma_f32_16x16x32_bf16 a[232:235], v[10:13], a[120:123], a[232:235]
buffer_load_dwordx4 a[20:23], v28, s[32:35], s47 offen offset:1024 sc0 sc1
v_mfma_f32_16x16x32_bf16 a[236:239], v[14:17], a[120:123], a[236:239]
buffer_load_dwordx4 a[64:67], v29, s[32:35], s47 offen offset:0 sc0 sc1
v_mfma_f32_16x16x32_bf16 a[104:107], v[84:87], a[120:123], a[104:107]
buffer_load_dwordx4 a[68:71], v29, s[32:35], s47 offen offset:1024 sc0 sc1
v_mfma_f32_16x16x32_bf16 a[240:243], v[2:5], a[168:171], a[240:243]
buffer_load_dwordx4 a[112:115], v30, s[32:35], s47 offen offset:0 sc0 sc1
v_mfma_f32_16x16x32_bf16 a[244:247], v[6:9], a[168:171], a[244:247]
buffer_load_dwordx4 a[116:119], v30, s[32:35], s47 offen offset:1024 sc0 sc1
v_mfma_f32_16x16x32_bf16 a[248:251], v[10:13], a[168:171], a[248:251]
buffer_load_dwordx4 a[160:163], v31, s[32:35], s47 offen offset:0 sc0 sc1
v_mfma_f32_16x16x32_bf16 a[252:255], v[14:17], a[168:171], a[252:255]
buffer_load_dwordx4 a[164:167], v31, s[32:35], s47 offen offset:1024 sc0 sc1
v_mfma_f32_16x16x32_bf16 a[152:155], v[84:87], a[168:171], a[152:155]
s_waitcnt vmcnt(8) lgkmcnt(4)
v_mfma_f32_16x16x32_bf16 v[96:99], v[40:43], a[0:3], v[96:99]
ds_read_b64_tr_b16 v[56:57], v32 offset:64
ds_read_b64_tr_b16 v[58:59], v32 offset:2624
v_mfma_f32_16x16x32_bf16 v[96:99], v[44:47], a[4:7], v[96:99]
v_lshlrev_b32 v36, 6, v1
s_and_b32 s3, s2, 63
v_add_u32 v36, s3, v36
v_lshlrev_b32 v36, 9, v36
s_lshl_b32 s3, s25, 2
s_add_u32 s3, s3, s61
s_lshl_b32 s3, s3, 2
s_add_u32 s3, s3, 92274752
v_mov_b32 v37, 1
s_mov_b64 exec, 15
buffer_store_dword v37, v36, s[40:43], s3 offen sc0 sc1
s_mov_b64 exec, -1
v_mfma_f32_16x16x32_bf16 v[100:103], v[40:43], a[48:51], v[100:103]
ds_read_b64_tr_b16 v[60:61], v32 offset:10304
ds_read_b64_tr_b16 v[62:63], v32 offset:12864
v_mfma_f32_16x16x32_bf16 v[100:103], v[44:47], a[52:55], v[100:103]
v_mfma_f32_16x16x32_bf16 v[104:107], v[40:43], a[96:99], v[104:107]
v_mfma_f32_16x16x32_bf16 v[104:107], v[44:47], a[100:103], v[104:107]
buffer_store_dwordx4 a[32:35], v28, s[40:43], s39 offen offset:0 sc0 sc1
v_mfma_f32_16x16x32_bf16 v[108:111], v[40:43], a[144:147], v[108:111]
v_mfma_f32_16x16x32_bf16 v[108:111], v[44:47], a[148:151], v[108:111]
s_waitcnt lgkmcnt(4)
v_mfma_f32_16x16x32_bf16 v[112:115], v[48:51], a[0:3], v[112:115]
ds_read_b64_tr_b16 v[40:41], v32 offset:96
ds_read_b64_tr_b16 v[42:43], v32 offset:2656
v_mfma_f32_16x16x32_bf16 v[112:115], v[52:55], a[4:7], v[112:115]
s_add_u32 s50, s44, 2048
v_mfma_f32_16x16x32_bf16 v[116:119], v[48:51], a[48:51], v[116:119]
ds_read_b64_tr_b16 v[44:45], v32 offset:10336
ds_read_b64_tr_b16 v[46:47], v32 offset:12896
v_mfma_f32_16x16x32_bf16 v[116:119], v[52:55], a[52:55], v[116:119]
buffer_load_dwordx4 a[28:31], v88, s[32:35], s50 offen sc0 sc1
v_mfma_f32_16x16x32_bf16 v[120:123], v[48:51], a[96:99], v[120:123]
buffer_load_dwordx4 a[76:79], v89, s[32:35], s50 offen sc0 sc1
v_mfma_f32_16x16x32_bf16 v[120:123], v[52:55], a[100:103], v[120:123]
v_mfma_f32_16x16x32_bf16 v[124:127], v[48:51], a[144:147], v[124:127]
v_mfma_f32_16x16x32_bf16 v[124:127], v[52:55], a[148:151], v[124:127]
s_waitcnt lgkmcnt(4)
v_mfma_f32_16x16x32_bf16 v[128:131], v[56:59], a[0:3], v[128:131]
ds_read_b64_tr_b16 v[48:49], v32 offset:128
ds_read_b64_tr_b16 v[50:51], v32 offset:2688
v_mfma_f32_16x16x32_bf16 v[128:131], v[60:63], a[4:7], v[128:131]
buffer_load_dwordx4 a[124:127], v90, s[32:35], s50 offen sc0 sc1
v_mfma_f32_16x16x32_bf16 v[132:135], v[56:59], a[48:51], v[132:135]
ds_read_b64_tr_b16 v[52:53], v32 offset:10368
ds_read_b64_tr_b16 v[54:55], v32 offset:12928
v_mfma_f32_16x16x32_bf16 v[132:135], v[60:63], a[52:55], v[132:135]
v_mfma_f32_16x16x32_bf16 v[136:139], v[56:59], a[96:99], v[136:139]
buffer_load_dwordx4 a[172:175], v91, s[32:35], s50 offen sc0 sc1
v_mfma_f32_16x16x32_bf16 v[136:139], v[60:63], a[100:103], v[136:139]
buffer_store_dwordx4 a[80:83], v29, s[40:43], s39 offen offset:0 sc0 sc1
v_mfma_f32_16x16x32_bf16 v[140:143], v[56:59], a[144:147], v[140:143]
s_add_u32 s46, s65, 0
s_add_u32 m0, s45, 122624
v_mfma_f32_16x16x32_bf16 v[140:143], v[60:63], a[148:151], v[140:143]
s_waitcnt lgkmcnt(4)
v_mfma_f32_16x16x32_bf16 v[144:147], v[40:43], a[0:3], v[144:147]
ds_read_b64_tr_b16 v[56:57], v32 offset:5120
ds_read_b64_tr_b16 v[58:59], v32 offset:7680
v_mfma_f32_16x16x32_bf16 v[144:147], v[44:47], a[4:7], v[144:147]
buffer_load_dwordx4 v26, s[28:31], s46 offen offset:0 sc0 sc1 lds
v_mfma_f32_16x16x32_bf16 v[148:151], v[40:43], a[48:51], v[148:151]
ds_read_b64_tr_b16 v[60:61], v32 offset:15360
ds_read_b64_tr_b16 v[62:63], v32 offset:17920
v_mfma_f32_16x16x32_bf16 v[148:151], v[44:47], a[52:55], v[148:151]
v_mfma_f32_16x16x32_bf16 v[152:155], v[40:43], a[96:99], v[152:155]
buffer_load_dwordx4 v26, s[28:31], s46 offen offset:1024 sc0 sc1 lds
v_mfma_f32_16x16x32_bf16 v[152:155], v[44:47], a[100:103], v[152:155]
v_mfma_f32_16x16x32_bf16 v[156:159], v[40:43], a[144:147], v[156:159]
v_mfma_f32_16x16x32_bf16 v[156:159], v[44:47], a[148:151], v[156:159]
s_waitcnt lgkmcnt(4)
v_mfma_f32_16x16x32_bf16 v[160:163], v[48:51], a[0:3], v[160:163]
ds_read_b64_tr_b16 v[40:41], v32 offset:5152
ds_read_b64_tr_b16 v[42:43], v32 offset:7712
v_mfma_f32_16x16x32_bf16 v[160:163], v[52:55], a[4:7], v[160:163]
buffer_load_dwordx4 v26, s[28:31], s46 offen offset:2048 sc0 sc1 lds
v_mfma_f32_16x16x32_bf16 v[164:167], v[48:51], a[48:51], v[164:167]
ds_read_b64_tr_b16 v[44:45], v32 offset:15392
ds_read_b64_tr_b16 v[46:47], v32 offset:17952
v_mfma_f32_16x16x32_bf16 v[164:167], v[52:55], a[52:55], v[164:167]
v_mfma_f32_16x16x32_bf16 v[168:171], v[48:51], a[96:99], v[168:171]
buffer_load_dwordx4 v26, s[28:31], s46 offen offset:3072 sc0 sc1 lds
v_mfma_f32_16x16x32_bf16 v[168:171], v[52:55], a[100:103], v[168:171]
buffer_store_dwordx4 a[128:131], v30, s[40:43], s39 offen offset:0 sc0 sc1
v_mfma_f32_16x16x32_bf16 v[172:175], v[48:51], a[144:147], v[172:175]
s_add_u32 m0, s45, 126720
v_mfma_f32_16x16x32_bf16 v[172:175], v[52:55], a[148:151], v[172:175]
s_waitcnt lgkmcnt(4)
v_mfma_f32_16x16x32_bf16 v[176:179], v[56:59], a[0:3], v[176:179]
ds_read_b64_tr_b16 v[48:49], v32 offset:5184
ds_read_b64_tr_b16 v[50:51], v32 offset:7744
v_mfma_f32_16x16x32_bf16 v[176:179], v[60:63], a[4:7], v[176:179]
buffer_load_dwordx4 v27, s[28:31], s46 offen sc0 sc1 lds
v_mfma_f32_16x16x32_bf16 v[180:183], v[56:59], a[48:51], v[180:183]
ds_read_b64_tr_b16 v[52:53], v32 offset:15424
ds_read_b64_tr_b16 v[54:55], v32 offset:17984
v_mfma_f32_16x16x32_bf16 v[180:183], v[60:63], a[52:55], v[180:183]
s_add_u32 s46, s66, 15360
s_add_u32 m0, s45, 49152
v_mfma_f32_16x16x32_bf16 v[184:187], v[56:59], a[96:99], v[184:187]
buffer_load_dwordx4 v26, s[28:31], s46 offen offset:0 sc0 sc1 lds
v_mfma_f32_16x16x32_bf16 v[184:187], v[60:63], a[100:103], v[184:187]
v_mfma_f32_16x16x32_bf16 v[188:191], v[56:59], a[144:147], v[188:191]
v_mfma_f32_16x16x32_bf16 v[188:191], v[60:63], a[148:151], v[188:191]
s_waitcnt lgkmcnt(4)
v_mfma_f32_16x16x32_bf16 v[192:195], v[40:43], a[0:3], v[192:195]
ds_read_b64_tr_b16 v[56:57], v32 offset:5216
ds_read_b64_tr_b16 v[58:59], v32 offset:7776
v_mfma_f32_16x16x32_bf16 v[192:195], v[44:47], a[4:7], v[192:195]
buffer_load_dwordx4 v26, s[28:31], s46 offen offset:1024 sc0 sc1 lds
v_mfma_f32_16x16x32_bf16 v[196:199], v[40:43], a[48:51], v[196:199]
ds_read_b64_tr_b16 v[60:61], v32 offset:15456
ds_read_b64_tr_b16 v[62:63], v32 offset:18016
v_mfma_f32_16x16x32_bf16 v[196:199], v[44:47], a[52:55], v[196:199]
buffer_load_dwordx4 v26, s[28:31], s46 offen offset:2048 sc0 sc1 lds
v_mfma_f32_16x16x32_bf16 v[200:203], v[40:43], a[96:99], v[200:203]
v_mfma_f32_16x16x32_bf16 v[200:203], v[44:47], a[100:103], v[200:203]
buffer_store_dwordx4 a[176:179], v31, s[40:43], s39 offen offset:0 sc0 sc1
v_mfma_f32_16x16x32_bf16 v[204:207], v[40:43], a[144:147], v[204:207]
v_mfma_f32_16x16x32_bf16 v[204:207], v[44:47], a[148:151], v[204:207]
s_waitcnt lgkmcnt(4)
v_mfma_f32_16x16x32_bf16 v[208:211], v[48:51], a[0:3], v[208:211]
ds_read_b64_tr_b16 v[40:41], v32 offset:5248
ds_read_b64_tr_b16 v[42:43], v32 offset:7808
v_mfma_f32_16x16x32_bf16 v[208:211], v[52:55], a[4:7], v[208:211]
buffer_load_dwordx4 v26, s[28:31], s46 offen offset:3072 sc0 sc1 lds
v_mfma_f32_16x16x32_bf16 v[212:215], v[48:51], a[48:51], v[212:215]
ds_read_b64_tr_b16 v[44:45], v32 offset:15488
ds_read_b64_tr_b16 v[46:47], v32 offset:18048
v_mfma_f32_16x16x32_bf16 v[212:215], v[52:55], a[52:55], v[212:215]
s_add_u32 m0, s45, 53248
v_mfma_f32_16x16x32_bf16 v[216:219], v[48:51], a[96:99], v[216:219]
buffer_load_dwordx4 v27, s[28:31], s46 offen sc0 sc1 lds
v_mfma_f32_16x16x32_bf16 v[216:219], v[52:55], a[100:103], v[216:219]
s_add_u32 s50, s44, 3072
v_mfma_f32_16x16x32_bf16 v[220:223], v[48:51], a[144:147], v[220:223]
v_mfma_f32_16x16x32_bf16 v[220:223], v[52:55], a[148:151], v[220:223]
s_waitcnt lgkmcnt(4)
v_mfma_f32_16x16x32_bf16 v[224:227], v[56:59], a[0:3], v[224:227]
s_waitcnt lgkmcnt(0)
s_barrier
v_mfma_f32_16x16x32_bf16 v[224:227], v[60:63], a[4:7], v[224:227]
v_mfma_f32_16x16x32_bf16 v[228:231], v[56:59], a[48:51], v[228:231]
ds_read_b64_tr_b16 v[64:65], v92 offset:20480
ds_read_b64_tr_b16 v[66:67], v92 offset:23040
v_mfma_f32_16x16x32_bf16 v[228:231], v[60:63], a[52:55], v[228:231]
buffer_load_dwordx4 a[40:43], v88, s[32:35], s50 offen sc0 sc1
v_mfma_f32_16x16x32_bf16 v[232:235], v[56:59], a[96:99], v[232:235]
ds_read_b64_tr_b16 v[68:69], v92 offset:20512
ds_read_b64_tr_b16 v[70:71], v92 offset:23072
v_mfma_f32_16x16x32_bf16 v[232:235], v[60:63], a[100:103], v[232:235]
buffer_store_dwordx4 a[36:39], v28, s[40:43], s39 offen offset:1024 sc0 sc1
v_mfma_f32_16x16x32_bf16 v[236:239], v[56:59], a[144:147], v[236:239]
ds_read_b64_tr_b16 v[72:73], v92 offset:20544
ds_read_b64_tr_b16 v[74:75], v92 offset:23104
v_mfma_f32_16x16x32_bf16 v[236:239], v[60:63], a[148:151], v[236:239]
v_mfma_f32_16x16x32_bf16 v[240:243], v[40:43], a[0:3], v[240:243]
buffer_load_dwordx4 a[88:91], v89, s[32:35], s50 offen sc0 sc1
v_mfma_f32_16x16x32_bf16 v[240:243], v[44:47], a[4:7], v[240:243]
ds_read_b64_tr_b16 v[76:77], v92 offset:20576
ds_read_b64_tr_b16 v[78:79], v92 offset:23136
v_mfma_f32_16x16x32_bf16 v[244:247], v[40:43], a[48:51], v[244:247]
buffer_load_dwordx4 a[136:139], v90, s[32:35], s50 offen sc0 sc1
v_mfma_f32_16x16x32_bf16 v[244:247], v[44:47], a[52:55], v[244:247]
ds_read_b64_tr_b16 v[80:81], v92 offset:20608
ds_read_b64_tr_b16 v[82:83], v92 offset:23168
v_mfma_f32_16x16x32_bf16 v[248:251], v[40:43], a[96:99], v[248:251]
buffer_load_dwordx4 a[184:187], v91, s[32:35], s50 offen sc0 sc1
v_mfma_f32_16x16x32_bf16 v[248:251], v[44:47], a[100:103], v[248:251]
v_mfma_f32_16x16x32_bf16 v[252:255], v[40:43], a[144:147], v[252:255]
v_mfma_f32_16x16x32_bf16 v[252:255], v[44:47], a[148:151], v[252:255]
s_waitcnt vmcnt(18) lgkmcnt(0)
v_mfma_f32_16x16x32_bf16 a[192:195], v[64:67], a[28:31], a[192:195]
v_mfma_f32_16x16x32_bf16 a[196:199], v[68:71], a[28:31], a[196:199]
ds_read_b64_tr_b16 v[48:49], v34 offset:0
ds_read_b64_tr_b16 v[50:51], v34 offset:2560
v_mfma_f32_16x16x32_bf16 a[200:203], v[72:75], a[28:31], a[200:203]
v_mfma_f32_16x16x32_bf16 a[204:207], v[76:79], a[28:31], a[204:207]
ds_read_b64_tr_b16 v[52:53], v34 offset:10240
ds_read_b64_tr_b16 v[54:55], v34 offset:12800
v_mfma_f32_16x16x32_bf16 a[8:11], v[80:83], a[28:31], a[8:11]
v_mfma_f32_16x16x32_bf16 a[208:211], v[64:67], a[76:79], a[208:211]
v_mfma_f32_16x16x32_bf16 a[212:215], v[68:71], a[76:79], a[212:215]
v_mfma_f32_16x16x32_bf16 a[216:219], v[72:75], a[76:79], a[216:219]
ds_read_b64_tr_b16 v[56:57], v34 offset:32
ds_read_b64_tr_b16 v[58:59], v34 offset:2592
v_mfma_f32_16x16x32_bf16 a[220:223], v[76:79], a[76:79], a[220:223]
v_mfma_f32_16x16x32_bf16 a[56:59], v[80:83], a[76:79], a[56:59]
ds_read_b64_tr_b16 v[60:61], v34 offset:10272
ds_read_b64_tr_b16 v[62:63], v34 offset:12832
v_mfma_f32_16x16x32_bf16 a[224:227], v[64:67], a[124:127], a[224:227]
v_mfma_f32_16x16x32_bf16 a[228:231], v[68:71], a[124:127], a[228:231]
v_mfma_f32_16x16x32_bf16 a[232:235], v[72:75], a[124:127], a[232:235]
buffer_store_dwordx4 a[84:87], v29, s[40:43], s39 offen offset:1024 sc0 sc1
v_mfma_f32_16x16x32_bf16 a[236:239], v[76:79], a[124:127], a[236:239]
v_mfma_f32_16x16x32_bf16 a[104:107], v[80:83], a[124:127], a[104:107]
v_mfma_f32_16x16x32_bf16 a[240:243], v[64:67], a[172:175], a[240:243]
v_mfma_f32_16x16x32_bf16 a[244:247], v[68:71], a[172:175], a[244:247]
v_mfma_f32_16x16x32_bf16 a[248:251], v[72:75], a[172:175], a[248:251]
v_mfma_f32_16x16x32_bf16 a[252:255], v[76:79], a[172:175], a[252:255]
v_mfma_f32_16x16x32_bf16 a[152:155], v[80:83], a[172:175], a[152:155]
s_waitcnt lgkmcnt(4)
v_mfma_f32_16x16x32_bf16 v[96:99], v[48:51], a[16:19], v[96:99]
ds_read_b64_tr_b16 v[40:41], v34 offset:64
ds_read_b64_tr_b16 v[42:43], v34 offset:2624
v_mfma_f32_16x16x32_bf16 v[96:99], v[52:55], a[20:23], v[96:99]
v_mfma_f32_16x16x32_bf16 v[100:103], v[48:51], a[64:67], v[100:103]
ds_read_b64_tr_b16 v[44:45], v34 offset:10304
ds_read_b64_tr_b16 v[46:47], v34 offset:12864
v_mfma_f32_16x16x32_bf16 v[100:103], v[52:55], a[68:71], v[100:103]
buffer_load_dword v35, v38, s[40:43], s51 offen offset:64 sc0 sc1
v_mfma_f32_16x16x32_bf16 v[104:107], v[48:51], a[112:115], v[104:107]
v_mfma_f32_16x16x32_bf16 v[104:107], v[52:55], a[116:119], v[104:107]
v_mfma_f32_16x16x32_bf16 v[108:111], v[48:51], a[160:163], v[108:111]
v_mfma_f32_16x16x32_bf16 v[108:111], v[52:55], a[164:167], v[108:111]
s_waitcnt lgkmcnt(4)
v_mfma_f32_16x16x32_bf16 v[112:115], v[56:59], a[16:19], v[112:115]
ds_read_b64_tr_b16 v[48:49], v34 offset:96
ds_read_b64_tr_b16 v[50:51], v34 offset:2656
v_mfma_f32_16x16x32_bf16 v[112:115], v[60:63], a[20:23], v[112:115]
v_mfma_f32_16x16x32_bf16 v[116:119], v[56:59], a[64:67], v[116:119]
ds_read_b64_tr_b16 v[52:53], v34 offset:10336
ds_read_b64_tr_b16 v[54:55], v34 offset:12896
v_mfma_f32_16x16x32_bf16 v[116:119], v[60:63], a[68:71], v[116:119]
buffer_store_dwordx4 a[132:135], v30, s[40:43], s39 offen offset:1024 sc0 sc1
v_mfma_f32_16x16x32_bf16 v[120:123], v[56:59], a[112:115], v[120:123]
v_mfma_f32_16x16x32_bf16 v[120:123], v[60:63], a[116:119], v[120:123]
v_mfma_f32_16x16x32_bf16 v[124:127], v[56:59], a[160:163], v[124:127]
v_mfma_f32_16x16x32_bf16 v[124:127], v[60:63], a[164:167], v[124:127]
s_waitcnt lgkmcnt(4)
v_mfma_f32_16x16x32_bf16 v[128:131], v[40:43], a[16:19], v[128:131]
ds_read_b64_tr_b16 v[56:57], v34 offset:128
ds_read_b64_tr_b16 v[58:59], v34 offset:2688
v_mfma_f32_16x16x32_bf16 v[128:131], v[44:47], a[20:23], v[128:131]
v_mfma_f32_16x16x32_bf16 v[132:135], v[40:43], a[64:67], v[132:135]
ds_read_b64_tr_b16 v[60:61], v34 offset:10368
ds_read_b64_tr_b16 v[62:63], v34 offset:12928
v_mfma_f32_16x16x32_bf16 v[132:135], v[44:47], a[68:71], v[132:135]
v_mfma_f32_16x16x32_bf16 v[136:139], v[40:43], a[112:115], v[136:139]
v_mfma_f32_16x16x32_bf16 v[136:139], v[44:47], a[116:119], v[136:139]
v_mfma_f32_16x16x32_bf16 v[140:143], v[40:43], a[160:163], v[140:143]
v_mfma_f32_16x16x32_bf16 v[140:143], v[44:47], a[164:167], v[140:143]
s_waitcnt lgkmcnt(4)
v_mfma_f32_16x16x32_bf16 v[144:147], v[48:51], a[16:19], v[144:147]
ds_read_b64_tr_b16 v[40:41], v34 offset:5120
ds_read_b64_tr_b16 v[42:43], v34 offset:7680
v_mfma_f32_16x16x32_bf16 v[144:147], v[52:55], a[20:23], v[144:147]
v_mfma_f32_16x16x32_bf16 v[148:151], v[48:51], a[64:67], v[148:151]
ds_read_b64_tr_b16 v[44:45], v34 offset:15360
ds_read_b64_tr_b16 v[46:47], v34 offset:17920
v_mfma_f32_16x16x32_bf16 v[148:151], v[52:55], a[68:71], v[148:151]
buffer_store_dwordx4 a[180:183], v31, s[40:43], s39 offen offset:1024 sc0 sc1
v_mfma_f32_16x16x32_bf16 v[152:155], v[48:51], a[112:115], v[152:155]
v_mfma_f32_16x16x32_bf16 v[152:155], v[52:55], a[116:119], v[152:155]
s_add_u32 s47, s69, 0
v_mfma_f32_16x16x32_bf16 v[156:159], v[48:51], a[160:163], v[156:159]
buffer_load_dwordx4 a[32:35], v28, s[32:35], s47 offen offset:0 sc0 sc1
v_mfma_f32_16x16x32_bf16 v[156:159], v[52:55], a[164:167], v[156:159]
s_waitcnt lgkmcnt(4)
v_mfma_f32_16x16x32_bf16 v[160:163], v[56:59], a[16:19], v[160:163]
ds_read_b64_tr_b16 v[48:49], v34 offset:5152
ds_read_b64_tr_b16 v[50:51], v34 offset:7712
v_mfma_f32_16x16x32_bf16 v[160:163], v[60:63], a[20:23], v[160:163]
buffer_load_dwordx4 a[36:39], v28, s[32:35], s47 offen offset:1024 sc0 sc1
v_mfma_f32_16x16x32_bf16 v[164:167], v[56:59], a[64:67], v[164:167]
ds_read_b64_tr_b16 v[52:53], v34 offset:15392
ds_read_b64_tr_b16 v[54:55], v34 offset:17952
v_mfma_f32_16x16x32_bf16 v[164:167], v[60:63], a[68:71], v[164:167]
buffer_load_dwordx4 a[80:83], v29, s[32:35], s47 offen offset:0 sc0 sc1
v_mfma_f32_16x16x32_bf16 v[168:171], v[56:59], a[112:115], v[168:171]
buffer_load_dwordx4 a[84:87], v29, s[32:35], s47 offen offset:1024 sc0 sc1
v_mfma_f32_16x16x32_bf16 v[168:171], v[60:63], a[116:119], v[168:171]
v_mfma_f32_16x16x32_bf16 v[172:175], v[56:59], a[160:163], v[172:175]
buffer_load_dwordx4 a[128:131], v30, s[32:35], s47 offen offset:0 sc0 sc1
v_mfma_f32_16x16x32_bf16 v[172:175], v[60:63], a[164:167], v[172:175]
s_waitcnt lgkmcnt(4)
v_mfma_f32_16x16x32_bf16 v[176:179], v[40:43], a[16:19], v[176:179]
ds_read_b64_tr_b16 v[56:57], v34 offset:5184
ds_read_b64_tr_b16 v[58:59], v34 offset:7744
v_mfma_f32_16x16x32_bf16 v[176:179], v[44:47], a[20:23], v[176:179]
buffer_load_dwordx4 a[132:135], v30, s[32:35], s47 offen offset:1024 sc0 sc1
v_mfma_f32_16x16x32_bf16 v[180:183], v[40:43], a[64:67], v[180:183]
ds_read_b64_tr_b16 v[60:61], v34 offset:15424
ds_read_b64_tr_b16 v[62:63], v34 offset:17984
v_mfma_f32_16x16x32_bf16 v[180:183], v[44:47], a[68:71], v[180:183]
buffer_load_dwordx4 a[176:179], v31, s[32:35], s47 offen offset:0 sc0 sc1
v_mfma_f32_16x16x32_bf16 v[184:187], v[40:43], a[112:115], v[184:187]
buffer_load_dwordx4 a[180:183], v31, s[32:35], s47 offen offset:1024 sc0 sc1
v_mfma_f32_16x16x32_bf16 v[184:187], v[44:47], a[116:119], v[184:187]
s_add_u32 s46, s63, 10240
s_add_u32 m0, s45, 143104
v_mfma_f32_16x16x32_bf16 v[188:191], v[40:43], a[160:163], v[188:191]
v_mfma_f32_16x16x32_bf16 v[188:191], v[44:47], a[164:167], v[188:191]
s_waitcnt lgkmcnt(4)
v_mfma_f32_16x16x32_bf16 v[192:195], v[48:51], a[16:19], v[192:195]
ds_read_b64_tr_b16 v[40:41], v34 offset:5216
ds_read_b64_tr_b16 v[42:43], v34 offset:7776
v_mfma_f32_16x16x32_bf16 v[192:195], v[52:55], a[20:23], v[192:195]
buffer_load_dwordx4 v26, s[28:31], s46 offen offset:0 sc0 sc1 lds
v_mfma_f32_16x16x32_bf16 v[196:199], v[48:51], a[64:67], v[196:199]
ds_read_b64_tr_b16 v[44:45], v34 offset:15456
ds_read_b64_tr_b16 v[46:47], v34 offset:18016
v_mfma_f32_16x16x32_bf16 v[196:199], v[52:55], a[68:71], v[196:199]
buffer_load_dwordx4 v26, s[28:31], s46 offen offset:1024 sc0 sc1 lds
v_mfma_f32_16x16x32_bf16 v[200:203], v[48:51], a[112:115], v[200:203]
buffer_load_dwordx4 v26, s[28:31], s46 offen offset:2048 sc0 sc1 lds
v_mfma_f32_16x16x32_bf16 v[200:203], v[52:55], a[116:119], v[200:203]
v_mfma_f32_16x16x32_bf16 v[204:207], v[48:51], a[160:163], v[204:207]
buffer_load_dwordx4 v26, s[28:31], s46 offen offset:3072 sc0 sc1 lds
v_mfma_f32_16x16x32_bf16 v[204:207], v[52:55], a[164:167], v[204:207]
s_waitcnt lgkmcnt(4)
v_mfma_f32_16x16x32_bf16 v[208:211], v[56:59], a[16:19], v[208:211]
ds_read_b64_tr_b16 v[48:49], v34 offset:5248
ds_read_b64_tr_b16 v[50:51], v34 offset:7808
v_mfma_f32_16x16x32_bf16 v[208:211], v[60:63], a[20:23], v[208:211]
s_add_u32 m0, s45, 147200
v_mfma_f32_16x16x32_bf16 v[212:215], v[56:59], a[64:67], v[212:215]
ds_read_b64_tr_b16 v[52:53], v34 offset:15488
ds_read_b64_tr_b16 v[54:55], v34 offset:18048
v_mfma_f32_16x16x32_bf16 v[212:215], v[60:63], a[68:71], v[212:215]
buffer_load_dwordx4 v27, s[28:31], s46 offen sc0 sc1 lds
v_mfma_f32_16x16x32_bf16 v[216:219], v[56:59], a[112:115], v[216:219]
s_add_u32 s46, s66, 20480
s_add_u32 m0, s45, 69632
v_mfma_f32_16x16x32_bf16 v[216:219], v[60:63], a[116:119], v[216:219]
buffer_load_dwordx4 v26, s[28:31], s46 offen offset:0 sc0 sc1 lds
v_mfma_f32_16x16x32_bf16 v[220:223], v[56:59], a[160:163], v[220:223]
buffer_load_dwordx4 v26, s[28:31], s46 offen offset:1024 sc0 sc1 lds
v_mfma_f32_16x16x32_bf16 v[220:223], v[60:63], a[164:167], v[220:223]
s_waitcnt lgkmcnt(4)
v_mfma_f32_16x16x32_bf16 v[224:227], v[40:43], a[16:19], v[224:227]
s_waitcnt vmcnt(30) lgkmcnt(0)
s_barrier
v_mfma_f32_16x16x32_bf16 v[224:227], v[44:47], a[20:23], v[224:227]
s_waitcnt vmcnt(24)
v_mfma_f32_16x16x32_bf16 v[228:231], v[40:43], a[64:67], v[228:231]
ds_read_b64_tr_b16 v[64:65], v93 offset:0
ds_read_b64_tr_b16 v[66:67], v93 offset:2560
v_mfma_f32_16x16x32_bf16 v[228:231], v[44:47], a[68:71], v[228:231]
buffer_load_dwordx4 v26, s[28:31], s46 offen offset:2048 sc0 sc1 lds
v_mfma_f32_16x16x32_bf16 v[232:235], v[40:43], a[112:115], v[232:235]
ds_read_b64_tr_b16 v[68:69], v93 offset:32
ds_read_b64_tr_b16 v[70:71], v93 offset:2592
v_mfma_f32_16x16x32_bf16 v[232:235], v[44:47], a[116:119], v[232:235]
buffer_load_dwordx4 v26, s[28:31], s46 offen offset:3072 sc0 sc1 lds
v_mfma_f32_16x16x32_bf16 v[236:239], v[40:43], a[160:163], v[236:239]
ds_read_b64_tr_b16 v[72:73], v93 offset:64
ds_read_b64_tr_b16 v[74:75], v93 offset:2624
v_mfma_f32_16x16x32_bf16 v[236:239], v[44:47], a[164:167], v[236:239]
v_mfma_f32_16x16x32_bf16 v[240:243], v[48:51], a[16:19], v[240:243]
s_add_u32 m0, s45, 73728
v_mfma_f32_16x16x32_bf16 v[240:243], v[52:55], a[20:23], v[240:243]
ds_read_b64_tr_b16 v[76:77], v93 offset:96
ds_read_b64_tr_b16 v[78:79], v93 offset:2656
v_mfma_f32_16x16x32_bf16 v[244:247], v[48:51], a[64:67], v[244:247]
buffer_load_dwordx4 v27, s[28:31], s46 offen sc0 sc1 lds
v_mfma_f32_16x16x32_bf16 v[244:247], v[52:55], a[68:71], v[244:247]
ds_read_b64_tr_b16 v[80:81], v93 offset:128
ds_read_b64_tr_b16 v[82:83], v93 offset:2688
v_mfma_f32_16x16x32_bf16 v[248:251], v[48:51], a[112:115], v[248:251]
s_add_u32 s50, s44, 4096
v_mfma_f32_16x16x32_bf16 v[248:251], v[52:55], a[116:119], v[248:251]
buffer_load_dwordx4 a[44:47], v88, s[32:35], s50 offen sc0 sc1
v_mfma_f32_16x16x32_bf16 v[252:255], v[48:51], a[160:163], v[252:255]
buffer_load_dwordx4 a[92:95], v89, s[32:35], s50 offen sc0 sc1
v_mfma_f32_16x16x32_bf16 v[252:255], v[52:55], a[164:167], v[252:255]
buffer_load_dwordx4 a[140:143], v90, s[32:35], s50 offen sc0 sc1
buffer_load_dwordx4 a[188:191], v91, s[32:35], s50 offen sc0 sc1
s_waitcnt vmcnt(26) lgkmcnt(0)
v_mfma_f32_16x16x32_bf16 a[192:195], v[64:67], a[40:43], a[192:195]
v_mfma_f32_16x16x32_bf16 a[196:199], v[68:71], a[40:43], a[196:199]
ds_read_b64_tr_b16 v[56:57], v34 offset:20480
ds_read_b64_tr_b16 v[58:59], v34 offset:23040
v_mfma_f32_16x16x32_bf16 a[200:203], v[72:75], a[40:43], a[200:203]
v_mfma_f32_16x16x32_bf16 a[204:207], v[76:79], a[40:43], a[204:207]
ds_read_b64_tr_b16 v[60:61], v34 offset:30720
ds_read_b64_tr_b16 v[62:63], v34 offset:33280
v_mfma_f32_16x16x32_bf16 a[8:11], v[80:83], a[40:43], a[8:11]
v_mfma_f32_16x16x32_bf16 a[208:211], v[64:67], a[88:91], a[208:211]
v_mfma_f32_16x16x32_bf16 a[212:215], v[68:71], a[88:91], a[212:215]
v_mfma_f32_16x16x32_bf16 a[216:219], v[72:75], a[88:91], a[216:219]
ds_read_b64_tr_b16 v[40:41], v34 offset:20512
ds_read_b64_tr_b16 v[42:43], v34 offset:23072
v_mfma_f32_16x16x32_bf16 a[220:223], v[76:79], a[88:91], a[220:223]
v_mfma_f32_16x16x32_bf16 a[56:59], v[80:83], a[88:91], a[56:59]
ds_read_b64_tr_b16 v[44:45], v34 offset:30752
ds_read_b64_tr_b16 v[46:47], v34 offset:33312
v_mfma_f32_16x16x32_bf16 a[224:227], v[64:67], a[136:139], a[224:227]
s_add_u32 s46, s66, 25600
s_add_u32 m0, s45, 20480
v_mfma_f32_16x16x32_bf16 a[228:231], v[68:71], a[136:139], a[228:231]
buffer_load_dwordx4 v26, s[28:31], s46 offen offset:0 sc0 sc1 lds
v_mfma_f32_16x16x32_bf16 a[232:235], v[72:75], a[136:139], a[232:235]
buffer_load_dwordx4 v26, s[28:31], s46 offen offset:1024 sc0 sc1 lds
v_mfma_f32_16x16x32_bf16 a[236:239], v[76:79], a[136:139], a[236:239]
buffer_load_dwordx4 v26, s[28:31], s46 offen offset:2048 sc0 sc1 lds
v_mfma_f32_16x16x32_bf16 a[104:107], v[80:83], a[136:139], a[104:107]
v_mfma_f32_16x16x32_bf16 a[240:243], v[64:67], a[184:187], a[240:243]
buffer_load_dwordx4 v26, s[28:31], s46 offen offset:3072 sc0 sc1 lds
v_mfma_f32_16x16x32_bf16 a[244:247], v[68:71], a[184:187], a[244:247]
s_add_u32 m0, s45, 24576
v_mfma_f32_16x16x32_bf16 a[248:251], v[72:75], a[184:187], a[248:251]
buffer_load_dwordx4 v27, s[28:31], s46 offen sc0 sc1 lds
v_mfma_f32_16x16x32_bf16 a[252:255], v[76:79], a[184:187], a[252:255]
v_mfma_f32_16x16x32_bf16 a[152:155], v[80:83], a[184:187], a[152:155]
s_waitcnt vmcnt(19) lgkmcnt(4)
v_mfma_f32_16x16x32_bf16 v[96:99], v[56:59], a[32:35], v[96:99]
ds_read_b64_tr_b16 v[48:49], v34 offset:20544
ds_read_b64_tr_b16 v[50:51], v34 offset:23104
v_mfma_f32_16x16x32_bf16 v[96:99], v[60:63], a[36:39], v[96:99]
v_cmp_ne_u32 vcc, 1, v35
s_nop 0
s_cmp_eq_u64 vcc, 0
s_cbranch_scc0 L_c_p1_spin
L_c_p1_ok:
v_mfma_f32_16x16x32_bf16 v[100:103], v[56:59], a[80:83], v[100:103]
ds_read_b64_tr_b16 v[52:53], v34 offset:30784
ds_read_b64_tr_b16 v[54:55], v34 offset:33344
v_mfma_f32_16x16x32_bf16 v[100:103], v[60:63], a[84:87], v[100:103]
v_mfma_f32_16x16x32_bf16 v[104:107], v[56:59], a[128:131], v[104:107]
s_add_u32 s47, s67, 2048
v_mfma_f32_16x16x32_bf16 v[104:107], v[60:63], a[132:135], v[104:107]
buffer_load_dwordx4 a[0:3], v28, s[32:35], s47 offen offset:0 sc0 sc1
v_mfma_f32_16x16x32_bf16 v[108:111], v[56:59], a[176:179], v[108:111]
v_mfma_f32_16x16x32_bf16 v[108:111], v[60:63], a[180:183], v[108:111]
s_waitcnt lgkmcnt(4)
v_mfma_f32_16x16x32_bf16 v[112:115], v[40:43], a[32:35], v[112:115]
ds_read_b64_tr_b16 v[56:57], v34 offset:20576
ds_read_b64_tr_b16 v[58:59], v34 offset:23136
v_mfma_f32_16x16x32_bf16 v[112:115], v[44:47], a[36:39], v[112:115]
buffer_load_dwordx4 a[4:7], v28, s[32:35], s47 offen offset:1024 sc0 sc1
v_mfma_f32_16x16x32_bf16 v[116:119], v[40:43], a[80:83], v[116:119]
ds_read_b64_tr_b16 v[60:61], v34 offset:30816
ds_read_b64_tr_b16 v[62:63], v34 offset:33376
v_mfma_f32_16x16x32_bf16 v[116:119], v[44:47], a[84:87], v[116:119]
buffer_load_dwordx4 a[48:51], v29, s[32:35], s47 offen offset:0 sc0 sc1
v_mfma_f32_16x16x32_bf16 v[120:123], v[40:43], a[128:131], v[120:123]
v_mfma_f32_16x16x32_bf16 v[120:123], v[44:47], a[132:135], v[120:123]
v_mfma_f32_16x16x32_bf16 v[124:127], v[40:43], a[176:179], v[124:127]
buffer_load_dwordx4 a[52:55], v29, s[32:35], s47 offen offset:1024 sc0 sc1
v_mfma_f32_16x16x32_bf16 v[124:127], v[44:47], a[180:183], v[124:127]
s_waitcnt lgkmcnt(4)
v_mfma_f32_16x16x32_bf16 v[128:131], v[48:51], a[32:35], v[128:131]
ds_read_b64_tr_b16 v[40:41], v34 offset:20608
ds_read_b64_tr_b16 v[42:43], v34 offset:23168
v_mfma_f32_16x16x32_bf16 v[128:131], v[52:55], a[36:39], v[128:131]
v_mfma_f32_16x16x32_bf16 v[132:135], v[48:51], a[80:83], v[132:135]
ds_read_b64_tr_b16 v[44:45], v34 offset:30848
ds_read_b64_tr_b16 v[46:47], v34 offset:33408
v_mfma_f32_16x16x32_bf16 v[132:135], v[52:55], a[84:87], v[132:135]
buffer_load_dwordx4 a[96:99], v30, s[32:35], s47 offen offset:0 sc0 sc1
v_mfma_f32_16x16x32_bf16 v[136:139], v[48:51], a[128:131], v[136:139]
v_mfma_f32_16x16x32_bf16 v[136:139], v[52:55], a[132:135], v[136:139]
buffer_load_dwordx4 a[100:103], v30, s[32:35], s47 offen offset:1024 sc0 sc1
v_mfma_f32_16x16x32_bf16 v[140:143], v[48:51], a[176:179], v[140:143]
v_mfma_f32_16x16x32_bf16 v[140:143], v[52:55], a[180:183], v[140:143]
s_waitcnt lgkmcnt(4)
v_mfma_f32_16x16x32_bf16 v[144:147], v[56:59], a[32:35], v[144:147]
ds_read_b64_tr_b16 v[48:49], v34 offset:25600
ds_read_b64_tr_b16 v[50:51], v34 offset:28160
v_mfma_f32_16x16x32_bf16 v[144:147], v[60:63], a[36:39], v[144:147]
buffer_load_dwordx4 a[144:147], v31, s[32:35], s47 offen offset:0 sc0 sc1
v_mfma_f32_16x16x32_bf16 v[148:151], v[56:59], a[80:83], v[148:151]
ds_read_b64_tr_b16 v[52:53], v34 offset:35840
ds_read_b64_tr_b16 v[54:55], v34 offset:38400
v_mfma_f32_16x16x32_bf16 v[148:151], v[60:63], a[84:87], v[148:151]
v_mfma_f32_16x16x32_bf16 v[152:155], v[56:59], a[128:131], v[152:155]
v_mfma_f32_16x16x32_bf16 v[152:155], v[60:63], a[132:135], v[152:155]
buffer_load_dwordx4 a[148:151], v31, s[32:35], s47 offen offset:1024 sc0 sc1
v_mfma_f32_16x16x32_bf16 v[156:159], v[56:59], a[176:179], v[156:159]
s_add_u32 s46, s64, 10240
s_add_u32 m0, s45, 0
v_mfma_f32_16x16x32_bf16 v[156:159], v[60:63], a[180:183], v[156:159]
s_waitcnt lgkmcnt(4)
v_mfma_f32_16x16x32_bf16 v[160:163], v[40:43], a[32:35], v[160:163]
ds_read_b64_tr_b16 v[56:57], v34 offset:25632
ds_read_b64_tr_b16 v[58:59], v34 offset:28192
v_mfma_f32_16x16x32_bf16 v[160:163], v[44:47], a[36:39], v[160:163]
buffer_load_dwordx4 v26, s[28:31], s46 offen offset:0 sc0 sc1 lds
v_mfma_f32_16x16x32_bf16 v[164:167], v[40:43], a[80:83], v[164:167]
ds_read_b64_tr_b16 v[60:61], v34 offset:35872
ds_read_b64_tr_b16 v[62:63], v34 offset:38432
v_mfma_f32_16x16x32_bf16 v[164:167], v[44:47], a[84:87], v[164:167]
v_mfma_f32_16x16x32_bf16 v[168:171], v[40:43], a[128:131], v[168:171]
buffer_load_dwordx4 v26, s[28:31], s46 offen offset:1024 sc0 sc1 lds
v_mfma_f32_16x16x32_bf16 v[168:171], v[44:47], a[132:135], v[168:171]
v_mfma_f32_16x16x32_bf16 v[172:175], v[40:43], a[176:179], v[172:175]
v_mfma_f32_16x16x32_bf16 v[172:175], v[44:47], a[180:183], v[172:175]
s_waitcnt lgkmcnt(4)
v_mfma_f32_16x16x32_bf16 v[176:179], v[48:51], a[32:35], v[176:179]
ds_read_b64_tr_b16 v[40:41], v34 offset:25664
ds_read_b64_tr_b16 v[42:43], v34 offset:28224
v_mfma_f32_16x16x32_bf16 v[176:179], v[52:55], a[36:39], v[176:179]
buffer_load_dwordx4 v26, s[28:31], s46 offen offset:2048 sc0 sc1 lds
v_mfma_f32_16x16x32_bf16 v[180:183], v[48:51], a[80:83], v[180:183]
ds_read_b64_tr_b16 v[44:45], v34 offset:35904
ds_read_b64_tr_b16 v[46:47], v34 offset:38464
v_mfma_f32_16x16x32_bf16 v[180:183], v[52:55], a[84:87], v[180:183]
buffer_load_dwordx4 v26, s[28:31], s46 offen offset:3072 sc0 sc1 lds
v_mfma_f32_16x16x32_bf16 v[184:187], v[48:51], a[128:131], v[184:187]
v_lshlrev_b32 v36, 6, v1
s_and_b32 s3, s2, 63
v_add_u32 v36, s3, v36
v_lshlrev_b32 v36, 9, v36
s_lshl_b32 s3, s25, 2
s_add_u32 s3, s3, s61
s_lshl_b32 s3, s3, 2
s_add_u32 s3, s3, 92274816
v_mov_b32 v37, 1
s_mov_b64 exec, 15
buffer_store_dword v37, v36, s[40:43], s3 offen sc0 sc1
s_mov_b64 exec, -1
v_mfma_f32_16x16x32_bf16 v[184:187], v[52:55], a[132:135], v[184:187]
s_add_u32 m0, s45, 4096
v_mfma_f32_16x16x32_bf16 v[188:191], v[48:51], a[176:179], v[188:191]
buffer_load_dwordx4 v27, s[28:31], s46 offen sc0 sc1 lds
v_mfma_f32_16x16x32_bf16 v[188:191], v[52:55], a[180:183], v[188:191]
s_waitcnt lgkmcnt(4)
v_mfma_f32_16x16x32_bf16 v[192:195], v[56:59], a[32:35], v[192:195]
ds_read_b64_tr_b16 v[48:49], v34 offset:25696
ds_read_b64_tr_b16 v[50:51], v34 offset:28256
v_mfma_f32_16x16x32_bf16 v[192:195], v[60:63], a[36:39], v[192:195]
s_add_u32 s50, s44, 5120
v_mfma_f32_16x16x32_bf16 v[196:199], v[56:59], a[80:83], v[196:199]
ds_read_b64_tr_b16 v[52:53], v34 offset:35936
ds_read_b64_tr_b16 v[54:55], v34 offset:38496
v_mfma_f32_16x16x32_bf16 v[196:199], v[60:63], a[84:87], v[196:199]
buffer_load_dwordx4 a[12:15], v88, s[32:35], s50 offen sc0 sc1
v_mfma_f32_16x16x32_bf16 v[200:203], v[56:59], a[128:131], v[200:203]
v_mfma_f32_16x16x32_bf16 v[200:203], v[60:63], a[132:135], v[200:203]
v_mfma_f32_16x16x32_bf16 v[204:207], v[56:59], a[176:179], v[204:207]
buffer_load_dwordx4 a[60:63], v89, s[32:35], s50 offen sc0 sc1
v_mfma_f32_16x16x32_bf16 v[204:207], v[60:63], a[180:183], v[204:207]
s_waitcnt lgkmcnt(4)
v_mfma_f32_16x16x32_bf16 v[208:211], v[40:43], a[32:35], v[208:211]
ds_read_b64_tr_b16 v[56:57], v34 offset:25728
ds_read_b64_tr_b16 v[58:59], v34 offset:28288
v_mfma_f32_16x16x32_bf16 v[208:211], v[44:47], a[36:39], v[208:211]
buffer_load_dwordx4 a[108:111], v90, s[32:35], s50 offen sc0 sc1
v_mfma_f32_16x16x32_bf16 v[212:215], v[40:43], a[80:83], v[212:215]
ds_read_b64_tr_b16 v[60:61], v34 offset:35968
ds_read_b64_tr_b16 v[62:63], v34 offset:38528
v_mfma_f32_16x16x32_bf16 v[212:215], v[44:47], a[84:87], v[212:215]
v_mfma_f32_16x16x32_bf16 v[216:219], v[40:43], a[128:131], v[216:219]
v_mfma_f32_16x16x32_bf16 v[216:219], v[44:47], a[132:135], v[216:219]
buffer_load_dwordx4 a[156:159], v91, s[32:35], s50 offen sc0 sc1
v_mfma_f32_16x16x32_bf16 v[220:223], v[40:43], a[176:179], v[220:223]
s_add_u32 s47, s68, 2048
v_mfma_f32_16x16x32_bf16 v[220:223], v[44:47], a[180:183], v[220:223]
s_waitcnt lgkmcnt(4)
v_mfma_f32_16x16x32_bf16 v[224:227], v[48:51], a[32:35], v[224:227]
s_waitcnt vmcnt(32) lgkmcnt(0)
s_barrier
v_mfma_f32_16x16x32_bf16 v[224:227], v[52:55], a[36:39], v[224:227]
s_waitcnt vmcnt(27)
v_mfma_f32_16x16x32_bf16 v[228:231], v[48:51], a[80:83], v[228:231]
ds_read_b64_tr_b16 v[64:65], v93 offset:20480
ds_read_b64_tr_b16 v[66:67], v93 offset:23040
v_mfma_f32_16x16x32_bf16 v[228:231], v[52:55], a[84:87], v[228:231]
buffer_load_dwordx4 a[16:19], v28, s[32:35], s47 offen offset:0 sc0 sc1
v_mfma_f32_16x16x32_bf16 v[232:235], v[48:51], a[128:131], v[232:235]
ds_read_b64_tr_b16 v[68:69], v93 offset:20512
ds_read_b64_tr_b16 v[70:71], v93 offset:23072
v_mfma_f32_16x16x32_bf16 v[232:235], v[52:55], a[132:135], v[232:235]
buffer_load_dwordx4 a[20:23], v28, s[32:35], s47 offen offset:1024 sc0 sc1
v_mfma_f32_16x16x32_bf16 v[236:239], v[48:51], a[176:179], v[236:239]
ds_read_b64_tr_b16 v[72:73], v93 offset:20544
ds_read_b64_tr_b16 v[74:75], v93 offset:23104
v_mfma_f32_16x16x32_bf16 v[236:239], v[52:55], a[180:183], v[236:239]
v_mfma_f32_16x16x32_bf16 v[240:243], v[56:59], a[32:35], v[240:243]
buffer_load_dwordx4 a[64:67], v29, s[32:35], s47 offen offset:0 sc0 sc1
v_mfma_f32_16x16x32_bf16 v[240:243], v[60:63], a[36:39], v[240:243]
ds_read_b64_tr_b16 v[76:77], v93 offset:20576
ds_read_b64_tr_b16 v[78:79], v93 offset:23136
v_mfma_f32_16x16x32_bf16 v[244:247], v[56:59], a[80:83], v[244:247]
v_mfma_f32_16x16x32_bf16 v[244:247], v[60:63], a[84:87], v[244:247]
ds_read_b64_tr_b16 v[80:81], v93 offset:20608
ds_read_b64_tr_b16 v[82:83], v93 offset:23168
v_mfma_f32_16x16x32_bf16 v[248:251], v[56:59], a[128:131], v[248:251]
buffer_load_dwordx4 a[68:71], v29, s[32:35], s47 offen offset:1024 sc0 sc1
v_mfma_f32_16x16x32_bf16 v[248:251], v[60:63], a[132:135], v[248:251]
v_mfma_f32_16x16x32_bf16 v[252:255], v[56:59], a[176:179], v[252:255]
v_mfma_f32_16x16x32_bf16 v[252:255], v[60:63], a[180:183], v[252:255]
s_waitcnt vmcnt(27) lgkmcnt(0)
v_mfma_f32_16x16x32_bf16 a[192:195], v[64:67], a[44:47], a[192:195]
v_mfma_f32_16x16x32_bf16 a[196:199], v[68:71], a[44:47], a[196:199]
ds_read_b64_tr_b16 v[40:41], v34 offset:40960
ds_read_b64_tr_b16 v[42:43], v34 offset:43520
v_mfma_f32_16x16x32_bf16 a[200:203], v[72:75], a[44:47], a[200:203]
v_mfma_f32_16x16x32_bf16 a[204:207], v[76:79], a[44:47], a[204:207]
ds_read_b64_tr_b16 v[44:45], v34 offset:51200
ds_read_b64_tr_b16 v[46:47], v34 offset:53760
v_mfma_f32_16x16x32_bf16 a[8:11], v[80:83], a[44:47], a[8:11]
v_mfma_f32_16x16x32_bf16 a[208:211], v[64:67], a[92:95], a[208:211]
v_mfma_f32_16x16x32_bf16 a[212:215], v[68:71], a[92:95], a[212:215]
v_mfma_f32_16x16x32_bf16 a[216:219], v[72:75], a[92:95], a[216:219]
ds_read_b64_tr_b16 v[48:49], v34 offset:40992
ds_read_b64_tr_b16 v[50:51], v34 offset:43552
v_mfma_f32_16x16x32_bf16 a[220:223], v[76:79], a[92:95], a[220:223]
v_mfma_f32_16x16x32_bf16 a[56:59], v[80:83], a[92:95], a[56:59]
ds_read_b64_tr_b16 v[52:53], v34 offset:51232
ds_read_b64_tr_b16 v[54:55], v34 offset:53792
v_mfma_f32_16x16x32_bf16 a[224:227], v[64:67], a[140:143], a[224:227]
buffer_load_dwordx4 a[112:115], v30, s[32:35], s47 offen offset:0 sc0 sc1
v_mfma_f32_16x16x32_bf16 a[228:231], v[68:71], a[140:143], a[228:231]
v_mfma_f32_16x16x32_bf16 a[232:235], v[72:75], a[140:143], a[232:235]
buffer_load_dwordx4 a[116:119], v30, s[32:35], s47 offen offset:1024 sc0 sc1
v_mfma_f32_16x16x32_bf16 a[236:239], v[76:79], a[140:143], a[236:239]
v_mfma_f32_16x16x32_bf16 a[104:107], v[80:83], a[140:143], a[104:107]
buffer_load_dwordx4 a[160:163], v31, s[32:35], s47 offen offset:0 sc0 sc1
v_mfma_f32_16x16x32_bf16 a[240:243], v[64:67], a[188:191], a[240:243]
v_mfma_f32_16x16x32_bf16 a[244:247], v[68:71], a[188:191], a[244:247]
buffer_load_dwordx4 a[164:167], v31, s[32:35], s47 offen offset:1024 sc0 sc1
v_mfma_f32_16x16x32_bf16 a[248:251], v[72:75], a[188:191], a[248:251]
v_mfma_f32_16x16x32_bf16 a[252:255], v[76:79], a[188:191], a[252:255]
v_mfma_f32_16x16x32_bf16 a[152:155], v[80:83], a[188:191], a[152:155]
s_waitcnt vmcnt(18) lgkmcnt(4)
v_mfma_f32_16x16x32_bf16 v[96:99], v[40:43], a[0:3], v[96:99]
ds_read_b64_tr_b16 v[56:57], v34 offset:41024
ds_read_b64_tr_b16 v[58:59], v34 offset:43584
v_mfma_f32_16x16x32_bf16 v[96:99], v[44:47], a[4:7], v[96:99]
s_add_u32 s47, s69, 2048
v_mfma_f32_16x16x32_bf16 v[100:103], v[40:43], a[48:51], v[100:103]
ds_read_b64_tr_b16 v[60:61], v34 offset:51264
ds_read_b64_tr_b16 v[62:63], v34 offset:53824
v_mfma_f32_16x16x32_bf16 v[100:103], v[44:47], a[52:55], v[100:103]
buffer_load_dwordx4 a[32:35], v28, s[32:35], s47 offen offset:0 sc0 sc1
v_mfma_f32_16x16x32_bf16 v[104:107], v[40:43], a[96:99], v[104:107]
buffer_load_dwordx4 a[36:39], v28, s[32:35], s47 offen offset:1024 sc0 sc1
v_mfma_f32_16x16x32_bf16 v[104:107], v[44:47], a[100:103], v[104:107]
v_mfma_f32_16x16x32_bf16 v[108:111], v[40:43], a[144:147], v[108:111]
v_mfma_f32_16x16x32_bf16 v[108:111], v[44:47], a[148:151], v[108:111]
s_waitcnt lgkmcnt(4)
v_mfma_f32_16x16x32_bf16 v[112:115], v[48:51], a[0:3], v[112:115]
ds_read_b64_tr_b16 v[40:41], v34 offset:41056
ds_read_b64_tr_b16 v[42:43], v34 offset:43616
v_mfma_f32_16x16x32_bf16 v[112:115], v[52:55], a[4:7], v[112:115]
buffer_load_dwordx4 a[80:83], v29, s[32:35], s47 offen offset:0 sc0 sc1
v_mfma_f32_16x16x32_bf16 v[116:119], v[48:51], a[48:51], v[116:119]
ds_read_b64_tr_b16 v[44:45], v34 offset:51296
ds_read_b64_tr_b16 v[46:47], v34 offset:53856
v_mfma_f32_16x16x32_bf16 v[116:119], v[52:55], a[52:55], v[116:119]
buffer_load_dwordx4 a[84:87], v29, s[32:35], s47 offen offset:1024 sc0 sc1
v_mfma_f32_16x16x32_bf16 v[120:123], v[48:51], a[96:99], v[120:123]
v_mfma_f32_16x16x32_bf16 v[120:123], v[52:55], a[100:103], v[120:123]
v_mfma_f32_16x16x32_bf16 v[124:127], v[48:51], a[144:147], v[124:127]
v_mfma_f32_16x16x32_bf16 v[124:127], v[52:55], a[148:151], v[124:127]
s_waitcnt lgkmcnt(4)
v_mfma_f32_16x16x32_bf16 v[128:131], v[56:59], a[0:3], v[128:131]
ds_read_b64_tr_b16 v[48:49], v34 offset:41088
ds_read_b64_tr_b16 v[50:51], v34 offset:43648
v_mfma_f32_16x16x32_bf16 v[128:131], v[60:63], a[4:7], v[128:131]
buffer_load_dwordx4 a[128:131], v30, s[32:35], s47 offen offset:0 sc0 sc1
v_mfma_f32_16x16x32_bf16 v[132:135], v[56:59], a[48:51], v[132:135]
ds_read_b64_tr_b16 v[52:53], v34 offset:51328
ds_read_b64_tr_b16 v[54:55], v34 offset:53888
v_mfma_f32_16x16x32_bf16 v[132:135], v[60:63], a[52:55], v[132:135]
buffer_load_dwordx4 a[132:135], v30, s[32:35], s47 offen offset:1024 sc0 sc1
v_mfma_f32_16x16x32_bf16 v[136:139], v[56:59], a[96:99], v[136:139]
v_mfma_f32_16x16x32_bf16 v[136:139], v[60:63], a[100:103], v[136:139]
v_mfma_f32_16x16x32_bf16 v[140:143], v[56:59], a[144:147], v[140:143]
buffer_load_dwordx4 a[176:179], v31, s[32:35], s47 offen offset:0 sc0 sc1
v_mfma_f32_16x16x32_bf16 v[140:143], v[60:63], a[148:151], v[140:143]
s_waitcnt lgkmcnt(4)
v_mfma_f32_16x16x32_bf16 v[144:147], v[40:43], a[0:3], v[144:147]
ds_read_b64_tr_b16 v[56:57], v34 offset:46080
ds_read_b64_tr_b16 v[58:59], v34 offset:48640
v_mfma_f32_16x16x32_bf16 v[144:147], v[44:47], a[4:7], v[144:147]
buffer_load_dwordx4 a[180:183], v31, s[32:35], s47 offen offset:1024 sc0 sc1
v_mfma_f32_16x16x32_bf16 v[148:151], v[40:43], a[48:51], v[148:151]
ds_read_b64_tr_b16 v[60:61], v34 offset:56320
ds_read_b64_tr_b16 v[62:63], v34 offset:58880
v_mfma_f32_16x16x32_bf16 v[148:151], v[44:47], a[52:55], v[148:151]
s_add_u32 s46, s65, 10240
s_add_u32 m0, s45, 102144
v_mfma_f32_16x16x32_bf16 v[152:155], v[40:43], a[96:99], v[152:155]
v_mfma_f32_16x16x32_bf16 v[152:155], v[44:47], a[100:103], v[152:155]
buffer_load_dwordx4 v26, s[28:31], s46 offen offset:0 sc0 sc1 lds
v_mfma_f32_16x16x32_bf16 v[156:159], v[40:43], a[144:147], v[156:159]
v_mfma_f32_16x16x32_bf16 v[156:159], v[44:47], a[148:151], v[156:159]
s_waitcnt lgkmcnt(4)
v_mfma_f32_16x16x32_bf16 v[160:163], v[48:51], a[0:3], v[160:163]
ds_read_b64_tr_b16 v[40:41], v34 offset:46112
ds_read_b64_tr_b16 v[42:43], v34 offset:48672
v_mfma_f32_16x16x32_bf16 v[160:163], v[52:55], a[4:7], v[160:163]
buffer_load_dwordx4 v26, s[28:31], s46 offen offset:1024 sc0 sc1 lds
v_mfma_f32_16x16x32_bf16 v[164:167], v[48:51], a[48:51], v[164:167]
ds_read_b64_tr_b16 v[44:45], v34 offset:56352
ds_read_b64_tr_b16 v[46:47], v34 offset:58912
v_mfma_f32_16x16x32_bf16 v[164:167], v[52:55], a[52:55], v[164:167]
v_mfma_f32_16x16x32_bf16 v[168:171], v[48:51], a[96:99], v[168:171]
buffer_load_dwordx4 v26, s[28:31], s46 offen offset:2048 sc0 sc1 lds
v_mfma_f32_16x16x32_bf16 v[168:171], v[52:55], a[100:103], v[168:171]
v_mfma_f32_16x16x32_bf16 v[172:175], v[48:51], a[144:147], v[172:175]
v_mfma_f32_16x16x32_bf16 v[172:175], v[52:55], a[148:151], v[172:175]
s_waitcnt lgkmcnt(4)
v_mfma_f32_16x16x32_bf16 v[176:179], v[56:59], a[0:3], v[176:179]
ds_read_b64_tr_b16 v[48:49], v34 offset:46144
ds_read_b64_tr_b16 v[50:51], v34 offset:48704
v_mfma_f32_16x16x32_bf16 v[176:179], v[60:63], a[4:7], v[176:179]
buffer_load_dword v35, v38, s[40:43], s51 offen offset:128 sc0 sc1
v_mfma_f32_16x16x32_bf16 v[180:183], v[56:59], a[48:51], v[180:183]
ds_read_b64_tr_b16 v[52:53], v34 offset:56384
ds_read_b64_tr_b16 v[54:55], v34 offset:58944
v_mfma_f32_16x16x32_bf16 v[180:183], v[60:63], a[52:55], v[180:183]
buffer_load_dwordx4 v26, s[28:31], s46 offen offset:3072 sc0 sc1 lds
v_mfma_f32_16x16x32_bf16 v[184:187], v[56:59], a[96:99], v[184:187]
s_add_u32 m0, s45, 106240
v_mfma_f32_16x16x32_bf16 v[184:187], v[60:63], a[100:103], v[184:187]
buffer_load_dwordx4 v27, s[28:31], s46 offen sc0 sc1 lds
v_mfma_f32_16x16x32_bf16 v[188:191], v[56:59], a[144:147], v[188:191]
s_add_u32 s46, s66, 30720
s_add_u32 m0, s45, 49152
v_mfma_f32_16x16x32_bf16 v[188:191], v[60:63], a[148:151], v[188:191]
s_waitcnt lgkmcnt(4)
v_mfma_f32_16x16x32_bf16 v[192:195], v[40:43], a[0:3], v[192:195]
ds_read_b64_tr_b16 v[56:57], v34 offset:46176
ds_read_b64_tr_b16 v[58:59], v34 offset:48736
v_mfma_f32_16x16x32_bf16 v[192:195], v[44:47], a[4:7], v[192:195]
buffer_load_dwordx4 v26, s[28:31], s46 offen offset:0 sc0 sc1 lds
v_mfma_f32_16x16x32_bf16 v[196:199], v[40:43], a[48:51], v[196:199]
ds_read_b64_tr_b16 v[60:61], v34 offset:56416
ds_read_b64_tr_b16 v[62:63], v34 offset:58976
v_mfma_f32_16x16x32_bf16 v[196:199], v[44:47], a[52:55], v[196:199]
buffer_load_dwordx4 v26, s[28:31], s46 offen offset:1024 sc0 sc1 lds
v_mfma_f32_16x16x32_bf16 v[200:203], v[40:43], a[96:99], v[200:203]
v_mfma_f32_16x16x32_bf16 v[200:203], v[44:47], a[100:103], v[200:203]
v_mfma_f32_16x16x32_bf16 v[204:207], v[40:43], a[144:147], v[204:207]
buffer_load_dwordx4 v26, s[28:31], s46 offen offset:2048 sc0 sc1 lds
v_mfma_f32_16x16x32_bf16 v[204:207], v[44:47], a[148:151], v[204:207]
s_waitcnt lgkmcnt(4)
v_mfma_f32_16x16x32_bf16 v[208:211], v[48:51], a[0:3], v[208:211]
ds_read_b64_tr_b16 v[40:41], v34 offset:46208
ds_read_b64_tr_b16 v[42:43], v34 offset:48768
v_mfma_f32_16x16x32_bf16 v[208:211], v[52:55], a[4:7], v[208:211]
buffer_load_dwordx4 v26, s[28:31], s46 offen offset:3072 sc0 sc1 lds
v_mfma_f32_16x16x32_bf16 v[212:215], v[48:51], a[48:51], v[212:215]
ds_read_b64_tr_b16 v[44:45], v34 offset:56448
ds_read_b64_tr_b16 v[46:47], v34 offset:59008
v_mfma_f32_16x16x32_bf16 v[212:215], v[52:55], a[52:55], v[212:215]
s_add_u32 m0, s45, 53248
v_mfma_f32_16x16x32_bf16 v[216:219], v[48:51], a[96:99], v[216:219]
v_mfma_f32_16x16x32_bf16 v[216:219], v[52:55], a[100:103], v[216:219]
buffer_load_dwordx4 v27, s[28:31], s46 offen sc0 sc1 lds
v_mfma_f32_16x16x32_bf16 v[220:223], v[48:51], a[144:147], v[220:223]
s_add_u32 s50, s44, 6144
v_mfma_f32_16x16x32_bf16 v[220:223], v[52:55], a[148:151], v[220:223]
s_waitcnt lgkmcnt(4)
v_mfma_f32_16x16x32_bf16 v[224:227], v[56:59], a[0:3], v[224:227]
s_waitcnt vmcnt(31) lgkmcnt(0)
s_barrier
v_mfma_f32_16x16x32_bf16 v[224:227], v[60:63], a[4:7], v[224:227]
v_mfma_f32_16x16x32_bf16 v[228:231], v[56:59], a[48:51], v[228:231]
ds_read_b64_tr_b16 v[64:65], v92 offset:20480
ds_read_b64_tr_b16 v[66:67], v92 offset:23040
v_mfma_f32_16x16x32_bf16 v[228:231], v[60:63], a[52:55], v[228:231]
buffer_load_dwordx4 a[24:27], v88, s[32:35], s50 offen sc0 sc1
v_mfma_f32_16x16x32_bf16 v[232:235], v[56:59], a[96:99], v[232:235]
ds_read_b64_tr_b16 v[68:69], v92 offset:20512
ds_read_b64_tr_b16 v[70:71], v92 offset:23072
v_mfma_f32_16x16x32_bf16 v[232:235], v[60:63], a[100:103], v[232:235]
buffer_load_dwordx4 a[72:75], v89, s[32:35], s50 offen sc0 sc1
v_mfma_f32_16x16x32_bf16 v[236:239], v[56:59], a[144:147], v[236:239]
ds_read_b64_tr_b16 v[72:73], v92 offset:20544
ds_read_b64_tr_b16 v[74:75], v92 offset:23104
v_mfma_f32_16x16x32_bf16 v[236:239], v[60:63], a[148:151], v[236:239]
v_mfma_f32_16x16x32_bf16 v[240:243], v[40:43], a[0:3], v[240:243]
buffer_load_dwordx4 a[120:123], v90, s[32:35], s50 offen sc0 sc1
v_mfma_f32_16x16x32_bf16 v[240:243], v[44:47], a[4:7], v[240:243]
ds_read_b64_tr_b16 v[76:77], v92 offset:20576
ds_read_b64_tr_b16 v[78:79], v92 offset:23136
v_mfma_f32_16x16x32_bf16 v[244:247], v[40:43], a[48:51], v[244:247]
v_mfma_f32_16x16x32_bf16 v[244:247], v[44:47], a[52:55], v[244:247]
ds_read_b64_tr_b16 v[80:81], v92 offset:20608
ds_read_b64_tr_b16 v[82:83], v92 offset:23168
v_mfma_f32_16x16x32_bf16 v[248:251], v[40:43], a[96:99], v[248:251]
buffer_load_dwordx4 a[168:171], v91, s[32:35], s50 offen sc0 sc1
v_mfma_f32_16x16x32_bf16 v[248:251], v[44:47], a[100:103], v[248:251]
v_mfma_f32_16x16x32_bf16 v[252:255], v[40:43], a[144:147], v[252:255]
v_mfma_f32_16x16x32_bf16 v[252:255], v[44:47], a[148:151], v[252:255]
s_waitcnt vmcnt(31) lgkmcnt(0)
v_mfma_f32_16x16x32_bf16 a[192:195], v[64:67], a[12:15], a[192:195]
v_mfma_f32_16x16x32_bf16 a[196:199], v[68:71], a[12:15], a[196:199]
ds_read_b64_tr_b16 v[48:49], v32 offset:0
ds_read_b64_tr_b16 v[50:51], v32 offset:2560
v_mfma_f32_16x16x32_bf16 a[200:203], v[72:75], a[12:15], a[200:203]
v_mfma_f32_16x16x32_bf16 a[204:207], v[76:79], a[12:15], a[204:207]
ds_read_b64_tr_b16 v[52:53], v32 offset:10240
ds_read_b64_tr_b16 v[54:55], v32 offset:12800
v_mfma_f32_16x16x32_bf16 a[8:11], v[80:83], a[12:15], a[8:11]
v_mfma_f32_16x16x32_bf16 a[208:211], v[64:67], a[60:63], a[208:211]
v_mfma_f32_16x16x32_bf16 a[212:215], v[68:71], a[60:63], a[212:215]
v_mfma_f32_16x16x32_bf16 a[216:219], v[72:75], a[60:63], a[216:219]
ds_read_b64_tr_b16 v[56:57], v32 offset:32
ds_read_b64_tr_b16 v[58:59], v32 offset:2592
v_mfma_f32_16x16x32_bf16 a[220:223], v[76:79], a[60:63], a[220:223]
v_mfma_f32_16x16x32_bf16 a[56:59], v[80:83], a[60:63], a[56:59]
ds_read_b64_tr_b16 v[60:61], v32 offset:10272
ds_read_b64_tr_b16 v[62:63], v32 offset:12832
v_mfma_f32_16x16x32_bf16 a[224:227], v[64:67], a[108:111], a[224:227]
s_add_u32 s46, s66, 35840
s_add_u32 m0, s45, 69632
v_mfma_f32_16x16x32_bf16 a[228:231], v[68:71], a[108:111], a[228:231]
buffer_load_dwordx4 v26, s[28:31], s46 offen offset:0 sc0 sc1 lds
v_mfma_f32_16x16x32_bf16 a[232:235], v[72:75], a[108:111], a[232:235]
buffer_load_dwordx4 v26, s[28:31], s46 offen offset:1024 sc0 sc1 lds
v_mfma_f32_16x16x32_bf16 a[236:239], v[76:79], a[108:111], a[236:239]
buffer_load_dwordx4 v26, s[28:31], s46 offen offset:2048 sc0 sc1 lds
v_mfma_f32_16x16x32_bf16 a[104:107], v[80:83], a[108:111], a[104:107]
v_mfma_f32_16x16x32_bf16 a[240:243], v[64:67], a[156:159], a[240:243]
buffer_load_dwordx4 v26, s[28:31], s46 offen offset:3072 sc0 sc1 lds
v_mfma_f32_16x16x32_bf16 a[244:247], v[68:71], a[156:159], a[244:247]
s_add_u32 m0, s45, 73728
v_mfma_f32_16x16x32_bf16 a[248:251], v[72:75], a[156:159], a[248:251]
buffer_load_dwordx4 v27, s[28:31], s46 offen sc0 sc1 lds
v_mfma_f32_16x16x32_bf16 a[252:255], v[76:79], a[156:159], a[252:255]
v_mfma_f32_16x16x32_bf16 a[152:155], v[80:83], a[156:159], a[152:155]
s_waitcnt vmcnt(28) lgkmcnt(4)
v_mfma_f32_16x16x32_bf16 v[96:99], v[48:51], a[16:19], v[96:99]
ds_read_b64_tr_b16 v[40:41], v32 offset:64
ds_read_b64_tr_b16 v[42:43], v32 offset:2624
v_mfma_f32_16x16x32_bf16 v[96:99], v[52:55], a[20:23], v[96:99]
s_waitcnt vmcnt(16)
v_cmp_ne_u32 vcc, 1, v35
s_nop 0
s_cmp_eq_u64 vcc, 0
s_cbranch_scc0 L_c_p2_spin
L_c_p2_ok:
v_mfma_f32_16x16x32_bf16 v[100:103], v[48:51], a[64:67], v[100:103]
ds_read_b64_tr_b16 v[44:45], v32 offset:10304
ds_read_b64_tr_b16 v[46:47], v32 offset:12864
v_mfma_f32_16x16x32_bf16 v[100:103], v[52:55], a[68:71], v[100:103]
v_mfma_f32_16x16x32_bf16 v[104:107], v[48:51], a[112:115], v[104:107]
s_add_u32 s47, s67, 4096
v_mfma_f32_16x16x32_bf16 v[104:107], v[52:55], a[116:119], v[104:107]
buffer_load_dwordx4 a[0:3], v28, s[32:35], s47 offen offset:0 sc0 sc1
v_mfma_f32_16x16x32_bf16 v[108:111], v[48:51], a[160:163], v[108:111]
v_mfma_f32_16x16x32_bf16 v[108:111], v[52:55], a[164:167], v[108:111]
s_waitcnt lgkmcnt(4)
v_mfma_f32_16x16x32_bf16 v[112:115], v[56:59], a[16:19], v[112:115]
ds_read_b64_tr_b16 v[48:49], v32 offset:96
ds_read_b64_tr_b16 v[50:51], v32 offset:2656
v_mfma_f32_16x16x32_bf16 v[112:115], v[60:63], a[20:23], v[112:115]
buffer_load_dwordx4 a[4:7], v28, s[32:35], s47 offen offset:1024 sc0 sc1
v_mfma_f32_16x16x32_bf16 v[116:119], v[56:59], a[64:67], v[116:119]
ds_read_b64_tr_b16 v[52:53], v32 offset:10336
ds_read_b64_tr_b16 v[54:55], v32 offset:12896
v_mfma_f32_16x16x32_bf16 v[116:119], v[60:63], a[68:71], v[116:119]
v_mfma_f32_16x16x32_bf16 v[120:123], v[56:59], a[112:115], v[120:123]
buffer_load_dwordx4 a[48:51], v29, s[32:35], s47 offen offset:0 sc0 sc1
v_mfma_f32_16x16x32_bf16 v[120:123], v[60:63], a[116:119], v[120:123]
v_mfma_f32_16x16x32_bf16 v[124:127], v[56:59], a[160:163], v[124:127]
v_mfma_f32_16x16x32_bf16 v[124:127], v[60:63], a[164:167], v[124:127]
s_waitcnt lgkmcnt(4)
v_mfma_f32_16x16x32_bf16 v[128:131], v[40:43], a[16:19], v[128:131]
ds_read_b64_tr_b16 v[56:57], v32 offset:128
ds_read_b64_tr_b16 v[58:59], v32 offset:2688
v_mfma_f32_16x16x32_bf16 v[128:131], v[44:47], a[20:23], v[128:131]
buffer_load_dwordx4 a[52:55], v29, s[32:35], s47 offen offset:1024 sc0 sc1
v_mfma_f32_16x16x32_bf16 v[132:135], v[40:43], a[64:67], v[132:135]
ds_read_b64_tr_b16 v[60:61], v32 offset:10368
ds_read_b64_tr_b16 v[62:63], v32 offset:12928
v_mfma_f32_16x16x32_bf16 v[132:135], v[44:47], a[68:71], v[132:135]
v_mfma_f32_16x16x32_bf16 v[136:139], v[40:43], a[112:115], v[136:139]
buffer_load_dwordx4 a[96:99], v30, s[32:35], s47 offen offset:0 sc0 sc1
v_mfma_f32_16x16x32_bf16 v[136:139], v[44:47], a[116:119], v[136:139]
v_mfma_f32_16x16x32_bf16 v[140:143], v[40:43], a[160:163], v[140:143]
v_mfma_f32_16x16x32_bf16 v[140:143], v[44:47], a[164:167], v[140:143]
s_waitcnt lgkmcnt(4)
v_mfma_f32_16x16x32_bf16 v[144:147], v[48:51], a[16:19], v[144:147]
ds_read_b64_tr_b16 v[40:41], v32 offset:5120
ds_read_b64_tr_b16 v[42:43], v32 offset:7680
v_mfma_f32_16x16x32_bf16 v[144:147], v[52:55], a[20:23], v[144:147]
buffer_load_dwordx4 a[100:103], v30, s[32:35], s47 offen offset:1024 sc0 sc1
v_mfma_f32_16x16x32_bf16 v[148:151], v[48:51], a[64:67], v[148:151]
ds_read_b64_tr_b16 v[44:45], v32 offset:15360
ds_read_b64_tr_b16 v[46:47], v32 offset:17920
v_mfma_f32_16x16x32_bf16 v[148:151], v[52:55], a[68:71], v[148:151]
v_mfma_f32_16x16x32_bf16 v[152:155], v[48:51], a[112:115], v[152:155]
v_mfma_f32_16x16x32_bf16 v[152:155], v[52:55], a[116:119], v[152:155]
buffer_load_dwordx4 a[144:147], v31, s[32:35], s47 offen offset:0 sc0 sc1
v_mfma_f32_16x16x32_bf16 v[156:159], v[48:51], a[160:163], v[156:159]
v_mfma_f32_16x16x32_bf16 v[156:159], v[52:55], a[164:167], v[156:159]
s_waitcnt lgkmcnt(4)
v_mfma_f32_16x16x32_bf16 v[160:163], v[56:59], a[16:19], v[160:163]
ds_read_b64_tr_b16 v[48:49], v32 offset:5152
ds_read_b64_tr_b16 v[50:51], v32 offset:7712
v_mfma_f32_16x16x32_bf16 v[160:163], v[60:63], a[20:23], v[160:163]
buffer_load_dwordx4 a[148:151], v31, s[32:35], s47 offen offset:1024 sc0 sc1
v_mfma_f32_16x16x32_bf16 v[164:167], v[56:59], a[64:67], v[164:167]
ds_read_b64_tr_b16 v[52:53], v32 offset:15392
ds_read_b64_tr_b16 v[54:55], v32 offset:17952
v_mfma_f32_16x16x32_bf16 v[164:167], v[60:63], a[68:71], v[164:167]
s_add_u32 s46, s63, 20480
s_add_u32 m0, s45, 122624
v_mfma_f32_16x16x32_bf16 v[168:171], v[56:59], a[112:115], v[168:171]
v_mfma_f32_16x16x32_bf16 v[168:171], v[60:63], a[116:119], v[168:171]
buffer_load_dwordx4 v26, s[28:31], s46 offen offset:0 sc0 sc1 lds
v_mfma_f32_16x16x32_bf16 v[172:175], v[56:59], a[160:163], v[172:175]
v_mfma_f32_16x16x32_bf16 v[172:175], v[60:63], a[164:167], v[172:175]
s_waitcnt lgkmcnt(4)
v_mfma_f32_16x16x32_bf16 v[176:179], v[40:43], a[16:19], v[176:179]
ds_read_b64_tr_b16 v[56:57], v32 offset:5184
ds_read_b64_tr_b16 v[58:59], v32 offset:7744
v_mfma_f32_16x16x32_bf16 v[176:179], v[44:47], a[20:23], v[176:179]
buffer_load_dwordx4 v26, s[28:31], s46 offen offset:1024 sc0 sc1 lds
v_mfma_f32_16x16x32_bf16 v[180:183], v[40:43], a[64:67], v[180:183]
ds_read_b64_tr_b16 v[60:61], v32 offset:15424
ds_read_b64_tr_b16 v[62:63], v32 offset:17984
v_mfma_f32_16x16x32_bf16 v[180:183], v[44:47], a[68:71], v[180:183]
v_mfma_f32_16x16x32_bf16 v[184:187], v[40:43], a[112:115], v[184:187]
v_mfma_f32_16x16x32_bf16 v[184:187], v[44:47], a[116:119], v[184:187]
buffer_load_dwordx4 v26, s[28:31], s46 offen offset:2048 sc0 sc1 lds
v_mfma_f32_16x16x32_bf16 v[188:191], v[40:43], a[160:163], v[188:191]
v_mfma_f32_16x16x32_bf16 v[188:191], v[44:47], a[164:167], v[188:191]
s_waitcnt lgkmcnt(4)
v_mfma_f32_16x16x32_bf16 v[192:195], v[48:51], a[16:19], v[192:195]
ds_read_b64_tr_b16 v[40:41], v32 offset:5216
ds_read_b64_tr_b16 v[42:43], v32 offset:7776
v_mfma_f32_16x16x32_bf16 v[192:195], v[52:55], a[20:23], v[192:195]
buffer_load_dwordx4 v26, s[28:31], s46 offen offset:3072 sc0 sc1 lds
v_mfma_f32_16x16x32_bf16 v[196:199], v[48:51], a[64:67], v[196:199]
ds_read_b64_tr_b16 v[44:45], v32 offset:15456
ds_read_b64_tr_b16 v[46:47], v32 offset:18016
v_mfma_f32_16x16x32_bf16 v[196:199], v[52:55], a[68:71], v[196:199]
v_mfma_f32_16x16x32_bf16 v[200:203], v[48:51], a[112:115], v[200:203]
s_add_u32 m0, s45, 126720
v_mfma_f32_16x16x32_bf16 v[200:203], v[52:55], a[116:119], v[200:203]
v_mfma_f32_16x16x32_bf16 v[204:207], v[48:51], a[160:163], v[204:207]
buffer_load_dwordx4 v27, s[28:31], s46 offen sc0 sc1 lds
v_mfma_f32_16x16x32_bf16 v[204:207], v[52:55], a[164:167], v[204:207]
s_waitcnt lgkmcnt(4)
v_mfma_f32_16x16x32_bf16 v[208:211], v[56:59], a[16:19], v[208:211]
ds_read_b64_tr_b16 v[48:49], v32 offset:5248
ds_read_b64_tr_b16 v[50:51], v32 offset:7808
v_mfma_f32_16x16x32_bf16 v[208:211], v[60:63], a[20:23], v[208:211]
s_add_u32 s46, s64, 20480
s_add_u32 m0, s45, 143104
v_mfma_f32_16x16x32_bf16 v[212:215], v[56:59], a[64:67], v[212:215]
ds_read_b64_tr_b16 v[52:53], v32 offset:15488
ds_read_b64_tr_b16 v[54:55], v32 offset:18048
v_mfma_f32_16x16x32_bf16 v[212:215], v[60:63], a[68:71], v[212:215]
buffer_load_dwordx4 v26, s[28:31], s46 offen offset:0 sc0 sc1 lds
v_mfma_f32_16x16x32_bf16 v[216:219], v[56:59], a[112:115], v[216:219]
v_mfma_f32_16x16x32_bf16 v[216:219], v[60:63], a[116:119], v[216:219]
v_mfma_f32_16x16x32_bf16 v[220:223], v[56:59], a[160:163], v[220:223]
buffer_load_dwordx4 v26, s[28:31], s46 offen offset:1024 sc0 sc1 lds
v_mfma_f32_16x16x32_bf16 v[220:223], v[60:63], a[164:167], v[220:223]
s_waitcnt lgkmcnt(4)
v_mfma_f32_16x16x32_bf16 v[224:227], v[40:43], a[16:19], v[224:227]
s_waitcnt vmcnt(29) lgkmcnt(0)
s_barrier
v_mfma_f32_16x16x32_bf16 v[224:227], v[44:47], a[20:23], v[224:227]
s_waitcnt vmcnt(24)
v_mfma_f32_16x16x32_bf16 v[228:231], v[40:43], a[64:67], v[228:231]
ds_read_b64_tr_b16 v[64:65], v93 offset:0
ds_read_b64_tr_b16 v[66:67], v93 offset:2560
v_mfma_f32_16x16x32_bf16 v[228:231], v[44:47], a[68:71], v[228:231]
buffer_load_dwordx4 v26, s[28:31], s46 offen offset:2048 sc0 sc1 lds
v_mfma_f32_16x16x32_bf16 v[232:235], v[40:43], a[112:115], v[232:235]
ds_read_b64_tr_b16 v[68:69], v93 offset:32
ds_read_b64_tr_b16 v[70:71], v93 offset:2592
v_mfma_f32_16x16x32_bf16 v[232:235], v[44:47], a[116:119], v[232:235]
v_mfma_f32_16x16x32_bf16 v[236:239], v[40:43], a[160:163], v[236:239]
ds_read_b64_tr_b16 v[72:73], v93 offset:64
ds_read_b64_tr_b16 v[74:75], v93 offset:2624
v_mfma_f32_16x16x32_bf16 v[236:239], v[44:47], a[164:167], v[236:239]
v_mfma_f32_16x16x32_bf16 v[240:243], v[48:51], a[16:19], v[240:243]
buffer_load_dwordx4 v26, s[28:31], s46 offen offset:3072 sc0 sc1 lds
v_mfma_f32_16x16x32_bf16 v[240:243], v[52:55], a[20:23], v[240:243]
ds_read_b64_tr_b16 v[76:77], v93 offset:96
ds_read_b64_tr_b16 v[78:79], v93 offset:2656
v_mfma_f32_16x16x32_bf16 v[244:247], v[48:51], a[64:67], v[244:247]
s_add_u32 m0, s45, 147200
v_mfma_f32_16x16x32_bf16 v[244:247], v[52:55], a[68:71], v[244:247]
ds_read_b64_tr_b16 v[80:81], v93 offset:128
ds_read_b64_tr_b16 v[82:83], v93 offset:2688
v_mfma_f32_16x16x32_bf16 v[248:251], v[48:51], a[112:115], v[248:251]
buffer_load_dwordx4 v27, s[28:31], s46 offen sc0 sc1 lds
v_mfma_f32_16x16x32_bf16 v[248:251], v[52:55], a[116:119], v[248:251]
v_mfma_f32_16x16x32_bf16 v[252:255], v[48:51], a[160:163], v[252:255]
v_mfma_f32_16x16x32_bf16 v[252:255], v[52:55], a[164:167], v[252:255]
s_waitcnt vmcnt(23) lgkmcnt(0)
v_mfma_f32_16x16x32_bf16 a[192:195], v[64:67], a[24:27], a[192:195]
v_mfma_f32_16x16x32_bf16 a[196:199], v[68:71], a[24:27], a[196:199]
ds_read_b64_tr_b16 v[56:57], v34 offset:0
ds_read_b64_tr_b16 v[58:59], v34 offset:2560
v_mfma_f32_16x16x32_bf16 a[200:203], v[72:75], a[24:27], a[200:203]
v_mfma_f32_16x16x32_bf16 a[204:207], v[76:79], a[24:27], a[204:207]
ds_read_b64_tr_b16 v[60:61], v34 offset:10240
ds_read_b64_tr_b16 v[62:63], v34 offset:12800
v_mfma_f32_16x16x32_bf16 a[8:11], v[80:83], a[24:27], a[8:11]
v_mfma_f32_16x16x32_bf16 a[208:211], v[64:67], a[72:75], a[208:211]
v_mfma_f32_16x16x32_bf16 a[212:215], v[68:71], a[72:75], a[212:215]
v_mfma_f32_16x16x32_bf16 a[216:219], v[72:75], a[72:75], a[216:219]
ds_read_b64_tr_b16 v[40:41], v34 offset:32
ds_read_b64_tr_b16 v[42:43], v34 offset:2592
v_mfma_f32_16x16x32_bf16 a[220:223], v[76:79], a[72:75], a[220:223]
v_mfma_f32_16x16x32_bf16 a[56:59], v[80:83], a[72:75], a[56:59]
ds_read_b64_tr_b16 v[44:45], v34 offset:10272
ds_read_b64_tr_b16 v[46:47], v34 offset:12832
v_mfma_f32_16x16x32_bf16 a[224:227], v[64:67], a[120:123], a[224:227]
s_add_u32 s50, s44, 7168
v_mfma_f32_16x16x32_bf16 a[228:231], v[68:71], a[120:123], a[228:231]
buffer_load_dwordx4 a[28:31], v88, s[32:35], s50 offen sc0 sc1
v_mfma_f32_16x16x32_bf16 a[232:235], v[72:75], a[120:123], a[232:235]
buffer_load_dwordx4 a[76:79], v89, s[32:35], s50 offen sc0 sc1
v_mfma_f32_16x16x32_bf16 a[236:239], v[76:79], a[120:123], a[236:239]
v_mfma_f32_16x16x32_bf16 a[104:107], v[80:83], a[120:123], a[104:107]
buffer_load_dwordx4 a[124:127], v90, s[32:35], s50 offen sc0 sc1
v_mfma_f32_16x16x32_bf16 a[240:243], v[64:67], a[168:171], a[240:243]
v_mfma_f32_16x16x32_bf16 a[244:247], v[68:71], a[168:171], a[244:247]
buffer_load_dwordx4 a[172:175], v91, s[32:35], s50 offen sc0 sc1
v_mfma_f32_16x16x32_bf16 a[248:251], v[72:75], a[168:171], a[248:251]
v_mfma_f32_16x16x32_bf16 a[252:255], v[76:79], a[168:171], a[252:255]
v_mfma_f32_16x16x32_bf16 a[152:155], v[80:83], a[168:171], a[152:155]
s_waitcnt lgkmcnt(4)
v_mfma_f32_16x16x32_bf16 v[96:99], v[56:59], a[32:35], v[96:99]
ds_read_b64_tr_b16 v[48:49], v34 offset:64
ds_read_b64_tr_b16 v[50:51], v34 offset:2624
v_mfma_f32_16x16x32_bf16 v[96:99], v[60:63], a[36:39], v[96:99]
s_add_u32 s47, s68, 4096
v_mfma_f32_16x16x32_bf16 v[100:103], v[56:59], a[80:83], v[100:103]
ds_read_b64_tr_b16 v[52:53], v34 offset:10304
ds_read_b64_tr_b16 v[54:55], v34 offset:12864
v_mfma_f32_16x16x32_bf16 v[100:103], v[60:63], a[84:87], v[100:103]
buffer_load_dwordx4 a[16:19], v28, s[32:35], s47 offen offset:0 sc0 sc1
v_mfma_f32_16x16x32_bf16 v[104:107], v[56:59], a[128:131], v[104:107]
buffer_load_dwordx4 a[20:23], v28, s[32:35], s47 offen offset:1024 sc0 sc1
v_mfma_f32_16x16x32_bf16 v[104:107], v[60:63], a[132:135], v[104:107]
v_mfma_f32_16x16x32_bf16 v[108:111], v[56:59], a[176:179], v[108:111]
v_mfma_f32_16x16x32_bf16 v[108:111], v[60:63], a[180:183], v[108:111]
s_waitcnt lgkmcnt(4)
v_mfma_f32_16x16x32_bf16 v[112:115], v[40:43], a[32:35], v[112:115]
ds_read_b64_tr_b16 v[56:57], v34 offset:96
ds_read_b64_tr_b16 v[58:59], v34 offset:2656
v_mfma_f32_16x16x32_bf16 v[112:115], v[44:47], a[36:39], v[112:115]
buffer_load_dwordx4 a[64:67], v29, s[32:35], s47 offen offset:0 sc0 sc1
v_mfma_f32_16x16x32_bf16 v[116:119], v[40:43], a[80:83], v[116:119]
ds_read_b64_tr_b16 v[60:61], v34 offset:10336
ds_read_b64_tr_b16 v[62:63], v34 offset:12896
v_mfma_f32_16x16x32_bf16 v[116:119], v[44:47], a[84:87], v[116:119]
buffer_load_dwordx4 a[68:71], v29, s[32:35], s47 offen offset:1024 sc0 sc1
v_mfma_f32_16x16x32_bf16 v[120:123], v[40:43], a[128:131], v[120:123]
v_mfma_f32_16x16x32_bf16 v[120:123], v[44:47], a[132:135], v[120:123]
v_mfma_f32_16x16x32_bf16 v[124:127], v[40:43], a[176:179], v[124:127]
v_mfma_f32_16x16x32_bf16 v[124:127], v[44:47], a[180:183], v[124:127]
s_waitcnt lgkmcnt(4)
v_mfma_f32_16x16x32_bf16 v[128:131], v[48:51], a[32:35], v[128:131]
ds_read_b64_tr_b16 v[40:41], v34 offset:128
ds_read_b64_tr_b16 v[42:43], v34 offset:2688
v_mfma_f32_16x16x32_bf16 v[128:131], v[52:55], a[36:39], v[128:131]
buffer_load_dwordx4 a[112:115], v30, s[32:35], s47 offen offset:0 sc0 sc1
v_mfma_f32_16x16x32_bf16 v[132:135], v[48:51], a[80:83], v[132:135]
ds_read_b64_tr_b16 v[44:45], v34 offset:10368
ds_read_b64_tr_b16 v[46:47], v34 offset:12928
v_mfma_f32_16x16x32_bf16 v[132:135], v[52:55], a[84:87], v[132:135]
buffer_load_dwordx4 a[116:119], v30, s[32:35], s47 offen offset:1024 sc0 sc1
v_mfma_f32_16x16x32_bf16 v[136:139], v[48:51], a[128:131], v[136:139]
v_mfma_f32_16x16x32_bf16 v[136:139], v[52:55], a[132:135], v[136:139]
v_mfma_f32_16x16x32_bf16 v[140:143], v[48:51], a[176:179], v[140:143]
buffer_load_dwordx4 a[160:163], v31, s[32:35], s47 offen offset:0 sc0 sc1
v_mfma_f32_16x16x32_bf16 v[140:143], v[52:55], a[180:183], v[140:143]
s_waitcnt lgkmcnt(4)
v_mfma_f32_16x16x32_bf16 v[144:147], v[56:59], a[32:35], v[144:147]
ds_read_b64_tr_b16 v[48:49], v34 offset:5120
ds_read_b64_tr_b16 v[50:51], v34 offset:7680
v_mfma_f32_16x16x32_bf16 v[144:147], v[60:63], a[36:39], v[144:147]
buffer_load_dwordx4 a[164:167], v31, s[32:35], s47 offen offset:1024 sc0 sc1
v_mfma_f32_16x16x32_bf16 v[148:151], v[56:59], a[80:83], v[148:151]
ds_read_b64_tr_b16 v[52:53], v34 offset:15360
ds_read_b64_tr_b16 v[54:55], v34 offset:17920
v_mfma_f32_16x16x32_bf16 v[148:151], v[60:63], a[84:87], v[148:151]
s_add_u32 s46, s65, 20480
s_add_u32 m0, s45, 0
v_mfma_f32_16x16x32_bf16 v[152:155], v[56:59], a[128:131], v[152:155]
v_mfma_f32_16x16x32_bf16 v[152:155], v[60:63], a[132:135], v[152:155]
buffer_load_dwordx4 v26, s[28:31], s46 offen offset:0 sc0 sc1 lds
v_mfma_f32_16x16x32_bf16 v[156:159], v[56:59], a[176:179], v[156:159]
v_mfma_f32_16x16x32_bf16 v[156:159], v[60:63], a[180:183], v[156:159]
s_waitcnt lgkmcnt(4)
v_mfma_f32_16x16x32_bf16 v[160:163], v[40:43], a[32:35], v[160:163]
ds_read_b64_tr_b16 v[56:57], v34 offset:5152
ds_read_b64_tr_b16 v[58:59], v34 offset:7712
v_mfma_f32_16x16x32_bf16 v[160:163], v[44:47], a[36:39], v[160:163]
buffer_load_dwordx4 v26, s[28:31], s46 offen offset:1024 sc0 sc1 lds
v_mfma_f32_16x16x32_bf16 v[164:167], v[40:43], a[80:83], v[164:167]
ds_read_b64_tr_b16 v[60:61], v34 offset:15392
ds_read_b64_tr_b16 v[62:63], v34 offset:17952
v_mfma_f32_16x16x32_bf16 v[164:167], v[44:47], a[84:87], v[164:167]
v_mfma_f32_16x16x32_bf16 v[168:171], v[40:43], a[128:131], v[168:171]
buffer_load_dwordx4 v26, s[28:31], s46 offen offset:2048 sc0 sc1 lds
v_mfma_f32_16x16x32_bf16 v[168:171], v[44:47], a[132:135], v[168:171]
v_mfma_f32_16x16x32_bf16 v[172:175], v[40:43], a[176:179], v[172:175]
v_mfma_f32_16x16x32_bf16 v[172:175], v[44:47], a[180:183], v[172:175]
s_waitcnt lgkmcnt(4)
v_mfma_f32_16x16x32_bf16 v[176:179], v[48:51], a[32:35], v[176:179]
ds_read_b64_tr_b16 v[40:41], v34 offset:5184
ds_read_b64_tr_b16 v[42:43], v34 offset:7744
v_mfma_f32_16x16x32_bf16 v[176:179], v[52:55], a[36:39], v[176:179]
buffer_load_dwordx4 v26, s[28:31], s46 offen offset:3072 sc0 sc1 lds
v_mfma_f32_16x16x32_bf16 v[180:183], v[48:51], a[80:83], v[180:183]
ds_read_b64_tr_b16 v[44:45], v34 offset:15424
ds_read_b64_tr_b16 v[46:47], v34 offset:17984
v_mfma_f32_16x16x32_bf16 v[180:183], v[52:55], a[84:87], v[180:183]
s_add_u32 m0, s45, 4096
v_mfma_f32_16x16x32_bf16 v[184:187], v[48:51], a[128:131], v[184:187]
buffer_load_dwordx4 v27, s[28:31], s46 offen sc0 sc1 lds
v_mfma_f32_16x16x32_bf16 v[184:187], v[52:55], a[132:135], v[184:187]
s_add_u32 s46, s66, 40960
s_add_u32 m0, s45, 20480
v_mfma_f32_16x16x32_bf16 v[188:191], v[48:51], a[176:179], v[188:191]
v_mfma_f32_16x16x32_bf16 v[188:191], v[52:55], a[180:183], v[188:191]
s_waitcnt lgkmcnt(4)
v_mfma_f32_16x16x32_bf16 v[192:195], v[56:59], a[32:35], v[192:195]
ds_read_b64_tr_b16 v[48:49], v34 offset:5216
ds_read_b64_tr_b16 v[50:51], v34 offset:7776
v_mfma_f32_16x16x32_bf16 v[192:195], v[60:63], a[36:39], v[192:195]
buffer_load_dwordx4 v26, s[28:31], s46 offen offset:0 sc0 sc1 lds
v_mfma_f32_16x16x32_bf16 v[196:199], v[56:59], a[80:83], v[196:199]
ds_read_b64_tr_b16 v[52:53], v34 offset:15456
ds_read_b64_tr_b16 v[54:55], v34 offset:18016
v_mfma_f32_16x16x32_bf16 v[196:199], v[60:63], a[84:87], v[196:199]
buffer_load_dwordx4 v26, s[28:31], s46 offen offset:1024 sc0 sc1 lds
v_mfma_f32_16x16x32_bf16 v[200:203], v[56:59], a[128:131], v[200:203]
v_mfma_f32_16x16x32_bf16 v[200:203], v[60:63], a[132:135], v[200:203]
v_mfma_f32_16x16x32_bf16 v[204:207], v[56:59], a[176:179], v[204:207]
buffer_load_dwordx4 v26, s[28:31], s46 offen offset:2048 sc0 sc1 lds
v_mfma_f32_16x16x32_bf16 v[204:207], v[60:63], a[180:183], v[204:207]
s_waitcnt lgkmcnt(4)
v_mfma_f32_16x16x32_bf16 v[208:211], v[40:43], a[32:35], v[208:211]
ds_read_b64_tr_b16 v[56:57], v34 offset:5248
ds_read_b64_tr_b16 v[58:59], v34 offset:7808
v_mfma_f32_16x16x32_bf16 v[208:211], v[44:47], a[36:39], v[208:211]
buffer_load_dwordx4 v26, s[28:31], s46 offen offset:3072 sc0 sc1 lds
v_mfma_f32_16x16x32_bf16 v[212:215], v[40:43], a[80:83], v[212:215]
ds_read_b64_tr_b16 v[60:61], v34 offset:15488
ds_read_b64_tr_b16 v[62:63], v34 offset:18048
v_mfma_f32_16x16x32_bf16 v[212:215], v[44:47], a[84:87], v[212:215]
s_add_u32 m0, s45, 24576
v_mfma_f32_16x16x32_bf16 v[216:219], v[40:43], a[128:131], v[216:219]
v_mfma_f32_16x16x32_bf16 v[216:219], v[44:47], a[132:135], v[216:219]
buffer_load_dwordx4 v27, s[28:31], s46 offen sc0 sc1 lds
v_mfma_f32_16x16x32_bf16 v[220:223], v[40:43], a[176:179], v[220:223]
s_add_u32 s50, s44, 8192
v_mfma_f32_16x16x32_bf16 v[220:223], v[44:47], a[180:183], v[220:223]
s_waitcnt lgkmcnt(4)
v_mfma_f32_16x16x32_bf16 v[224:227], v[48:51], a[32:35], v[224:227]
s_waitcnt vmcnt(27) lgkmcnt(0)
s_barrier
v_mfma_f32_16x16x32_bf16 v[224:227], v[52:55], a[36:39], v[224:227]
ds_read_b64_tr_b16 v[40:41], v34 offset:20480
ds_read_b64_tr_b16 v[42:43], v34 offset:23040
v_mfma_f32_16x16x32_bf16 v[228:231], v[48:51], a[80:83], v[228:231]
buffer_load_dwordx4 a[40:43], v88, s[32:35], s50 offen sc0 sc1
v_mfma_f32_16x16x32_bf16 v[228:231], v[52:55], a[84:87], v[228:231]
ds_read_b64_tr_b16 v[44:45], v34 offset:30720
ds_read_b64_tr_b16 v[46:47], v34 offset:33280
v_mfma_f32_16x16x32_bf16 v[232:235], v[48:51], a[128:131], v[232:235]
buffer_load_dwordx4 a[88:91], v89, s[32:35], s50 offen sc0 sc1
v_mfma_f32_16x16x32_bf16 v[232:235], v[52:55], a[132:135], v[232:235]
v_mfma_f32_16x16x32_bf16 v[236:239], v[48:51], a[176:179], v[236:239]
v_mfma_f32_16x16x32_bf16 v[236:239], v[52:55], a[180:183], v[236:239]
v_mfma_f32_16x16x32_bf16 v[240:243], v[56:59], a[32:35], v[240:243]
ds_read_b64_tr_b16 v[48:49], v34 offset:20512
ds_read_b64_tr_b16 v[50:51], v34 offset:23072
v_mfma_f32_16x16x32_bf16 v[240:243], v[60:63], a[36:39], v[240:243]
buffer_load_dwordx4 a[136:139], v90, s[32:35], s50 offen sc0 sc1
v_mfma_f32_16x16x32_bf16 v[244:247], v[56:59], a[80:83], v[244:247]
ds_read_b64_tr_b16 v[52:53], v34 offset:30752
ds_read_b64_tr_b16 v[54:55], v34 offset:33312
v_mfma_f32_16x16x32_bf16 v[244:247], v[60:63], a[84:87], v[244:247]
buffer_load_dwordx4 a[184:187], v91, s[32:35], s50 offen sc0 sc1
v_mfma_f32_16x16x32_bf16 v[248:251], v[56:59], a[128:131], v[248:251]
v_mfma_f32_16x16x32_bf16 v[248:251], v[60:63], a[132:135], v[248:251]
v_mfma_f32_16x16x32_bf16 v[252:255], v[56:59], a[176:179], v[252:255]
v_mfma_f32_16x16x32_bf16 v[252:255], v[60:63], a[180:183], v[252:255]
s_waitcnt lgkmcnt(4)
v_mfma_f32_16x16x32_bf16 v[96:99], v[40:43], a[0:3], v[96:99]
ds_read_b64_tr_b16 v[56:57], v34 offset:20544
ds_read_b64_tr_b16 v[58:59], v34 offset:23104
v_mfma_f32_16x16x32_bf16 v[96:99], v[44:47], a[4:7], v[96:99]
s_add_u32 s47, s69, 4096
v_mfma_f32_16x16x32_bf16 v[100:103], v[40:43], a[48:51], v[100:103]
ds_read_b64_tr_b16 v[60:61], v34 offset:30784
ds_read_b64_tr_b16 v[62:63], v34 offset:33344
v_mfma_f32_16x16x32_bf16 v[100:103], v[44:47], a[52:55], v[100:103]
buffer_load_dwordx4 a[32:35], v28, s[32:35], s47 offen offset:0 sc0 sc1
v_mfma_f32_16x16x32_bf16 v[104:107], v[40:43], a[96:99], v[104:107]
buffer_load_dwordx4 a[36:39], v28, s[32:35], s47 offen offset:1024 sc0 sc1
v_mfma_f32_16x16x32_bf16 v[104:107], v[44:47], a[100:103], v[104:107]
v_mfma_f32_16x16x32_bf16 v[108:111], v[40:43], a[144:147], v[108:111]
buffer_load_dwordx4 a[80:83], v29, s[32:35], s47 offen offset:0 sc0 sc1
v_mfma_f32_16x16x32_bf16 v[108:111], v[44:47], a[148:151], v[108:111]
s_waitcnt lgkmcnt(4)
v_mfma_f32_16x16x32_bf16 v[112:115], v[48:51], a[0:3], v[112:115]
ds_read_b64_tr_b16 v[40:41], v34 offset:20576
ds_read_b64_tr_b16 v[42:43], v34 offset:23136
v_mfma_f32_16x16x32_bf16 v[112:115], v[52:55], a[4:7], v[112:115]
buffer_load_dwordx4 a[84:87], v29, s[32:35], s47 offen offset:1024 sc0 sc1
v_mfma_f32_16x16x32_bf16 v[116:119], v[48:51], a[48:51], v[116:119]
ds_read_b64_tr_b16 v[44:45], v34 offset:30816
ds_read_b64_tr_b16 v[46:47], v34 offset:33376
v_mfma_f32_16x16x32_bf16 v[116:119], v[52:55], a[52:55], v[116:119]
v_mfma_f32_16x16x32_bf16 v[120:123], v[48:51], a[96:99], v[120:123]
buffer_load_dwordx4 a[128:131], v30, s[32:35], s47 offen offset:0 sc0 sc1
v_mfma_f32_16x16x32_bf16 v[120:123], v[52:55], a[100:103], v[120:123]
v_mfma_f32_16x16x32_bf16 v[124:127], v[48:51], a[144:147], v[124:127]
v_mfma_f32_16x16x32_bf16 v[124:127], v[52:55], a[148:151], v[124:127]
s_waitcnt lgkmcnt(4)
v_mfma_f32_16x16x32_bf16 v[128:131], v[56:59], a[0:3], v[128:131]
ds_read_b64_tr_b16 v[48:49], v34 offset:20608
ds_read_b64_tr_b16 v[50:51], v34 offset:23168
v_mfma_f32_16x16x32_bf16 v[128:131], v[60:63], a[4:7], v[128:131]
buffer_load_dwordx4 a[132:135], v30, s[32:35], s47 offen offset:1024 sc0 sc1
v_mfma_f32_16x16x32_bf16 v[132:135], v[56:59], a[48:51], v[132:135]
ds_read_b64_tr_b16 v[52:53], v34 offset:30848
ds_read_b64_tr_b16 v[54:55], v34 offset:33408
v_mfma_f32_16x16x32_bf16 v[132:135], v[60:63], a[52:55], v[132:135]
buffer_load_dwordx4 a[176:179], v31, s[32:35], s47 offen offset:0 sc0 sc1
v_mfma_f32_16x16x32_bf16 v[136:139], v[56:59], a[96:99], v[136:139]
v_mfma_f32_16x16x32_bf16 v[136:139], v[60:63], a[100:103], v[136:139]
buffer_load_dwordx4 a[180:183], v31, s[32:35], s47 offen offset:1024 sc0 sc1
v_mfma_f32_16x16x32_bf16 v[140:143], v[56:59], a[144:147], v[140:143]
s_add_u32 s46, s66, 46080
s_add_u32 m0, s45, 49152
v_mfma_f32_16x16x32_bf16 v[140:143], v[60:63], a[148:151], v[140:143]
s_waitcnt lgkmcnt(4)
v_mfma_f32_16x16x32_bf16 v[144:147], v[40:43], a[0:3], v[144:147]
s_waitcnt vmcnt(34) lgkmcnt(0)
s_barrier
v_mfma_f32_16x16x32_bf16 v[144:147], v[44:47], a[4:7], v[144:147]
ds_read_b64_tr_b16 v[56:57], v34 offset:40960
ds_read_b64_tr_b16 v[58:59], v34 offset:43520
v_mfma_f32_16x16x32_bf16 v[148:151], v[40:43], a[48:51], v[148:151]
buffer_load_dwordx4 v26, s[28:31], s46 offen offset:0 sc0 sc1 lds
v_mfma_f32_16x16x32_bf16 v[148:151], v[44:47], a[52:55], v[148:151]
ds_read_b64_tr_b16 v[60:61], v34 offset:51200
ds_read_b64_tr_b16 v[62:63], v34 offset:53760
v_mfma_f32_16x16x32_bf16 v[152:155], v[40:43], a[96:99], v[152:155]
buffer_load_dwordx4 v26, s[28:31], s46 offen offset:1024 sc0 sc1 lds
v_mfma_f32_16x16x32_bf16 v[152:155], v[44:47], a[100:103], v[152:155]
v_mfma_f32_16x16x32_bf16 v[156:159], v[40:43], a[144:147], v[156:159]
buffer_load_dwordx4 v26, s[28:31], s46 offen offset:2048 sc0 sc1 lds
v_mfma_f32_16x16x32_bf16 v[156:159], v[44:47], a[148:151], v[156:159]
v_mfma_f32_16x16x32_bf16 v[160:163], v[48:51], a[0:3], v[160:163]
ds_read_b64_tr_b16 v[40:41], v34 offset:40992
ds_read_b64_tr_b16 v[42:43], v34 offset:43552
v_mfma_f32_16x16x32_bf16 v[160:163], v[52:55], a[4:7], v[160:163]
buffer_load_dwordx4 v26, s[28:31], s46 offen offset:3072 sc0 sc1 lds
v_mfma_f32_16x16x32_bf16 v[164:167], v[48:51], a[48:51], v[164:167]
ds_read_b64_tr_b16 v[44:45], v34 offset:51232
ds_read_b64_tr_b16 v[46:47], v34 offset:53792
v_mfma_f32_16x16x32_bf16 v[164:167], v[52:55], a[52:55], v[164:167]
s_add_u32 m0, s45, 53248
v_mfma_f32_16x16x32_bf16 v[168:171], v[48:51], a[96:99], v[168:171]
buffer_load_dwordx4 v27, s[28:31], s46 offen sc0 sc1 lds
v_mfma_f32_16x16x32_bf16 v[168:171], v[52:55], a[100:103], v[168:171]
v_mfma_f32_16x16x32_bf16 v[172:175], v[48:51], a[144:147], v[172:175]
v_mfma_f32_16x16x32_bf16 v[172:175], v[52:55], a[148:151], v[172:175]
s_waitcnt vmcnt(27) lgkmcnt(4)
v_mfma_f32_16x16x32_bf16 v[96:99], v[56:59], a[16:19], v[96:99]
ds_read_b64_tr_b16 v[48:49], v34 offset:41024
ds_read_b64_tr_b16 v[50:51], v34 offset:43584
v_mfma_f32_16x16x32_bf16 v[96:99], v[60:63], a[20:23], v[96:99]
s_add_u32 s46, s66, 51200
s_add_u32 m0, s45, 102144
v_mfma_f32_16x16x32_bf16 v[100:103], v[56:59], a[64:67], v[100:103]
ds_read_b64_tr_b16 v[52:53], v34 offset:51264
ds_read_b64_tr_b16 v[54:55], v34 offset:53824
v_mfma_f32_16x16x32_bf16 v[100:103], v[60:63], a[68:71], v[100:103]
buffer_load_dwordx4 v26, s[28:31], s46 offen offset:0 sc0 sc1 lds
v_mfma_f32_16x16x32_bf16 v[104:107], v[56:59], a[112:115], v[104:107]
v_mfma_f32_16x16x32_bf16 v[104:107], v[60:63], a[116:119], v[104:107]
buffer_load_dwordx4 v26, s[28:31], s46 offen offset:1024 sc0 sc1 lds
v_mfma_f32_16x16x32_bf16 v[108:111], v[56:59], a[160:163], v[108:111]
v_mfma_f32_16x16x32_bf16 v[108:111], v[60:63], a[164:167], v[108:111]
s_waitcnt lgkmcnt(4)
v_mfma_f32_16x16x32_bf16 v[112:115], v[40:43], a[16:19], v[112:115]
ds_read_b64_tr_b16 v[56:57], v34 offset:41056
ds_read_b64_tr_b16 v[58:59], v34 offset:43616
v_mfma_f32_16x16x32_bf16 v[112:115], v[44:47], a[20:23], v[112:115]
buffer_load_dwordx4 v26, s[28:31], s46 offen offset:2048 sc0 sc1 lds
v_mfma_f32_16x16x32_bf16 v[116:119], v[40:43], a[64:67], v[116:119]
ds_read_b64_tr_b16 v[60:61], v34 offset:51296
ds_read_b64_tr_b16 v[62:63], v34 offset:53856
v_mfma_f32_16x16x32_bf16 v[116:119], v[44:47], a[68:71], v[116:119]
v_mfma_f32_16x16x32_bf16 v[120:123], v[40:43], a[112:115], v[120:123]
v_mfma_f32_16x16x32_bf16 v[120:123], v[44:47], a[116:119], v[120:123]
buffer_load_dwordx4 v26, s[28:31], s46 offen offset:3072 sc0 sc1 lds
v_mfma_f32_16x16x32_bf16 v[124:127], v[40:43], a[160:163], v[124:127]
v_mfma_f32_16x16x32_bf16 v[124:127], v[44:47], a[164:167], v[124:127]
s_waitcnt lgkmcnt(4)
v_mfma_f32_16x16x32_bf16 v[128:131], v[48:51], a[16:19], v[128:131]
ds_read_b64_tr_b16 v[40:41], v34 offset:41088
ds_read_b64_tr_b16 v[42:43], v34 offset:43648
v_mfma_f32_16x16x32_bf16 v[128:131], v[52:55], a[20:23], v[128:131]
s_add_u32 m0, s45, 106240
v_mfma_f32_16x16x32_bf16 v[132:135], v[48:51], a[64:67], v[132:135]
ds_read_b64_tr_b16 v[44:45], v34 offset:51328
ds_read_b64_tr_b16 v[46:47], v34 offset:53888
v_mfma_f32_16x16x32_bf16 v[132:135], v[52:55], a[68:71], v[132:135]
buffer_load_dwordx4 v27, s[28:31], s46 offen sc0 sc1 lds
v_mfma_f32_16x16x32_bf16 v[136:139], v[48:51], a[112:115], v[136:139]
s_add_u32 s50, s44, 9216
v_mfma_f32_16x16x32_bf16 v[136:139], v[52:55], a[116:119], v[136:139]
v_mfma_f32_16x16x32_bf16 v[140:143], v[48:51], a[160:163], v[140:143]
buffer_load_dwordx4 a[44:47], v88, s[32:35], s50 offen sc0 sc1
v_mfma_f32_16x16x32_bf16 v[140:143], v[52:55], a[164:167], v[140:143]
s_waitcnt lgkmcnt(4)
v_mfma_f32_16x16x32_bf16 v[144:147], v[56:59], a[16:19], v[144:147]
s_waitcnt vmcnt(28) lgkmcnt(0)
s_barrier
v_mfma_f32_16x16x32_bf16 v[144:147], v[60:63], a[20:23], v[144:147]
ds_read_b64_tr_b16 v[48:49], v32 offset:0
ds_read_b64_tr_b16 v[50:51], v32 offset:2560
v_mfma_f32_16x16x32_bf16 v[148:151], v[56:59], a[64:67], v[148:151]
buffer_load_dwordx4 a[92:95], v89, s[32:35], s50 offen sc0 sc1
v_mfma_f32_16x16x32_bf16 v[148:151], v[60:63], a[68:71], v[148:151]
ds_read_b64_tr_b16 v[52:53], v32 offset:10240
ds_read_b64_tr_b16 v[54:55], v32 offset:12800
v_mfma_f32_16x16x32_bf16 v[152:155], v[56:59], a[112:115], v[152:155]
v_mfma_f32_16x16x32_bf16 v[152:155], v[60:63], a[116:119], v[152:155]
v_mfma_f32_16x16x32_bf16 v[156:159], v[56:59], a[160:163], v[156:159]
buffer_load_dwordx4 a[140:143], v90, s[32:35], s50 offen sc0 sc1
v_mfma_f32_16x16x32_bf16 v[156:159], v[60:63], a[164:167], v[156:159]
v_mfma_f32_16x16x32_bf16 v[160:163], v[40:43], a[16:19], v[160:163]
ds_read_b64_tr_b16 v[56:57], v32 offset:32
ds_read_b64_tr_b16 v[58:59], v32 offset:2592
v_mfma_f32_16x16x32_bf16 v[160:163], v[44:47], a[20:23], v[160:163]
v_mfma_f32_16x16x32_bf16 v[164:167], v[40:43], a[64:67], v[164:167]
ds_read_b64_tr_b16 v[60:61], v32 offset:10272
ds_read_b64_tr_b16 v[62:63], v32 offset:12832
v_mfma_f32_16x16x32_bf16 v[164:167], v[44:47], a[68:71], v[164:167]
buffer_load_dwordx4 a[188:191], v91, s[32:35], s50 offen sc0 sc1
v_mfma_f32_16x16x32_bf16 v[168:171], v[40:43], a[112:115], v[168:171]
v_mfma_f32_16x16x32_bf16 v[168:171], v[44:47], a[116:119], v[168:171]
v_mfma_f32_16x16x32_bf16 v[172:175], v[40:43], a[160:163], v[172:175]
v_mfma_f32_16x16x32_bf16 v[172:175], v[44:47], a[164:167], v[172:175]
s_waitcnt vmcnt(14) lgkmcnt(4)
v_mfma_f32_16x16x32_bf16 v[96:99], v[48:51], a[32:35], v[96:99]
ds_read_b64_tr_b16 v[40:41], v32 offset:64
ds_read_b64_tr_b16 v[42:43], v32 offset:2624
v_mfma_f32_16x16x32_bf16 v[96:99], v[52:55], a[36:39], v[96:99]
s_add_u32 s50, s44, 10240
v_mfma_f32_16x16x32_bf16 v[100:103], v[48:51], a[80:83], v[100:103]
ds_read_b64_tr_b16 v[44:45], v32 offset:10304
ds_read_b64_tr_b16 v[46:47], v32 offset:12864
v_mfma_f32_16x16x32_bf16 v[100:103], v[52:55], a[84:87], v[100:103]
buffer_load_dwordx4 a[12:15], v88, s[32:35], s50 offen sc0 sc1
v_mfma_f32_16x16x32_bf16 v[104:107], v[48:51], a[128:131], v[104:107]
v_mfma_f32_16x16x32_bf16 v[104:107], v[52:55], a[132:135], v[104:107]
buffer_load_dwordx4 a[60:63], v89, s[32:35], s50 offen sc0 sc1
v_mfma_f32_16x16x32_bf16 v[108:111], v[48:51], a[176:179], v[108:111]
v_mfma_f32_16x16x32_bf16 v[108:111], v[52:55], a[180:183], v[108:111]
s_waitcnt lgkmcnt(4)
v_mfma_f32_16x16x32_bf16 v[112:115], v[56:59], a[32:35], v[112:115]
ds_read_b64_tr_b16 v[48:49], v32 offset:96
ds_read_b64_tr_b16 v[50:51], v32 offset:2656
v_mfma_f32_16x16x32_bf16 v[112:115], v[60:63], a[36:39], v[112:115]
buffer_load_dwordx4 a[108:111], v90, s[32:35], s50 offen sc0 sc1
v_mfma_f32_16x16x32_bf16 v[116:119], v[56:59], a[80:83], v[116:119]
ds_read_b64_tr_b16 v[52:53], v32 offset:10336
ds_read_b64_tr_b16 v[54:55], v32 offset:12896
v_mfma_f32_16x16x32_bf16 v[116:119], v[60:63], a[84:87], v[116:119]
v_mfma_f32_16x16x32_bf16 v[120:123], v[56:59], a[128:131], v[120:123]
v_mfma_f32_16x16x32_bf16 v[120:123], v[60:63], a[132:135], v[120:123]
buffer_load_dwordx4 a[156:159], v91, s[32:35], s50 offen sc0 sc1
v_mfma_f32_16x16x32_bf16 v[124:127], v[56:59], a[176:179], v[124:127]
v_mfma_f32_16x16x32_bf16 v[124:127], v[60:63], a[180:183], v[124:127]
s_waitcnt lgkmcnt(4)
v_mfma_f32_16x16x32_bf16 v[128:131], v[40:43], a[32:35], v[128:131]
ds_read_b64_tr_b16 v[56:57], v32 offset:128
ds_read_b64_tr_b16 v[58:59], v32 offset:2688
v_mfma_f32_16x16x32_bf16 v[128:131], v[44:47], a[36:39], v[128:131]
s_add_u32 s50, s44, 11264
v_mfma_f32_16x16x32_bf16 v[132:135], v[40:43], a[80:83], v[132:135]
ds_read_b64_tr_b16 v[60:61], v32 offset:10368
ds_read_b64_tr_b16 v[62:63], v32 offset:12928
v_mfma_f32_16x16x32_bf16 v[132:135], v[44:47], a[84:87], v[132:135]
buffer_load_dwordx4 a[24:27], v88, s[32:35], s50 offen sc0 sc1
v_mfma_f32_16x16x32_bf16 v[136:139], v[40:43], a[128:131], v[136:139]
v_mfma_f32_16x16x32_bf16 v[136:139], v[44:47], a[132:135], v[136:139]
v_mfma_f32_16x16x32_bf16 v[140:143], v[40:43], a[176:179], v[140:143]
buffer_load_dwordx4 a[72:75], v89, s[32:35], s50 offen sc0 sc1
v_mfma_f32_16x16x32_bf16 v[140:143], v[44:47], a[180:183], v[140:143]
s_waitcnt lgkmcnt(4)
v_mfma_f32_16x16x32_bf16 v[144:147], v[48:51], a[32:35], v[144:147]
v_mfma_f32_16x16x32_bf16 v[144:147], v[52:55], a[36:39], v[144:147]
ds_read_b64_tr_b16 v[40:41], v34 offset:25600
ds_read_b64_tr_b16 v[42:43], v34 offset:28160
v_mfma_f32_16x16x32_bf16 v[148:151], v[48:51], a[80:83], v[148:151]
buffer_load_dwordx4 a[120:123], v90, s[32:35], s50 offen sc0 sc1
v_mfma_f32_16x16x32_bf16 v[148:151], v[52:55], a[84:87], v[148:151]
ds_read_b64_tr_b16 v[44:45], v34 offset:35840
ds_read_b64_tr_b16 v[46:47], v34 offset:38400
v_mfma_f32_16x16x32_bf16 v[152:155], v[48:51], a[128:131], v[152:155]
v_mfma_f32_16x16x32_bf16 v[152:155], v[52:55], a[132:135], v[152:155]
v_mfma_f32_16x16x32_bf16 v[156:159], v[48:51], a[176:179], v[156:159]
buffer_load_dwordx4 a[168:171], v91, s[32:35], s50 offen sc0 sc1
v_mfma_f32_16x16x32_bf16 v[156:159], v[52:55], a[180:183], v[156:159]
s_waitcnt lgkmcnt(4)
v_mfma_f32_16x16x32_bf16 v[160:163], v[56:59], a[32:35], v[160:163]
ds_read_b64_tr_b16 v[48:49], v34 offset:25632
ds_read_b64_tr_b16 v[50:51], v34 offset:28192
v_mfma_f32_16x16x32_bf16 v[160:163], v[60:63], a[36:39], v[160:163]
v_mfma_f32_16x16x32_bf16 v[164:167], v[56:59], a[80:83], v[164:167]
ds_read_b64_tr_b16 v[52:53], v34 offset:35872
ds_read_b64_tr_b16 v[54:55], v34 offset:38432
v_mfma_f32_16x16x32_bf16 v[164:167], v[60:63], a[84:87], v[164:167]
buffer_load_dword v35, v39, s[40:43], s51 offen offset:192 sc0 sc1
v_mfma_f32_16x16x32_bf16 v[168:171], v[56:59], a[128:131], v[168:171]
v_mfma_f32_16x16x32_bf16 v[168:171], v[60:63], a[132:135], v[168:171]
v_mfma_f32_16x16x32_bf16 v[172:175], v[56:59], a[176:179], v[172:175]
v_mfma_f32_16x16x32_bf16 v[172:175], v[60:63], a[180:183], v[172:175]
s_waitcnt lgkmcnt(4)
v_mfma_f32_16x16x32_bf16 v[176:179], v[40:43], a[0:3], v[176:179]
ds_read_b64_tr_b16 v[56:57], v34 offset:25664
ds_read_b64_tr_b16 v[58:59], v34 offset:28224
v_mfma_f32_16x16x32_bf16 v[176:179], v[44:47], a[4:7], v[176:179]
v_mfma_f32_16x16x32_bf16 v[180:183], v[40:43], a[48:51], v[180:183]
ds_read_b64_tr_b16 v[60:61], v34 offset:35904
ds_read_b64_tr_b16 v[62:63], v34 offset:38464
s_lshl_b32 s3, s25, 1
v_mfma_f32_16x16x32_bf16 v[180:183], v[44:47], a[52:55], v[180:183]
s_add_u32 s3, s3, 0
s_lshl_b32 s38, s3, 3
s_add_u32 s38, s38, s95
v_mfma_f32_16x16x32_bf16 v[184:187], v[40:43], a[96:99], v[184:187]
s_add_u32 s38, s38, s60
s_mul_i32 s38, s38, 10240
s_add_u32 s38, s38, 54525952
v_mfma_f32_16x16x32_bf16 v[184:187], v[44:47], a[100:103], v[184:187]
s_cmp_eq_u32 s3, s60
s_cselect_b32 s38, 0x7f000000, s38
s_cselect_b32 s82, 1, 0
v_mfma_f32_16x16x32_bf16 v[188:191], v[40:43], a[144:147], v[188:191]
s_and_b32 s3, s61, 1
s_mul_i32 s3, s3, 5120
s_xor_b32 s39, s3, 5120
v_mfma_f32_16x16x32_bf16 v[188:191], v[44:47], a[148:151], v[188:191]
s_add_u32 s39, s39, s38
s_add_u32 s38, s38, s3
s_waitcnt lgkmcnt(4)
v_mfma_f32_16x16x32_bf16 v[192:195], v[48:51], a[0:3], v[192:195]
ds_read_b64_tr_b16 v[40:41], v34 offset:25696
ds_read_b64_tr_b16 v[42:43], v34 offset:28256
v_mfma_f32_16x16x32_bf16 v[192:195], v[52:55], a[4:7], v[192:195]
v_cvt_pk_bf16_f32 v96, v96, v97
v_cvt_pk_bf16_f32 v97, v98, v99
v_mfma_f32_16x16x32_bf16 v[196:199], v[48:51], a[48:51], v[196:199]
ds_read_b64_tr_b16 v[44:45], v34 offset:35936
ds_read_b64_tr_b16 v[46:47], v34 offset:38496
v_mfma_f32_16x16x32_bf16 v[196:199], v[52:55], a[52:55], v[196:199]
v_cvt_pk_bf16_f32 v98, v112, v113
v_cvt_pk_bf16_f32 v99, v114, v115
v_mfma_f32_16x16x32_bf16 v[200:203], v[48:51], a[96:99], v[200:203]
buffer_store_dwordx4 v[96:99], v26, s[40:43], s38 offen offset:0 sc0 sc1
v_mfma_f32_16x16x32_bf16 v[200:203], v[52:55], a[100:103], v[200:203]
v_mfma_f32_16x16x32_bf16 v[204:207], v[48:51], a[144:147], v[204:207]
v_mfma_f32_16x16x32_bf16 v[204:207], v[52:55], a[148:151], v[204:207]
s_waitcnt lgkmcnt(4)
v_mfma_f32_16x16x32_bf16 v[208:211], v[56:59], a[0:3], v[208:211]
ds_read_b64_tr_b16 v[48:49], v34 offset:25728
ds_read_b64_tr_b16 v[50:51], v34 offset:28288
v_mfma_f32_16x16x32_bf16 v[208:211], v[60:63], a[4:7], v[208:211]
v_mfma_f32_16x16x32_bf16 v[212:215], v[56:59], a[48:51], v[212:215]
ds_read_b64_tr_b16 v[52:53], v34 offset:35968
ds_read_b64_tr_b16 v[54:55], v34 offset:38528
v_mfma_f32_16x16x32_bf16 v[212:215], v[60:63], a[52:55], v[212:215]
v_cvt_pk_bf16_f32 v128, v128, v129
v_cvt_pk_bf16_f32 v129, v130, v131
v_mfma_f32_16x16x32_bf16 v[216:219], v[56:59], a[96:99], v[216:219]
v_cvt_pk_bf16_f32 v130, v144, v145
v_cvt_pk_bf16_f32 v131, v146, v147
v_mfma_f32_16x16x32_bf16 v[216:219], v[60:63], a[100:103], v[216:219]
buffer_store_dwordx4 v[128:131], v26, s[40:43], s38 offen offset:1024 sc0 sc1
v_mfma_f32_16x16x32_bf16 v[220:223], v[56:59], a[144:147], v[220:223]
v_mfma_f32_16x16x32_bf16 v[220:223], v[60:63], a[148:151], v[220:223]
s_waitcnt lgkmcnt(4)
v_mfma_f32_16x16x32_bf16 v[224:227], v[40:43], a[0:3], v[224:227]
v_mfma_f32_16x16x32_bf16 v[224:227], v[44:47], a[4:7], v[224:227]
ds_read_b64_tr_b16 v[56:57], v34 offset:46080
ds_read_b64_tr_b16 v[58:59], v34 offset:48640
v_mfma_f32_16x16x32_bf16 v[228:231], v[40:43], a[48:51], v[228:231]
v_mfma_f32_16x16x32_bf16 v[228:231], v[44:47], a[52:55], v[228:231]
ds_read_b64_tr_b16 v[60:61], v34 offset:56320
ds_read_b64_tr_b16 v[62:63], v34 offset:58880
v_mfma_f32_16x16x32_bf16 v[232:235], v[40:43], a[96:99], v[232:235]
v_cvt_pk_bf16_f32 v100, v100, v101
v_cvt_pk_bf16_f32 v101, v102, v103
v_mfma_f32_16x16x32_bf16 v[232:235], v[44:47], a[100:103], v[232:235]
v_cvt_pk_bf16_f32 v102, v116, v117
v_cvt_pk_bf16_f32 v103, v118, v119
v_mfma_f32_16x16x32_bf16 v[236:239], v[40:43], a[144:147], v[236:239]
buffer_store_dwordx4 v[100:103], v26, s[40:43], s38 offen offset:2048 sc0 sc1
v_mfma_f32_16x16x32_bf16 v[236:239], v[44:47], a[148:151], v[236:239]
s_waitcnt lgkmcnt(4)
v_mfma_f32_16x16x32_bf16 v[240:243], v[48:51], a[0:3], v[240:243]
ds_read_b64_tr_b16 v[40:41], v34 offset:46112
ds_read_b64_tr_b16 v[42:43], v34 offset:48672
v_mfma_f32_16x16x32_bf16 v[240:243], v[52:55], a[4:7], v[240:243]
v_mfma_f32_16x16x32_bf16 v[244:247], v[48:51], a[48:51], v[244:247]
ds_read_b64_tr_b16 v[44:45], v34 offset:56352
ds_read_b64_tr_b16 v[46:47], v34 offset:58912
v_mfma_f32_16x16x32_bf16 v[244:247], v[52:55], a[52:55], v[244:247]
v_mfma_f32_16x16x32_bf16 v[248:251], v[48:51], a[96:99], v[248:251]
v_mfma_f32_16x16x32_bf16 v[248:251], v[52:55], a[100:103], v[248:251]
v_mfma_f32_16x16x32_bf16 v[252:255], v[48:51], a[144:147], v[252:255]
v_mfma_f32_16x16x32_bf16 v[252:255], v[52:55], a[148:151], v[252:255]
s_waitcnt lgkmcnt(4)
v_mfma_f32_16x16x32_bf16 v[176:179], v[56:59], a[16:19], v[176:179]
ds_read_b64_tr_b16 v[48:49], v34 offset:46144
ds_read_b64_tr_b16 v[50:51], v34 offset:48704
v_mfma_f32_16x16x32_bf16 v[176:179], v[60:63], a[20:23], v[176:179]
v_cvt_pk_bf16_f32 v132, v132, v133
v_cvt_pk_bf16_f32 v133, v134, v135
v_mfma_f32_16x16x32_bf16 v[180:183], v[56:59], a[64:67], v[180:183]
ds_read_b64_tr_b16 v[52:53], v34 offset:56384
ds_read_b64_tr_b16 v[54:55], v34 offset:58944
v_mfma_f32_16x16x32_bf16 v[180:183], v[60:63], a[68:71], v[180:183]
v_cvt_pk_bf16_f32 v134, v148, v149
v_cvt_pk_bf16_f32 v135, v150, v151
v_mfma_f32_16x16x32_bf16 v[184:187], v[56:59], a[112:115], v[184:187]
buffer_store_dwordx4 v[132:135], v26, s[40:43], s38 offen offset:3072 sc0 sc1
v_mfma_f32_16x16x32_bf16 v[184:187], v[60:63], a[116:119], v[184:187]
v_mfma_f32_16x16x32_bf16 v[188:191], v[56:59], a[160:163], v[188:191]
v_mfma_f32_16x16x32_bf16 v[188:191], v[60:63], a[164:167], v[188:191]
s_waitcnt lgkmcnt(4)
v_mfma_f32_16x16x32_bf16 v[192:195], v[40:43], a[16:19], v[192:195]
ds_read_b64_tr_b16 v[56:57], v34 offset:46176
ds_read_b64_tr_b16 v[58:59], v34 offset:48736
v_mfma_f32_16x16x32_bf16 v[192:195], v[44:47], a[20:23], v[192:195]
v_mfma_f32_16x16x32_bf16 v[196:199], v[40:43], a[64:67], v[196:199]
ds_read_b64_tr_b16 v[60:61], v34 offset:56416
ds_read_b64_tr_b16 v[62:63], v34 offset:58976
v_mfma_f32_16x16x32_bf16 v[196:199], v[44:47], a[68:71], v[196:199]
v_cvt_pk_bf16_f32 v160, v160, v161
v_cvt_pk_bf16_f32 v161, v162, v163
v_mfma_f32_16x16x32_bf16 v[200:203], v[40:43], a[112:115], v[200:203]
v_cvt_pk_bf16_f32 v162, v164, v165
v_cvt_pk_bf16_f32 v163, v166, v167
v_mfma_f32_16x16x32_bf16 v[200:203], v[44:47], a[116:119], v[200:203]
buffer_store_dwordx4 v[160:163], v27, s[40:43], s38 offen offset:0 sc0 sc1
v_mfma_f32_16x16x32_bf16 v[204:207], v[40:43], a[160:163], v[204:207]
v_mfma_f32_16x16x32_bf16 v[204:207], v[44:47], a[164:167], v[204:207]
s_waitcnt lgkmcnt(4)
v_mfma_f32_16x16x32_bf16 v[208:211], v[48:51], a[16:19], v[208:211]
ds_read_b64_tr_b16 v[40:41], v34 offset:46208
ds_read_b64_tr_b16 v[42:43], v34 offset:48768
v_mfma_f32_16x16x32_bf16 v[208:211], v[52:55], a[20:23], v[208:211]
v_mfma_f32_16x16x32_bf16 v[212:215], v[48:51], a[64:67], v[212:215]
ds_read_b64_tr_b16 v[44:45], v34 offset:56448
ds_read_b64_tr_b16 v[46:47], v34 offset:59008
v_mfma_f32_16x16x32_bf16 v[212:215], v[52:55], a[68:71], v[212:215]
v_cvt_pk_bf16_f32 v104, v104, v105
v_cvt_pk_bf16_f32 v105, v106, v107
v_mfma_f32_16x16x32_bf16 v[216:219], v[48:51], a[112:115], v[216:219]
v_cvt_pk_bf16_f32 v106, v120, v121
v_cvt_pk_bf16_f32 v107, v122, v123
v_mfma_f32_16x16x32_bf16 v[216:219], v[52:55], a[116:119], v[216:219]
buffer_store_dwordx4 v[104:107], v26, s[40:43], s39 offen offset:0 sc0 sc1
v_mfma_f32_16x16x32_bf16 v[220:223], v[48:51], a[160:163], v[220:223]
v_mfma_f32_16x16x32_bf16 v[220:223], v[52:55], a[164:167], v[220:223]
s_waitcnt lgkmcnt(4)
v_mfma_f32_16x16x32_bf16 v[224:227], v[56:59], a[16:19], v[224:227]
v_mfma_f32_16x16x32_bf16 v[224:227], v[60:63], a[20:23], v[224:227]
ds_read_b64_tr_b16 v[48:49], v32 offset:5120
ds_read_b64_tr_b16 v[50:51], v32 offset:7680
v_mfma_f32_16x16x32_bf16 v[228:231], v[56:59], a[64:67], v[228:231]
v_mfma_f32_16x16x32_bf16 v[228:231], v[60:63], a[68:71], v[228:231]
ds_read_b64_tr_b16 v[52:53], v32 offset:15360
ds_read_b64_tr_b16 v[54:55], v32 offset:17920
v_mfma_f32_16x16x32_bf16 v[232:235], v[56:59], a[112:115], v[232:235]
v_cvt_pk_bf16_f32 v136, v136, v137
v_cvt_pk_bf16_f32 v137, v138, v139
v_mfma_f32_16x16x32_bf16 v[232:235], v[60:63], a[116:119], v[232:235]
v_cvt_pk_bf16_f32 v138, v152, v153
v_cvt_pk_bf16_f32 v139, v154, v155
v_mfma_f32_16x16x32_bf16 v[236:239], v[56:59], a[160:163], v[236:239]
buffer_store_dwordx4 v[136:139], v26, s[40:43], s39 offen offset:1024 sc0 sc1
v_mfma_f32_16x16x32_bf16 v[236:239], v[60:63], a[164:167], v[236:239]
s_waitcnt lgkmcnt(4)
v_mfma_f32_16x16x32_bf16 v[240:243], v[40:43], a[16:19], v[240:243]
ds_read_b64_tr_b16 v[56:57], v32 offset:5152
ds_read_b64_tr_b16 v[58:59], v32 offset:7712
v_mfma_f32_16x16x32_bf16 v[240:243], v[44:47], a[20:23], v[240:243]
v_mfma_f32_16x16x32_bf16 v[244:247], v[40:43], a[64:67], v[244:247]
ds_read_b64_tr_b16 v[60:61], v32 offset:15392
ds_read_b64_tr_b16 v[62:63], v32 offset:17952
v_mfma_f32_16x16x32_bf16 v[244:247], v[44:47], a[68:71], v[244:247]
v_mfma_f32_16x16x32_bf16 v[248:251], v[40:43], a[112:115], v[248:251]
v_mfma_f32_16x16x32_bf16 v[248:251], v[44:47], a[116:119], v[248:251]
v_mfma_f32_16x16x32_bf16 v[252:255], v[40:43], a[160:163], v[252:255]
v_mfma_f32_16x16x32_bf16 v[252:255], v[44:47], a[164:167], v[252:255]
s_waitcnt lgkmcnt(4)
v_mfma_f32_16x16x32_bf16 v[176:179], v[48:51], a[32:35], v[176:179]
ds_read_b64_tr_b16 v[40:41], v32 offset:5184
ds_read_b64_tr_b16 v[42:43], v32 offset:7744
v_mfma_f32_16x16x32_bf16 v[176:179], v[52:55], a[36:39], v[176:179]
v_cvt_pk_bf16_f32 v108, v108, v109
v_cvt_pk_bf16_f32 v109, v110, v111
v_mfma_f32_16x16x32_bf16 v[180:183], v[48:51], a[80:83], v[180:183]
ds_read_b64_tr_b16 v[44:45], v32 offset:15424
ds_read_b64_tr_b16 v[46:47], v32 offset:17984
v_mfma_f32_16x16x32_bf16 v[180:183], v[52:55], a[84:87], v[180:183]
v_cvt_pk_bf16_f32 v110, v124, v125
v_cvt_pk_bf16_f32 v111, v126, v127
v_mfma_f32_16x16x32_bf16 v[184:187], v[48:51], a[128:131], v[184:187]
buffer_store_dwordx4 v[108:111], v26, s[40:43], s39 offen offset:2048 sc0 sc1
v_mfma_f32_16x16x32_bf16 v[184:187], v[52:55], a[132:135], v[184:187]
v_mfma_f32_16x16x32_bf16 v[188:191], v[48:51], a[176:179], v[188:191]
v_mfma_f32_16x16x32_bf16 v[188:191], v[52:55], a[180:183], v[188:191]
s_waitcnt lgkmcnt(4)
v_mfma_f32_16x16x32_bf16 v[192:195], v[56:59], a[32:35], v[192:195]
ds_read_b64_tr_b16 v[48:49], v32 offset:5216
ds_read_b64_tr_b16 v[50:51], v32 offset:7776
v_mfma_f32_16x16x32_bf16 v[192:195], v[60:63], a[36:39], v[192:195]
v_mfma_f32_16x16x32_bf16 v[196:199], v[56:59], a[80:83], v[196:199]
ds_read_b64_tr_b16 v[52:53], v32 offset:15456
ds_read_b64_tr_b16 v[54:55], v32 offset:18016
v_mfma_f32_16x16x32_bf16 v[196:199], v[60:63], a[84:87], v[196:199]
v_mfma_f32_16x16x32_bf16 v[200:203], v[56:59], a[128:131], v[200:203]
v_mfma_f32_16x16x32_bf16 v[200:203], v[60:63], a[132:135], v[200:203]
v_cvt_pk_bf16_f32 v140, v140, v141
v_cvt_pk_bf16_f32 v141, v142, v143
v_mfma_f32_16x16x32_bf16 v[204:207], v[56:59], a[176:179], v[204:207]
v_cvt_pk_bf16_f32 v142, v156, v157
v_cvt_pk_bf16_f32 v143, v158, v159
v_mfma_f32_16x16x32_bf16 v[204:207], v[60:63], a[180:183], v[204:207]
s_waitcnt lgkmcnt(4)
v_mfma_f32_16x16x32_bf16 v[208:211], v[40:43], a[32:35], v[208:211]
ds_read_b64_tr_b16 v[56:57], v32 offset:5248
ds_read_b64_tr_b16 v[58:59], v32 offset:7808
v_mfma_f32_16x16x32_bf16 v[208:211], v[44:47], a[36:39], v[208:211]
buffer_store_dwordx4 v[140:143], v26, s[40:43], s39 offen offset:3072 sc0 sc1
v_mfma_f32_16x16x32_bf16 v[212:215], v[40:43], a[80:83], v[212:215]
ds_read_b64_tr_b16 v[60:61], v32 offset:15488
ds_read_b64_tr_b16 v[62:63], v32 offset:18048
v_mfma_f32_16x16x32_bf16 v[212:215], v[44:47], a[84:87], v[212:215]
v_mfma_f32_16x16x32_bf16 v[216:219], v[40:43], a[128:131], v[216:219]
v_mfma_f32_16x16x32_bf16 v[216:219], v[44:47], a[132:135], v[216:219]
v_mfma_f32_16x16x32_bf16 v[220:223], v[40:43], a[176:179], v[220:223]
v_mfma_f32_16x16x32_bf16 v[220:223], v[44:47], a[180:183], v[220:223]
s_waitcnt lgkmcnt(4)
v_mfma_f32_16x16x32_bf16 v[224:227], v[48:51], a[32:35], v[224:227]
v_mfma_f32_16x16x32_bf16 v[224:227], v[52:55], a[36:39], v[224:227]
v_mfma_f32_16x16x32_bf16 v[228:231], v[48:51], a[80:83], v[228:231]
ds_read_b64_tr_b16 v[64:65], v93 offset:20480
ds_read_b64_tr_b16 v[66:67], v93 offset:23040
v_mfma_f32_16x16x32_bf16 v[228:231], v[52:55], a[84:87], v[228:231]
v_cvt_pk_bf16_f32 v168, v168, v169
v_cvt_pk_bf16_f32 v169, v170, v171
v_mfma_f32_16x16x32_bf16 v[232:235], v[48:51], a[128:131], v[232:235]
ds_read_b64_tr_b16 v[68:69], v93 offset:20512
ds_read_b64_tr_b16 v[70:71], v93 offset:23072
v_mfma_f32_16x16x32_bf16 v[232:235], v[52:55], a[132:135], v[232:235]
v_cvt_pk_bf16_f32 v170, v172, v173
v_cvt_pk_bf16_f32 v171, v174, v175
v_mfma_f32_16x16x32_bf16 v[236:239], v[48:51], a[176:179], v[236:239]
ds_read_b64_tr_b16 v[72:73], v93 offset:20544
ds_read_b64_tr_b16 v[74:75], v93 offset:23104
v_mfma_f32_16x16x32_bf16 v[236:239], v[52:55], a[180:183], v[236:239]
s_waitcnt lgkmcnt(6)
v_mfma_f32_16x16x32_bf16 v[240:243], v[56:59], a[32:35], v[240:243]
buffer_store_dwordx4 v[168:171], v27, s[40:43], s39 offen offset:0 sc0 sc1
v_mfma_f32_16x16x32_bf16 v[240:243], v[60:63], a[36:39], v[240:243]
ds_read_b64_tr_b16 v[76:77], v93 offset:20576
ds_read_b64_tr_b16 v[78:79], v93 offset:23136
v_mfma_f32_16x16x32_bf16 v[244:247], v[56:59], a[80:83], v[244:247]
v_mfma_f32_16x16x32_bf16 v[244:247], v[60:63], a[84:87], v[244:247]
ds_read_b64_tr_b16 v[80:81], v93 offset:20608
ds_read_b64_tr_b16 v[82:83], v93 offset:23168
v_mfma_f32_16x16x32_bf16 v[248:251], v[56:59], a[128:131], v[248:251]
v_mfma_f32_16x16x32_bf16 v[248:251], v[60:63], a[132:135], v[248:251]
v_mfma_f32_16x16x32_bf16 v[252:255], v[56:59], a[176:179], v[252:255]
v_mfma_f32_16x16x32_bf16 v[252:255], v[60:63], a[180:183], v[252:255]
s_nop 7
s_lshl_b32 s3, s25, 1
s_add_u32 s3, s3, 1
s_lshl_b32 s38, s3, 3
s_add_u32 s38, s38, s95
s_add_u32 s38, s38, s60
s_mul_i32 s38, s38, 10240
s_add_u32 s38, s38, 54525952
s_cmp_eq_u32 s3, s60
s_cselect_b32 s38, 0x7f000000, s38
s_cselect_b32 s83, 1, 0
s_and_b32 s3, s61, 1
s_mul_i32 s3, s3, 5120
s_xor_b32 s39, s3, 5120
s_add_u32 s39, s39, s38
s_add_u32 s38, s38, s3
.p2align 3
v_cvt_pk_bf16_f32 v176, v176, v177
v_cvt_pk_bf16_f32 v177, v178, v179
v_cvt_pk_bf16_f32 v178, v192, v193
v_cvt_pk_bf16_f32 v179, v194, v195
buffer_store_dwordx4 v[176:179], v26, s[40:43], s38 offen offset:0 sc0 sc1
v_cvt_pk_bf16_f32 v208, v208, v209
v_cvt_pk_bf16_f32 v209, v210, v211
v_cvt_pk_bf16_f32 v210, v224, v225
v_cvt_pk_bf16_f32 v211, v226, v227
buffer_store_dwordx4 v[208:211], v26, s[40:43], s38 offen offset:1024 sc0 sc1
v_cvt_pk_bf16_f32 v180, v180, v181
v_cvt_pk_bf16_f32 v181, v182, v183
v_cvt_pk_bf16_f32 v182, v196, v197
v_cvt_pk_bf16_f32 v183, v198, v199
buffer_store_dwordx4 v[180:183], v26, s[40:43], s38 offen offset:2048 sc0 sc1
v_cvt_pk_bf16_f32 v212, v212, v213
v_cvt_pk_bf16_f32 v213, v214, v215
v_cvt_pk_bf16_f32 v214, v228, v229
v_cvt_pk_bf16_f32 v215, v230, v231
buffer_store_dwordx4 v[212:215], v26, s[40:43], s38 offen offset:3072 sc0 sc1
v_cvt_pk_bf16_f32 v240, v240, v241
v_cvt_pk_bf16_f32 v241, v242, v243
v_cvt_pk_bf16_f32 v242, v244, v245
v_cvt_pk_bf16_f32 v243, v246, v247
buffer_store_dwordx4 v[240:243], v27, s[40:43], s38 offen offset:0 sc0 sc1
v_cvt_pk_bf16_f32 v184, v184, v185
v_cvt_pk_bf16_f32 v185, v186, v187
v_cvt_pk_bf16_f32 v186, v200, v201
v_cvt_pk_bf16_f32 v187, v202, v203
buffer_store_dwordx4 v[184:187], v26, s[40:43], s39 offen offset:0 sc0 sc1
v_cvt_pk_bf16_f32 v216, v216, v217
v_cvt_pk_bf16_f32 v217, v218, v219
v_cvt_pk_bf16_f32 v218, v232, v233
v_cvt_pk_bf16_f32 v219, v234, v235
buffer_store_dwordx4 v[216:219], v26, s[40:43], s39 offen offset:1024 sc0 sc1
v_cvt_pk_bf16_f32 v188, v188, v189
v_cvt_pk_bf16_f32 v189, v190, v191
v_cvt_pk_bf16_f32 v190, v204, v205
v_cvt_pk_bf16_f32 v191, v206, v207
buffer_store_dwordx4 v[188:191], v26, s[40:43], s39 offen offset:2048 sc0 sc1
v_cvt_pk_bf16_f32 v220, v220, v221
v_cvt_pk_bf16_f32 v221, v222, v223
v_cvt_pk_bf16_f32 v222, v236, v237
v_cvt_pk_bf16_f32 v223, v238, v239
buffer_store_dwordx4 v[220:223], v26, s[40:43], s39 offen offset:3072 sc0 sc1
v_cvt_pk_bf16_f32 v248, v248, v249
v_cvt_pk_bf16_f32 v249, v250, v251
v_cvt_pk_bf16_f32 v250, v252, v253
v_cvt_pk_bf16_f32 v251, v254, v255
buffer_store_dwordx4 v[248:251], v27, s[40:43], s39 offen offset:0 sc0 sc1
s_cmp_eq_u32 s82, 0
s_cbranch_scc1 L_c_own0
s_and_b32 s3, s61, 1
s_mul_i32 s3, s3, 5120
s_add_u32 s92, s3, 90112
v_add_u32 v36, s92, v26
s_xor_b32 s3, s3, 5120
s_add_u32 s92, s3, 90112
v_add_u32 v37, s92, v26
.p2align 3
ds_write_b128 v36, v[96:99] offset:0
ds_write_b128 v36, v[128:131] offset:1024
ds_write_b128 v36, v[100:103] offset:2048
ds_write_b128 v36, v[132:135] offset:3072
ds_write_b128 v36, v[160:163] offset:4096
ds_write_b128 v37, v[104:107] offset:0
ds_write_b128 v37, v[136:139] offset:1024
ds_write_b128 v37, v[108:111] offset:2048
ds_write_b128 v37, v[140:143] offset:3072
ds_write_b128 v37, v[168:171] offset:4096
s_waitcnt lgkmcnt(0)
L_c_own0:
s_waitcnt vmcnt(20)
v_cmp_eq_u32 vcc, 1, v35
s_nop 0
s_and_b32 s55, vcc_lo, 0xff
s_lshl_b32 s3, s55, 8
s_or_b32 s55, s55, s3
s_add_u32 s3, s60, 1
s_lshr_b32 s55, s55, s3
s_and_b32 s55, s55, 0x7f
s_mov_b32 s54, s55
s_waitcnt lgkmcnt(0)
v_mfma_f32_16x16x32_bf16 a[192:195], v[64:67], a[28:31], a[192:195]
v_mfma_f32_16x16x32_bf16 a[196:199], v[68:71], a[28:31], a[196:199]
ds_read_b64_tr_b16 v[40:41], v92 offset:20480
ds_read_b64_tr_b16 v[42:43], v92 offset:23040
v_mfma_f32_16x16x32_bf16 a[200:203], v[72:75], a[28:31], a[200:203]
v_mfma_f32_16x16x32_bf16 a[204:207], v[76:79], a[28:31], a[204:207]
ds_read_b64_tr_b16 v[44:45], v92 offset:20512
ds_read_b64_tr_b16 v[46:47], v92 offset:23072
v_mfma_f32_16x16x32_bf16 a[8:11], v[80:83], a[28:31], a[8:11]
v_mfma_f32_16x16x32_bf16 a[208:211], v[64:67], a[76:79], a[208:211]
ds_read_b64_tr_b16 v[48:49], v92 offset:20544
ds_read_b64_tr_b16 v[50:51], v92 offset:23104
v_mfma_f32_16x16x32_bf16 a[212:215], v[68:71], a[76:79], a[212:215]
v_mfma_f32_16x16x32_bf16 a[216:219], v[72:75], a[76:79], a[216:219]
ds_read_b64_tr_b16 v[52:53], v92 offset:20576
ds_read_b64_tr_b16 v[54:55], v92 offset:23136
v_mfma_f32_16x16x32_bf16 a[220:223], v[76:79], a[76:79], a[220:223]
v_mfma_f32_16x16x32_bf16 a[56:59], v[80:83], a[76:79], a[56:59]
ds_read_b64_tr_b16 v[56:57], v92 offset:20608
ds_read_b64_tr_b16 v[58:59], v92 offset:23168
v_mfma_f32_16x16x32_bf16 a[224:227], v[64:67], a[124:127], a[224:227]
s_add_u32 s46, s66, 56320
s_add_u32 m0, s45, 69632
v_mfma_f32_16x16x32_bf16 a[228:231], v[68:71], a[124:127], a[228:231]
buffer_load_dwordx4 v26, s[28:31], s46 offen offset:0 sc0 sc1 lds
v_mfma_f32_16x16x32_bf16 a[232:235], v[72:75], a[124:127], a[232:235]
buffer_load_dwordx4 v26, s[28:31], s46 offen offset:1024 sc0 sc1 lds
v_mfma_f32_16x16x32_bf16 a[236:239], v[76:79], a[124:127], a[236:239]
buffer_load_dwordx4 v26, s[28:31], s46 offen offset:2048 sc0 sc1 lds
v_mfma_f32_16x16x32_bf16 a[104:107], v[80:83], a[124:127], a[104:107]
v_mfma_f32_16x16x32_bf16 a[240:243], v[64:67], a[172:175], a[240:243]
buffer_load_dwordx4 v26, s[28:31], s46 offen offset:3072 sc0 sc1 lds
v_mfma_f32_16x16x32_bf16 a[244:247], v[68:71], a[172:175], a[244:247]
s_add_u32 m0, s45, 73728
v_mfma_f32_16x16x32_bf16 a[248:251], v[72:75], a[172:175], a[248:251]
buffer_load_dwordx4 v27, s[28:31], s46 offen sc0 sc1 lds
v_mfma_f32_16x16x32_bf16 a[252:255], v[76:79], a[172:175], a[252:255]
v_mfma_f32_16x16x32_bf16 a[152:155], v[80:83], a[172:175], a[152:155]
s_cmp_eq_u32 s83, 0
s_cbranch_scc1 L_c_own1
s_and_b32 s3, s61, 1
s_mul_i32 s3, s3, 5120
s_add_u32 s92, s3, 90112
v_add_u32 v36, s92, v26
s_xor_b32 s3, s3, 5120
s_add_u32 s92, s3, 90112
v_add_u32 v37, s92, v26
.p2align 3
ds_write_b128 v36, v[176:179] offset:0
ds_write_b128 v36, v[208:211] offset:1024
ds_write_b128 v36, v[180:183] offset:2048
ds_write_b128 v36, v[212:215] offset:3072
ds_write_b128 v36, v[240:243] offset:4096
ds_write_b128 v37, v[184:187] offset:0
ds_write_b128 v37, v[216:219] offset:1024
ds_write_b128 v37, v[188:191] offset:2048
ds_write_b128 v37, v[220:223] offset:3072
ds_write_b128 v37, v[248:251] offset:4096
s_waitcnt lgkmcnt(0)
L_c_own1:
s_mov_b32 s12, s48
s_mov_b32 s13, s49
s_mov_b32 s14, 2621440
s_mov_b32 s15, 0x00020000
s_mov_b32 s86, 2621440
s_mov_b32 s87, 0x00020000
s_lshl_b32 s3, s94, 4
s_lshl_b32 s92, s25, 4
s_add_u32 s3, s3, s92
v_and_b32 v18, 15, v1
v_add_u32 v18, s3, v18
v_mul_u32_u24 v18, 1280, v18
v_lshrrev_b32 v19, 4, v1
v_lshl_add_u32 v18, v19, 3, v18
v_add_u32 v25, s93, v18
buffer_load_dwordx2 v[2:3], v25, s[12:15], 0 offen offset:0
buffer_load_dwordx2 v[4:5], v25, s[12:15], 0 offen offset:32
buffer_load_dwordx2 v[6:7], v25, s[12:15], 0 offen offset:64
buffer_load_dwordx2 v[8:9], v25, s[12:15], 0 offen offset:96
buffer_load_dwordx2 v[10:11], v25, s[12:15], 0 offen offset:128
s_waitcnt vmcnt(10)
s_lshl_b32 s3, s25, 1
s_and_b32 s39, s2, 0xf8
s_add_u32 s3, s3, s39
v_add_u32 v23, s3, v1
s_lshl_b32 s3, s60, 2
s_add_u32 s3, s3, 92274880
v_lshlrev_b32 v23, 9, v23
v_mov_b32 v24, 1
s_mov_b64 exec, 3
buffer_store_dword v24, v23, s[40:43], s3 offen sc0 sc1
s_mov_b64 exec, -1
s_waitcnt lgkmcnt(0)
v_mfma_f32_16x16x32_bf16 a[192:195], v[40:43], a[40:43], a[192:195]
v_mfma_f32_16x16x32_bf16 a[196:199], v[44:47], a[40:43], a[196:199]
ds_read_b64_tr_b16 v[64:65], v93 offset:0
ds_read_b64_tr_b16 v[66:67], v93 offset:2560
v_mfma_f32_16x16x32_bf16 a[200:203], v[48:51], a[40:43], a[200:203]
v_mfma_f32_16x16x32_bf16 a[204:207], v[52:55], a[40:43], a[204:207]
ds_read_b64_tr_b16 v[68:69], v93 offset:32
ds_read_b64_tr_b16 v[70:71], v93 offset:2592
v_mfma_f32_16x16x32_bf16 a[8:11], v[56:59], a[40:43], a[8:11]
v_mfma_f32_16x16x32_bf16 a[208:211], v[40:43], a[88:91], a[208:211]
ds_read_b64_tr_b16 v[72:73], v93 offset:64
ds_read_b64_tr_b16 v[74:75], v93 offset:2624
v_mfma_f32_16x16x32_bf16 a[212:215], v[44:47], a[88:91], a[212:215]
v_mfma_f32_16x16x32_bf16 a[216:219], v[48:51], a[88:91], a[216:219]
ds_read_b64_tr_b16 v[76:77], v93 offset:96
ds_read_b64_tr_b16 v[78:79], v93 offset:2656
v_mfma_f32_16x16x32_bf16 a[220:223], v[52:55], a[88:91], a[220:223]
v_mfma_f32_16x16x32_bf16 a[56:59], v[56:59], a[88:91], a[56:59]
ds_read_b64_tr_b16 v[80:81], v93 offset:128
ds_read_b64_tr_b16 v[82:83], v93 offset:2688
v_mfma_f32_16x16x32_bf16 a[224:227], v[40:43], a[136:139], a[224:227]
v_mfma_f32_16x16x32_bf16 a[228:231], v[44:47], a[136:139], a[228:231]
v_mfma_f32_16x16x32_bf16 a[232:235], v[48:51], a[136:139], a[232:235]
v_mfma_f32_16x16x32_bf16 a[236:239], v[52:55], a[136:139], a[236:239]
v_mfma_f32_16x16x32_bf16 a[104:107], v[56:59], a[136:139], a[104:107]
v_mfma_f32_16x16x32_bf16 a[240:243], v[40:43], a[184:187], a[240:243]
v_mfma_f32_16x16x32_bf16 a[244:247], v[44:47], a[184:187], a[244:247]
v_mfma_f32_16x16x32_bf16 a[248:251], v[48:51], a[184:187], a[248:251]
v_mfma_f32_16x16x32_bf16 a[252:255], v[52:55], a[184:187], a[252:255]
v_mfma_f32_16x16x32_bf16 a[152:155], v[56:59], a[184:187], a[152:155]
s_waitcnt lgkmcnt(0)
v_mfma_f32_16x16x32_bf16 a[192:195], v[64:67], a[44:47], a[192:195]
v_mfma_f32_16x16x32_bf16 a[196:199], v[68:71], a[44:47], a[196:199]
ds_read_b64_tr_b16 v[40:41], v94 offset:0
ds_read_b64_tr_b16 v[42:43], v94 offset:2560
v_mfma_f32_16x16x32_bf16 a[200:203], v[72:75], a[44:47], a[200:203]
v_mfma_f32_16x16x32_bf16 a[204:207], v[76:79], a[44:47], a[204:207]
ds_read_b64_tr_b16 v[44:45], v94 offset:32
ds_read_b64_tr_b16 v[46:47], v94 offset:2592
v_mfma_f32_16x16x32_bf16 a[8:11], v[80:83], a[44:47], a[8:11]
v_mfma_f32_16x16x32_bf16 a[208:211], v[64:67], a[92:95], a[208:211]
ds_read_b64_tr_b16 v[48:49], v94 offset:64
ds_read_b64_tr_b16 v[50:51], v94 offset:2624
v_mfma_f32_16x16x32_bf16 a[212:215], v[68:71], a[92:95], a[212:215]
v_mfma_f32_16x16x32_bf16 a[216:219], v[72:75], a[92:95], a[216:219]
ds_read_b64_tr_b16 v[52:53], v94 offset:96
ds_read_b64_tr_b16 v[54:55], v94 offset:2656
v_mfma_f32_16x16x32_bf16 a[220:223], v[76:79], a[92:95], a[220:223]
v_mfma_f32_16x16x32_bf16 a[56:59], v[80:83], a[92:95], a[56:59]
ds_read_b64_tr_b16 v[56:57], v94 offset:128
ds_read_b64_tr_b16 v[58:59], v94 offset:2688
v_mfma_f32_16x16x32_bf16 a[224:227], v[64:67], a[140:143], a[224:227]
s_lshl_b32 s3, s60, 3
s_add_u32 s3, s3, s95
v_mfma_f32_16x16x32_bf16 a[228:231], v[68:71], a[140:143], a[228:231]
s_mul_i32 s38, s3, 10240
s_add_u32 s38, s38, 54525952
v_mfma_f32_16x16x32_bf16 a[232:235], v[72:75], a[140:143], a[232:235]
s_lshr_b32 s3, s25, 1
s_mul_i32 s3, s3, 5120
v_mfma_f32_16x16x32_bf16 a[236:239], v[76:79], a[140:143], a[236:239]
s_add_u32 s38, s38, s3
s_and_b32 s3, s25, 1
v_mfma_f32_16x16x32_bf16 a[104:107], v[80:83], a[140:143], a[104:107]
s_lshl_b32 s39, s3, 11
v_add_u32 v36, s39, v26
v_mfma_f32_16x16x32_bf16 a[240:243], v[64:67], a[188:191], a[240:243]
s_lshl_b32 s39, s3, 3
v_add_u32 v37, s39, v27
v_mfma_f32_16x16x32_bf16 a[244:247], v[68:71], a[188:191], a[244:247]
s_add_u32 s3, s60, 1
s_and_b32 s3, s3, 7
v_mfma_f32_16x16x32_bf16 a[248:251], v[72:75], a[188:191], a[248:251]
s_mul_i32 s3, s3, 10240
s_add_u32 s39, s38, s3
v_mfma_f32_16x16x32_bf16 a[252:255], v[76:79], a[188:191], a[252:255]
s_bitcmp1_b32 s54, 0
s_cselect_b32 s39, s39, 0x7f000000
v_mfma_f32_16x16x32_bf16 a[152:155], v[80:83], a[188:191], a[152:155]
buffer_load_dwordx4 v[96:99], v36, s[40:43], s39 offen sc0 sc1
buffer_load_dwordx4 v[100:103], v36, s[40:43], s39 offen offset:1024 sc0 sc1
buffer_load_dwordx2 v[104:105], v37, s[40:43], s39 offen sc0 sc1
s_waitcnt lgkmcnt(0)
v_mfma_f32_16x16x32_bf16 a[192:195], v[40:43], a[12:15], a[192:195]
s_waitcnt vmcnt(9)
v_mfma_f32_16x16x32_bf16 a[196:199], v[44:47], a[12:15], a[196:199]
ds_read_b64_tr_b16 v[64:65], v93 offset:20480
ds_read_b64_tr_b16 v[66:67], v93 offset:23040
v_mfma_f32_16x16x32_bf16 a[200:203], v[48:51], a[12:15], a[200:203]
v_mfma_f32_16x16x32_bf16 a[204:207], v[52:55], a[12:15], a[204:207]
ds_read_b64_tr_b16 v[68:69], v93 offset:20512
ds_read_b64_tr_b16 v[70:71], v93 offset:23072
v_mfma_f32_16x16x32_bf16 a[8:11], v[56:59], a[12:15], a[8:11]
v_mfma_f32_16x16x32_bf16 a[208:211], v[40:43], a[60:63], a[208:211]
ds_read_b64_tr_b16 v[72:73], v93 offset:20544
ds_read_b64_tr_b16 v[74:75], v93 offset:23104
v_mfma_f32_16x16x32_bf16 a[212:215], v[44:47], a[60:63], a[212:215]
v_mfma_f32_16x16x32_bf16 a[216:219], v[48:51], a[60:63], a[216:219]
ds_read_b64_tr_b16 v[76:77], v93 offset:20576
ds_read_b64_tr_b16 v[78:79], v93 offset:23136
v_mfma_f32_16x16x32_bf16 a[220:223], v[52:55], a[60:63], a[220:223]
v_mfma_f32_16x16x32_bf16 a[56:59], v[56:59], a[60:63], a[56:59]
ds_read_b64_tr_b16 v[80:81], v93 offset:20608
ds_read_b64_tr_b16 v[82:83], v93 offset:23168
v_mfma_f32_16x16x32_bf16 a[224:227], v[40:43], a[108:111], a[224:227]
s_add_u32 s3, s60, 2
s_and_b32 s3, s3, 7
v_mfma_f32_16x16x32_bf16 a[228:231], v[44:47], a[108:111], a[228:231]
s_mul_i32 s3, s3, 10240
s_add_u32 s39, s38, s3
v_mfma_f32_16x16x32_bf16 a[232:235], v[48:51], a[108:111], a[232:235]
s_bitcmp1_b32 s54, 1
s_cselect_b32 s39, s39, 0x7f000000
v_mfma_f32_16x16x32_bf16 a[236:239], v[52:55], a[108:111], a[236:239]
buffer_load_dwordx4 v[106:109], v36, s[40:43], s39 offen sc0 sc1
v_mfma_f32_16x16x32_bf16 a[104:107], v[56:59], a[108:111], a[104:107]
buffer_load_dwordx4 v[110:113], v36, s[40:43], s39 offen offset:1024 sc0 sc1
v_mfma_f32_16x16x32_bf16 a[240:243], v[40:43], a[156:159], a[240:243]
buffer_load_dwordx2 v[114:115], v37, s[40:43], s39 offen sc0 sc1
v_mfma_f32_16x16x32_bf16 a[244:247], v[44:47], a[156:159], a[244:247]
s_add_u32 s3, s60, 3
s_and_b32 s3, s3, 7
v_mfma_f32_16x16x32_bf16 a[248:251], v[48:51], a[156:159], a[248:251]
s_mul_i32 s3, s3, 10240
s_add_u32 s39, s38, s3
v_mfma_f32_16x16x32_bf16 a[252:255], v[52:55], a[156:159], a[252:255]
s_bitcmp1_b32 s54, 2
s_cselect_b32 s39, s39, 0x7f000000
v_mfma_f32_16x16x32_bf16 a[152:155], v[56:59], a[156:159], a[152:155]
buffer_load_dwordx4 v[116:119], v36, s[40:43], s39 offen sc0 sc1
buffer_load_dwordx4 v[120:123], v36, s[40:43], s39 offen offset:1024 sc0 sc1
buffer_load_dwordx2 v[124:125], v37, s[40:43], s39 offen sc0 sc1
s_add_u32 s3, s60, 4
s_and_b32 s3, s3, 7
s_mul_i32 s3, s3, 10240
s_add_u32 s39, s38, s3
s_bitcmp1_b32 s54, 3
s_cselect_b32 s39, s39, 0x7f000000
buffer_load_dwordx4 v[126:129], v36, s[40:43], s39 offen sc0 sc1
buffer_load_dwordx4 v[130:133], v36, s[40:43], s39 offen offset:1024 sc0 sc1
buffer_load_dwordx2 v[134:135], v37, s[40:43], s39 offen sc0 sc1
s_waitcnt lgkmcnt(0)
v_mfma_f32_16x16x32_bf16 a[192:195], v[64:67], a[24:27], a[192:195]
s_add_u32 s3, s60, 5
s_and_b32 s3, s3, 7
v_mfma_f32_16x16x32_bf16 a[196:199], v[68:71], a[24:27], a[196:199]
s_mul_i32 s3, s3, 10240
s_add_u32 s39, s38, s3
v_mfma_f32_16x16x32_bf16 a[200:203], v[72:75], a[24:27], a[200:203]
s_bitcmp1_b32 s54, 4
s_cselect_b32 s39, s39, 0x7f000000
v_mfma_f32_16x16x32_bf16 a[204:207], v[76:79], a[24:27], a[204:207]
buffer_load_dwordx4 v[136:139], v36, s[40:43], s39 offen sc0 sc1
v_mfma_f32_16x16x32_bf16 a[8:11], v[80:83], a[24:27], a[8:11]
buffer_load_dwordx4 v[140:143], v36, s[40:43], s39 offen offset:1024 sc0 sc1
v_mfma_f32_16x16x32_bf16 a[208:211], v[64:67], a[72:75], a[208:211]
buffer_load_dwordx2 v[144:145], v37, s[40:43], s39 offen sc0 sc1
v_mfma_f32_16x16x32_bf16 a[212:215], v[68:71], a[72:75], a[212:215]
s_add_u32 s3, s60, 6
s_and_b32 s3, s3, 7
v_mfma_f32_16x16x32_bf16 a[216:219], v[72:75], a[72:75], a[216:219]
s_mul_i32 s3, s3, 10240
s_add_u32 s39, s38, s3
v_mfma_f32_16x16x32_bf16 a[220:223], v[76:79], a[72:75], a[220:223]
s_bitcmp1_b32 s54, 5
s_cselect_b32 s39, s39, 0x7f000000
v_mfma_f32_16x16x32_bf16 a[56:59], v[80:83], a[72:75], a[56:59]
buffer_load_dwordx4 v[146:149], v36, s[40:43], s39 offen sc0 sc1
v_mfma_f32_16x16x32_bf16 a[224:227], v[64:67], a[120:123], a[224:227]
buffer_load_dwordx4 v[150:153], v36, s[40:43], s39 offen offset:1024 sc0 sc1
v_mfma_f32_16x16x32_bf16 a[228:231], v[68:71], a[120:123], a[228:231]
buffer_load_dwordx2 v[154:155], v37, s[40:43], s39 offen sc0 sc1
v_mfma_f32_16x16x32_bf16 a[232:235], v[72:75], a[120:123], a[232:235]
s_add_u32 s3, s60, 7
s_and_b32 s3, s3, 7
v_mfma_f32_16x16x32_bf16 a[236:239], v[76:79], a[120:123], a[236:239]
s_mul_i32 s3, s3, 10240
s_add_u32 s39, s38, s3
v_mfma_f32_16x16x32_bf16 a[104:107], v[80:83], a[120:123], a[104:107]
s_bitcmp1_b32 s54, 6
s_cselect_b32 s39, s39, 0x7f000000
v_mfma_f32_16x16x32_bf16 a[240:243], v[64:67], a[168:171], a[240:243]
buffer_load_dwordx4 v[156:159], v36, s[40:43], s39 offen sc0 sc1
v_mfma_f32_16x16x32_bf16 a[244:247], v[68:71], a[168:171], a[244:247]
buffer_load_dwordx4 v[160:163], v36, s[40:43], s39 offen offset:1024 sc0 sc1
v_mfma_f32_16x16x32_bf16 a[248:251], v[72:75], a[168:171], a[248:251]
buffer_load_dwordx2 v[164:165], v37, s[40:43], s39 offen sc0 sc1
v_mfma_f32_16x16x32_bf16 a[252:255], v[76:79], a[168:171], a[252:255]
v_mfma_f32_16x16x32_bf16 a[152:155], v[80:83], a[168:171], a[152:155]
s_waitcnt lgkmcnt(0)
s_barrier
s_add_u32 s3, s25, 1
s_and_b32 s3, s3, 3
s_mul_i32 s3, s3, 15360
s_add_u32 s3, s3, 10240
v_add_u32 v20, s3, v26
ds_write_b128 v20, a[208:211] offset:0
ds_write_b128 v20, a[212:215] offset:1024
ds_write_b128 v20, a[216:219] offset:2048
ds_write_b128 v20, a[220:223] offset:3072
ds_write_b128 v20, a[56:59] offset:4096
s_add_u32 s3, s25, 2
s_and_b32 s3, s3, 3
s_mul_i32 s3, s3, 15360
s_add_u32 s3, s3, 5120
v_add_u32 v20, s3, v26
ds_write_b128 v20, a[224:227] offset:0
ds_write_b128 v20, a[228:231] offset:1024
ds_write_b128 v20, a[232:235] offset:2048
ds_write_b128 v20, a[236:239] offset:3072
ds_write_b128 v20, a[104:107] offset:4096
s_add_u32 s3, s25, 3
s_and_b32 s3, s3, 3
s_mul_i32 s3, s3, 15360
s_add_u32 s3, s3, 0
v_add_u32 v20, s3, v26
.p2align 3
ds_write_b128 v20, a[240:243] offset:0
ds_write_b128 v20, a[244:247] offset:1024
ds_write_b128 v20, a[248:251] offset:2048
ds_write_b128 v20, a[252:255] offset:3072
ds_write_b128 v20, a[152:155] offset:4096
v_accvgpr_read_b32 v196, a192
v_accvgpr_read_b32 v197, a193
v_accvgpr_read_b32 v198, a194
v_accvgpr_read_b32 v199, a195
v_accvgpr_read_b32 v200, a196
v_accvgpr_read_b32 v201, a197
v_accvgpr_read_b32 v202, a198
v_accvgpr_read_b32 v203, a199
v_accvgpr_read_b32 v204, a200
v_accvgpr_read_b32 v205, a201
v_accvgpr_read_b32 v206, a202
v_accvgpr_read_b32 v207, a203
v_accvgpr_read_b32 v208, a204
v_accvgpr_read_b32 v209, a205
v_accvgpr_read_b32 v210, a206
v_accvgpr_read_b32 v211, a207
v_accvgpr_read_b32 v212, a8
v_accvgpr_read_b32 v213, a9
v_accvgpr_read_b32 v214, a10
v_accvgpr_read_b32 v215, a11
s_mul_i32 s3, s25, 15360
s_add_u32 s3, s3, 0
v_add_u32 v20, s3, v26
s_lshr_b32 s3, s25, 1
s_mul_i32 s3, s3, 5120
s_add_u32 s3, s3, 90112
s_and_b32 s39, s25, 1
s_lshl_b32 s50, s39, 11
s_add_u32 s50, s50, s3
v_add_u32 v21, s50, v26
s_lshl_b32 s50, s39, 3
s_add_u32 s50, s50, s3
v_add_u32 v22, s50, v27
s_mov_b32 s50, 0xffff0000
s_waitcnt lgkmcnt(0)
s_barrier
.p2align 3
ds_read_b128 v[216:219], v20 offset:0
ds_read_b128 v[220:223], v20 offset:1024
ds_read_b128 v[224:227], v20 offset:2048
ds_read_b128 v[228:231], v20 offset:3072
ds_read_b128 v[232:235], v20 offset:4096
ds_read_b128 v[236:239], v20 offset:5120
ds_read_b128 v[240:243], v20 offset:6144
ds_read_b128 v[244:247], v20 offset:7168
ds_read_b128 v[248:251], v20 offset:8192
ds_read_b128 v[252:255], v20 offset:9216
ds_read_b128 v[40:43], v21
ds_read_b128 v[44:47], v21 offset:1024
ds_read_b64 v[48:49], v22
ds_read_b128 v[56:59], v20 offset:10240
ds_read_b128 v[60:63], v20 offset:11264
ds_read_b128 v[64:67], v20 offset:12288
ds_read_b128 v[68:71], v20 offset:13312
ds_read_b128 v[72:75], v20 offset:14336
s_waitcnt lgkmcnt(5)
.p2align 3
v_pk_add_f32 v[196:197], v[196:197], v[216:217]
v_pk_add_f32 v[198:199], v[198:199], v[218:219]
v_pk_add_f32 v[200:201], v[200:201], v[220:221]
v_pk_add_f32 v[202:203], v[202:203], v[222:223]
v_pk_add_f32 v[204:205], v[204:205], v[224:225]
v_pk_add_f32 v[206:207], v[206:207], v[226:227]
v_pk_add_f32 v[208:209], v[208:209], v[228:229]
v_pk_add_f32 v[210:211], v[210:211], v[230:231]
v_pk_add_f32 v[212:213], v[212:213], v[232:233]
v_pk_add_f32 v[214:215], v[214:215], v[234:235]
v_pk_add_f32 v[196:197], v[196:197], v[236:237]
v_pk_add_f32 v[198:199], v[198:199], v[238:239]
v_pk_add_f32 v[200:201], v[200:201], v[240:241]
v_pk_add_f32 v[202:203], v[202:203], v[242:243]
v_pk_add_f32 v[204:205], v[204:205], v[244:245]
v_pk_add_f32 v[206:207], v[206:207], v[246:247]
v_pk_add_f32 v[208:209], v[208:209], v[248:249]
v_pk_add_f32 v[210:211], v[210:211], v[250:251]
v_pk_add_f32 v[212:213], v[212:213], v[252:253]
v_pk_add_f32 v[214:215], v[214:215], v[254:255]
s_waitcnt lgkmcnt(0)
.p2align 3
v_pk_add_f32 v[196:197], v[196:197], v[56:57]
v_pk_add_f32 v[198:199], v[198:199], v[58:59]
v_pk_add_f32 v[200:201], v[200:201], v[60:61]
v_pk_add_f32 v[202:203], v[202:203], v[62:63]
v_pk_add_f32 v[204:205], v[204:205], v[64:65]
v_pk_add_f32 v[206:207], v[206:207], v[66:67]
v_pk_add_f32 v[208:209], v[208:209], v[68:69]
v_pk_add_f32 v[210:211], v[210:211], v[70:71]
v_pk_add_f32 v[212:213], v[212:213], v[72:73]
v_pk_add_f32 v[214:215], v[214:215], v[74:75]
v_lshlrev_b32 v176, 16, v40
v_and_b32 v177, s50, v40
v_lshlrev_b32 v178, 16, v41
v_and_b32 v179, s50, v41
v_lshlrev_b32 v180, 16, v42
v_and_b32 v181, s50, v42
v_lshlrev_b32 v182, 16, v43
v_and_b32 v183, s50, v43
v_lshlrev_b32 v184, 16, v44
v_and_b32 v185, s50, v44
v_lshlrev_b32 v186, 16, v45
v_and_b32 v187, s50, v45
v_lshlrev_b32 v188, 16, v46
v_and_b32 v189, s50, v46
v_lshlrev_b32 v190, 16, v47
v_and_b32 v191, s50, v47
v_lshlrev_b32 v192, 16, v48
v_and_b32 v193, s50, v48
v_lshlrev_b32 v194, 16, v49
v_and_b32 v195, s50, v49
s_mov_b32 s3, 0x4119ac27
s_mov_b32 s39, 0xbfb8aa3b
v_mul_f32 v196, s3, v196
v_mul_f32 v197, s3, v197
v_mul_f32 v198, s3, v198
v_mul_f32 v199, s3, v199
v_cvt_pk_bf16_f32 v56, v196, v197
v_cvt_pk_bf16_f32 v57, v198, v199
v_lshlrev_b32 v196, 16, v56
v_and_b32 v197, s50, v56
v_lshlrev_b32 v198, 16, v57
v_and_b32 v199, s50, v57
v_mul_f32 v56, s39, v196
v_mul_f32 v57, s39, v197
v_mul_f32 v58, s39, v198
v_mul_f32 v59, s39, v199
v_exp_f32 v56, v56
v_exp_f32 v57, v57
v_exp_f32 v58, v58
v_exp_f32 v59, v59
v_add_f32 v56, 1.0, v56
v_add_f32 v57, 1.0, v57
v_add_f32 v58, 1.0, v58
v_add_f32 v59, 1.0, v59
v_rcp_f32 v56, v56
v_rcp_f32 v57, v57
v_rcp_f32 v58, v58
v_rcp_f32 v59, v59
v_mul_f32 v196, v196, v56
v_mul_f32 v197, v197, v57
v_mul_f32 v198, v198, v58
v_mul_f32 v199, v199, v59
v_cvt_pk_bf16_f32 v56, v196, v197
v_cvt_pk_bf16_f32 v57, v198, v199
v_lshlrev_b32 v196, 16, v56
v_and_b32 v197, s50, v56
v_lshlrev_b32 v198, 16, v57
v_and_b32 v199, s50, v57
v_mul_f32 v200, s3, v200
v_mul_f32 v201, s3, v201
v_mul_f32 v202, s3, v202
v_mul_f32 v203, s3, v203
v_cvt_pk_bf16_f32 v60, v200, v201
v_cvt_pk_bf16_f32 v61, v202, v203
v_lshlrev_b32 v200, 16, v60
v_and_b32 v201, s50, v60
v_lshlrev_b32 v202, 16, v61
v_and_b32 v203, s50, v61
v_mul_f32 v60, s39, v200
v_mul_f32 v61, s39, v201
v_mul_f32 v62, s39, v202
v_mul_f32 v63, s39, v203
v_exp_f32 v60, v60
v_exp_f32 v61, v61
v_exp_f32 v62, v62
v_exp_f32 v63, v63
v_add_f32 v60, 1.0, v60
v_add_f32 v61, 1.0, v61
v_add_f32 v62, 1.0, v62
v_add_f32 v63, 1.0, v63
v_rcp_f32 v60, v60
v_rcp_f32 v61, v61
v_rcp_f32 v62, v62
v_rcp_f32 v63, v63
v_mul_f32 v200, v200, v60
v_mul_f32 v201, v201, v61
v_mul_f32 v202, v202, v62
v_mul_f32 v203, v203, v63
v_cvt_pk_bf16_f32 v60, v200, v201
v_cvt_pk_bf16_f32 v61, v202, v203
v_lshlrev_b32 v200, 16, v60
v_and_b32 v201, s50, v60
v_lshlrev_b32 v202, 16, v61
v_and_b32 v203, s50, v61
v_mul_f32 v204, s3, v204
v_mul_f32 v205, s3, v205
v_mul_f32 v206, s3, v206
v_mul_f32 v207, s3, v207
v_cvt_pk_bf16_f32 v56, v204, v205
v_cvt_pk_bf16_f32 v57, v206, v207
v_lshlrev_b32 v204, 16, v56
v_and_b32 v205, s50, v56
v_lshlrev_b32 v206, 16, v57
v_and_b32 v207, s50, v57
v_mul_f32 v56, s39, v204
v_mul_f32 v57, s39, v205
v_mul_f32 v58, s39, v206
v_mul_f32 v59, s39, v207
v_exp_f32 v56, v56
v_exp_f32 v57, v57
v_exp_f32 v58, v58
v_exp_f32 v59, v59
v_add_f32 v56, 1.0, v56
v_add_f32 v57, 1.0, v57
v_add_f32 v58, 1.0, v58
v_add_f32 v59, 1.0, v59
v_rcp_f32 v56, v56
v_rcp_f32 v57, v57
v_rcp_f32 v58, v58
v_rcp_f32 v59, v59
v_mul_f32 v204, v204, v56
v_mul_f32 v205, v205, v57
v_mul_f32 v206, v206, v58
v_mul_f32 v207, v207, v59
v_cvt_pk_bf16_f32 v56, v204, v205
v_cvt_pk_bf16_f32 v57, v206, v207
v_lshlrev_b32 v204, 16, v56
v_and_b32 v205, s50, v56
v_lshlrev_b32 v206, 16, v57
v_and_b32 v207, s50, v57
v_mul_f32 v208, s3, v208
v_mul_f32 v209, s3, v209
v_mul_f32 v210, s3, v210
v_mul_f32 v211, s3, v211
v_cvt_pk_bf16_f32 v60, v208, v209
v_cvt_pk_bf16_f32 v61, v210, v211
v_lshlrev_b32 v208, 16, v60
v_and_b32 v209, s50, v60
v_lshlrev_b32 v210, 16, v61
v_and_b32 v211, s50, v61
v_mul_f32 v60, s39, v208
v_mul_f32 v61, s39, v209
v_mul_f32 v62, s39, v210
v_mul_f32 v63, s39, v211
v_exp_f32 v60, v60
v_exp_f32 v61, v61
v_exp_f32 v62, v62
v_exp_f32 v63, v63
v_add_f32 v60, 1.0, v60
v_add_f32 v61, 1.0, v61
v_add_f32 v62, 1.0, v62
v_add_f32 v63, 1.0, v63
v_rcp_f32 v60, v60
v_rcp_f32 v61, v61
v_rcp_f32 v62, v62
v_rcp_f32 v63, v63
v_mul_f32 v208, v208, v60
v_mul_f32 v209, v209, v61
v_mul_f32 v210, v210, v62
v_mul_f32 v211, v211, v63
v_cvt_pk_bf16_f32 v60, v208, v209
v_cvt_pk_bf16_f32 v61, v210, v211
v_lshlrev_b32 v208, 16, v60
v_and_b32 v209, s50, v60
v_lshlrev_b32 v210, 16, v61
v_and_b32 v211, s50, v61
v_mul_f32 v212, s3, v212
v_mul_f32 v213, s3, v213
v_mul_f32 v214, s3, v214
v_mul_f32 v215, s3, v215
v_cvt_pk_bf16_f32 v56, v212, v213
v_cvt_pk_bf16_f32 v57, v214, v215
v_lshlrev_b32 v212, 16, v56
v_and_b32 v213, s50, v56
v_lshlrev_b32 v214, 16, v57
v_and_b32 v215, s50, v57
v_mul_f32 v56, s39, v212
v_mul_f32 v57, s39, v213
v_mul_f32 v58, s39, v214
v_mul_f32 v59, s39, v215
v_exp_f32 v56, v56
v_exp_f32 v57, v57
v_exp_f32 v58, v58
v_exp_f32 v59, v59
v_add_f32 v56, 1.0, v56
v_add_f32 v57, 1.0, v57
v_add_f32 v58, 1.0, v58
v_add_f32 v59, 1.0, v59
v_rcp_f32 v56, v56
v_rcp_f32 v57, v57
v_rcp_f32 v58, v58
v_rcp_f32 v59, v59
v_mul_f32 v212, v212, v56
v_mul_f32 v213, v213, v57
v_mul_f32 v214, v214, v58
v_mul_f32 v215, v215, v59
v_cvt_pk_bf16_f32 v56, v212, v213
v_cvt_pk_bf16_f32 v57, v214, v215
v_lshlrev_b32 v212, 16, v56
v_and_b32 v213, s50, v56
v_lshlrev_b32 v214, 16, v57
v_and_b32 v215, s50, v57
s_waitcnt vmcnt(22)
v_lshlrev_b32 v216, 16, v2
v_and_b32 v217, s50, v2
v_lshlrev_b32 v218, 16, v3
v_and_b32 v219, s50, v3
v_lshlrev_b32 v220, 16, v4
v_and_b32 v221, s50, v4
v_lshlrev_b32 v222, 16, v5
v_and_b32 v223, s50, v5
v_lshlrev_b32 v224, 16, v6
v_and_b32 v225, s50, v6
v_lshlrev_b32 v226, 16, v7
v_and_b32 v227, s50, v7
v_lshlrev_b32 v228, 16, v8
v_and_b32 v229, s50, v8
v_lshlrev_b32 v230, 16, v9
v_and_b32 v231, s50, v9
v_lshlrev_b32 v232, 16, v10
v_and_b32 v233, s50, v10
v_lshlrev_b32 v234, 16, v11
v_and_b32 v235, s50, v11
s_waitcnt vmcnt(18)
s_bitcmp1_b32 s54, 0
s_cbranch_scc0 L_c_e0
v_lshlrev_b32 v40, 16, v96
v_and_b32 v41, s50, v96
v_pk_add_f32 v[176:177], v[176:177], v[40:41]
v_lshlrev_b32 v42, 16, v97
v_and_b32 v43, s50, v97
v_pk_add_f32 v[178:179], v[178:179], v[42:43]
v_lshlrev_b32 v44, 16, v98
v_and_b32 v45, s50, v98
v_pk_add_f32 v[180:181], v[180:181], v[44:45]
v_lshlrev_b32 v46, 16, v99
v_and_b32 v47, s50, v99
v_pk_add_f32 v[182:183], v[182:183], v[46:47]
v_lshlrev_b32 v40, 16, v100
v_and_b32 v41, s50, v100
v_pk_add_f32 v[184:185], v[184:185], v[40:41]
v_lshlrev_b32 v42, 16, v101
v_and_b32 v43, s50, v101
v_pk_add_f32 v[186:187], v[186:187], v[42:43]
v_lshlrev_b32 v44, 16, v102
v_and_b32 v45, s50, v102
v_pk_add_f32 v[188:189], v[188:189], v[44:45]
v_lshlrev_b32 v46, 16, v103
v_and_b32 v47, s50, v103
v_pk_add_f32 v[190:191], v[190:191], v[46:47]
v_lshlrev_b32 v40, 16, v104
v_and_b32 v41, s50, v104
v_pk_add_f32 v[192:193], v[192:193], v[40:41]
v_lshlrev_b32 v42, 16, v105
v_and_b32 v43, s50, v105
v_pk_add_f32 v[194:195], v[194:195], v[42:43]
L_c_e0:
s_waitcnt vmcnt(15)
s_bitcmp1_b32 s54, 1
s_cbranch_scc0 L_c_e1
v_lshlrev_b32 v40, 16, v106
v_and_b32 v41, s50, v106
v_pk_add_f32 v[176:177], v[176:177], v[40:41]
v_lshlrev_b32 v42, 16, v107
v_and_b32 v43, s50, v107
v_pk_add_f32 v[178:179], v[178:179], v[42:43]
v_lshlrev_b32 v44, 16, v108
v_and_b32 v45, s50, v108
v_pk_add_f32 v[180:181], v[180:181], v[44:45]
v_lshlrev_b32 v46, 16, v109
v_and_b32 v47, s50, v109
v_pk_add_f32 v[182:183], v[182:183], v[46:47]
v_lshlrev_b32 v40, 16, v110
v_and_b32 v41, s50, v110
v_pk_add_f32 v[184:185], v[184:185], v[40:41]
v_lshlrev_b32 v42, 16, v111
v_and_b32 v43, s50, v111
v_pk_add_f32 v[186:187], v[186:187], v[42:43]
v_lshlrev_b32 v44, 16, v112
v_and_b32 v45, s50, v112
v_pk_add_f32 v[188:189], v[188:189], v[44:45]
v_lshlrev_b32 v46, 16, v113
v_and_b32 v47, s50, v113
v_pk_add_f32 v[190:191], v[190:191], v[46:47]
v_lshlrev_b32 v40, 16, v114
v_and_b32 v41, s50, v114
v_pk_add_f32 v[192:193], v[192:193], v[40:41]
v_lshlrev_b32 v42, 16, v115
v_and_b32 v43, s50, v115
v_pk_add_f32 v[194:195], v[194:195], v[42:43]
L_c_e1:
s_waitcnt vmcnt(12)
s_bitcmp1_b32 s54, 2
s_cbranch_scc0 L_c_e2
v_lshlrev_b32 v40, 16, v116
v_and_b32 v41, s50, v116
v_pk_add_f32 v[176:177], v[176:177], v[40:41]
v_lshlrev_b32 v42, 16, v117
v_and_b32 v43, s50, v117
v_pk_add_f32 v[178:179], v[178:179], v[42:43]
v_lshlrev_b32 v44, 16, v118
v_and_b32 v45, s50, v118
v_pk_add_f32 v[180:181], v[180:181], v[44:45]
v_lshlrev_b32 v46, 16, v119
v_and_b32 v47, s50, v119
v_pk_add_f32 v[182:183], v[182:183], v[46:47]
v_lshlrev_b32 v40, 16, v120
v_and_b32 v41, s50, v120
v_pk_add_f32 v[184:185], v[184:185], v[40:41]
v_lshlrev_b32 v42, 16, v121
v_and_b32 v43, s50, v121
v_pk_add_f32 v[186:187], v[186:187], v[42:43]
v_lshlrev_b32 v44, 16, v122
v_and_b32 v45, s50, v122
v_pk_add_f32 v[188:189], v[188:189], v[44:45]
v_lshlrev_b32 v46, 16, v123
v_and_b32 v47, s50, v123
v_pk_add_f32 v[190:191], v[190:191], v[46:47]
v_lshlrev_b32 v40, 16, v124
v_and_b32 v41, s50, v124
v_pk_add_f32 v[192:193], v[192:193], v[40:41]
v_lshlrev_b32 v42, 16, v125
v_and_b32 v43, s50, v125
v_pk_add_f32 v[194:195], v[194:195], v[42:43]
L_c_e2:
s_waitcnt vmcnt(9)
s_bitcmp1_b32 s54, 3
s_cbranch_scc0 L_c_e3
v_lshlrev_b32 v40, 16, v126
v_and_b32 v41, s50, v126
v_pk_add_f32 v[176:177], v[176:177], v[40:41]
v_lshlrev_b32 v42, 16, v127
v_and_b32 v43, s50, v127
v_pk_add_f32 v[178:179], v[178:179], v[42:43]
v_lshlrev_b32 v44, 16, v128
v_and_b32 v45, s50, v128
v_pk_add_f32 v[180:181], v[180:181], v[44:45]
v_lshlrev_b32 v46, 16, v129
v_and_b32 v47, s50, v129
v_pk_add_f32 v[182:183], v[182:183], v[46:47]
v_lshlrev_b32 v40, 16, v130
v_and_b32 v41, s50, v130
v_pk_add_f32 v[184:185], v[184:185], v[40:41]
v_lshlrev_b32 v42, 16, v131
v_and_b32 v43, s50, v131
v_pk_add_f32 v[186:187], v[186:187], v[42:43]
v_lshlrev_b32 v44, 16, v132
v_and_b32 v45, s50, v132
v_pk_add_f32 v[188:189], v[188:189], v[44:45]
v_lshlrev_b32 v46, 16, v133
v_and_b32 v47, s50, v133
v_pk_add_f32 v[190:191], v[190:191], v[46:47]
v_lshlrev_b32 v40, 16, v134
v_and_b32 v41, s50, v134
v_pk_add_f32 v[192:193], v[192:193], v[40:41]
v_lshlrev_b32 v42, 16, v135
v_and_b32 v43, s50, v135
v_pk_add_f32 v[194:195], v[194:195], v[42:43]
L_c_e3:
s_waitcnt vmcnt(6)
s_bitcmp1_b32 s54, 4
s_cbranch_scc0 L_c_e4
v_lshlrev_b32 v40, 16, v136
v_and_b32 v41, s50, v136
v_pk_add_f32 v[176:177], v[176:177], v[40:41]
v_lshlrev_b32 v42, 16, v137
v_and_b32 v43, s50, v137
v_pk_add_f32 v[178:179], v[178:179], v[42:43]
v_lshlrev_b32 v44, 16, v138
v_and_b32 v45, s50, v138
v_pk_add_f32 v[180:181], v[180:181], v[44:45]
v_lshlrev_b32 v46, 16, v139
v_and_b32 v47, s50, v139
v_pk_add_f32 v[182:183], v[182:183], v[46:47]
v_lshlrev_b32 v40, 16, v140
v_and_b32 v41, s50, v140
v_pk_add_f32 v[184:185], v[184:185], v[40:41]
v_lshlrev_b32 v42, 16, v141
v_and_b32 v43, s50, v141
v_pk_add_f32 v[186:187], v[186:187], v[42:43]
v_lshlrev_b32 v44, 16, v142
v_and_b32 v45, s50, v142
v_pk_add_f32 v[188:189], v[188:189], v[44:45]
v_lshlrev_b32 v46, 16, v143
v_and_b32 v47, s50, v143
v_pk_add_f32 v[190:191], v[190:191], v[46:47]
v_lshlrev_b32 v40, 16, v144
v_and_b32 v41, s50, v144
v_pk_add_f32 v[192:193], v[192:193], v[40:41]
v_lshlrev_b32 v42, 16, v145
v_and_b32 v43, s50, v145
v_pk_add_f32 v[194:195], v[194:195], v[42:43]
L_c_e4:
s_waitcnt vmcnt(3)
s_bitcmp1_b32 s54, 5
s_cbranch_scc0 L_c_e5
v_lshlrev_b32 v40, 16, v146
v_and_b32 v41, s50, v146
v_pk_add_f32 v[176:177], v[176:177], v[40:41]
v_lshlrev_b32 v42, 16, v147
v_and_b32 v43, s50, v147
v_pk_add_f32 v[178:179], v[178:179], v[42:43]
v_lshlrev_b32 v44, 16, v148
v_and_b32 v45, s50, v148
v_pk_add_f32 v[180:181], v[180:181], v[44:45]
v_lshlrev_b32 v46, 16, v149
v_and_b32 v47, s50, v149
v_pk_add_f32 v[182:183], v[182:183], v[46:47]
v_lshlrev_b32 v40, 16, v150
v_and_b32 v41, s50, v150
v_pk_add_f32 v[184:185], v[184:185], v[40:41]
v_lshlrev_b32 v42, 16, v151
v_and_b32 v43, s50, v151
v_pk_add_f32 v[186:187], v[186:187], v[42:43]
v_lshlrev_b32 v44, 16, v152
v_and_b32 v45, s50, v152
v_pk_add_f32 v[188:189], v[188:189], v[44:45]
v_lshlrev_b32 v46, 16, v153
v_and_b32 v47, s50, v153
v_pk_add_f32 v[190:191], v[190:191], v[46:47]
v_lshlrev_b32 v40, 16, v154
v_and_b32 v41, s50, v154
v_pk_add_f32 v[192:193], v[192:193], v[40:41]
v_lshlrev_b32 v42, 16, v155
v_and_b32 v43, s50, v155
v_pk_add_f32 v[194:195], v[194:195], v[42:43]
L_c_e5:
s_waitcnt vmcnt(0)
s_bitcmp1_b32 s54, 6
s_cbranch_scc0 L_c_e6
v_lshlrev_b32 v40, 16, v156
v_and_b32 v41, s50, v156
v_pk_add_f32 v[176:177], v[176:177], v[40:41]
v_lshlrev_b32 v42, 16, v157
v_and_b32 v43, s50, v157
v_pk_add_f32 v[178:179], v[178:179], v[42:43]
v_lshlrev_b32 v44, 16, v158
v_and_b32 v45, s50, v158
v_pk_add_f32 v[180:181], v[180:181], v[44:45]
v_lshlrev_b32 v46, 16, v159
v_and_b32 v47, s50, v159
v_pk_add_f32 v[182:183], v[182:183], v[46:47]
v_lshlrev_b32 v40, 16, v160
v_and_b32 v41, s50, v160
v_pk_add_f32 v[184:185], v[184:185], v[40:41]
v_lshlrev_b32 v42, 16, v161
v_and_b32 v43, s50, v161
v_pk_add_f32 v[186:187], v[186:187], v[42:43]
v_lshlrev_b32 v44, 16, v162
v_and_b32 v45, s50, v162
v_pk_add_f32 v[188:189], v[188:189], v[44:45]
v_lshlrev_b32 v46, 16, v163
v_and_b32 v47, s50, v163
v_pk_add_f32 v[190:191], v[190:191], v[46:47]
v_lshlrev_b32 v40, 16, v164
v_and_b32 v41, s50, v164
v_pk_add_f32 v[192:193], v[192:193], v[40:41]
v_lshlrev_b32 v42, 16, v165
v_and_b32 v43, s50, v165
v_pk_add_f32 v[194:195], v[194:195], v[42:43]
L_c_e6:
s_cmp_eq_u32 s54, 0x7f
s_cbranch_scc1 L_c_all
s_mov_b32 s92, 262144
L_c_late:
buffer_load_dword v35, v39, s[40:43], s51 offen offset:192 sc0 sc1
s_waitcnt vmcnt(0)
v_cmp_eq_u32 vcc, 1, v35
s_nop 0
s_and_b32 s55, vcc_lo, 0xff
s_lshl_b32 s3, s55, 8
s_or_b32 s55, s55, s3
s_add_u32 s3, s60, 1
s_lshr_b32 s55, s55, s3
s_and_b32 s55, s55, 0x7f
s_andn2_b32 s55, s55, s54
s_cmp_eq_u32 s92, 0
s_cselect_b32 s3, 0x7f, 0
s_andn2_b32 s3, s3, s54
s_or_b32 s55, s55, s3
s_bitcmp1_b32 s55, 0
s_cbranch_scc0 L_c_l0
s_add_u32 s3, s60, 1
s_and_b32 s3, s3, 7
s_mul_i32 s3, s3, 10240
s_add_u32 s39, s38, s3
buffer_load_dwordx4 v[96:99], v36, s[40:43], s39 offen sc0 sc1
buffer_load_dwordx4 v[100:103], v36, s[40:43], s39 offen offset:1024 sc0 sc1
buffer_load_dwordx2 v[104:105], v37, s[40:43], s39 offen sc0 sc1
L_c_l0:
s_bitcmp1_b32 s55, 1
s_cbranch_scc0 L_c_l1
s_add_u32 s3, s60, 2
s_and_b32 s3, s3, 7
s_mul_i32 s3, s3, 10240
s_add_u32 s39, s38, s3
buffer_load_dwordx4 v[106:109], v36, s[40:43], s39 offen sc0 sc1
buffer_load_dwordx4 v[110:113], v36, s[40:43], s39 offen offset:1024 sc0 sc1
buffer_load_dwordx2 v[114:115], v37, s[40:43], s39 offen sc0 sc1
L_c_l1:
s_bitcmp1_b32 s55, 2
s_cbranch_scc0 L_c_l2
s_add_u32 s3, s60, 3
s_and_b32 s3, s3, 7
s_mul_i32 s3, s3, 10240
s_add_u32 s39, s38, s3
buffer_load_dwordx4 v[116:119], v36, s[40:43], s39 offen sc0 sc1
buffer_load_dwordx4 v[120:123], v36, s[40:43], s39 offen offset:1024 sc0 sc1
buffer_load_dwordx2 v[124:125], v37, s[40:43], s39 offen sc0 sc1
L_c_l2:
s_bitcmp1_b32 s55, 3
s_cbranch_scc0 L_c_l3
s_add_u32 s3, s60, 4
s_and_b32 s3, s3, 7
s_mul_i32 s3, s3, 10240
s_add_u32 s39, s38, s3
buffer_load_dwordx4 v[126:129], v36, s[40:43], s39 offen sc0 sc1
buffer_load_dwordx4 v[130:133], v36, s[40:43], s39 offen offset:1024 sc0 sc1
buffer_load_dwordx2 v[134:135], v37, s[40:43], s39 offen sc0 sc1
L_c_l3:
s_bitcmp1_b32 s55, 4
s_cbranch_scc0 L_c_l4
s_add_u32 s3, s60, 5
s_and_b32 s3, s3, 7
s_mul_i32 s3, s3, 10240
s_add_u32 s39, s38, s3
buffer_load_dwordx4 v[136:139], v36, s[40:43], s39 offen sc0 sc1
buffer_load_dwordx4 v[140:143], v36, s[40:43], s39 offen offset:1024 sc0 sc1
buffer_load_dwordx2 v[144:145], v37, s[40:43], s39 offen sc0 sc1
L_c_l4:
s_bitcmp1_b32 s55, 5
s_cbranch_scc0 L_c_l5
s_add_u32 s3, s60, 6
s_and_b32 s3, s3, 7
s_mul_i32 s3, s3, 10240
s_add_u32 s39, s38, s3
buffer_load_dwordx4 v[146:149], v36, s[40:43], s39 offen sc0 sc1
buffer_load_dwordx4 v[150:153], v36, s[40:43], s39 offen offset:1024 sc0 sc1
buffer_load_dwordx2 v[154:155], v37, s[40:43], s39 offen sc0 sc1
L_c_l5:
s_bitcmp1_b32 s55, 6
s_cbranch_scc0 L_c_l6
s_add_u32 s3, s60, 7
s_and_b32 s3, s3, 7
s_mul_i32 s3, s3, 10240
s_add_u32 s39, s38, s3
buffer_load_dwordx4 v[156:159], v36, s[40:43], s39 offen sc0 sc1
buffer_load_dwordx4 v[160:163], v36, s[40:43], s39 offen offset:1024 sc0 sc1
buffer_load_dwordx2 v[164:165], v37, s[40:43], s39 offen sc0 sc1
L_c_l6:
s_waitcnt vmcnt(0)
s_bitcmp1_b32 s55, 0
s_cbranch_scc0 L_c_m0
v_lshlrev_b32 v40, 16, v96
v_and_b32 v41, s50, v96
v_pk_add_f32 v[176:177], v[176:177], v[40:41]
v_lshlrev_b32 v42, 16, v97
v_and_b32 v43, s50, v97
v_pk_add_f32 v[178:179], v[178:179], v[42:43]
v_lshlrev_b32 v44, 16, v98
v_and_b32 v45, s50, v98
v_pk_add_f32 v[180:181], v[180:181], v[44:45]
v_lshlrev_b32 v46, 16, v99
v_and_b32 v47, s50, v99
v_pk_add_f32 v[182:183], v[182:183], v[46:47]
v_lshlrev_b32 v40, 16, v100
v_and_b32 v41, s50, v100
v_pk_add_f32 v[184:185], v[184:185], v[40:41]
v_lshlrev_b32 v42, 16, v101
v_and_b32 v43, s50, v101
v_pk_add_f32 v[186:187], v[186:187], v[42:43]
v_lshlrev_b32 v44, 16, v102
v_and_b32 v45, s50, v102
v_pk_add_f32 v[188:189], v[188:189], v[44:45]
v_lshlrev_b32 v46, 16, v103
v_and_b32 v47, s50, v103
v_pk_add_f32 v[190:191], v[190:191], v[46:47]
v_lshlrev_b32 v40, 16, v104
v_and_b32 v41, s50, v104
v_pk_add_f32 v[192:193], v[192:193], v[40:41]
v_lshlrev_b32 v42, 16, v105
v_and_b32 v43, s50, v105
v_pk_add_f32 v[194:195], v[194:195], v[42:43]
L_c_m0:
s_bitcmp1_b32 s55, 1
s_cbranch_scc0 L_c_m1
v_lshlrev_b32 v40, 16, v106
v_and_b32 v41, s50, v106
v_pk_add_f32 v[176:177], v[176:177], v[40:41]
v_lshlrev_b32 v42, 16, v107
v_and_b32 v43, s50, v107
v_pk_add_f32 v[178:179], v[178:179], v[42:43]
v_lshlrev_b32 v44, 16, v108
v_and_b32 v45, s50, v108
v_pk_add_f32 v[180:181], v[180:181], v[44:45]
v_lshlrev_b32 v46, 16, v109
v_and_b32 v47, s50, v109
v_pk_add_f32 v[182:183], v[182:183], v[46:47]
v_lshlrev_b32 v40, 16, v110
v_and_b32 v41, s50, v110
v_pk_add_f32 v[184:185], v[184:185], v[40:41]
v_lshlrev_b32 v42, 16, v111
v_and_b32 v43, s50, v111
v_pk_add_f32 v[186:187], v[186:187], v[42:43]
v_lshlrev_b32 v44, 16, v112
v_and_b32 v45, s50, v112
v_pk_add_f32 v[188:189], v[188:189], v[44:45]
v_lshlrev_b32 v46, 16, v113
v_and_b32 v47, s50, v113
v_pk_add_f32 v[190:191], v[190:191], v[46:47]
v_lshlrev_b32 v40, 16, v114
v_and_b32 v41, s50, v114
v_pk_add_f32 v[192:193], v[192:193], v[40:41]
v_lshlrev_b32 v42, 16, v115
v_and_b32 v43, s50, v115
v_pk_add_f32 v[194:195], v[194:195], v[42:43]
L_c_m1:
s_bitcmp1_b32 s55, 2
s_cbranch_scc0 L_c_m2
v_lshlrev_b32 v40, 16, v116
v_and_b32 v41, s50, v116
v_pk_add_f32 v[176:177], v[176:177], v[40:41]
v_lshlrev_b32 v42, 16, v117
v_and_b32 v43, s50, v117
v_pk_add_f32 v[178:179], v[178:179], v[42:43]
v_lshlrev_b32 v44, 16, v118
v_and_b32 v45, s50, v118
v_pk_add_f32 v[180:181], v[180:181], v[44:45]
v_lshlrev_b32 v46, 16, v119
v_and_b32 v47, s50, v119
v_pk_add_f32 v[182:183], v[182:183], v[46:47]
v_lshlrev_b32 v40, 16, v120
v_and_b32 v41, s50, v120
v_pk_add_f32 v[184:185], v[184:185], v[40:41]
v_lshlrev_b32 v42, 16, v121
v_and_b32 v43, s50, v121
v_pk_add_f32 v[186:187], v[186:187], v[42:43]
v_lshlrev_b32 v44, 16, v122
v_and_b32 v45, s50, v122
v_pk_add_f32 v[188:189], v[188:189], v[44:45]
v_lshlrev_b32 v46, 16, v123
v_and_b32 v47, s50, v123
v_pk_add_f32 v[190:191], v[190:191], v[46:47]
v_lshlrev_b32 v40, 16, v124
v_and_b32 v41, s50, v124
v_pk_add_f32 v[192:193], v[192:193], v[40:41]
v_lshlrev_b32 v42, 16, v125
v_and_b32 v43, s50, v125
v_pk_add_f32 v[194:195], v[194:195], v[42:43]
L_c_m2:
s_bitcmp1_b32 s55, 3
s_cbranch_scc0 L_c_m3
v_lshlrev_b32 v40, 16, v126
v_and_b32 v41, s50, v126
v_pk_add_f32 v[176:177], v[176:177], v[40:41]
v_lshlrev_b32 v42, 16, v127
v_and_b32 v43, s50, v127
v_pk_add_f32 v[178:179], v[178:179], v[42:43]
v_lshlrev_b32 v44, 16, v128
v_and_b32 v45, s50, v128
v_pk_add_f32 v[180:181], v[180:181], v[44:45]
v_lshlrev_b32 v46, 16, v129
v_and_b32 v47, s50, v129
v_pk_add_f32 v[182:183], v[182:183], v[46:47]
v_lshlrev_b32 v40, 16, v130
v_and_b32 v41, s50, v130
v_pk_add_f32 v[184:185], v[184:185], v[40:41]
v_lshlrev_b32 v42, 16, v131
v_and_b32 v43, s50, v131
v_pk_add_f32 v[186:187], v[186:187], v[42:43]
v_lshlrev_b32 v44, 16, v132
v_and_b32 v45, s50, v132
v_pk_add_f32 v[188:189], v[188:189], v[44:45]
v_lshlrev_b32 v46, 16, v133
v_and_b32 v47, s50, v133
v_pk_add_f32 v[190:191], v[190:191], v[46:47]
v_lshlrev_b32 v40, 16, v134
v_and_b32 v41, s50, v134
v_pk_add_f32 v[192:193], v[192:193], v[40:41]
v_lshlrev_b32 v42, 16, v135
v_and_b32 v43, s50, v135
v_pk_add_f32 v[194:195], v[194:195], v[42:43]
L_c_m3:
s_bitcmp1_b32 s55, 4
s_cbranch_scc0 L_c_m4
v_lshlrev_b32 v40, 16, v136
v_and_b32 v41, s50, v136
v_pk_add_f32 v[176:177], v[176:177], v[40:41]
v_lshlrev_b32 v42, 16, v137
v_and_b32 v43, s50, v137
v_pk_add_f32 v[178:179], v[178:179], v[42:43]
v_lshlrev_b32 v44, 16, v138
v_and_b32 v45, s50, v138
v_pk_add_f32 v[180:181], v[180:181], v[44:45]
v_lshlrev_b32 v46, 16, v139
v_and_b32 v47, s50, v139
v_pk_add_f32 v[182:183], v[182:183], v[46:47]
v_lshlrev_b32 v40, 16, v140
v_and_b32 v41, s50, v140
v_pk_add_f32 v[184:185], v[184:185], v[40:41]
v_lshlrev_b32 v42, 16, v141
v_and_b32 v43, s50, v141
v_pk_add_f32 v[186:187], v[186:187], v[42:43]
v_lshlrev_b32 v44, 16, v142
v_and_b32 v45, s50, v142
v_pk_add_f32 v[188:189], v[188:189], v[44:45]
v_lshlrev_b32 v46, 16, v143
v_and_b32 v47, s50, v143
v_pk_add_f32 v[190:191], v[190:191], v[46:47]
v_lshlrev_b32 v40, 16, v144
v_and_b32 v41, s50, v144
v_pk_add_f32 v[192:193], v[192:193], v[40:41]
v_lshlrev_b32 v42, 16, v145
v_and_b32 v43, s50, v145
v_pk_add_f32 v[194:195], v[194:195], v[42:43]
L_c_m4:
s_bitcmp1_b32 s55, 5
s_cbranch_scc0 L_c_m5
v_lshlrev_b32 v40, 16, v146
v_and_b32 v41, s50, v146
v_pk_add_f32 v[176:177], v[176:177], v[40:41]
v_lshlrev_b32 v42, 16, v147
v_and_b32 v43, s50, v147
v_pk_add_f32 v[178:179], v[178:179], v[42:43]
v_lshlrev_b32 v44, 16, v148
v_and_b32 v45, s50, v148
v_pk_add_f32 v[180:181], v[180:181], v[44:45]
v_lshlrev_b32 v46, 16, v149
v_and_b32 v47, s50, v149
v_pk_add_f32 v[182:183], v[182:183], v[46:47]
v_lshlrev_b32 v40, 16, v150
v_and_b32 v41, s50, v150
v_pk_add_f32 v[184:185], v[184:185], v[40:41]
v_lshlrev_b32 v42, 16, v151
v_and_b32 v43, s50, v151
v_pk_add_f32 v[186:187], v[186:187], v[42:43]
v_lshlrev_b32 v44, 16, v152
v_and_b32 v45, s50, v152
v_pk_add_f32 v[188:189], v[188:189], v[44:45]
v_lshlrev_b32 v46, 16, v153
v_and_b32 v47, s50, v153
v_pk_add_f32 v[190:191], v[190:191], v[46:47]
v_lshlrev_b32 v40, 16, v154
v_and_b32 v41, s50, v154
v_pk_add_f32 v[192:193], v[192:193], v[40:41]
v_lshlrev_b32 v42, 16, v155
v_and_b32 v43, s50, v155
v_pk_add_f32 v[194:195], v[194:195], v[42:43]
L_c_m5:
s_bitcmp1_b32 s55, 6
s_cbranch_scc0 L_c_m6
v_lshlrev_b32 v40, 16, v156
v_and_b32 v41, s50, v156
v_pk_add_f32 v[176:177], v[176:177], v[40:41]
v_lshlrev_b32 v42, 16, v157
v_and_b32 v43, s50, v157
v_pk_add_f32 v[178:179], v[178:179], v[42:43]
v_lshlrev_b32 v44, 16, v158
v_and_b32 v45, s50, v158
v_pk_add_f32 v[180:181], v[180:181], v[44:45]
v_lshlrev_b32 v46, 16, v159
v_and_b32 v47, s50, v159
v_pk_add_f32 v[182:183], v[182:183], v[46:47]
v_lshlrev_b32 v40, 16, v160
v_and_b32 v41, s50, v160
v_pk_add_f32 v[184:185], v[184:185], v[40:41]
v_lshlrev_b32 v42, 16, v161
v_and_b32 v43, s50, v161
v_pk_add_f32 v[186:187], v[186:187], v[42:43]
v_lshlrev_b32 v44, 16, v162
v_and_b32 v45, s50, v162
v_pk_add_f32 v[188:189], v[188:189], v[44:45]
v_lshlrev_b32 v46, 16, v163
v_and_b32 v47, s50, v163
v_pk_add_f32 v[190:191], v[190:191], v[46:47]
v_lshlrev_b32 v40, 16, v164
v_and_b32 v41, s50, v164
v_pk_add_f32 v[192:193], v[192:193], v[40:41]
v_lshlrev_b32 v42, 16, v165
v_and_b32 v43, s50, v165
v_pk_add_f32 v[194:195], v[194:195], v[42:43]
L_c_m6:
s_or_b32 s54, s54, s55
s_cmp_eq_u32 s54, 0x7f
s_cbranch_scc1 L_c_all
s_max_u32 s92, s92, 1
s_sub_u32 s92, s92, 1
s_sleep 1
s_branch L_c_late
L_c_all:
v_cvt_pk_bf16_f32 v40, v176, v177
v_cvt_pk_bf16_f32 v41, v178, v179
v_lshlrev_b32 v176, 16, v40
v_and_b32 v177, s50, v40
v_lshlrev_b32 v178, 16, v41
v_and_b32 v179, s50, v41
v_pk_mul_f32 v[176:177], v[176:177], v[196:197]
v_pk_mul_f32 v[178:179], v[178:179], v[198:199]
v_cvt_pk_bf16_f32 v40, v176, v177
v_cvt_pk_bf16_f32 v41, v178, v179
v_lshlrev_b32 v176, 16, v40
v_and_b32 v177, s50, v40
v_lshlrev_b32 v178, 16, v41
v_and_b32 v179, s50, v41
.p2align 3
v_pk_add_f32 v[176:177], v[176:177], v[216:217]
v_pk_add_f32 v[178:179], v[178:179], v[218:219]
v_cvt_pk_bf16_f32 v44, v176, v177
v_cvt_pk_bf16_f32 v45, v178, v179
buffer_store_dwordx2 v[44:45], v25, s[84:87], 0 offen offset:0
v_cvt_pk_bf16_f32 v48, v180, v181
v_cvt_pk_bf16_f32 v49, v182, v183
v_lshlrev_b32 v180, 16, v48
v_and_b32 v181, s50, v48
v_lshlrev_b32 v182, 16, v49
v_and_b32 v183, s50, v49
v_pk_mul_f32 v[180:181], v[180:181], v[200:201]
v_pk_mul_f32 v[182:183], v[182:183], v[202:203]
v_cvt_pk_bf16_f32 v48, v180, v181
v_cvt_pk_bf16_f32 v49, v182, v183
v_lshlrev_b32 v180, 16, v48
v_and_b32 v181, s50, v48
v_lshlrev_b32 v182, 16, v49
v_and_b32 v183, s50, v49
.p2align 3
v_pk_add_f32 v[180:181], v[180:181], v[220:221]
v_pk_add_f32 v[182:183], v[182:183], v[222:223]
v_cvt_pk_bf16_f32 v52, v180, v181
v_cvt_pk_bf16_f32 v53, v182, v183
buffer_store_dwordx2 v[52:53], v25, s[84:87], 0 offen offset:32
v_cvt_pk_bf16_f32 v56, v184, v185
v_cvt_pk_bf16_f32 v57, v186, v187
v_lshlrev_b32 v184, 16, v56
v_and_b32 v185, s50, v56
v_lshlrev_b32 v186, 16, v57
v_and_b32 v187, s50, v57
v_pk_mul_f32 v[184:185], v[184:185], v[204:205]
v_pk_mul_f32 v[186:187], v[186:187], v[206:207]
v_cvt_pk_bf16_f32 v56, v184, v185
v_cvt_pk_bf16_f32 v57, v186, v187
v_lshlrev_b32 v184, 16, v56
v_and_b32 v185, s50, v56
v_lshlrev_b32 v186, 16, v57
v_and_b32 v187, s50, v57
.p2align 3
v_pk_add_f32 v[184:185], v[184:185], v[224:225]
v_pk_add_f32 v[186:187], v[186:187], v[226:227]
v_cvt_pk_bf16_f32 v60, v184, v185
v_cvt_pk_bf16_f32 v61, v186, v187
buffer_store_dwordx2 v[60:61], v25, s[84:87], 0 offen offset:64
v_cvt_pk_bf16_f32 v40, v188, v189
v_cvt_pk_bf16_f32 v41, v190, v191
v_lshlrev_b32 v188, 16, v40
v_and_b32 v189, s50, v40
v_lshlrev_b32 v190, 16, v41
v_and_b32 v191, s50, v41
v_pk_mul_f32 v[188:189], v[188:189], v[208:209]
v_pk_mul_f32 v[190:191], v[190:191], v[210:211]
v_cvt_pk_bf16_f32 v40, v188, v189
v_cvt_pk_bf16_f32 v41, v190, v191
v_lshlrev_b32 v188, 16, v40
v_and_b32 v189, s50, v40
v_lshlrev_b32 v190, 16, v41
v_and_b32 v191, s50, v41
.p2align 3
v_pk_add_f32 v[188:189], v[188:189], v[228:229]
v_pk_add_f32 v[190:191], v[190:191], v[230:231]
v_cvt_pk_bf16_f32 v44, v188, v189
v_cvt_pk_bf16_f32 v45, v190, v191
buffer_store_dwordx2 v[44:45], v25, s[84:87], 0 offen offset:96
v_cvt_pk_bf16_f32 v48, v192, v193
v_cvt_pk_bf16_f32 v49, v194, v195
v_lshlrev_b32 v192, 16, v48
v_and_b32 v193, s50, v48
v_lshlrev_b32 v194, 16, v49
v_and_b32 v195, s50, v49
v_pk_mul_f32 v[192:193], v[192:193], v[212:213]
v_pk_mul_f32 v[194:195], v[194:195], v[214:215]
v_cvt_pk_bf16_f32 v48, v192, v193
v_cvt_pk_bf16_f32 v49, v194, v195
v_lshlrev_b32 v192, 16, v48
v_and_b32 v193, s50, v48
v_lshlrev_b32 v194, 16, v49
v_and_b32 v195, s50, v49
v_pk_add_f32 v[192:193], v[192:193], v[232:233]
v_pk_add_f32 v[194:195], v[194:195], v[234:235]
v_cvt_pk_bf16_f32 v52, v192, v193
v_cvt_pk_bf16_f32 v53, v194, v195
buffer_store_dwordx2 v[52:53], v25, s[84:87], 0 offen offset:128
L_k2_end:
s_endpgm
L_c_p0_spin:
s_mov_b32 s92, 262144
L_c_p0_again:
s_sleep 1
buffer_load_dword v35, v38, s[40:43], s51 offen offset:0 sc0 sc1
s_waitcnt vmcnt(0)
v_cmp_ne_u32 vcc, 1, v35
s_nop 0
s_cmp_eq_u64 vcc, 0
s_cbranch_scc1 L_c_p0_ok
s_sub_u32 s92, s92, 1
s_cmp_lg_u32 s92, 0
s_cbranch_scc1 L_c_p0_again
s_branch L_c_p0_ok
L_c_p1_spin:
s_mov_b32 s92, 262144
L_c_p1_again:
s_sleep 1
buffer_load_dword v35, v38, s[40:43], s51 offen offset:64 sc0 sc1
s_waitcnt vmcnt(0)
v_cmp_ne_u32 vcc, 1, v35
s_nop 0
s_cmp_eq_u64 vcc, 0
s_cbranch_scc1 L_c_p1_ok
s_sub_u32 s92, s92, 1
s_cmp_lg_u32 s92, 0
s_cbranch_scc1 L_c_p1_again
s_branch L_c_p1_ok
L_c_p2_spin:
s_mov_b32 s92, 262144
L_c_p2_again:
s_sleep 1
buffer_load_dword v35, v38, s[40:43], s51 offen offset:128 sc0 sc1
s_waitcnt vmcnt(0)
v_cmp_ne_u32 vcc, 1, v35
s_nop 0
s_cmp_eq_u64 vcc, 0
s_cbranch_scc1 L_c_p2_ok
s_sub_u32 s92, s92, 1
s_cmp_lg_u32 s92, 0
s_cbranch_scc1 L_c_p2_again
s_branch L_c_p2_ok
L_hook:
s_cmp_lg_u32 s25, 0
s_cbranch_scc1 L_hook_back
s_cmp_eq_u32 s24, 15
s_cbranch_scc1 L_hook_arrive
s_cmp_eq_u32 s24, 8
s_cbranch_scc1 L_hook_load
s_cmp_eq_u32 s24, 6
s_cbranch_scc0 L_hook_back
s_mov_b32 s92, 262144
L_hook_check:
v_readfirstlane_b32 s3, v253
s_nop 0
s_cmp_ge_u32 s3, 256
s_cbranch_scc1 L_hook_back
s_sub_u32 s92, s92, 1
s_cmp_eq_u32 s92, 0
s_cbranch_scc1 L_hook_back
s_sleep 1
global_load_dword v253, v252, s[90:91] sc0 sc1
s_waitcnt vmcnt(0)
s_branch L_hook_check
L_hook_arrive:
v_mov_b32 v252, 0
v_mov_b32 v253, 1
s_mov_b64 exec, 1
global_atomic_add v252, v253, s[90:91] sc1
s_mov_b64 exec, -1
s_branch L_hook_back
L_hook_load:
global_load_dword v253, v252, s[90:91] sc0 sc1
s_branch L_hook_back
L_k2_slow:
s_mov_b32 s52, 1
s_mov_b32 s20, 0
s_mov_b32 s21, 0
s_mov_b32 s24, 64
s_waitcnt vmcnt(0)
.p2align 3
v_accvgpr_write_b32 a0, 0
v_accvgpr_write_b32 a1, 0
v_accvgpr_write_b32 a2, 0
v_accvgpr_write_b32 a3, 0
v_accvgpr_write_b32 a4, 0
v_accvgpr_write_b32 a5, 0
v_accvgpr_write_b32 a6, 0
v_accvgpr_write_b32 a7, 0
v_accvgpr_write_b32 a8, 0
v_accvgpr_write_b32 a9, 0
v_accvgpr_write_b32 a10, 0
v_accvgpr_write_b32 a11, 0
v_accvgpr_write_b32 a12, 0
v_accvgpr_write_b32 a13, 0
v_accvgpr_write_b32 a14, 0
v_accvgpr_write_b32 a15, 0
v_accvgpr_write_b32 a16, 0
v_accvgpr_write_b32 a17, 0
v_accvgpr_write_b32 a18, 0
v_accvgpr_write_b32 a19, 0
v_accvgpr_write_b32 a20, 0
v_accvgpr_write_b32 a21, 0
v_accvgpr_write_b32 a22, 0
v_accvgpr_write_b32 a23, 0
v_accvgpr_write_b32 a24, 0
v_accvgpr_write_b32 a25, 0
v_accvgpr_write_b32 a26, 0
v_accvgpr_write_b32 a27, 0
v_accvgpr_write_b32 a28, 0
v_accvgpr_write_b32 a29, 0
v_accvgpr_write_b32 a30, 0
v_accvgpr_write_b32 a31, 0
v_accvgpr_write_b32 a32, 0
v_accvgpr_write_b32 a33, 0
v_accvgpr_write_b32 a34, 0
v_accvgpr_write_b32 a35, 0
v_accvgpr_write_b32 a36, 0
v_accvgpr_write_b32 a37, 0
v_accvgpr_write_b32 a38, 0
v_accvgpr_write_b32 a39, 0
v_accvgpr_write_b32 a40, 0
v_accvgpr_write_b32 a41, 0
v_accvgpr_write_b32 a42, 0
v_accvgpr_write_b32 a43, 0
v_accvgpr_write_b32 a44, 0
v_accvgpr_write_b32 a45, 0
v_accvgpr_write_b32 a46, 0
v_accvgpr_write_b32 a47, 0
v_accvgpr_write_b32 a48, 0
v_accvgpr_write_b32 a49, 0
v_accvgpr_write_b32 a50, 0
v_accvgpr_write_b32 a51, 0
v_accvgpr_write_b32 a52, 0
v_accvgpr_write_b32 a53, 0
v_accvgpr_write_b32 a54, 0
v_accvgpr_write_b32 a55, 0
v_accvgpr_write_b32 a56, 0
v_accvgpr_write_b32 a57, 0
v_accvgpr_write_b32 a58, 0
v_accvgpr_write_b32 a59, 0
v_accvgpr_write_b32 a60, 0
v_accvgpr_write_b32 a61, 0
v_accvgpr_write_b32 a62, 0
v_accvgpr_write_b32 a63, 0
v_accvgpr_write_b32 a64, 0
v_accvgpr_write_b32 a65, 0
v_accvgpr_write_b32 a66, 0
v_accvgpr_write_b32 a67, 0
v_accvgpr_write_b32 a68, 0
v_accvgpr_write_b32 a69, 0
v_accvgpr_write_b32 a70, 0
v_accvgpr_write_b32 a71, 0
v_accvgpr_write_b32 a72, 0
v_accvgpr_write_b32 a73, 0
v_accvgpr_write_b32 a74, 0
v_accvgpr_write_b32 a75, 0
v_accvgpr_write_b32 a76, 0
v_accvgpr_write_b32 a77, 0
v_accvgpr_write_b32 a78, 0
v_accvgpr_write_b32 a79, 0
v_accvgpr_write_b32 a80, 0
v_accvgpr_write_b32 a81, 0
v_accvgpr_write_b32 a82, 0
v_accvgpr_write_b32 a83, 0
v_accvgpr_write_b32 a84, 0
v_accvgpr_write_b32 a85, 0
v_accvgpr_write_b32 a86, 0
v_accvgpr_write_b32 a87, 0
v_accvgpr_write_b32 a88, 0
v_accvgpr_write_b32 a89, 0
v_accvgpr_write_b32 a90, 0
v_accvgpr_write_b32 a91, 0
v_accvgpr_write_b32 a92, 0
v_accvgpr_write_b32 a93, 0
v_accvgpr_write_b32 a94, 0
v_accvgpr_write_b32 a95, 0
v_accvgpr_write_b32 a96, 0
v_accvgpr_write_b32 a97, 0
v_accvgpr_write_b32 a98, 0
v_accvgpr_write_b32 a99, 0
v_accvgpr_write_b32 a100, 0
v_accvgpr_write_b32 a101, 0
v_accvgpr_write_b32 a102, 0
v_accvgpr_write_b32 a103, 0
v_accvgpr_write_b32 a104, 0
v_accvgpr_write_b32 a105, 0
v_accvgpr_write_b32 a106, 0
v_accvgpr_write_b32 a107, 0
v_accvgpr_write_b32 a108, 0
v_accvgpr_write_b32 a109, 0
v_accvgpr_write_b32 a110, 0
v_accvgpr_write_b32 a111, 0
v_accvgpr_write_b32 a112, 0
v_accvgpr_write_b32 a113, 0
v_accvgpr_write_b32 a114, 0
v_accvgpr_write_b32 a115, 0
v_accvgpr_write_b32 a116, 0
v_accvgpr_write_b32 a117, 0
v_accvgpr_write_b32 a118, 0
v_accvgpr_write_b32 a119, 0
v_accvgpr_write_b32 a120, 0
v_accvgpr_write_b32 a121, 0
v_accvgpr_write_b32 a122, 0
v_accvgpr_write_b32 a123, 0
v_accvgpr_write_b32 a124, 0
v_accvgpr_write_b32 a125, 0
v_accvgpr_write_b32 a126, 0
v_accvgpr_write_b32 a127, 0
v_accvgpr_write_b32 a128, 0
v_accvgpr_write_b32 a129, 0
v_accvgpr_write_b32 a130, 0
v_accvgpr_write_b32 a131, 0
v_accvgpr_write_b32 a132, 0
v_accvgpr_write_b32 a133, 0
v_accvgpr_write_b32 a134, 0
v_accvgpr_write_b32 a135, 0
v_accvgpr_write_b32 a136, 0
v_accvgpr_write_b32 a137, 0
v_accvgpr_write_b32 a138, 0
v_accvgpr_write_b32 a139, 0
v_accvgpr_write_b32 a140, 0
v_accvgpr_write_b32 a141, 0
v_accvgpr_write_b32 a142, 0
v_accvgpr_write_b32 a143, 0
v_accvgpr_write_b32 a144, 0
v_accvgpr_write_b32 a145, 0
v_accvgpr_write_b32 a146, 0
v_accvgpr_write_b32 a147, 0
v_accvgpr_write_b32 a148, 0
v_accvgpr_write_b32 a149, 0
v_accvgpr_write_b32 a150, 0
v_accvgpr_write_b32 a151, 0
v_accvgpr_write_b32 a152, 0
v_accvgpr_write_b32 a153, 0
v_accvgpr_write_b32 a154, 0
v_accvgpr_write_b32 a155, 0
v_accvgpr_write_b32 a156, 0
v_accvgpr_write_b32 a157, 0
v_accvgpr_write_b32 a158, 0
v_accvgpr_write_b32 a159, 0
v_accvgpr_write_b32 a160, 0
v_accvgpr_write_b32 a161, 0
v_accvgpr_write_b32 a162, 0
v_accvgpr_write_b32 a163, 0
v_accvgpr_write_b32 a164, 0
v_accvgpr_write_b32 a165, 0
v_accvgpr_write_b32 a166, 0
v_accvgpr_write_b32 a167, 0
v_accvgpr_write_b32 a168, 0
v_accvgpr_write_b32 a169, 0
v_accvgpr_write_b32 a170, 0
v_accvgpr_write_b32 a171, 0
v_accvgpr_write_b32 a172, 0
v_accvgpr_write_b32 a173, 0
v_accvgpr_write_b32 a174, 0
v_accvgpr_write_b32 a175, 0
v_accvgpr_write_b32 a176, 0
v_accvgpr_write_b32 a177, 0
v_accvgpr_write_b32 a178, 0
v_accvgpr_write_b32 a179, 0
v_accvgpr_write_b32 a180, 0
v_accvgpr_write_b32 a181, 0
v_accvgpr_write_b32 a182, 0
v_accvgpr_write_b32 a183, 0
v_accvgpr_write_b32 a184, 0
v_accvgpr_write_b32 a185, 0
v_accvgpr_write_b32 a186, 0
v_accvgpr_write_b32 a187, 0
v_accvgpr_write_b32 a188, 0
v_accvgpr_write_b32 a189, 0
v_accvgpr_write_b32 a190, 0
v_accvgpr_write_b32 a191, 0
v_mov_b32 v14, 0
v_mov_b32 v160, 0xff7fffff
v_mov_b32 v15, 0
v_mov_b32 v161, 0xff7fffff
v_mov_b32 v16, 0
v_mov_b32 v162, 0xff7fffff
v_mov_b32 v17, 0
v_mov_b32 v163, 0xff7fffff
L_k2_slow_loop:
s_barrier
s_add_u32 m0, s22, 24576
s_nop 0
buffer_load_dwordx4 v8, s[8:11], s20 offen offset:0 lds
buffer_load_dwordx4 v9, s[8:11], s20 offen offset:1024 lds
buffer_load_dwordx4 v10, s[8:11], s20 offen offset:2048 lds
s_add_u32 s20, s20, 12288
s_add_u32 m0, s23, 24576
s_nop 0
buffer_load_dwordx4 v11, s[12:15], s21 offen offset:0 lds
buffer_load_dwordx4 v12, s[12:15], s21 offen offset:1024 lds
buffer_load_dwordx4 v13, s[12:15], s21 offen offset:2048 lds
s_add_u32 s21, s21, 12288
s_waitcnt vmcnt(0)
s_barrier
.p2align 3
ds_read_b128 v[176:179], v2 offset:24576
ds_read_b128 v[180:183], v3 offset:24576
ds_read_b128 v[184:187], v2 offset:24704
ds_read_b128 v[188:191], v3 offset:24704
ds_read_b128 v[192:195], v2 offset:24832
ds_read_b128 v[196:199], v3 offset:24832
ds_read_b128 v[200:203], v2 offset:30720
ds_read_b128 v[204:207], v3 offset:30720
ds_read_b128 v[208:211], v2 offset:30848
ds_read_b128 v[212:215], v3 offset:30848
ds_read_b128 v[216:219], v2 offset:30976
ds_read_b128 v[220:223], v3 offset:30976
s_waitcnt lgkmcnt(0)
v_mfma_f32_16x16x32_bf16 v[96:99], v[176:179], a[192:195], 0
v_mfma_f32_16x16x32_bf16 v[96:99], v[180:183], a[196:199], v[96:99]
v_mfma_f32_16x16x32_bf16 v[96:99], v[184:187], a[200:203], v[96:99]
v_mfma_f32_16x16x32_bf16 v[96:99], v[188:191], a[204:207], v[96:99]
v_mfma_f32_16x16x32_bf16 v[96:99], v[192:195], a[208:211], v[96:99]
v_mfma_f32_16x16x32_bf16 v[96:99], v[196:199], a[212:215], v[96:99]
v_mfma_f32_16x16x32_bf16 v[104:107], v[176:179], a[216:219], 0
v_mfma_f32_16x16x32_bf16 v[104:107], v[180:183], a[220:223], v[104:107]
v_mfma_f32_16x16x32_bf16 v[104:107], v[184:187], a[224:227], v[104:107]
v_mfma_f32_16x16x32_bf16 v[104:107], v[188:191], a[228:231], v[104:107]
v_mfma_f32_16x16x32_bf16 v[104:107], v[192:195], a[232:235], v[104:107]
v_mfma_f32_16x16x32_bf16 v[104:107], v[196:199], a[236:239], v[104:107]
v_mfma_f32_16x16x32_bf16 v[112:115], v[176:179], a[240:243], 0
v_mfma_f32_16x16x32_bf16 v[112:115], v[180:183], a[244:247], v[112:115]
v_mfma_f32_16x16x32_bf16 v[112:115], v[184:187], a[248:251], v[112:115]
v_mfma_f32_16x16x32_bf16 v[112:115], v[188:191], a[252:255], v[112:115]
v_mfma_f32_16x16x32_bf16 v[112:115], v[192:195], v[64:67], v[112:115]
v_mfma_f32_16x16x32_bf16 v[112:115], v[196:199], v[68:71], v[112:115]
v_mfma_f32_16x16x32_bf16 v[120:123], v[176:179], v[72:75], 0
v_mfma_f32_16x16x32_bf16 v[120:123], v[180:183], v[76:79], v[120:123]
v_mfma_f32_16x16x32_bf16 v[120:123], v[184:187], v[80:83], v[120:123]
v_mfma_f32_16x16x32_bf16 v[120:123], v[188:191], v[84:87], v[120:123]
v_mfma_f32_16x16x32_bf16 v[120:123], v[192:195], v[88:91], v[120:123]
v_mfma_f32_16x16x32_bf16 v[120:123], v[196:199], v[92:95], v[120:123]
v_mfma_f32_16x16x32_bf16 v[100:103], v[200:203], a[192:195], 0
v_mfma_f32_16x16x32_bf16 v[100:103], v[204:207], a[196:199], v[100:103]
v_mfma_f32_16x16x32_bf16 v[100:103], v[208:211], a[200:203], v[100:103]
v_mfma_f32_16x16x32_bf16 v[100:103], v[212:215], a[204:207], v[100:103]
v_mfma_f32_16x16x32_bf16 v[100:103], v[216:219], a[208:211], v[100:103]
v_mfma_f32_16x16x32_bf16 v[100:103], v[220:223], a[212:215], v[100:103]
v_mfma_f32_16x16x32_bf16 v[108:111], v[200:203], a[216:219], 0
v_mfma_f32_16x16x32_bf16 v[108:111], v[204:207], a[220:223], v[108:111]
v_mfma_f32_16x16x32_bf16 v[108:111], v[208:211], a[224:227], v[108:111]
v_mfma_f32_16x16x32_bf16 v[108:111], v[212:215], a[228:231], v[108:111]
v_mfma_f32_16x16x32_bf16 v[108:111], v[216:219], a[232:235], v[108:111]
v_mfma_f32_16x16x32_bf16 v[108:111], v[220:223], a[236:239], v[108:111]
v_mfma_f32_16x16x32_bf16 v[116:119], v[200:203], a[240:243], 0
v_mfma_f32_16x16x32_bf16 v[116:119], v[204:207], a[244:247], v[116:119]
v_mfma_f32_16x16x32_bf16 v[116:119], v[208:211], a[248:251], v[116:119]
v_mfma_f32_16x16x32_bf16 v[116:119], v[212:215], a[252:255], v[116:119]
v_mfma_f32_16x16x32_bf16 v[116:119], v[216:219], v[64:67], v[116:119]
v_mfma_f32_16x16x32_bf16 v[116:119], v[220:223], v[68:71], v[116:119]
v_mfma_f32_16x16x32_bf16 v[124:127], v[200:203], v[72:75], 0
v_mfma_f32_16x16x32_bf16 v[124:127], v[204:207], v[76:79], v[124:127]
v_mfma_f32_16x16x32_bf16 v[124:127], v[208:211], v[80:83], v[124:127]
v_mfma_f32_16x16x32_bf16 v[124:127], v[212:215], v[84:87], v[124:127]
v_mfma_f32_16x16x32_bf16 v[124:127], v[216:219], v[88:91], v[124:127]
v_mfma_f32_16x16x32_bf16 v[124:127], v[220:223], v[92:95], v[124:127]
s_nop 7
.p2align 3
ds_read_b64_tr_b16 v[176:177], v4 offset:24576
ds_read_b64_tr_b16 v[178:179], v4 offset:30720
ds_read_b64_tr_b16 v[180:181], v5 offset:24576
ds_read_b64_tr_b16 v[182:183], v5 offset:30720
ds_read_b64_tr_b16 v[184:185], v6 offset:24576
ds_read_b64_tr_b16 v[186:187], v6 offset:30720
ds_read_b64_tr_b16 v[188:189], v7 offset:24576
ds_read_b64_tr_b16 v[190:191], v7 offset:30720
ds_read_b64_tr_b16 v[192:193], v4 offset:24704
ds_read_b64_tr_b16 v[194:195], v4 offset:30848
ds_read_b64_tr_b16 v[196:197], v5 offset:24704
ds_read_b64_tr_b16 v[198:199], v5 offset:30848
ds_read_b64_tr_b16 v[200:201], v6 offset:24704
ds_read_b64_tr_b16 v[202:203], v6 offset:30848
ds_read_b64_tr_b16 v[204:205], v7 offset:24704
ds_read_b64_tr_b16 v[206:207], v7 offset:30848
ds_read_b64_tr_b16 v[208:209], v4 offset:24832
ds_read_b64_tr_b16 v[210:211], v4 offset:30976
ds_read_b64_tr_b16 v[212:213], v5 offset:24832
ds_read_b64_tr_b16 v[214:215], v5 offset:30976
ds_read_b64_tr_b16 v[216:217], v6 offset:24832
ds_read_b64_tr_b16 v[218:219], v6 offset:30976
ds_read_b64_tr_b16 v[220:221], v7 offset:24832
ds_read_b64_tr_b16 v[222:223], v7 offset:30976
v_max3_f32 v168, v96, v97, v98
v_max3_f32 v168, v168, v99, v100
v_max3_f32 v168, v168, v101, v102
v_max3_f32 v168, v168, v103, v160
v_mov_b32 v22, v168
s_nop 1
v_permlane16_swap_b32 v168, v22
v_max_f32 v168, v168, v22
v_mov_b32 v22, v168
s_nop 1
v_permlane32_swap_b32 v168, v22
v_max_f32 v168, v168, v22
v_sub_f32 v164, v160, v168
v_exp_f32 v164, v164
v_mov_b32 v160, v168
v_sub_f32 v96, v96, v168
v_sub_f32 v97, v97, v168
v_sub_f32 v98, v98, v168
v_sub_f32 v99, v99, v168
v_sub_f32 v100, v100, v168
v_sub_f32 v101, v101, v168
v_sub_f32 v102, v102, v168
v_sub_f32 v103, v103, v168
v_exp_f32 v96, v96
v_exp_f32 v97, v97
v_exp_f32 v98, v98
v_exp_f32 v99, v99
v_exp_f32 v100, v100
v_exp_f32 v101, v101
v_exp_f32 v102, v102
v_exp_f32 v103, v103
v_mul_f32 v14, v14, v164
v_add_f32 v14, v14, v96
v_add_f32 v14, v14, v97
v_add_f32 v14, v14, v98
v_add_f32 v14, v14, v99
v_add_f32 v14, v14, v100
v_add_f32 v14, v14, v101
v_add_f32 v14, v14, v102
v_add_f32 v14, v14, v103
.p2align 3
v_cvt_pk_bf16_f32 v96, v96, v97
v_cvt_pk_bf16_f32 v97, v98, v99
v_cvt_pk_bf16_f32 v98, v100, v101
v_cvt_pk_bf16_f32 v99, v102, v103
v_accvgpr_read_b32 v18, a0
v_accvgpr_read_b32 v19, a1
v_accvgpr_read_b32 v20, a2
v_accvgpr_read_b32 v21, a3
v_mul_f32 v18, v18, v164
v_mul_f32 v19, v19, v164
v_mul_f32 v20, v20, v164
v_mul_f32 v21, v21, v164
.p2align 3
v_accvgpr_write_b32 a0, v18
v_accvgpr_write_b32 a1, v19
v_accvgpr_write_b32 a2, v20
v_accvgpr_write_b32 a3, v21
v_accvgpr_read_b32 v18, a4
v_accvgpr_read_b32 v19, a5
v_accvgpr_read_b32 v20, a6
v_accvgpr_read_b32 v21, a7
v_mul_f32 v18, v18, v164
v_mul_f32 v19, v19, v164
v_mul_f32 v20, v20, v164
v_mul_f32 v21, v21, v164
.p2align 3
v_accvgpr_write_b32 a4, v18
v_accvgpr_write_b32 a5, v19
v_accvgpr_write_b32 a6, v20
v_accvgpr_write_b32 a7, v21
v_accvgpr_read_b32 v18, a8
v_accvgpr_read_b32 v19, a9
v_accvgpr_read_b32 v20, a10
v_accvgpr_read_b32 v21, a11
v_mul_f32 v18, v18, v164
v_mul_f32 v19, v19, v164
v_mul_f32 v20, v20, v164
v_mul_f32 v21, v21, v164
.p2align 3
v_accvgpr_write_b32 a8, v18
v_accvgpr_write_b32 a9, v19
v_accvgpr_write_b32 a10, v20
v_accvgpr_write_b32 a11, v21
v_accvgpr_read_b32 v18, a12
v_accvgpr_read_b32 v19, a13
v_accvgpr_read_b32 v20, a14
v_accvgpr_read_b32 v21, a15
v_mul_f32 v18, v18, v164
v_mul_f32 v19, v19, v164
v_mul_f32 v20, v20, v164
v_mul_f32 v21, v21, v164
.p2align 3
v_accvgpr_write_b32 a12, v18
v_accvgpr_write_b32 a13, v19
v_accvgpr_write_b32 a14, v20
v_accvgpr_write_b32 a15, v21
v_accvgpr_read_b32 v18, a16
v_accvgpr_read_b32 v19, a17
v_accvgpr_read_b32 v20, a18
v_accvgpr_read_b32 v21, a19
v_mul_f32 v18, v18, v164
v_mul_f32 v19, v19, v164
v_mul_f32 v20, v20, v164
v_mul_f32 v21, v21, v164
.p2align 3
v_accvgpr_write_b32 a16, v18
v_accvgpr_write_b32 a17, v19
v_accvgpr_write_b32 a18, v20
v_accvgpr_write_b32 a19, v21
v_accvgpr_read_b32 v18, a20
v_accvgpr_read_b32 v19, a21
v_accvgpr_read_b32 v20, a22
v_accvgpr_read_b32 v21, a23
v_mul_f32 v18, v18, v164
v_mul_f32 v19, v19, v164
v_mul_f32 v20, v20, v164
v_mul_f32 v21, v21, v164
.p2align 3
v_accvgpr_write_b32 a20, v18
v_accvgpr_write_b32 a21, v19
v_accvgpr_write_b32 a22, v20
v_accvgpr_write_b32 a23, v21
v_accvgpr_read_b32 v18, a24
v_accvgpr_read_b32 v19, a25
v_accvgpr_read_b32 v20, a26
v_accvgpr_read_b32 v21, a27
v_mul_f32 v18, v18, v164
v_mul_f32 v19, v19, v164
v_mul_f32 v20, v20, v164
v_mul_f32 v21, v21, v164
.p2align 3
v_accvgpr_write_b32 a24, v18
v_accvgpr_write_b32 a25, v19
v_accvgpr_write_b32 a26, v20
v_accvgpr_write_b32 a27, v21
v_accvgpr_read_b32 v18, a28
v_accvgpr_read_b32 v19, a29
v_accvgpr_read_b32 v20, a30
v_accvgpr_read_b32 v21, a31
v_mul_f32 v18, v18, v164
v_mul_f32 v19, v19, v164
v_mul_f32 v20, v20, v164
v_mul_f32 v21, v21, v164
.p2align 3
v_accvgpr_write_b32 a28, v18
v_accvgpr_write_b32 a29, v19
v_accvgpr_write_b32 a30, v20
v_accvgpr_write_b32 a31, v21
v_accvgpr_read_b32 v18, a32
v_accvgpr_read_b32 v19, a33
v_accvgpr_read_b32 v20, a34
v_accvgpr_read_b32 v21, a35
v_mul_f32 v18, v18, v164
v_mul_f32 v19, v19, v164
v_mul_f32 v20, v20, v164
v_mul_f32 v21, v21, v164
.p2align 3
v_accvgpr_write_b32 a32, v18
v_accvgpr_write_b32 a33, v19
v_accvgpr_write_b32 a34, v20
v_accvgpr_write_b32 a35, v21
v_accvgpr_read_b32 v18, a36
v_accvgpr_read_b32 v19, a37
v_accvgpr_read_b32 v20, a38
v_accvgpr_read_b32 v21, a39
v_mul_f32 v18, v18, v164
v_mul_f32 v19, v19, v164
v_mul_f32 v20, v20, v164
v_mul_f32 v21, v21, v164
.p2align 3
v_accvgpr_write_b32 a36, v18
v_accvgpr_write_b32 a37, v19
v_accvgpr_write_b32 a38, v20
v_accvgpr_write_b32 a39, v21
v_accvgpr_read_b32 v18, a40
v_accvgpr_read_b32 v19, a41
v_accvgpr_read_b32 v20, a42
v_accvgpr_read_b32 v21, a43
v_mul_f32 v18, v18, v164
v_mul_f32 v19, v19, v164
v_mul_f32 v20, v20, v164
v_mul_f32 v21, v21, v164
.p2align 3
v_accvgpr_write_b32 a40, v18
v_accvgpr_write_b32 a41, v19
v_accvgpr_write_b32 a42, v20
v_accvgpr_write_b32 a43, v21
v_accvgpr_read_b32 v18, a44
v_accvgpr_read_b32 v19, a45
v_accvgpr_read_b32 v20, a46
v_accvgpr_read_b32 v21, a47
v_mul_f32 v18, v18, v164
v_mul_f32 v19, v19, v164
v_mul_f32 v20, v20, v164
v_mul_f32 v21, v21, v164
.p2align 3
v_accvgpr_write_b32 a44, v18
v_accvgpr_write_b32 a45, v19
v_accvgpr_write_b32 a46, v20
v_accvgpr_write_b32 a47, v21
v_max3_f32 v169, v104, v105, v106
v_max3_f32 v169, v169, v107, v108
v_max3_f32 v169, v169, v109, v110
v_max3_f32 v169, v169, v111, v161
v_mov_b32 v22, v169
s_nop 1
v_permlane16_swap_b32 v169, v22
v_max_f32 v169, v169, v22
v_mov_b32 v22, v169
s_nop 1
v_permlane32_swap_b32 v169, v22
v_max_f32 v169, v169, v22
v_sub_f32 v165, v161, v169
v_exp_f32 v165, v165
v_mov_b32 v161, v169
v_sub_f32 v104, v104, v169
v_sub_f32 v105, v105, v169
v_sub_f32 v106, v106, v169
v_sub_f32 v107, v107, v169
v_sub_f32 v108, v108, v169
v_sub_f32 v109, v109, v169
v_sub_f32 v110, v110, v169
v_sub_f32 v111, v111, v169
v_exp_f32 v104, v104
v_exp_f32 v105, v105
v_exp_f32 v106, v106
v_exp_f32 v107, v107
v_exp_f32 v108, v108
v_exp_f32 v109, v109
v_exp_f32 v110, v110
v_exp_f32 v111, v111
v_mul_f32 v15, v15, v165
v_add_f32 v15, v15, v104
v_add_f32 v15, v15, v105
v_add_f32 v15, v15, v106
v_add_f32 v15, v15, v107
v_add_f32 v15, v15, v108
v_add_f32 v15, v15, v109
v_add_f32 v15, v15, v110
v_add_f32 v15, v15, v111
.p2align 3
v_cvt_pk_bf16_f32 v104, v104, v105
v_cvt_pk_bf16_f32 v105, v106, v107
v_cvt_pk_bf16_f32 v106, v108, v109
v_cvt_pk_bf16_f32 v107, v110, v111
v_accvgpr_read_b32 v18, a48
v_accvgpr_read_b32 v19, a49
v_accvgpr_read_b32 v20, a50
v_accvgpr_read_b32 v21, a51
v_mul_f32 v18, v18, v165
v_mul_f32 v19, v19, v165
v_mul_f32 v20, v20, v165
v_mul_f32 v21, v21, v165
.p2align 3
v_accvgpr_write_b32 a48, v18
v_accvgpr_write_b32 a49, v19
v_accvgpr_write_b32 a50, v20
v_accvgpr_write_b32 a51, v21
v_accvgpr_read_b32 v18, a52
v_accvgpr_read_b32 v19, a53
v_accvgpr_read_b32 v20, a54
v_accvgpr_read_b32 v21, a55
v_mul_f32 v18, v18, v165
v_mul_f32 v19, v19, v165
v_mul_f32 v20, v20, v165
v_mul_f32 v21, v21, v165
.p2align 3
v_accvgpr_write_b32 a52, v18
v_accvgpr_write_b32 a53, v19
v_accvgpr_write_b32 a54, v20
v_accvgpr_write_b32 a55, v21
v_accvgpr_read_b32 v18, a56
v_accvgpr_read_b32 v19, a57
v_accvgpr_read_b32 v20, a58
v_accvgpr_read_b32 v21, a59
v_mul_f32 v18, v18, v165
v_mul_f32 v19, v19, v165
v_mul_f32 v20, v20, v165
v_mul_f32 v21, v21, v165
.p2align 3
v_accvgpr_write_b32 a56, v18
v_accvgpr_write_b32 a57, v19
v_accvgpr_write_b32 a58, v20
v_accvgpr_write_b32 a59, v21
v_accvgpr_read_b32 v18, a60
v_accvgpr_read_b32 v19, a61
v_accvgpr_read_b32 v20, a62
v_accvgpr_read_b32 v21, a63
v_mul_f32 v18, v18, v165
v_mul_f32 v19, v19, v165
v_mul_f32 v20, v20, v165
v_mul_f32 v21, v21, v165
.p2align 3
v_accvgpr_write_b32 a60, v18
v_accvgpr_write_b32 a61, v19
v_accvgpr_write_b32 a62, v20
v_accvgpr_write_b32 a63, v21
v_accvgpr_read_b32 v18, a64
v_accvgpr_read_b32 v19, a65
v_accvgpr_read_b32 v20, a66
v_accvgpr_read_b32 v21, a67
v_mul_f32 v18, v18, v165
v_mul_f32 v19, v19, v165
v_mul_f32 v20, v20, v165
v_mul_f32 v21, v21, v165
.p2align 3
v_accvgpr_write_b32 a64, v18
v_accvgpr_write_b32 a65, v19
v_accvgpr_write_b32 a66, v20
v_accvgpr_write_b32 a67, v21
v_accvgpr_read_b32 v18, a68
v_accvgpr_read_b32 v19, a69
v_accvgpr_read_b32 v20, a70
v_accvgpr_read_b32 v21, a71
v_mul_f32 v18, v18, v165
v_mul_f32 v19, v19, v165
v_mul_f32 v20, v20, v165
v_mul_f32 v21, v21, v165
.p2align 3
v_accvgpr_write_b32 a68, v18
v_accvgpr_write_b32 a69, v19
v_accvgpr_write_b32 a70, v20
v_accvgpr_write_b32 a71, v21
v_accvgpr_read_b32 v18, a72
v_accvgpr_read_b32 v19, a73
v_accvgpr_read_b32 v20, a74
v_accvgpr_read_b32 v21, a75
v_mul_f32 v18, v18, v165
v_mul_f32 v19, v19, v165
v_mul_f32 v20, v20, v165
v_mul_f32 v21, v21, v165
.p2align 3
v_accvgpr_write_b32 a72, v18
v_accvgpr_write_b32 a73, v19
v_accvgpr_write_b32 a74, v20
v_accvgpr_write_b32 a75, v21
v_accvgpr_read_b32 v18, a76
v_accvgpr_read_b32 v19, a77
v_accvgpr_read_b32 v20, a78
v_accvgpr_read_b32 v21, a79
v_mul_f32 v18, v18, v165
v_mul_f32 v19, v19, v165
v_mul_f32 v20, v20, v165
v_mul_f32 v21, v21, v165
.p2align 3
v_accvgpr_write_b32 a76, v18
v_accvgpr_write_b32 a77, v19
v_accvgpr_write_b32 a78, v20
v_accvgpr_write_b32 a79, v21
v_accvgpr_read_b32 v18, a80
v_accvgpr_read_b32 v19, a81
v_accvgpr_read_b32 v20, a82
v_accvgpr_read_b32 v21, a83
v_mul_f32 v18, v18, v165
v_mul_f32 v19, v19, v165
v_mul_f32 v20, v20, v165
v_mul_f32 v21, v21, v165
.p2align 3
v_accvgpr_write_b32 a80, v18
v_accvgpr_write_b32 a81, v19
v_accvgpr_write_b32 a82, v20
v_accvgpr_write_b32 a83, v21
v_accvgpr_read_b32 v18, a84
v_accvgpr_read_b32 v19, a85
v_accvgpr_read_b32 v20, a86
v_accvgpr_read_b32 v21, a87
v_mul_f32 v18, v18, v165
v_mul_f32 v19, v19, v165
v_mul_f32 v20, v20, v165
v_mul_f32 v21, v21, v165
.p2align 3
v_accvgpr_write_b32 a84, v18
v_accvgpr_write_b32 a85, v19
v_accvgpr_write_b32 a86, v20
v_accvgpr_write_b32 a87, v21
v_accvgpr_read_b32 v18, a88
v_accvgpr_read_b32 v19, a89
v_accvgpr_read_b32 v20, a90
v_accvgpr_read_b32 v21, a91
v_mul_f32 v18, v18, v165
v_mul_f32 v19, v19, v165
v_mul_f32 v20, v20, v165
v_mul_f32 v21, v21, v165
.p2align 3
v_accvgpr_write_b32 a88, v18
v_accvgpr_write_b32 a89, v19
v_accvgpr_write_b32 a90, v20
v_accvgpr_write_b32 a91, v21
v_accvgpr_read_b32 v18, a92
v_accvgpr_read_b32 v19, a93
v_accvgpr_read_b32 v20, a94
v_accvgpr_read_b32 v21, a95
v_mul_f32 v18, v18, v165
v_mul_f32 v19, v19, v165
v_mul_f32 v20, v20, v165
v_mul_f32 v21, v21, v165
.p2align 3
v_accvgpr_write_b32 a92, v18
v_accvgpr_write_b32 a93, v19
v_accvgpr_write_b32 a94, v20
v_accvgpr_write_b32 a95, v21
v_max3_f32 v170, v112, v113, v114
v_max3_f32 v170, v170, v115, v116
v_max3_f32 v170, v170, v117, v118
v_max3_f32 v170, v170, v119, v162
v_mov_b32 v22, v170
s_nop 1
v_permlane16_swap_b32 v170, v22
v_max_f32 v170, v170, v22
v_mov_b32 v22, v170
s_nop 1
v_permlane32_swap_b32 v170, v22
v_max_f32 v170, v170, v22
v_sub_f32 v166, v162, v170
v_exp_f32 v166, v166
v_mov_b32 v162, v170
v_sub_f32 v112, v112, v170
v_sub_f32 v113, v113, v170
v_sub_f32 v114, v114, v170
v_sub_f32 v115, v115, v170
v_sub_f32 v116, v116, v170
v_sub_f32 v117, v117, v170
v_sub_f32 v118, v118, v170
v_sub_f32 v119, v119, v170
v_exp_f32 v112, v112
v_exp_f32 v113, v113
v_exp_f32 v114, v114
v_exp_f32 v115, v115
v_exp_f32 v116, v116
v_exp_f32 v117, v117
v_exp_f32 v118, v118
v_exp_f32 v119, v119
v_mul_f32 v16, v16, v166
v_add_f32 v16, v16, v112
v_add_f32 v16, v16, v113
v_add_f32 v16, v16, v114
v_add_f32 v16, v16, v115
v_add_f32 v16, v16, v116
v_add_f32 v16, v16, v117
v_add_f32 v16, v16, v118
v_add_f32 v16, v16, v119
.p2align 3
v_cvt_pk_bf16_f32 v112, v112, v113
v_cvt_pk_bf16_f32 v113, v114, v115
v_cvt_pk_bf16_f32 v114, v116, v117
v_cvt_pk_bf16_f32 v115, v118, v119
v_accvgpr_read_b32 v18, a96
v_accvgpr_read_b32 v19, a97
v_accvgpr_read_b32 v20, a98
v_accvgpr_read_b32 v21, a99
v_mul_f32 v18, v18, v166
v_mul_f32 v19, v19, v166
v_mul_f32 v20, v20, v166
v_mul_f32 v21, v21, v166
.p2align 3
v_accvgpr_write_b32 a96, v18
v_accvgpr_write_b32 a97, v19
v_accvgpr_write_b32 a98, v20
v_accvgpr_write_b32 a99, v21
v_accvgpr_read_b32 v18, a100
v_accvgpr_read_b32 v19, a101
v_accvgpr_read_b32 v20, a102
v_accvgpr_read_b32 v21, a103
v_mul_f32 v18, v18, v166
v_mul_f32 v19, v19, v166
v_mul_f32 v20, v20, v166
v_mul_f32 v21, v21, v166
.p2align 3
v_accvgpr_write_b32 a100, v18
v_accvgpr_write_b32 a101, v19
v_accvgpr_write_b32 a102, v20
v_accvgpr_write_b32 a103, v21
v_accvgpr_read_b32 v18, a104
v_accvgpr_read_b32 v19, a105
v_accvgpr_read_b32 v20, a106
v_accvgpr_read_b32 v21, a107
v_mul_f32 v18, v18, v166
v_mul_f32 v19, v19, v166
v_mul_f32 v20, v20, v166
v_mul_f32 v21, v21, v166
.p2align 3
v_accvgpr_write_b32 a104, v18
v_accvgpr_write_b32 a105, v19
v_accvgpr_write_b32 a106, v20
v_accvgpr_write_b32 a107, v21
v_accvgpr_read_b32 v18, a108
v_accvgpr_read_b32 v19, a109
v_accvgpr_read_b32 v20, a110
v_accvgpr_read_b32 v21, a111
v_mul_f32 v18, v18, v166
v_mul_f32 v19, v19, v166
v_mul_f32 v20, v20, v166
v_mul_f32 v21, v21, v166
.p2align 3
v_accvgpr_write_b32 a108, v18
v_accvgpr_write_b32 a109, v19
v_accvgpr_write_b32 a110, v20
v_accvgpr_write_b32 a111, v21
v_accvgpr_read_b32 v18, a112
v_accvgpr_read_b32 v19, a113
v_accvgpr_read_b32 v20, a114
v_accvgpr_read_b32 v21, a115
v_mul_f32 v18, v18, v166
v_mul_f32 v19, v19, v166
v_mul_f32 v20, v20, v166
v_mul_f32 v21, v21, v166
.p2align 3
v_accvgpr_write_b32 a112, v18
v_accvgpr_write_b32 a113, v19
v_accvgpr_write_b32 a114, v20
v_accvgpr_write_b32 a115, v21
v_accvgpr_read_b32 v18, a116
v_accvgpr_read_b32 v19, a117
v_accvgpr_read_b32 v20, a118
v_accvgpr_read_b32 v21, a119
v_mul_f32 v18, v18, v166
v_mul_f32 v19, v19, v166
v_mul_f32 v20, v20, v166
v_mul_f32 v21, v21, v166
.p2align 3
v_accvgpr_write_b32 a116, v18
v_accvgpr_write_b32 a117, v19
v_accvgpr_write_b32 a118, v20
v_accvgpr_write_b32 a119, v21
v_accvgpr_read_b32 v18, a120
v_accvgpr_read_b32 v19, a121
v_accvgpr_read_b32 v20, a122
v_accvgpr_read_b32 v21, a123
v_mul_f32 v18, v18, v166
v_mul_f32 v19, v19, v166
v_mul_f32 v20, v20, v166
v_mul_f32 v21, v21, v166
.p2align 3
v_accvgpr_write_b32 a120, v18
v_accvgpr_write_b32 a121, v19
v_accvgpr_write_b32 a122, v20
v_accvgpr_write_b32 a123, v21
v_accvgpr_read_b32 v18, a124
v_accvgpr_read_b32 v19, a125
v_accvgpr_read_b32 v20, a126
v_accvgpr_read_b32 v21, a127
v_mul_f32 v18, v18, v166
v_mul_f32 v19, v19, v166
v_mul_f32 v20, v20, v166
v_mul_f32 v21, v21, v166
.p2align 3
v_accvgpr_write_b32 a124, v18
v_accvgpr_write_b32 a125, v19
v_accvgpr_write_b32 a126, v20
v_accvgpr_write_b32 a127, v21
v_accvgpr_read_b32 v18, a128
v_accvgpr_read_b32 v19, a129
v_accvgpr_read_b32 v20, a130
v_accvgpr_read_b32 v21, a131
v_mul_f32 v18, v18, v166
v_mul_f32 v19, v19, v166
v_mul_f32 v20, v20, v166
v_mul_f32 v21, v21, v166
.p2align 3
v_accvgpr_write_b32 a128, v18
v_accvgpr_write_b32 a129, v19
v_accvgpr_write_b32 a130, v20
v_accvgpr_write_b32 a131, v21
v_accvgpr_read_b32 v18, a132
v_accvgpr_read_b32 v19, a133
v_accvgpr_read_b32 v20, a134
v_accvgpr_read_b32 v21, a135
v_mul_f32 v18, v18, v166
v_mul_f32 v19, v19, v166
v_mul_f32 v20, v20, v166
v_mul_f32 v21, v21, v166
.p2align 3
v_accvgpr_write_b32 a132, v18
v_accvgpr_write_b32 a133, v19
v_accvgpr_write_b32 a134, v20
v_accvgpr_write_b32 a135, v21
v_accvgpr_read_b32 v18, a136
v_accvgpr_read_b32 v19, a137
v_accvgpr_read_b32 v20, a138
v_accvgpr_read_b32 v21, a139
v_mul_f32 v18, v18, v166
v_mul_f32 v19, v19, v166
v_mul_f32 v20, v20, v166
v_mul_f32 v21, v21, v166
.p2align 3
v_accvgpr_write_b32 a136, v18
v_accvgpr_write_b32 a137, v19
v_accvgpr_write_b32 a138, v20
v_accvgpr_write_b32 a139, v21
v_accvgpr_read_b32 v18, a140
v_accvgpr_read_b32 v19, a141
v_accvgpr_read_b32 v20, a142
v_accvgpr_read_b32 v21, a143
v_mul_f32 v18, v18, v166
v_mul_f32 v19, v19, v166
v_mul_f32 v20, v20, v166
v_mul_f32 v21, v21, v166
.p2align 3
v_accvgpr_write_b32 a140, v18
v_accvgpr_write_b32 a141, v19
v_accvgpr_write_b32 a142, v20
v_accvgpr_write_b32 a143, v21
v_max3_f32 v171, v120, v121, v122
v_max3_f32 v171, v171, v123, v124
v_max3_f32 v171, v171, v125, v126
v_max3_f32 v171, v171, v127, v163
v_mov_b32 v22, v171
s_nop 1
v_permlane16_swap_b32 v171, v22
v_max_f32 v171, v171, v22
v_mov_b32 v22, v171
s_nop 1
v_permlane32_swap_b32 v171, v22
v_max_f32 v171, v171, v22
v_sub_f32 v167, v163, v171
v_exp_f32 v167, v167
v_mov_b32 v163, v171
v_sub_f32 v120, v120, v171
v_sub_f32 v121, v121, v171
v_sub_f32 v122, v122, v171
v_sub_f32 v123, v123, v171
v_sub_f32 v124, v124, v171
v_sub_f32 v125, v125, v171
v_sub_f32 v126, v126, v171
v_sub_f32 v127, v127, v171
v_exp_f32 v120, v120
v_exp_f32 v121, v121
v_exp_f32 v122, v122
v_exp_f32 v123, v123
v_exp_f32 v124, v124
v_exp_f32 v125, v125
v_exp_f32 v126, v126
v_exp_f32 v127, v127
v_mul_f32 v17, v17, v167
v_add_f32 v17, v17, v120
v_add_f32 v17, v17, v121
v_add_f32 v17, v17, v122
v_add_f32 v17, v17, v123
v_add_f32 v17, v17, v124
v_add_f32 v17, v17, v125
v_add_f32 v17, v17, v126
v_add_f32 v17, v17, v127
.p2align 3
v_cvt_pk_bf16_f32 v120, v120, v121
v_cvt_pk_bf16_f32 v121, v122, v123
v_cvt_pk_bf16_f32 v122, v124, v125
v_cvt_pk_bf16_f32 v123, v126, v127
v_accvgpr_read_b32 v18, a144
v_accvgpr_read_b32 v19, a145
v_accvgpr_read_b32 v20, a146
v_accvgpr_read_b32 v21, a147
v_mul_f32 v18, v18, v167
v_mul_f32 v19, v19, v167
v_mul_f32 v20, v20, v167
v_mul_f32 v21, v21, v167
.p2align 3
v_accvgpr_write_b32 a144, v18
v_accvgpr_write_b32 a145, v19
v_accvgpr_write_b32 a146, v20
v_accvgpr_write_b32 a147, v21
v_accvgpr_read_b32 v18, a148
v_accvgpr_read_b32 v19, a149
v_accvgpr_read_b32 v20, a150
v_accvgpr_read_b32 v21, a151
v_mul_f32 v18, v18, v167
v_mul_f32 v19, v19, v167
v_mul_f32 v20, v20, v167
v_mul_f32 v21, v21, v167
.p2align 3
v_accvgpr_write_b32 a148, v18
v_accvgpr_write_b32 a149, v19
v_accvgpr_write_b32 a150, v20
v_accvgpr_write_b32 a151, v21
v_accvgpr_read_b32 v18, a152
v_accvgpr_read_b32 v19, a153
v_accvgpr_read_b32 v20, a154
v_accvgpr_read_b32 v21, a155
v_mul_f32 v18, v18, v167
v_mul_f32 v19, v19, v167
v_mul_f32 v20, v20, v167
v_mul_f32 v21, v21, v167
.p2align 3
v_accvgpr_write_b32 a152, v18
v_accvgpr_write_b32 a153, v19
v_accvgpr_write_b32 a154, v20
v_accvgpr_write_b32 a155, v21
v_accvgpr_read_b32 v18, a156
v_accvgpr_read_b32 v19, a157
v_accvgpr_read_b32 v20, a158
v_accvgpr_read_b32 v21, a159
v_mul_f32 v18, v18, v167
v_mul_f32 v19, v19, v167
v_mul_f32 v20, v20, v167
v_mul_f32 v21, v21, v167
.p2align 3
v_accvgpr_write_b32 a156, v18
v_accvgpr_write_b32 a157, v19
v_accvgpr_write_b32 a158, v20
v_accvgpr_write_b32 a159, v21
v_accvgpr_read_b32 v18, a160
v_accvgpr_read_b32 v19, a161
v_accvgpr_read_b32 v20, a162
v_accvgpr_read_b32 v21, a163
v_mul_f32 v18, v18, v167
v_mul_f32 v19, v19, v167
v_mul_f32 v20, v20, v167
v_mul_f32 v21, v21, v167
.p2align 3
v_accvgpr_write_b32 a160, v18
v_accvgpr_write_b32 a161, v19
v_accvgpr_write_b32 a162, v20
v_accvgpr_write_b32 a163, v21
v_accvgpr_read_b32 v18, a164
v_accvgpr_read_b32 v19, a165
v_accvgpr_read_b32 v20, a166
v_accvgpr_read_b32 v21, a167
v_mul_f32 v18, v18, v167
v_mul_f32 v19, v19, v167
v_mul_f32 v20, v20, v167
v_mul_f32 v21, v21, v167
.p2align 3
v_accvgpr_write_b32 a164, v18
v_accvgpr_write_b32 a165, v19
v_accvgpr_write_b32 a166, v20
v_accvgpr_write_b32 a167, v21
v_accvgpr_read_b32 v18, a168
v_accvgpr_read_b32 v19, a169
v_accvgpr_read_b32 v20, a170
v_accvgpr_read_b32 v21, a171
v_mul_f32 v18, v18, v167
v_mul_f32 v19, v19, v167
v_mul_f32 v20, v20, v167
v_mul_f32 v21, v21, v167
.p2align 3
v_accvgpr_write_b32 a168, v18
v_accvgpr_write_b32 a169, v19
v_accvgpr_write_b32 a170, v20
v_accvgpr_write_b32 a171, v21
v_accvgpr_read_b32 v18, a172
v_accvgpr_read_b32 v19, a173
v_accvgpr_read_b32 v20, a174
v_accvgpr_read_b32 v21, a175
v_mul_f32 v18, v18, v167
v_mul_f32 v19, v19, v167
v_mul_f32 v20, v20, v167
v_mul_f32 v21, v21, v167
.p2align 3
v_accvgpr_write_b32 a172, v18
v_accvgpr_write_b32 a173, v19
v_accvgpr_write_b32 a174, v20
v_accvgpr_write_b32 a175, v21
v_accvgpr_read_b32 v18, a176
v_accvgpr_read_b32 v19, a177
v_accvgpr_read_b32 v20, a178
v_accvgpr_read_b32 v21, a179
v_mul_f32 v18, v18, v167
v_mul_f32 v19, v19, v167
v_mul_f32 v20, v20, v167
v_mul_f32 v21, v21, v167
.p2align 3
v_accvgpr_write_b32 a176, v18
v_accvgpr_write_b32 a177, v19
v_accvgpr_write_b32 a178, v20
v_accvgpr_write_b32 a179, v21
v_accvgpr_read_b32 v18, a180
v_accvgpr_read_b32 v19, a181
v_accvgpr_read_b32 v20, a182
v_accvgpr_read_b32 v21, a183
v_mul_f32 v18, v18, v167
v_mul_f32 v19, v19, v167
v_mul_f32 v20, v20, v167
v_mul_f32 v21, v21, v167
.p2align 3
v_accvgpr_write_b32 a180, v18
v_accvgpr_write_b32 a181, v19
v_accvgpr_write_b32 a182, v20
v_accvgpr_write_b32 a183, v21
v_accvgpr_read_b32 v18, a184
v_accvgpr_read_b32 v19, a185
v_accvgpr_read_b32 v20, a186
v_accvgpr_read_b32 v21, a187
v_mul_f32 v18, v18, v167
v_mul_f32 v19, v19, v167
v_mul_f32 v20, v20, v167
v_mul_f32 v21, v21, v167
.p2align 3
v_accvgpr_write_b32 a184, v18
v_accvgpr_write_b32 a185, v19
v_accvgpr_write_b32 a186, v20
v_accvgpr_write_b32 a187, v21
v_accvgpr_read_b32 v18, a188
v_accvgpr_read_b32 v19, a189
v_accvgpr_read_b32 v20, a190
v_accvgpr_read_b32 v21, a191
v_mul_f32 v18, v18, v167
v_mul_f32 v19, v19, v167
v_mul_f32 v20, v20, v167
v_mul_f32 v21, v21, v167
v_accvgpr_write_b32 a188, v18
v_accvgpr_write_b32 a189, v19
v_accvgpr_write_b32 a190, v20
v_accvgpr_write_b32 a191, v21
s_waitcnt lgkmcnt(0)
s_nop 1
v_mfma_f32_16x16x32_bf16 a[0:3], v[176:179], v[96:99], a[0:3]
v_mfma_f32_16x16x32_bf16 a[48:51], v[176:179], v[104:107], a[48:51]
v_mfma_f32_16x16x32_bf16 a[96:99], v[176:179], v[112:115], a[96:99]
v_mfma_f32_16x16x32_bf16 a[144:147], v[176:179], v[120:123], a[144:147]
v_mfma_f32_16x16x32_bf16 a[4:7], v[180:183], v[96:99], a[4:7]
v_mfma_f32_16x16x32_bf16 a[52:55], v[180:183], v[104:107], a[52:55]
v_mfma_f32_16x16x32_bf16 a[100:103], v[180:183], v[112:115], a[100:103]
v_mfma_f32_16x16x32_bf16 a[148:151], v[180:183], v[120:123], a[148:151]
v_mfma_f32_16x16x32_bf16 a[8:11], v[184:187], v[96:99], a[8:11]
v_mfma_f32_16x16x32_bf16 a[56:59], v[184:187], v[104:107], a[56:59]
v_mfma_f32_16x16x32_bf16 a[104:107], v[184:187], v[112:115], a[104:107]
v_mfma_f32_16x16x32_bf16 a[152:155], v[184:187], v[120:123], a[152:155]
v_mfma_f32_16x16x32_bf16 a[12:15], v[188:191], v[96:99], a[12:15]
v_mfma_f32_16x16x32_bf16 a[60:63], v[188:191], v[104:107], a[60:63]
v_mfma_f32_16x16x32_bf16 a[108:111], v[188:191], v[112:115], a[108:111]
v_mfma_f32_16x16x32_bf16 a[156:159], v[188:191], v[120:123], a[156:159]
v_mfma_f32_16x16x32_bf16 a[16:19], v[192:195], v[96:99], a[16:19]
v_mfma_f32_16x16x32_bf16 a[64:67], v[192:195], v[104:107], a[64:67]
v_mfma_f32_16x16x32_bf16 a[112:115], v[192:195], v[112:115], a[112:115]
v_mfma_f32_16x16x32_bf16 a[160:163], v[192:195], v[120:123], a[160:163]
v_mfma_f32_16x16x32_bf16 a[20:23], v[196:199], v[96:99], a[20:23]
v_mfma_f32_16x16x32_bf16 a[68:71], v[196:199], v[104:107], a[68:71]
v_mfma_f32_16x16x32_bf16 a[116:119], v[196:199], v[112:115], a[116:119]
v_mfma_f32_16x16x32_bf16 a[164:167], v[196:199], v[120:123], a[164:167]
v_mfma_f32_16x16x32_bf16 a[24:27], v[200:203], v[96:99], a[24:27]
v_mfma_f32_16x16x32_bf16 a[72:75], v[200:203], v[104:107], a[72:75]
v_mfma_f32_16x16x32_bf16 a[120:123], v[200:203], v[112:115], a[120:123]
v_mfma_f32_16x16x32_bf16 a[168:171], v[200:203], v[120:123], a[168:171]
v_mfma_f32_16x16x32_bf16 a[28:31], v[204:207], v[96:99], a[28:31]
v_mfma_f32_16x16x32_bf16 a[76:79], v[204:207], v[104:107], a[76:79]
v_mfma_f32_16x16x32_bf16 a[124:127], v[204:207], v[112:115], a[124:127]
v_mfma_f32_16x16x32_bf16 a[172:175], v[204:207], v[120:123], a[172:175]
v_mfma_f32_16x16x32_bf16 a[32:35], v[208:211], v[96:99], a[32:35]
v_mfma_f32_16x16x32_bf16 a[80:83], v[208:211], v[104:107], a[80:83]
v_mfma_f32_16x16x32_bf16 a[128:131], v[208:211], v[112:115], a[128:131]
v_mfma_f32_16x16x32_bf16 a[176:179], v[208:211], v[120:123], a[176:179]
v_mfma_f32_16x16x32_bf16 a[36:39], v[212:215], v[96:99], a[36:39]
v_mfma_f32_16x16x32_bf16 a[84:87], v[212:215], v[104:107], a[84:87]
v_mfma_f32_16x16x32_bf16 a[132:135], v[212:215], v[112:115], a[132:135]
v_mfma_f32_16x16x32_bf16 a[180:183], v[212:215], v[120:123], a[180:183]
v_mfma_f32_16x16x32_bf16 a[40:43], v[216:219], v[96:99], a[40:43]
v_mfma_f32_16x16x32_bf16 a[88:91], v[216:219], v[104:107], a[88:91]
v_mfma_f32_16x16x32_bf16 a[136:139], v[216:219], v[112:115], a[136:139]
v_mfma_f32_16x16x32_bf16 a[184:187], v[216:219], v[120:123], a[184:187]
v_mfma_f32_16x16x32_bf16 a[44:47], v[220:223], v[96:99], a[44:47]
v_mfma_f32_16x16x32_bf16 a[92:95], v[220:223], v[104:107], a[92:95]
v_mfma_f32_16x16x32_bf16 a[140:143], v[220:223], v[112:115], a[140:143]
v_mfma_f32_16x16x32_bf16 a[188:191], v[220:223], v[120:123], a[188:191]
s_nop 7
s_sub_u32 s24, s24, 1
s_cmp_lg_u32 s24, 0
s_cbranch_scc1 L_k2_slow_loop
s_nop 7
v_mov_b32 v22, v14
s_nop 1
v_permlane16_swap_b32 v14, v22
v_add_f32 v14, v14, v22
v_mov_b32 v22, v14
s_nop 1
v_permlane32_swap_b32 v14, v22
v_add_f32 v14, v14, v22
v_mov_b32 v22, v15
s_nop 1
v_permlane16_swap_b32 v15, v22
v_add_f32 v15, v15, v22
v_mov_b32 v22, v15
s_nop 1
v_permlane32_swap_b32 v15, v22
v_add_f32 v15, v15, v22
v_mov_b32 v22, v16
s_nop 1
v_permlane16_swap_b32 v16, v22
v_add_f32 v16, v16, v22
v_mov_b32 v22, v16
s_nop 1
v_permlane32_swap_b32 v16, v22
v_add_f32 v16, v16, v22
v_mov_b32 v22, v17
s_nop 1
v_permlane16_swap_b32 v17, v22
v_add_f32 v17, v17, v22
v_mov_b32 v22, v17
s_nop 1
v_permlane32_swap_b32 v17, v22
v_add_f32 v17, v17, v22
v_rcp_f32 v18, v14
v_rcp_f32 v20, v15
v_rcp_f32 v22, v16
v_rcp_f32 v24, v17
s_barrier
s_branch L_k2_conv
.section .rodata,"a"
.p2align 6
.amdhsa_kernel recurrent_scan__gqa_block_cached__dense_activation_relu__prompt_kernel
  .amdhsa_next_free_vgpr 512
  .amdhsa_next_free_sgpr 102
  .amdhsa_accum_offset 256
  .amdhsa_group_segment_fixed_size 0
  .amdhsa_kernarg_size 88
  .amdhsa_user_sgpr_count 2
  .amdhsa_user_sgpr_kernarg_segment_ptr 1
  .amdhsa_system_sgpr_workgroup_id_x 1
  .amdhsa_float_denorm_mode_32 3
.end_amdhsa_kernel
```
